```python
import torch

def _softmax(x, axis=-1):
    return torch.softmax(x, dim=axis)
def _gelu(x):
    return torch.nn.functional.gelu(x, approximate="tanh")
def _silu(x):
    return torch.nn.functional.silu(x)
def _sigmoid(x):
    return torch.sigmoid(x)
def _layernorm(x, axis=-1, eps=1e-5):
    m = x.mean(dim=axis, keepdim=True)
    v = x.var(dim=axis, keepdim=True, unbiased=False)
    return (x - m) / torch.sqrt(v + eps)
def _scatter_add(tgt, idx, src, axis=0):
    return tgt.clone().index_add_(axis, idx, src)
def _segment_sum(src, seg, n):
    out = torch.zeros((n,) + src.shape[1:], dtype=src.dtype)
    return out.index_add_(0, seg, src)
def _pad(x, pw):
    flat = tuple(v for pair in reversed(pw) for v in pair)
    return torch.nn.functional.pad(x, flat)

kernel_name = 'standalone__gqa_block_cached__near_ridge'

def setup_inputs():

    _w = (lambda a: (lambda t: t.to(torch.bfloat16) if t.is_floating_point() else t)(torch.as_tensor(a)))
    B, Sq, D = 8, 160, 640
    Hq, Hkv, Sk, Dh = 32, 32, 1024, 128
    assert Hq % Hkv == 0, (Hq, Hkv)
    return {
        "x": _w((lambda *s: torch.randn(*s, dtype=torch.bfloat16) * 0.8)(B, Sq, D)),
        "k_cache": _w((lambda *s: torch.randn(*s, dtype=torch.bfloat16) * 0.8)(B, Hkv, Sk, Dh)),
        "v_cache": _w((lambda *s: torch.randn(*s, dtype=torch.bfloat16) * 0.05)(B, Hkv, Sk, Dh)),
        "wq": _w((lambda *s: torch.randn(*s, dtype=torch.bfloat16) * 0.8)(D, Hq * Dh) * (D ** -0.5)),
        "wo": _w((lambda *s: torch.randn(*s, dtype=torch.bfloat16) * 0.05)(Hq * Dh, D) * ((Hq * Dh) ** -0.5)),
    }

def reference(x, k_cache, v_cache, wq, wo):
    B, Sq, D = x.shape
    Hq, Dh = 32, 128
    Hkv = k_cache.shape[1]
    rep = Hq // Hkv
    q = (lambda x, *d: x.permute(*d))((x @ wq).reshape(B, Sq, Hq, Dh), 0, 2, 1, 3)
    k = (lambda x, n, axis: torch.repeat_interleave(x, n, dim=axis))(k_cache, rep, axis=1)
    v = (lambda x, n, axis: torch.repeat_interleave(x, n, dim=axis))(v_cache, rep, axis=1)
    scores = torch.einsum("bhqd,bhkd->bhqk", q, k) * (Dh ** -0.5)
    p = _softmax(scores, axis=-1)
    o = torch.einsum("bhqk,bhkd->bhqd", p, v)
    return (lambda x, *d: x.permute(*d))(o, 0, 2, 1, 3).reshape(B, Sq, Hq * Dh) @ wo
```

```asm
; @launch grid=(256,1,1) block=(256,1,1) lds=163840
.amdgcn_target "amdgcn-amd-amdhsa--gfx950"
.text
.globl standalone__gqa_block_cached__near_ridge_kernel
.p2align 8
.type standalone__gqa_block_cached__near_ridge_kernel,@function
standalone__gqa_block_cached__near_ridge_kernel:
 s_cmp_ge_u32 s2, 256
 s_cbranch_scc1 L_end
 s_getpc_b64 s[56:57]
L_pc:
 s_lshr_b32 s3, s2, 3
 s_mul_i32 s3, s3, 3072
 v_min_u32 v13, 23, v0
 v_lshl_add_u32 v13, v13, 7, s3
 v_min_u32 v13, L_code_end-L_pc-4, v13
 global_load_dword v230, v13, s[56:57]
 s_load_dwordx16 s[4:19], s[0:1], 0
 v_lshrrev_b32 v1, 6, v0
 v_and_b32 v2, 63, v0
 v_readfirstlane_b32 s40, v1
 s_and_b32 s54, s2, 7
 s_lshr_b32 s55, s2, 3
 s_and_b32 s56, s2, 3
 s_mul_i32 s41, s55, 43
 s_lshr_b32 s41, s41, 8
 s_mul_i32 s3, s41, 6
 s_sub_u32 s42, s55, s3
 s_sub_u32 s3, s55, 29
 s_sub_u32 s46, s55, 28
 s_cmp_lt_i32 s3, s56
 s_cselect_b32 s3, s3, s46
 s_sub_u32 s46, s55, 25
 s_cmp_lt_u32 s55, 29
 s_cselect_b32 s3, s46, s3
 s_cselect_b32 s46, 7, 6
 s_cmp_eq_u32 s55, 24
 s_cselect_b32 s3, s56, s3
 s_cselect_b32 s46, 6, s46
 s_cmp_ge_u32 s55, 24
 s_cselect_b32 s41, s3, s41
 s_cselect_b32 s42, s46, s42
 s_add_u32 s3, s41, s42
 s_mul_i32 s46, s3, 64
 s_lshr_b32 s46, s46, 8
 s_mul_i32 s46, s46, 4
 s_sub_u32 s3, s3, s46
 s_mul_i32 s3, s3, 640
 s_add_u32 s3, s3, 40
 s_lshr_b32 s3, s3, 8
 s_lshl_b32 s56, s56, 3
 s_add_u32 s42, s42, s56
 s_and_b32 s56, s2, 4
 s_add_u32 s41, s41, s56
 s_lshl_b32 s52, s3, 7
 s_lshl_b32 s53, s3, 19
 s_mul_i32 s43, s40, 5120
 s_lshl_b32 s44, s40, 12
 v_lshrrev_b32 v3, 4, v2
 v_and_b32 v4, 15, v2
 v_and_b32 v5, 1, v1
 v_lshrrev_b32 v6, 1, v1
 v_bfe_u32 v7, v2, 2, 2
 v_and_b32 v8, 3, v2
 v_lshrrev_b32 v9, 3, v2
 v_mul_u32_u24 v10, 40, v1
 v_add_u32 v10, v10, v9
 v_mul_u32_u24 v10, 1280, v10
 v_and_b32 v12, 7, v2
 v_lshl_or_b32 v11, v5, 2, v3
 v_xor_b32 v11, v11, v12
 v_lshl_add_u32 v96, v11, 4, v10
 v_xor_b32 v11, 4, v11
 v_lshl_add_u32 v11, v11, 4, v10
 v_add_u32 v97, 9216, v11
 v_add_u32 v98, 18432, v96
 v_add_u32 v99, 27648, v11
 v_add_u32 v100, 40960, v96
 v_lshl_add_u32 v10, v1, 4, v3
 v_lshlrev_b32 v10, 13, v10
 v_lshlrev_b32 v11, 2, v3
 v_xor_b32 v11, v11, v4
 v_lshl_add_u32 v101, v11, 4, v10
 v_add_u32 v102, 31744, v101
 v_add_u32 v103, 63488, v101
 v_add_u32 v104, 95232, v101
 s_waitcnt lgkmcnt(0)
 s_mul_i32 s3, s41, 204800
 s_add_u32 s20, s4, s3
 s_addc_u32 s21, s5, 0
 s_mov_b32 s22, 204800
 s_mov_b32 s23, 0x20000
 s_lshl_b32 s3, s42, 8
 s_add_u32 s24, s10, s3
 s_addc_u32 s25, s11, 0
 s_sub_u32 s26, 0x500000, s3
 s_mov_b32 s27, 0x20000
 s_add_u32 m0, s43, 118784
 s_nop 0
 buffer_load_dwordx4 v96, s[20:23], s52 offen offset:0  lds
 buffer_load_dwordx4 v97, s[20:23], s52 offen offset:1024  lds
 buffer_load_dwordx4 v98, s[20:23], s52 offen offset:2048  lds
 buffer_load_dwordx4 v99, s[20:23], s52 offen offset:3072  lds
 s_add_u32 m0, s43, 122880
 s_nop 0
 buffer_load_dwordx4 v100, s[20:23], s52 offen offset:0  lds
 s_add_u32 m0, s44, 81920
 s_add_u32 s52, s52, 128
 buffer_load_dwordx4 v101, s[24:27], s53 offen offset:0  lds
 buffer_load_dwordx4 v102, s[24:27], s53 offen offset:1024  lds
 buffer_load_dwordx4 v103, s[24:27], s53 offen offset:2048  lds
 buffer_load_dwordx4 v104, s[24:27], s53 offen offset:3072  lds
 s_cmp_eq_u32 s52, 1280
 s_cselect_b32 s52, 0, s52
 s_lshl_b32 s53, s52, 12
 s_lshl_b32 s3, s41, 5
 s_add_u32 s3, s3, s42
 s_lshl_b32 s3, s3, 18
 s_add_u32 s28, s6, s3
 s_addc_u32 s29, s7, 0
 s_mov_b32 s30, 0x40000
 s_mov_b32 s31, 0x20000
 s_add_u32 s32, s8, s3
 s_addc_u32 s33, s9, 0
 s_mov_b32 s34, 0x40000
 s_mov_b32 s35, 0x20000
 s_mov_b32 s36, s18
 s_mov_b32 s37, s19
 s_mov_b32 s38, 16809984
 s_mov_b32 s39, 0x20000
 s_add_u32 m0, s43, 98304
 s_nop 0
 buffer_load_dwordx4 v96, s[20:23], s52 offen offset:0  lds
 buffer_load_dwordx4 v97, s[20:23], s52 offen offset:1024  lds
 buffer_load_dwordx4 v98, s[20:23], s52 offen offset:2048  lds
 buffer_load_dwordx4 v99, s[20:23], s52 offen offset:3072  lds
 s_add_u32 m0, s43, 102400
 s_nop 0
 buffer_load_dwordx4 v100, s[20:23], s52 offen offset:0  lds
 s_add_u32 m0, s44, 32768
 s_add_u32 s52, s52, 128
 buffer_load_dwordx4 v101, s[24:27], s53 offen offset:0  lds
 buffer_load_dwordx4 v102, s[24:27], s53 offen offset:1024  lds
 buffer_load_dwordx4 v103, s[24:27], s53 offen offset:2048  lds
 buffer_load_dwordx4 v104, s[24:27], s53 offen offset:3072  lds
 s_cmp_eq_u32 s52, 1280
 s_cselect_b32 s52, 0, s52
 s_lshl_b32 s53, s52, 12
 s_cmp_lt_u32 s2, 200
 s_cbranch_scc1 L_nochore
 s_sub_u32 s3, s2, 200
 s_lshl_b32 s56, s3, 8
 v_add_u32 v15, s56, v0
 v_lshlrev_b32 v15, 7, v15
 s_lshr_b32 s3, s3, 3
 s_lshl_b32 s3, s3, 2
 s_add_u32 s47, s3, s40
 v_lshlrev_b32 v14, 7, v2
 s_mov_b32 s90, 1245259792
 s_mov_b32 s91, 243100763
 s_and_b32 s48, s2, 4
 s_lshl_b32 s48, s48, 5
 s_and_b32 s49, s2, 3
 s_lshl_b32 s3, s49, 3
 s_add_u32 s48, s48, s3
 s_mul_i32 s49, s49, 32
 s_add_u32 s49, s49, 6
 v_add_u32 v13, 0, v15
 v_min_u32 v13, 5242752, v13
 global_load_dword v230, v13, s[12:13]
 v_add_u32 v13, 1835008, v15
 v_min_u32 v13, 5242752, v13
 global_load_dword v230, v13, s[12:13]
 v_add_u32 v13, 3670016, v15
 v_min_u32 v13, 5242752, v13
 global_load_dword v230, v13, s[12:13]
L_nochore:
 v_lshlrev_b32 v189, 4, v2
 s_mul_i32 s3, s55, 52
 s_lshr_b32 s3, s3, 8
 s_mul_i32 s46, s3, 5
 s_sub_u32 s46, s55, s46
 s_and_b32 s55, s54, 1
 s_mul_i32 s55, s55, 5
 s_add_u32 s55, s55, s46
 s_lshr_b32 s54, s54, 1
 s_mul_i32 s54, s54, 5
 s_add_u32 s54, s54, s3
 s_lshl_b32 s3, s55, 7
 s_mul_i32 s46, s40, 1310720
 s_add_u32 s3, s3, s46
 s_add_u32 s4, s12, s3
 s_addc_u32 s5, s13, 0
 s_sub_u32 s6, 5242880, s3
 s_mov_b32 s7, 0x20000
 s_mov_b32 s8, s14
 s_mov_b32 s9, s15
 s_mov_b32 s10, 1638400
 s_mov_b32 s11, 0x20000
 s_add_u32 s3, s54, s55
 s_lshl_b32 s56, s54, 19
 s_lshl_b32 s46, s40, 15
 s_add_u32 s56, s56, s46
 s_add_u32 s46, s3, 0
 s_and_b32 s46, s46, 3
 s_mul_i32 s96, s46, 40960
 s_mul_i32 s46, s46, 1024
 s_add_u32 s92, s46, s56
 s_add_u32 s46, s3, 1
 s_and_b32 s46, s46, 3
 s_mul_i32 s97, s46, 40960
 s_mul_i32 s46, s46, 1024
 s_add_u32 s93, s46, s56
 s_add_u32 s46, s3, 2
 s_and_b32 s46, s46, 3
 s_mul_i32 s98, s46, 40960
 s_mul_i32 s46, s46, 1024
 s_add_u32 s94, s46, s56
 s_add_u32 s46, s3, 3
 s_and_b32 s46, s46, 3
 s_mul_i32 s99, s46, 40960
 s_mul_i32 s46, s46, 1024
 s_add_u32 s95, s46, s56
 v_mul_u32_u24 v10, 1280, v9
 v_lshlrev_b32 v11, 1, v3
 v_xor_b32 v11, v11, v12
 v_lshl_add_u32 v234, v11, 4, v10
 v_add_u32 v235, 9216, v234
 v_add_u32 v236, 18432, v234
 v_add_u32 v237, 27648, v234
 v_lshl_add_u32 v11, v3, 2, v7
 v_lshlrev_b32 v10, 7, v11
 v_lshl_add_u32 v10, v8, 3, v10
 v_add_u32 v10, s44, v10
 v_bfe_u32 v11, v11, 1, 2
 v_xor_b32 v13, 0, v11
 v_lshl_add_u32 v238, v13, 5, v10
 v_add_u32 v242, 0x10000, v238
 v_add_u32 v246, 0x20000, v238
 v_xor_b32 v13, 1, v11
 v_lshl_add_u32 v239, v13, 5, v10
 v_add_u32 v243, 0x10000, v239
 v_add_u32 v247, 0x20000, v239
 v_xor_b32 v13, 2, v11
 v_lshl_add_u32 v240, v13, 5, v10
 v_add_u32 v244, 0x10000, v240
 v_add_u32 v248, 0x20000, v240
 v_xor_b32 v13, 3, v11
 v_lshl_add_u32 v241, v13, 5, v10
 v_add_u32 v245, 0x10000, v241
 v_add_u32 v249, 0x20000, v241
 v_lshlrev_b32 v10, 8, v3
 v_lshl_add_u32 v10, v1, 12, v10
 v_or_b32 v11, 0, v3
 v_xor_b32 v11, v11, v4
 v_lshl_add_u32 v214, v11, 4, v10
 v_or_b32 v11, 4, v3
 v_xor_b32 v11, v11, v4
 v_lshl_add_u32 v215, v11, 4, v10
 v_or_b32 v11, 8, v3
 v_xor_b32 v11, v11, v4
 v_lshl_add_u32 v216, v11, 4, v10
 v_or_b32 v11, 12, v3
 v_xor_b32 v11, v11, v4
 v_lshl_add_u32 v217, v11, 4, v10
 v_or_b32 v11, 0, v3
 v_lshlrev_b32 v11, 1, v11
 v_xor_b32 v11, v11, v4
 v_lshl_add_u32 v218, v11, 4, v10
 v_or_b32 v11, 4, v3
 v_lshlrev_b32 v11, 1, v11
 v_xor_b32 v11, v11, v4
 v_lshl_add_u32 v219, v11, 4, v10
 v_mul_u32_u24 v10, 80, v5
 v_add_u32 v10, v10, v4
 v_lshlrev_b32 v10, 7, v10
 v_add_u32 v10, 98304, v10
 v_lshrrev_b32 v11, 1, v4
 v_or_b32 v12, 0, v3
 v_xor_b32 v12, v12, v11
 v_lshl_add_u32 v220, v12, 4, v10
 v_or_b32 v12, 4, v3
 v_xor_b32 v12, v12, v11
 v_lshl_add_u32 v221, v12, 4, v10
 v_lshl_add_u32 v10, v3, 3, v7
 v_lshlrev_b32 v10, 8, v10
 v_lshl_add_u32 v10, v8, 4, v10
 v_add_u32 v10, 32768, v10
 v_lshlrev_b32 v13, 1, v6
 v_xor_b32 v11, 0, v13
 v_xor_b32 v11, v11, v7
 v_lshl_add_u32 v222, v11, 6, v10
 v_xor_b32 v11, 1, v13
 v_xor_b32 v11, v11, v7
 v_lshl_add_u32 v223, v11, 6, v10
 v_lshl_add_u32 v10, v6, 5, v4
 v_lshlrev_b32 v10, 8, v10
 v_xor_b32 v11, 0, v13
 v_lshl_or_b32 v11, v11, 2, v3
 v_xor_b32 v11, v11, v4
 v_lshl_add_u32 v190, v11, 4, v10
 v_add_u32 v194, 131072, v190
 v_xor_b32 v11, 1, v13
 v_lshl_or_b32 v11, v11, 2, v3
 v_xor_b32 v11, v11, v4
 v_lshl_add_u32 v191, v11, 4, v10
 v_add_u32 v195, 131072, v191
 v_xor_b32 v11, 2, v13
 v_lshl_or_b32 v11, v11, 2, v3
 v_xor_b32 v11, v11, v4
 v_lshl_add_u32 v192, v11, 4, v10
 v_add_u32 v196, 131072, v192
 v_xor_b32 v11, 3, v13
 v_lshl_or_b32 v11, v11, 2, v3
 v_xor_b32 v11, v11, v4
 v_lshl_add_u32 v193, v11, 4, v10
 v_add_u32 v197, 131072, v193
 v_lshl_add_u32 v11, v3, 2, v7
 v_lshl_add_u32 v10, v6, 5, v11
 v_lshlrev_b32 v10, 8, v10
 v_lshl_add_u32 v10, v8, 3, v10
 v_add_u32 v10, 65536, v10
 v_and_b32 v11, 7, v11
 v_lshlrev_b32 v12, 2, v6
 v_xor_b32 v11, v11, v12
 v_xor_b32 v12, 0, v11
 v_lshl_add_u32 v198, v12, 5, v10
 v_add_u32 v206, 81920, v198
 v_xor_b32 v12, 1, v11
 v_lshl_add_u32 v199, v12, 5, v10
 v_add_u32 v207, 81920, v199
 v_xor_b32 v12, 2, v11
 v_lshl_add_u32 v200, v12, 5, v10
 v_add_u32 v208, 81920, v200
 v_xor_b32 v12, 3, v11
 v_lshl_add_u32 v201, v12, 5, v10
 v_add_u32 v209, 81920, v201
 v_xor_b32 v12, 4, v11
 v_lshl_add_u32 v202, v12, 5, v10
 v_add_u32 v210, 81920, v202
 v_xor_b32 v12, 5, v11
 v_lshl_add_u32 v203, v12, 5, v10
 v_add_u32 v211, 81920, v203
 v_xor_b32 v12, 6, v11
 v_lshl_add_u32 v204, v12, 5, v10
 v_add_u32 v212, 81920, v204
 v_xor_b32 v12, 7, v11
 v_lshl_add_u32 v205, v12, 5, v10
 v_add_u32 v213, 81920, v205
 v_mov_b32 v10, 0x3f803f80
 v_cmp_eq_u32 vcc, 0, v8
 s_mov_b32 s45, 0x40004000
 s_nop 0
 v_cndmask_b32 v184, 0, v10, vcc
 v_mov_b32 v185, v184
 v_mov_b32 v186, v184
 v_mov_b32 v187, v184
 v_accvgpr_write_b32 a72, 0
 v_accvgpr_write_b32 a73, 0
 v_accvgpr_write_b32 a74, 0
 v_accvgpr_write_b32 a75, 0
 v_accvgpr_write_b32 a76, 0
 v_accvgpr_write_b32 a77, 0
 v_accvgpr_write_b32 a78, 0
 v_accvgpr_write_b32 a79, 0
 v_accvgpr_write_b32 a80, 0
 v_accvgpr_write_b32 a81, 0
 v_accvgpr_write_b32 a82, 0
 v_accvgpr_write_b32 a83, 0
 v_accvgpr_write_b32 a84, 0
 v_accvgpr_write_b32 a85, 0
 v_accvgpr_write_b32 a86, 0
 v_accvgpr_write_b32 a87, 0
 v_accvgpr_write_b32 a88, 0
 v_accvgpr_write_b32 a89, 0
 v_accvgpr_write_b32 a90, 0
 v_accvgpr_write_b32 a91, 0
 v_accvgpr_write_b32 a92, 0
 v_accvgpr_write_b32 a93, 0
 v_accvgpr_write_b32 a94, 0
 v_accvgpr_write_b32 a95, 0
 v_accvgpr_write_b32 a96, 0
 v_accvgpr_write_b32 a97, 0
 v_accvgpr_write_b32 a98, 0
 v_accvgpr_write_b32 a99, 0
 v_accvgpr_write_b32 a100, 0
 v_accvgpr_write_b32 a101, 0
 v_accvgpr_write_b32 a102, 0
 v_accvgpr_write_b32 a103, 0
 v_accvgpr_write_b32 a104, 0
 v_accvgpr_write_b32 a105, 0
 v_accvgpr_write_b32 a106, 0
 v_accvgpr_write_b32 a107, 0
 v_accvgpr_write_b32 a108, 0
 v_accvgpr_write_b32 a109, 0
 v_accvgpr_write_b32 a110, 0
 v_accvgpr_write_b32 a111, 0
 v_accvgpr_write_b32 a112, 0
 v_accvgpr_write_b32 a113, 0
 v_accvgpr_write_b32 a114, 0
 v_accvgpr_write_b32 a115, 0
 v_accvgpr_write_b32 a116, 0
 v_accvgpr_write_b32 a117, 0
 v_accvgpr_write_b32 a118, 0
 v_accvgpr_write_b32 a119, 0
 v_accvgpr_write_b32 a120, 0
 v_accvgpr_write_b32 a121, 0
 v_accvgpr_write_b32 a122, 0
 v_accvgpr_write_b32 a123, 0
 v_accvgpr_write_b32 a124, 0
 v_accvgpr_write_b32 a125, 0
 v_accvgpr_write_b32 a126, 0
 v_accvgpr_write_b32 a127, 0
 v_accvgpr_write_b32 a128, 0
 v_accvgpr_write_b32 a129, 0
 v_accvgpr_write_b32 a130, 0
 v_accvgpr_write_b32 a131, 0
 v_accvgpr_write_b32 a132, 0
 v_accvgpr_write_b32 a133, 0
 v_accvgpr_write_b32 a134, 0
 v_accvgpr_write_b32 a135, 0
 v_accvgpr_write_b32 a136, 0
 v_accvgpr_write_b32 a137, 0
 v_accvgpr_write_b32 a138, 0
 v_accvgpr_write_b32 a139, 0
 v_accvgpr_write_b32 a140, 0
 v_accvgpr_write_b32 a141, 0
 v_accvgpr_write_b32 a142, 0
 v_accvgpr_write_b32 a143, 0
 v_accvgpr_write_b32 a144, 0
 v_accvgpr_write_b32 a145, 0
 v_accvgpr_write_b32 a146, 0
 v_accvgpr_write_b32 a147, 0
 v_accvgpr_write_b32 a148, 0
 v_accvgpr_write_b32 a149, 0
 v_accvgpr_write_b32 a150, 0
 v_accvgpr_write_b32 a151, 0
 v_accvgpr_write_b32 a152, 0
 v_accvgpr_write_b32 a153, 0
 v_accvgpr_write_b32 a154, 0
 v_accvgpr_write_b32 a155, 0
 v_accvgpr_write_b32 a156, 0
 v_accvgpr_write_b32 a157, 0
 v_accvgpr_write_b32 a158, 0
 v_accvgpr_write_b32 a159, 0
 v_mov_b32 v136, 0
 v_mov_b32 v137, 0
 v_mov_b32 v138, 0
 v_mov_b32 v139, 0
 v_mov_b32 v140, 0
 v_mov_b32 v141, 0
 v_mov_b32 v142, 0
 v_mov_b32 v143, 0
 v_mov_b32 v144, 0
 v_mov_b32 v145, 0
 v_mov_b32 v146, 0
 v_mov_b32 v147, 0
 v_mov_b32 v148, 0
 v_mov_b32 v149, 0
 v_mov_b32 v150, 0
 v_mov_b32 v151, 0
 v_mov_b32 v152, 0
 v_mov_b32 v153, 0
 v_mov_b32 v154, 0
 v_mov_b32 v155, 0
 v_mov_b32 v156, 0
 v_mov_b32 v157, 0
 v_mov_b32 v158, 0
 v_mov_b32 v159, 0
 v_mov_b32 v160, 0
 v_mov_b32 v161, 0
 v_mov_b32 v162, 0
 v_mov_b32 v163, 0
 v_mov_b32 v164, 0
 v_mov_b32 v165, 0
 v_mov_b32 v166, 0
 v_mov_b32 v167, 0
 v_mov_b32 v168, 0
 v_mov_b32 v169, 0
 v_mov_b32 v170, 0
 v_mov_b32 v171, 0
 v_mov_b32 v172, 0
 v_mov_b32 v173, 0
 v_mov_b32 v174, 0
 v_mov_b32 v175, 0
 s_lshl_b32 s3, s2, 2
 s_add_u32 s3, s3, s40
 s_cmp_lg_u32 s3, 800
 s_cbranch_scc1 L_notag
 v_lshlrev_b32 v14, 7, v2
 s_mov_b32 s3, 16777216
 buffer_load_dword v10, v14, s[36:39], s3 offen sc1
 s_mov_b32 s3, 16785408
 buffer_load_dword v11, v14, s[36:39], s3 offen sc1
 s_mov_b32 s3, 16793600
 buffer_load_dword v12, v14, s[36:39], s3 offen sc1
 s_mov_b32 s3, 16801792
 buffer_load_dword v13, v14, s[36:39], s3 offen sc1
 v_and_b32 v15, 15, v2
 v_lshlrev_b32 v14, 2, v15
 v_add_u32 v14, 139264, v14
 v_cmp_eq_u32 vcc, 0, v15
 v_mov_b32 v8, 139328
 v_mov_b32 v9, -1
 v_cndmask_b32 v7, 0, 1, vcc
 ds_write_b32 v14, v7
 ds_write_b32 v8, v9
 s_waitcnt vmcnt(0)
 v_readfirstlane_b32 s3, v10
 v_bfe_u32 v9, v10, 5, 4
 v_lshlrev_b32 v9, 2, v9
 v_add_u32 v9, 139264, v9
 v_lshlrev_b32_e64 v10, v10, 1
 ds_or_b32 v9, v10
 v_bfe_u32 v9, v11, 5, 4
 v_lshlrev_b32 v9, 2, v9
 v_add_u32 v9, 139264, v9
 v_lshlrev_b32_e64 v11, v11, 1
 ds_or_b32 v9, v11
 v_bfe_u32 v9, v12, 5, 4
 v_lshlrev_b32 v9, 2, v9
 v_add_u32 v9, 139264, v9
 v_lshlrev_b32_e64 v12, v12, 1
 ds_or_b32 v9, v12
 v_bfe_u32 v9, v13, 5, 4
 v_lshlrev_b32 v9, 2, v9
 v_add_u32 v9, 139264, v9
 v_lshlrev_b32_e64 v13, v13, 1
 ds_or_b32 v9, v13
 ds_read_b32 v10, v14
 s_waitcnt lgkmcnt(0)
 v_not_b32 v10, v10
 v_ffbl_b32 v10, v10
 v_cmp_gt_i32 vcc, 0, v10
 v_lshl_add_u32 v11, v15, 5, v10
 s_nop 0
 v_cndmask_b32 v10, v11, v10, vcc
 ds_min_u32 v8, v10
 ds_read_b32 v10, v8
 v_mov_b32 v8, 0
 s_add_u32 s3, s3, 512
 s_andn2_b32 s3, s3, 511
 s_waitcnt lgkmcnt(0)
 v_or_b32 v10, s3, v10
 global_store_dword v8, v10, s[16:17] sc1
L_notag:
 s_waitcnt vmcnt(9)
 s_barrier
 ds_read_b64_tr_b16 a[0:1], v222 offset:49152
 ds_read_b64_tr_b16 a[2:3], v222 offset:50176
 ds_read_b128 a[16:19], v220 offset:20480
 ds_read_b128 a[20:23], v220 offset:22528
 ds_read_b128 a[24:27], v220 offset:24576
 ds_read_b128 a[28:31], v220 offset:26624
 ds_read_b128 a[32:35], v220 offset:28672
 ds_read_b64_tr_b16 a[4:5], v222 offset:49160
 ds_read_b64_tr_b16 a[6:7], v222 offset:50184
 ds_read_b64_tr_b16 a[8:9], v223 offset:49152
 ds_read_b64_tr_b16 a[10:11], v223 offset:50176
 ds_read_b64_tr_b16 a[12:13], v223 offset:49160
 ds_read_b64_tr_b16 a[14:15], v223 offset:50184
 s_waitcnt lgkmcnt(0)
 v_mfma_f32_16x16x32_bf16 v[16:19], a[0:3], a[16:19], 0
 ds_read_b64_tr_b16 a[36:37], v222 offset:57344
 s_add_u32 m0, s43, 143360
 s_nop 0
 buffer_load_dwordx4 v96, s[20:23], s52 offen offset:0  lds
 v_mfma_f32_16x16x32_bf16 v[32:35], a[0:3], a[20:23], 0
 ds_read_b64_tr_b16 a[38:39], v222 offset:58368
 v_mfma_f32_16x16x32_bf16 v[48:51], a[0:3], a[24:27], 0
 ds_read_b128 a[52:55], v221 offset:20480
 buffer_load_dwordx4 v97, s[20:23], s52 offen offset:1024  lds
 v_mfma_f32_16x16x32_bf16 v[64:67], a[0:3], a[28:31], 0
 ds_read_b128 a[56:59], v221 offset:22528
 v_mfma_f32_16x16x32_bf16 v[80:83], a[0:3], a[32:35], 0
 ds_read_b128 a[60:63], v221 offset:24576
 buffer_load_dwordx4 v98, s[20:23], s52 offen offset:2048  lds
 v_mfma_f32_16x16x32_bf16 v[20:23], a[4:7], a[16:19], 0
 ds_read_b128 a[64:67], v221 offset:26624
 v_mfma_f32_16x16x32_bf16 v[36:39], a[4:7], a[20:23], 0
 ds_read_b128 a[68:71], v221 offset:28672
 buffer_load_dwordx4 v99, s[20:23], s52 offen offset:3072  lds
 v_mfma_f32_16x16x32_bf16 v[52:55], a[4:7], a[24:27], 0
 ds_read_b64_tr_b16 a[40:41], v222 offset:57352
 v_mfma_f32_16x16x32_bf16 v[68:71], a[4:7], a[28:31], 0
 ds_read_b64_tr_b16 a[42:43], v222 offset:58376
 s_add_u32 m0, s43, 147456
 s_nop 0
 buffer_load_dwordx4 v100, s[20:23], s52 offen offset:0  lds
 v_mfma_f32_16x16x32_bf16 v[84:87], a[4:7], a[32:35], 0
 ds_read_b64_tr_b16 a[44:45], v223 offset:57344
 v_mfma_f32_16x16x32_bf16 v[24:27], a[8:11], a[16:19], 0
 ds_read_b64_tr_b16 a[46:47], v223 offset:58368
 s_add_u32 m0, s44, 49152
 s_add_u32 s52, s52, 128
 buffer_load_dwordx4 v101, s[24:27], s53 offen offset:0  lds
 v_mfma_f32_16x16x32_bf16 v[40:43], a[8:11], a[20:23], 0
 ds_read_b64_tr_b16 a[48:49], v223 offset:57352
 v_mfma_f32_16x16x32_bf16 v[56:59], a[8:11], a[24:27], 0
 ds_read_b64_tr_b16 a[50:51], v223 offset:58376
 buffer_load_dwordx4 v102, s[24:27], s53 offen offset:1024  lds
 v_mfma_f32_16x16x32_bf16 v[72:75], a[8:11], a[28:31], 0
 v_mfma_f32_16x16x32_bf16 v[88:91], a[8:11], a[32:35], 0
 buffer_load_dwordx4 v103, s[24:27], s53 offen offset:2048  lds
 v_mfma_f32_16x16x32_bf16 v[28:31], a[12:15], a[16:19], 0
 v_mfma_f32_16x16x32_bf16 v[44:47], a[12:15], a[20:23], 0
 buffer_load_dwordx4 v104, s[24:27], s53 offen offset:3072  lds
 s_cmp_eq_u32 s52, 1280
 s_cselect_b32 s52, 0, s52
 s_lshl_b32 s53, s52, 12
 v_mfma_f32_16x16x32_bf16 v[60:63], a[12:15], a[24:27], 0
 v_mfma_f32_16x16x32_bf16 v[76:79], a[12:15], a[28:31], 0
 v_mfma_f32_16x16x32_bf16 v[92:95], a[12:15], a[32:35], 0
 s_waitcnt vmcnt(9) lgkmcnt(0)
 s_barrier
 v_mfma_f32_16x16x32_bf16 v[16:19], a[36:39], a[52:55], v[16:19]
 ds_read_b64_tr_b16 a[0:1], v222 offset:0
 s_add_u32 m0, s43, 118784
 s_nop 0
 buffer_load_dwordx4 v96, s[20:23], s52 offen offset:0  lds
 v_mfma_f32_16x16x32_bf16 v[32:35], a[36:39], a[56:59], v[32:35]
 ds_read_b64_tr_b16 a[2:3], v222 offset:1024
 v_mfma_f32_16x16x32_bf16 v[48:51], a[36:39], a[60:63], v[48:51]
 ds_read_b128 a[16:19], v220 offset:0
 v_mfma_f32_16x16x32_bf16 v[64:67], a[36:39], a[64:67], v[64:67]
 ds_read_b128 a[20:23], v220 offset:2048
 v_mfma_f32_16x16x32_bf16 v[80:83], a[36:39], a[68:71], v[80:83]
 ds_read_b128 a[24:27], v220 offset:4096
 buffer_load_dwordx4 v97, s[20:23], s52 offen offset:1024  lds
 v_mfma_f32_16x16x32_bf16 v[20:23], a[40:43], a[52:55], v[20:23]
 ds_read_b128 a[28:31], v220 offset:6144
 v_mfma_f32_16x16x32_bf16 v[36:39], a[40:43], a[56:59], v[36:39]
 ds_read_b128 a[32:35], v220 offset:8192
 v_mfma_f32_16x16x32_bf16 v[52:55], a[40:43], a[60:63], v[52:55]
 ds_read_b64_tr_b16 a[4:5], v222 offset:8
 v_mfma_f32_16x16x32_bf16 v[68:71], a[40:43], a[64:67], v[68:71]
 ds_read_b64_tr_b16 a[6:7], v222 offset:1032
 buffer_load_dwordx4 v98, s[20:23], s52 offen offset:2048  lds
 v_mfma_f32_16x16x32_bf16 v[84:87], a[40:43], a[68:71], v[84:87]
 ds_read_b64_tr_b16 a[8:9], v223 offset:0
 v_mfma_f32_16x16x32_bf16 v[24:27], a[44:47], a[52:55], v[24:27]
 ds_read_b64_tr_b16 a[10:11], v223 offset:1024
 v_mfma_f32_16x16x32_bf16 v[40:43], a[44:47], a[56:59], v[40:43]
 ds_read_b64_tr_b16 a[12:13], v223 offset:8
 v_mfma_f32_16x16x32_bf16 v[56:59], a[44:47], a[60:63], v[56:59]
 ds_read_b64_tr_b16 a[14:15], v223 offset:1032
 buffer_load_dwordx4 v99, s[20:23], s52 offen offset:3072  lds
 v_mfma_f32_16x16x32_bf16 v[72:75], a[44:47], a[64:67], v[72:75]
 v_mfma_f32_16x16x32_bf16 v[88:91], a[44:47], a[68:71], v[88:91]
 v_mfma_f32_16x16x32_bf16 v[28:31], a[48:51], a[52:55], v[28:31]
 v_mfma_f32_16x16x32_bf16 v[44:47], a[48:51], a[56:59], v[44:47]
 s_add_u32 m0, s43, 122880
 s_nop 0
 buffer_load_dwordx4 v100, s[20:23], s52 offen offset:0  lds
 v_mfma_f32_16x16x32_bf16 v[60:63], a[48:51], a[60:63], v[60:63]
 v_mfma_f32_16x16x32_bf16 v[76:79], a[48:51], a[64:67], v[76:79]
 v_mfma_f32_16x16x32_bf16 v[92:95], a[48:51], a[68:71], v[92:95]
 s_waitcnt lgkmcnt(0)
 v_mfma_f32_16x16x32_bf16 v[16:19], a[0:3], a[16:19], v[16:19]
 ds_read_b64_tr_b16 a[36:37], v222 offset:8192
 s_add_u32 m0, s44, 81920
 s_add_u32 s52, s52, 128
 buffer_load_dwordx4 v101, s[24:27], s53 offen offset:0  lds
 v_mfma_f32_16x16x32_bf16 v[32:35], a[0:3], a[20:23], v[32:35]
 ds_read_b64_tr_b16 a[38:39], v222 offset:9216
 v_mfma_f32_16x16x32_bf16 v[48:51], a[0:3], a[24:27], v[48:51]
 ds_read_b128 a[52:55], v221 offset:0
 v_mfma_f32_16x16x32_bf16 v[64:67], a[0:3], a[28:31], v[64:67]
 ds_read_b128 a[56:59], v221 offset:2048
 v_mfma_f32_16x16x32_bf16 v[80:83], a[0:3], a[32:35], v[80:83]
 ds_read_b128 a[60:63], v221 offset:4096
 buffer_load_dwordx4 v102, s[24:27], s53 offen offset:1024  lds
 v_mfma_f32_16x16x32_bf16 v[20:23], a[4:7], a[16:19], v[20:23]
 ds_read_b128 a[64:67], v221 offset:6144
 v_mfma_f32_16x16x32_bf16 v[36:39], a[4:7], a[20:23], v[36:39]
 ds_read_b128 a[68:71], v221 offset:8192
 v_mfma_f32_16x16x32_bf16 v[52:55], a[4:7], a[24:27], v[52:55]
 ds_read_b64_tr_b16 a[40:41], v222 offset:8200
 v_mfma_f32_16x16x32_bf16 v[68:71], a[4:7], a[28:31], v[68:71]
 ds_read_b64_tr_b16 a[42:43], v222 offset:9224
 buffer_load_dwordx4 v103, s[24:27], s53 offen offset:2048  lds
 v_mfma_f32_16x16x32_bf16 v[84:87], a[4:7], a[32:35], v[84:87]
 ds_read_b64_tr_b16 a[44:45], v223 offset:8192
 v_mfma_f32_16x16x32_bf16 v[24:27], a[8:11], a[16:19], v[24:27]
 ds_read_b64_tr_b16 a[46:47], v223 offset:9216
 v_mfma_f32_16x16x32_bf16 v[40:43], a[8:11], a[20:23], v[40:43]
 ds_read_b64_tr_b16 a[48:49], v223 offset:8200
 v_mfma_f32_16x16x32_bf16 v[56:59], a[8:11], a[24:27], v[56:59]
 ds_read_b64_tr_b16 a[50:51], v223 offset:9224
 buffer_load_dwordx4 v104, s[24:27], s53 offen offset:3072  lds
 s_cmp_eq_u32 s52, 1280
 s_cselect_b32 s52, 0, s52
 s_lshl_b32 s53, s52, 12
 v_mfma_f32_16x16x32_bf16 v[72:75], a[8:11], a[28:31], v[72:75]
 v_mfma_f32_16x16x32_bf16 v[88:91], a[8:11], a[32:35], v[88:91]
 v_mfma_f32_16x16x32_bf16 v[28:31], a[12:15], a[16:19], v[28:31]
 v_mfma_f32_16x16x32_bf16 v[44:47], a[12:15], a[20:23], v[44:47]
 v_mfma_f32_16x16x32_bf16 v[60:63], a[12:15], a[24:27], v[60:63]
 v_mfma_f32_16x16x32_bf16 v[76:79], a[12:15], a[28:31], v[76:79]
 v_mfma_f32_16x16x32_bf16 v[92:95], a[12:15], a[32:35], v[92:95]
 s_waitcnt vmcnt(9) lgkmcnt(0)
 s_barrier
 v_mfma_f32_16x16x32_bf16 v[16:19], a[36:39], a[52:55], v[16:19]
 ds_read_b64_tr_b16 a[0:1], v222 offset:16384
 s_add_u32 m0, s43, 98304
 s_nop 0
 buffer_load_dwordx4 v96, s[20:23], s52 offen offset:0  lds
 v_mfma_f32_16x16x32_bf16 v[32:35], a[36:39], a[56:59], v[32:35]
 ds_read_b64_tr_b16 a[2:3], v222 offset:17408
 v_mfma_f32_16x16x32_bf16 v[48:51], a[36:39], a[60:63], v[48:51]
 ds_read_b128 a[16:19], v220 offset:45056
 buffer_load_dwordx4 v97, s[20:23], s52 offen offset:1024  lds
 v_mfma_f32_16x16x32_bf16 v[64:67], a[36:39], a[64:67], v[64:67]
 ds_read_b128 a[20:23], v220 offset:47104
 v_mfma_f32_16x16x32_bf16 v[80:83], a[36:39], a[68:71], v[80:83]
 ds_read_b128 a[24:27], v220 offset:49152
 v_mfma_f32_16x16x32_bf16 v[20:23], a[40:43], a[52:55], v[20:23]
 ds_read_b128 a[28:31], v220 offset:51200
 buffer_load_dwordx4 v98, s[20:23], s52 offen offset:2048  lds
 v_mfma_f32_16x16x32_bf16 v[36:39], a[40:43], a[56:59], v[36:39]
 ds_read_b128 a[32:35], v220 offset:53248
 v_mfma_f32_16x16x32_bf16 v[52:55], a[40:43], a[60:63], v[52:55]
 ds_read_b64_tr_b16 a[4:5], v222 offset:16392
 v_mfma_f32_16x16x32_bf16 v[68:71], a[40:43], a[64:67], v[68:71]
 ds_read_b64_tr_b16 a[6:7], v222 offset:17416
 buffer_load_dwordx4 v99, s[20:23], s52 offen offset:3072  lds
 v_mfma_f32_16x16x32_bf16 v[84:87], a[40:43], a[68:71], v[84:87]
 ds_read_b64_tr_b16 a[8:9], v223 offset:16384
 v_mfma_f32_16x16x32_bf16 v[24:27], a[44:47], a[52:55], v[24:27]
 ds_read_b64_tr_b16 a[10:11], v223 offset:17408
 v_mfma_f32_16x16x32_bf16 v[40:43], a[44:47], a[56:59], v[40:43]
 ds_read_b64_tr_b16 a[12:13], v223 offset:16392
 s_add_u32 m0, s43, 102400
 s_nop 0
 buffer_load_dwordx4 v100, s[20:23], s52 offen offset:0  lds
 v_mfma_f32_16x16x32_bf16 v[56:59], a[44:47], a[60:63], v[56:59]
 ds_read_b64_tr_b16 a[14:15], v223 offset:17416
 v_mfma_f32_16x16x32_bf16 v[72:75], a[44:47], a[64:67], v[72:75]
 s_add_u32 m0, s44, 32768
 s_add_u32 s52, s52, 128
 buffer_load_dwordx4 v101, s[24:27], s53 offen offset:0  lds
 v_mfma_f32_16x16x32_bf16 v[88:91], a[44:47], a[68:71], v[88:91]
 v_mfma_f32_16x16x32_bf16 v[28:31], a[48:51], a[52:55], v[28:31]
 v_mfma_f32_16x16x32_bf16 v[44:47], a[48:51], a[56:59], v[44:47]
 buffer_load_dwordx4 v102, s[24:27], s53 offen offset:1024  lds
 v_mfma_f32_16x16x32_bf16 v[60:63], a[48:51], a[60:63], v[60:63]
 v_mfma_f32_16x16x32_bf16 v[76:79], a[48:51], a[64:67], v[76:79]
 v_mfma_f32_16x16x32_bf16 v[92:95], a[48:51], a[68:71], v[92:95]
 buffer_load_dwordx4 v103, s[24:27], s53 offen offset:2048  lds
 s_waitcnt lgkmcnt(0)
 v_mfma_f32_16x16x32_bf16 v[16:19], a[0:3], a[16:19], v[16:19]
 ds_read_b64_tr_b16 a[36:37], v222 offset:24576
 v_mfma_f32_16x16x32_bf16 v[32:35], a[0:3], a[20:23], v[32:35]
 ds_read_b64_tr_b16 a[38:39], v222 offset:25600
 v_mfma_f32_16x16x32_bf16 v[48:51], a[0:3], a[24:27], v[48:51]
 ds_read_b128 a[52:55], v221 offset:45056
 buffer_load_dwordx4 v104, s[24:27], s53 offen offset:3072  lds
 s_cmp_eq_u32 s52, 1280
 s_cselect_b32 s52, 0, s52
 s_lshl_b32 s53, s52, 12
 v_mfma_f32_16x16x32_bf16 v[64:67], a[0:3], a[28:31], v[64:67]
 ds_read_b128 a[56:59], v221 offset:47104
 v_mfma_f32_16x16x32_bf16 v[80:83], a[0:3], a[32:35], v[80:83]
 ds_read_b128 a[60:63], v221 offset:49152
 s_add_u32 m0, s44, 0
 s_mov_b32 s46, 0
 buffer_load_dwordx4 v214, s[28:31], s46 offen offset:0 nt lds
 v_mfma_f32_16x16x32_bf16 v[20:23], a[4:7], a[16:19], v[20:23]
 ds_read_b128 a[64:67], v221 offset:51200
 v_mfma_f32_16x16x32_bf16 v[36:39], a[4:7], a[20:23], v[36:39]
 ds_read_b128 a[68:71], v221 offset:53248
 v_mfma_f32_16x16x32_bf16 v[52:55], a[4:7], a[24:27], v[52:55]
 ds_read_b64_tr_b16 a[40:41], v222 offset:24584
 buffer_load_dwordx4 v215, s[28:31], s46 offen offset:1024 nt lds
 v_mfma_f32_16x16x32_bf16 v[68:71], a[4:7], a[28:31], v[68:71]
 ds_read_b64_tr_b16 a[42:43], v222 offset:25608
 v_mfma_f32_16x16x32_bf16 v[84:87], a[4:7], a[32:35], v[84:87]
 ds_read_b64_tr_b16 a[44:45], v223 offset:24576
 v_mfma_f32_16x16x32_bf16 v[24:27], a[8:11], a[16:19], v[24:27]
 ds_read_b64_tr_b16 a[46:47], v223 offset:25600
 s_add_u32 m0, s44, 0
 s_mov_b32 s46, 0
 buffer_load_dwordx4 v216, s[28:31], s46 offen offset:2048 nt lds
 v_mfma_f32_16x16x32_bf16 v[40:43], a[8:11], a[20:23], v[40:43]
 ds_read_b64_tr_b16 a[48:49], v223 offset:24584
 v_mfma_f32_16x16x32_bf16 v[56:59], a[8:11], a[24:27], v[56:59]
 ds_read_b64_tr_b16 a[50:51], v223 offset:25608
 v_mfma_f32_16x16x32_bf16 v[72:75], a[8:11], a[28:31], v[72:75]
 buffer_load_dwordx4 v217, s[28:31], s46 offen offset:3072 nt lds
 v_mfma_f32_16x16x32_bf16 v[88:91], a[8:11], a[32:35], v[88:91]
 v_mfma_f32_16x16x32_bf16 v[28:31], a[12:15], a[16:19], v[28:31]
 v_mfma_f32_16x16x32_bf16 v[44:47], a[12:15], a[20:23], v[44:47]
 v_mfma_f32_16x16x32_bf16 v[60:63], a[12:15], a[24:27], v[60:63]
 v_mfma_f32_16x16x32_bf16 v[76:79], a[12:15], a[28:31], v[76:79]
 v_mfma_f32_16x16x32_bf16 v[92:95], a[12:15], a[32:35], v[92:95]
 s_waitcnt vmcnt(13) lgkmcnt(0)
 s_barrier
 v_mfma_f32_16x16x32_bf16 v[16:19], a[36:39], a[52:55], v[16:19]
 ds_read_b64_tr_b16 a[0:1], v222 offset:49152
 s_add_u32 m0, s43, 143360
 s_nop 0
 buffer_load_dwordx4 v96, s[20:23], s52 offen offset:0  lds
 v_mfma_f32_16x16x32_bf16 v[32:35], a[36:39], a[56:59], v[32:35]
 ds_read_b64_tr_b16 a[2:3], v222 offset:50176
 v_mfma_f32_16x16x32_bf16 v[48:51], a[36:39], a[60:63], v[48:51]
 ds_read_b128 a[16:19], v220 offset:20480
 buffer_load_dwordx4 v97, s[20:23], s52 offen offset:1024  lds
 v_mfma_f32_16x16x32_bf16 v[64:67], a[36:39], a[64:67], v[64:67]
 ds_read_b128 a[20:23], v220 offset:22528
 v_mfma_f32_16x16x32_bf16 v[80:83], a[36:39], a[68:71], v[80:83]
 ds_read_b128 a[24:27], v220 offset:24576
 v_mfma_f32_16x16x32_bf16 v[20:23], a[40:43], a[52:55], v[20:23]
 ds_read_b128 a[28:31], v220 offset:26624
 buffer_load_dwordx4 v98, s[20:23], s52 offen offset:2048  lds
 v_mfma_f32_16x16x32_bf16 v[36:39], a[40:43], a[56:59], v[36:39]
 ds_read_b128 a[32:35], v220 offset:28672
 v_mfma_f32_16x16x32_bf16 v[52:55], a[40:43], a[60:63], v[52:55]
 ds_read_b64_tr_b16 a[4:5], v222 offset:49160
 v_mfma_f32_16x16x32_bf16 v[68:71], a[40:43], a[64:67], v[68:71]
 ds_read_b64_tr_b16 a[6:7], v222 offset:50184
 buffer_load_dwordx4 v99, s[20:23], s52 offen offset:3072  lds
 v_mfma_f32_16x16x32_bf16 v[84:87], a[40:43], a[68:71], v[84:87]
 ds_read_b64_tr_b16 a[8:9], v223 offset:49152
 v_mfma_f32_16x16x32_bf16 v[24:27], a[44:47], a[52:55], v[24:27]
 ds_read_b64_tr_b16 a[10:11], v223 offset:50176
 v_mfma_f32_16x16x32_bf16 v[40:43], a[44:47], a[56:59], v[40:43]
 ds_read_b64_tr_b16 a[12:13], v223 offset:49160
 s_add_u32 m0, s43, 147456
 s_nop 0
 buffer_load_dwordx4 v100, s[20:23], s52 offen offset:0  lds
 v_mfma_f32_16x16x32_bf16 v[56:59], a[44:47], a[60:63], v[56:59]
 ds_read_b64_tr_b16 a[14:15], v223 offset:50184
 v_mfma_f32_16x16x32_bf16 v[72:75], a[44:47], a[64:67], v[72:75]
 s_add_u32 m0, s44, 49152
 s_add_u32 s52, s52, 128
 buffer_load_dwordx4 v101, s[24:27], s53 offen offset:0  lds
 v_mfma_f32_16x16x32_bf16 v[88:91], a[44:47], a[68:71], v[88:91]
 v_mfma_f32_16x16x32_bf16 v[28:31], a[48:51], a[52:55], v[28:31]
 v_mfma_f32_16x16x32_bf16 v[44:47], a[48:51], a[56:59], v[44:47]
 buffer_load_dwordx4 v102, s[24:27], s53 offen offset:1024  lds
 v_mfma_f32_16x16x32_bf16 v[60:63], a[48:51], a[60:63], v[60:63]
 v_mfma_f32_16x16x32_bf16 v[76:79], a[48:51], a[64:67], v[76:79]
 v_mfma_f32_16x16x32_bf16 v[92:95], a[48:51], a[68:71], v[92:95]
 buffer_load_dwordx4 v103, s[24:27], s53 offen offset:2048  lds
 s_waitcnt lgkmcnt(0)
 v_mfma_f32_16x16x32_bf16 v[16:19], a[0:3], a[16:19], v[16:19]
 ds_read_b64_tr_b16 a[36:37], v222 offset:57344
 v_mfma_f32_16x16x32_bf16 v[32:35], a[0:3], a[20:23], v[32:35]
 ds_read_b64_tr_b16 a[38:39], v222 offset:58368
 v_mfma_f32_16x16x32_bf16 v[48:51], a[0:3], a[24:27], v[48:51]
 ds_read_b128 a[52:55], v221 offset:20480
 buffer_load_dwordx4 v104, s[24:27], s53 offen offset:3072  lds
 s_cmp_eq_u32 s52, 1280
 s_cselect_b32 s52, 0, s52
 s_lshl_b32 s53, s52, 12
 v_mfma_f32_16x16x32_bf16 v[64:67], a[0:3], a[28:31], v[64:67]
 ds_read_b128 a[56:59], v221 offset:22528
 v_mfma_f32_16x16x32_bf16 v[80:83], a[0:3], a[32:35], v[80:83]
 ds_read_b128 a[60:63], v221 offset:24576
 s_add_u32 m0, s44, 16384
 s_mov_b32 s46, 16384
 buffer_load_dwordx4 v214, s[28:31], s46 offen offset:0 nt lds
 v_mfma_f32_16x16x32_bf16 v[20:23], a[4:7], a[16:19], v[20:23]
 ds_read_b128 a[64:67], v221 offset:26624
 v_mfma_f32_16x16x32_bf16 v[36:39], a[4:7], a[20:23], v[36:39]
 ds_read_b128 a[68:71], v221 offset:28672
 v_mfma_f32_16x16x32_bf16 v[52:55], a[4:7], a[24:27], v[52:55]
 ds_read_b64_tr_b16 a[40:41], v222 offset:57352
 buffer_load_dwordx4 v215, s[28:31], s46 offen offset:1024 nt lds
 v_mfma_f32_16x16x32_bf16 v[68:71], a[4:7], a[28:31], v[68:71]
 ds_read_b64_tr_b16 a[42:43], v222 offset:58376
 v_mfma_f32_16x16x32_bf16 v[84:87], a[4:7], a[32:35], v[84:87]
 ds_read_b64_tr_b16 a[44:45], v223 offset:57344
 v_mfma_f32_16x16x32_bf16 v[24:27], a[8:11], a[16:19], v[24:27]
 ds_read_b64_tr_b16 a[46:47], v223 offset:58368
 s_add_u32 m0, s44, 16384
 s_mov_b32 s46, 16384
 buffer_load_dwordx4 v216, s[28:31], s46 offen offset:2048 nt lds
 v_mfma_f32_16x16x32_bf16 v[40:43], a[8:11], a[20:23], v[40:43]
 ds_read_b64_tr_b16 a[48:49], v223 offset:57352
 v_mfma_f32_16x16x32_bf16 v[56:59], a[8:11], a[24:27], v[56:59]
 ds_read_b64_tr_b16 a[50:51], v223 offset:58376
 v_mfma_f32_16x16x32_bf16 v[72:75], a[8:11], a[28:31], v[72:75]
 buffer_load_dwordx4 v217, s[28:31], s46 offen offset:3072 nt lds
 v_mfma_f32_16x16x32_bf16 v[88:91], a[8:11], a[32:35], v[88:91]
 v_mfma_f32_16x16x32_bf16 v[28:31], a[12:15], a[16:19], v[28:31]
 v_mfma_f32_16x16x32_bf16 v[44:47], a[12:15], a[20:23], v[44:47]
 v_mfma_f32_16x16x32_bf16 v[60:63], a[12:15], a[24:27], v[60:63]
 v_mfma_f32_16x16x32_bf16 v[76:79], a[12:15], a[28:31], v[76:79]
 v_mfma_f32_16x16x32_bf16 v[92:95], a[12:15], a[32:35], v[92:95]
 s_waitcnt vmcnt(17) lgkmcnt(0)
 s_barrier
 v_mfma_f32_16x16x32_bf16 v[16:19], a[36:39], a[52:55], v[16:19]
 ds_read_b64_tr_b16 a[0:1], v222 offset:0
 s_add_u32 m0, s43, 118784
 s_nop 0
 buffer_load_dwordx4 v96, s[20:23], s52 offen offset:0  lds
 v_mfma_f32_16x16x32_bf16 v[32:35], a[36:39], a[56:59], v[32:35]
 ds_read_b64_tr_b16 a[2:3], v222 offset:1024
 v_mfma_f32_16x16x32_bf16 v[48:51], a[36:39], a[60:63], v[48:51]
 ds_read_b128 a[16:19], v220 offset:0
 buffer_load_dwordx4 v97, s[20:23], s52 offen offset:1024  lds
 v_mfma_f32_16x16x32_bf16 v[64:67], a[36:39], a[64:67], v[64:67]
 ds_read_b128 a[20:23], v220 offset:2048
 v_mfma_f32_16x16x32_bf16 v[80:83], a[36:39], a[68:71], v[80:83]
 ds_read_b128 a[24:27], v220 offset:4096
 v_mfma_f32_16x16x32_bf16 v[20:23], a[40:43], a[52:55], v[20:23]
 ds_read_b128 a[28:31], v220 offset:6144
 buffer_load_dwordx4 v98, s[20:23], s52 offen offset:2048  lds
 v_mfma_f32_16x16x32_bf16 v[36:39], a[40:43], a[56:59], v[36:39]
 ds_read_b128 a[32:35], v220 offset:8192
 v_mfma_f32_16x16x32_bf16 v[52:55], a[40:43], a[60:63], v[52:55]
 ds_read_b64_tr_b16 a[4:5], v222 offset:8
 v_mfma_f32_16x16x32_bf16 v[68:71], a[40:43], a[64:67], v[68:71]
 ds_read_b64_tr_b16 a[6:7], v222 offset:1032
 buffer_load_dwordx4 v99, s[20:23], s52 offen offset:3072  lds
 v_mfma_f32_16x16x32_bf16 v[84:87], a[40:43], a[68:71], v[84:87]
 ds_read_b64_tr_b16 a[8:9], v223 offset:0
 v_mfma_f32_16x16x32_bf16 v[24:27], a[44:47], a[52:55], v[24:27]
 ds_read_b64_tr_b16 a[10:11], v223 offset:1024
 v_mfma_f32_16x16x32_bf16 v[40:43], a[44:47], a[56:59], v[40:43]
 ds_read_b64_tr_b16 a[12:13], v223 offset:8
 s_add_u32 m0, s43, 122880
 s_nop 0
 buffer_load_dwordx4 v100, s[20:23], s52 offen offset:0  lds
 v_mfma_f32_16x16x32_bf16 v[56:59], a[44:47], a[60:63], v[56:59]
 ds_read_b64_tr_b16 a[14:15], v223 offset:1032
 v_mfma_f32_16x16x32_bf16 v[72:75], a[44:47], a[64:67], v[72:75]
 s_add_u32 m0, s44, 81920
 s_add_u32 s52, s52, 128
 buffer_load_dwordx4 v101, s[24:27], s53 offen offset:0  lds
 v_mfma_f32_16x16x32_bf16 v[88:91], a[44:47], a[68:71], v[88:91]
 v_mfma_f32_16x16x32_bf16 v[28:31], a[48:51], a[52:55], v[28:31]
 v_mfma_f32_16x16x32_bf16 v[44:47], a[48:51], a[56:59], v[44:47]
 buffer_load_dwordx4 v102, s[24:27], s53 offen offset:1024  lds
 v_mfma_f32_16x16x32_bf16 v[60:63], a[48:51], a[60:63], v[60:63]
 v_mfma_f32_16x16x32_bf16 v[76:79], a[48:51], a[64:67], v[76:79]
 v_mfma_f32_16x16x32_bf16 v[92:95], a[48:51], a[68:71], v[92:95]
 buffer_load_dwordx4 v103, s[24:27], s53 offen offset:2048  lds
 s_waitcnt lgkmcnt(0)
 v_mfma_f32_16x16x32_bf16 v[16:19], a[0:3], a[16:19], v[16:19]
 ds_read_b64_tr_b16 a[36:37], v222 offset:8192
 v_mfma_f32_16x16x32_bf16 v[32:35], a[0:3], a[20:23], v[32:35]
 ds_read_b64_tr_b16 a[38:39], v222 offset:9216
 v_mfma_f32_16x16x32_bf16 v[48:51], a[0:3], a[24:27], v[48:51]
 ds_read_b128 a[52:55], v221 offset:0
 buffer_load_dwordx4 v104, s[24:27], s53 offen offset:3072  lds
 s_cmp_eq_u32 s52, 1280
 s_cselect_b32 s52, 0, s52
 s_lshl_b32 s53, s52, 12
 v_mfma_f32_16x16x32_bf16 v[64:67], a[0:3], a[28:31], v[64:67]
 ds_read_b128 a[56:59], v221 offset:2048
 v_mfma_f32_16x16x32_bf16 v[80:83], a[0:3], a[32:35], v[80:83]
 ds_read_b128 a[60:63], v221 offset:4096
 s_add_u32 m0, s44, 65536
 s_mov_b32 s46, 0
 buffer_load_dwordx4 v218, s[32:35], s46 offen offset:0 nt lds
 v_mfma_f32_16x16x32_bf16 v[20:23], a[4:7], a[16:19], v[20:23]
 ds_read_b128 a[64:67], v221 offset:6144
 v_mfma_f32_16x16x32_bf16 v[36:39], a[4:7], a[20:23], v[36:39]
 ds_read_b128 a[68:71], v221 offset:8192
 v_mfma_f32_16x16x32_bf16 v[52:55], a[4:7], a[24:27], v[52:55]
 ds_read_b64_tr_b16 a[40:41], v222 offset:8200
 buffer_load_dwordx4 v219, s[32:35], s46 offen offset:1024 nt lds
 v_mfma_f32_16x16x32_bf16 v[68:71], a[4:7], a[28:31], v[68:71]
 ds_read_b64_tr_b16 a[42:43], v222 offset:9224
 v_mfma_f32_16x16x32_bf16 v[84:87], a[4:7], a[32:35], v[84:87]
 ds_read_b64_tr_b16 a[44:45], v223 offset:8192
 v_mfma_f32_16x16x32_bf16 v[24:27], a[8:11], a[16:19], v[24:27]
 ds_read_b64_tr_b16 a[46:47], v223 offset:9216
 s_add_u32 m0, s44, 65536
 s_mov_b32 s46, 0
 buffer_load_dwordx4 v218, s[32:35], s46 offen offset:2048 nt lds
 v_mfma_f32_16x16x32_bf16 v[40:43], a[8:11], a[20:23], v[40:43]
 ds_read_b64_tr_b16 a[48:49], v223 offset:8200
 v_mfma_f32_16x16x32_bf16 v[56:59], a[8:11], a[24:27], v[56:59]
 ds_read_b64_tr_b16 a[50:51], v223 offset:9224
 v_mfma_f32_16x16x32_bf16 v[72:75], a[8:11], a[28:31], v[72:75]
 buffer_load_dwordx4 v219, s[32:35], s46 offen offset:3072 nt lds
 v_mfma_f32_16x16x32_bf16 v[88:91], a[8:11], a[32:35], v[88:91]
 v_mfma_f32_16x16x32_bf16 v[28:31], a[12:15], a[16:19], v[28:31]
 v_mfma_f32_16x16x32_bf16 v[44:47], a[12:15], a[20:23], v[44:47]
 v_mfma_f32_16x16x32_bf16 v[60:63], a[12:15], a[24:27], v[60:63]
 v_mfma_f32_16x16x32_bf16 v[76:79], a[12:15], a[28:31], v[76:79]
 v_mfma_f32_16x16x32_bf16 v[92:95], a[12:15], a[32:35], v[92:95]
 s_waitcnt vmcnt(17) lgkmcnt(0)
 s_barrier
 v_mfma_f32_16x16x32_bf16 v[16:19], a[36:39], a[52:55], v[16:19]
 ds_read_b64_tr_b16 a[0:1], v222 offset:16384
 s_add_u32 m0, s43, 98304
 s_nop 0
 buffer_load_dwordx4 v96, s[20:23], s52 offen offset:0  lds
 v_mfma_f32_16x16x32_bf16 v[32:35], a[36:39], a[56:59], v[32:35]
 ds_read_b64_tr_b16 a[2:3], v222 offset:17408
 v_mfma_f32_16x16x32_bf16 v[48:51], a[36:39], a[60:63], v[48:51]
 ds_read_b128 a[16:19], v220 offset:45056
 v_mfma_f32_16x16x32_bf16 v[64:67], a[36:39], a[64:67], v[64:67]
 ds_read_b128 a[20:23], v220 offset:47104
 v_mfma_f32_16x16x32_bf16 v[80:83], a[36:39], a[68:71], v[80:83]
 ds_read_b128 a[24:27], v220 offset:49152
 buffer_load_dwordx4 v97, s[20:23], s52 offen offset:1024  lds
 v_mfma_f32_16x16x32_bf16 v[20:23], a[40:43], a[52:55], v[20:23]
 ds_read_b128 a[28:31], v220 offset:51200
 v_mfma_f32_16x16x32_bf16 v[36:39], a[40:43], a[56:59], v[36:39]
 ds_read_b128 a[32:35], v220 offset:53248
 v_mfma_f32_16x16x32_bf16 v[52:55], a[40:43], a[60:63], v[52:55]
 ds_read_b64_tr_b16 a[4:5], v222 offset:16392
 v_mfma_f32_16x16x32_bf16 v[68:71], a[40:43], a[64:67], v[68:71]
 ds_read_b64_tr_b16 a[6:7], v222 offset:17416
 buffer_load_dwordx4 v98, s[20:23], s52 offen offset:2048  lds
 v_mfma_f32_16x16x32_bf16 v[84:87], a[40:43], a[68:71], v[84:87]
 ds_read_b64_tr_b16 a[8:9], v223 offset:16384
 v_mfma_f32_16x16x32_bf16 v[24:27], a[44:47], a[52:55], v[24:27]
 ds_read_b64_tr_b16 a[10:11], v223 offset:17408
 v_mfma_f32_16x16x32_bf16 v[40:43], a[44:47], a[56:59], v[40:43]
 ds_read_b64_tr_b16 a[12:13], v223 offset:16392
 v_mfma_f32_16x16x32_bf16 v[56:59], a[44:47], a[60:63], v[56:59]
 ds_read_b64_tr_b16 a[14:15], v223 offset:17416
 buffer_load_dwordx4 v99, s[20:23], s52 offen offset:3072  lds
 v_mfma_f32_16x16x32_bf16 v[72:75], a[44:47], a[64:67], v[72:75]
 v_mfma_f32_16x16x32_bf16 v[88:91], a[44:47], a[68:71], v[88:91]
 v_mfma_f32_16x16x32_bf16 v[28:31], a[48:51], a[52:55], v[28:31]
 v_mfma_f32_16x16x32_bf16 v[44:47], a[48:51], a[56:59], v[44:47]
 s_add_u32 m0, s43, 102400
 s_nop 0
 buffer_load_dwordx4 v100, s[20:23], s52 offen offset:0  lds
 v_mfma_f32_16x16x32_bf16 v[60:63], a[48:51], a[60:63], v[60:63]
 v_mfma_f32_16x16x32_bf16 v[76:79], a[48:51], a[64:67], v[76:79]
 v_mfma_f32_16x16x32_bf16 v[92:95], a[48:51], a[68:71], v[92:95]
 s_waitcnt lgkmcnt(0)
 v_mfma_f32_16x16x32_bf16 v[16:19], a[0:3], a[16:19], v[16:19]
 ds_read_b64_tr_b16 a[36:37], v222 offset:24576
 s_add_u32 m0, s44, 32768
 s_add_u32 s52, s52, 128
 buffer_load_dwordx4 v101, s[24:27], s53 offen offset:0  lds
 v_mfma_f32_16x16x32_bf16 v[32:35], a[0:3], a[20:23], v[32:35]
 ds_read_b64_tr_b16 a[38:39], v222 offset:25600
 v_mfma_f32_16x16x32_bf16 v[48:51], a[0:3], a[24:27], v[48:51]
 ds_read_b128 a[52:55], v221 offset:45056
 v_mfma_f32_16x16x32_bf16 v[64:67], a[0:3], a[28:31], v[64:67]
 ds_read_b128 a[56:59], v221 offset:47104
 v_mfma_f32_16x16x32_bf16 v[80:83], a[0:3], a[32:35], v[80:83]
 ds_read_b128 a[60:63], v221 offset:49152
 buffer_load_dwordx4 v102, s[24:27], s53 offen offset:1024  lds
 v_mfma_f32_16x16x32_bf16 v[20:23], a[4:7], a[16:19], v[20:23]
 ds_read_b128 a[64:67], v221 offset:51200
 v_mfma_f32_16x16x32_bf16 v[36:39], a[4:7], a[20:23], v[36:39]
 ds_read_b128 a[68:71], v221 offset:53248
 v_mfma_f32_16x16x32_bf16 v[52:55], a[4:7], a[24:27], v[52:55]
 ds_read_b64_tr_b16 a[40:41], v222 offset:24584
 v_mfma_f32_16x16x32_bf16 v[68:71], a[4:7], a[28:31], v[68:71]
 ds_read_b64_tr_b16 a[42:43], v222 offset:25608
 buffer_load_dwordx4 v103, s[24:27], s53 offen offset:2048  lds
 v_mfma_f32_16x16x32_bf16 v[84:87], a[4:7], a[32:35], v[84:87]
 ds_read_b64_tr_b16 a[44:45], v223 offset:24576
 v_mfma_f32_16x16x32_bf16 v[24:27], a[8:11], a[16:19], v[24:27]
 ds_read_b64_tr_b16 a[46:47], v223 offset:25600
 v_mfma_f32_16x16x32_bf16 v[40:43], a[8:11], a[20:23], v[40:43]
 ds_read_b64_tr_b16 a[48:49], v223 offset:24584
 v_mfma_f32_16x16x32_bf16 v[56:59], a[8:11], a[24:27], v[56:59]
 ds_read_b64_tr_b16 a[50:51], v223 offset:25608
 buffer_load_dwordx4 v104, s[24:27], s53 offen offset:3072  lds
 s_cmp_eq_u32 s52, 1280
 s_cselect_b32 s52, 0, s52
 s_lshl_b32 s53, s52, 12
 v_mfma_f32_16x16x32_bf16 v[72:75], a[8:11], a[28:31], v[72:75]
 v_mfma_f32_16x16x32_bf16 v[88:91], a[8:11], a[32:35], v[88:91]
 v_mfma_f32_16x16x32_bf16 v[28:31], a[12:15], a[16:19], v[28:31]
 v_mfma_f32_16x16x32_bf16 v[44:47], a[12:15], a[20:23], v[44:47]
 v_mfma_f32_16x16x32_bf16 v[60:63], a[12:15], a[24:27], v[60:63]
 v_mfma_f32_16x16x32_bf16 v[76:79], a[12:15], a[28:31], v[76:79]
 v_mfma_f32_16x16x32_bf16 v[92:95], a[12:15], a[32:35], v[92:95]
 s_waitcnt vmcnt(13) lgkmcnt(0)
 s_barrier
 v_mfma_f32_16x16x32_bf16 v[16:19], a[36:39], a[52:55], v[16:19]
 ds_read_b64_tr_b16 a[0:1], v222 offset:49152
 s_add_u32 m0, s43, 143360
 s_nop 0
 buffer_load_dwordx4 v96, s[20:23], s52 offen offset:0  lds
 v_mfma_f32_16x16x32_bf16 v[32:35], a[36:39], a[56:59], v[32:35]
 ds_read_b64_tr_b16 a[2:3], v222 offset:50176
 v_mfma_f32_16x16x32_bf16 v[48:51], a[36:39], a[60:63], v[48:51]
 ds_read_b128 a[16:19], v220 offset:20480
 v_mfma_f32_16x16x32_bf16 v[64:67], a[36:39], a[64:67], v[64:67]
 ds_read_b128 a[20:23], v220 offset:22528
 v_mfma_f32_16x16x32_bf16 v[80:83], a[36:39], a[68:71], v[80:83]
 ds_read_b128 a[24:27], v220 offset:24576
 buffer_load_dwordx4 v97, s[20:23], s52 offen offset:1024  lds
 v_mfma_f32_16x16x32_bf16 v[20:23], a[40:43], a[52:55], v[20:23]
 ds_read_b128 a[28:31], v220 offset:26624
 v_mfma_f32_16x16x32_bf16 v[36:39], a[40:43], a[56:59], v[36:39]
 ds_read_b128 a[32:35], v220 offset:28672
 v_mfma_f32_16x16x32_bf16 v[52:55], a[40:43], a[60:63], v[52:55]
 ds_read_b64_tr_b16 a[4:5], v222 offset:49160
 v_mfma_f32_16x16x32_bf16 v[68:71], a[40:43], a[64:67], v[68:71]
 ds_read_b64_tr_b16 a[6:7], v222 offset:50184
 buffer_load_dwordx4 v98, s[20:23], s52 offen offset:2048  lds
 v_mfma_f32_16x16x32_bf16 v[84:87], a[40:43], a[68:71], v[84:87]
 ds_read_b64_tr_b16 a[8:9], v223 offset:49152
 v_mfma_f32_16x16x32_bf16 v[24:27], a[44:47], a[52:55], v[24:27]
 ds_read_b64_tr_b16 a[10:11], v223 offset:50176
 v_mfma_f32_16x16x32_bf16 v[40:43], a[44:47], a[56:59], v[40:43]
 ds_read_b64_tr_b16 a[12:13], v223 offset:49160
 v_mfma_f32_16x16x32_bf16 v[56:59], a[44:47], a[60:63], v[56:59]
 ds_read_b64_tr_b16 a[14:15], v223 offset:50184
 buffer_load_dwordx4 v99, s[20:23], s52 offen offset:3072  lds
 v_mfma_f32_16x16x32_bf16 v[72:75], a[44:47], a[64:67], v[72:75]
 v_mfma_f32_16x16x32_bf16 v[88:91], a[44:47], a[68:71], v[88:91]
 v_mfma_f32_16x16x32_bf16 v[28:31], a[48:51], a[52:55], v[28:31]
 v_mfma_f32_16x16x32_bf16 v[44:47], a[48:51], a[56:59], v[44:47]
 s_add_u32 m0, s43, 147456
 s_nop 0
 buffer_load_dwordx4 v100, s[20:23], s52 offen offset:0  lds
 v_mfma_f32_16x16x32_bf16 v[60:63], a[48:51], a[60:63], v[60:63]
 v_mfma_f32_16x16x32_bf16 v[76:79], a[48:51], a[64:67], v[76:79]
 v_mfma_f32_16x16x32_bf16 v[92:95], a[48:51], a[68:71], v[92:95]
 s_waitcnt lgkmcnt(0)
 v_mfma_f32_16x16x32_bf16 v[16:19], a[0:3], a[16:19], v[16:19]
 ds_read_b64_tr_b16 a[36:37], v222 offset:57344
 s_add_u32 m0, s44, 49152
 s_add_u32 s52, s52, 128
 buffer_load_dwordx4 v101, s[24:27], s53 offen offset:0  lds
 v_mfma_f32_16x16x32_bf16 v[32:35], a[0:3], a[20:23], v[32:35]
 ds_read_b64_tr_b16 a[38:39], v222 offset:58368
 v_mfma_f32_16x16x32_bf16 v[48:51], a[0:3], a[24:27], v[48:51]
 ds_read_b128 a[52:55], v221 offset:20480
 v_mfma_f32_16x16x32_bf16 v[64:67], a[0:3], a[28:31], v[64:67]
 ds_read_b128 a[56:59], v221 offset:22528
 v_mfma_f32_16x16x32_bf16 v[80:83], a[0:3], a[32:35], v[80:83]
 ds_read_b128 a[60:63], v221 offset:24576
 buffer_load_dwordx4 v102, s[24:27], s53 offen offset:1024  lds
 v_mfma_f32_16x16x32_bf16 v[20:23], a[4:7], a[16:19], v[20:23]
 ds_read_b128 a[64:67], v221 offset:26624
 v_mfma_f32_16x16x32_bf16 v[36:39], a[4:7], a[20:23], v[36:39]
 ds_read_b128 a[68:71], v221 offset:28672
 v_mfma_f32_16x16x32_bf16 v[52:55], a[4:7], a[24:27], v[52:55]
 ds_read_b64_tr_b16 a[40:41], v222 offset:57352
 v_mfma_f32_16x16x32_bf16 v[68:71], a[4:7], a[28:31], v[68:71]
 ds_read_b64_tr_b16 a[42:43], v222 offset:58376
 buffer_load_dwordx4 v103, s[24:27], s53 offen offset:2048  lds
 v_mfma_f32_16x16x32_bf16 v[84:87], a[4:7], a[32:35], v[84:87]
 ds_read_b64_tr_b16 a[44:45], v223 offset:57344
 v_mfma_f32_16x16x32_bf16 v[24:27], a[8:11], a[16:19], v[24:27]
 ds_read_b64_tr_b16 a[46:47], v223 offset:58368
 v_mfma_f32_16x16x32_bf16 v[40:43], a[8:11], a[20:23], v[40:43]
 ds_read_b64_tr_b16 a[48:49], v223 offset:57352
 v_mfma_f32_16x16x32_bf16 v[56:59], a[8:11], a[24:27], v[56:59]
 ds_read_b64_tr_b16 a[50:51], v223 offset:58376
 buffer_load_dwordx4 v104, s[24:27], s53 offen offset:3072  lds
 s_cmp_eq_u32 s52, 1280
 s_cselect_b32 s52, 0, s52
 s_lshl_b32 s53, s52, 12
 v_mfma_f32_16x16x32_bf16 v[72:75], a[8:11], a[28:31], v[72:75]
 v_mfma_f32_16x16x32_bf16 v[88:91], a[8:11], a[32:35], v[88:91]
 v_mfma_f32_16x16x32_bf16 v[28:31], a[12:15], a[16:19], v[28:31]
 v_mfma_f32_16x16x32_bf16 v[44:47], a[12:15], a[20:23], v[44:47]
 v_mfma_f32_16x16x32_bf16 v[60:63], a[12:15], a[24:27], v[60:63]
 v_mfma_f32_16x16x32_bf16 v[76:79], a[12:15], a[28:31], v[76:79]
 v_mfma_f32_16x16x32_bf16 v[92:95], a[12:15], a[32:35], v[92:95]
 s_waitcnt vmcnt(9) lgkmcnt(0)
 s_barrier
 v_mfma_f32_16x16x32_bf16 v[16:19], a[36:39], a[52:55], v[16:19]
 ds_read_b64_tr_b16 a[0:1], v222 offset:0
 s_add_u32 m0, s43, 118784
 s_nop 0
 buffer_load_dwordx4 v96, s[20:23], s52 offen offset:0  lds
 v_mfma_f32_16x16x32_bf16 v[32:35], a[36:39], a[56:59], v[32:35]
 ds_read_b64_tr_b16 a[2:3], v222 offset:1024
 v_mfma_f32_16x16x32_bf16 v[48:51], a[36:39], a[60:63], v[48:51]
 ds_read_b128 a[16:19], v220 offset:0
 v_mfma_f32_16x16x32_bf16 v[64:67], a[36:39], a[64:67], v[64:67]
 ds_read_b128 a[20:23], v220 offset:2048
 v_mfma_f32_16x16x32_bf16 v[80:83], a[36:39], a[68:71], v[80:83]
 ds_read_b128 a[24:27], v220 offset:4096
 buffer_load_dwordx4 v97, s[20:23], s52 offen offset:1024  lds
 v_mfma_f32_16x16x32_bf16 v[20:23], a[40:43], a[52:55], v[20:23]
 ds_read_b128 a[28:31], v220 offset:6144
 v_mfma_f32_16x16x32_bf16 v[36:39], a[40:43], a[56:59], v[36:39]
 ds_read_b128 a[32:35], v220 offset:8192
 v_mfma_f32_16x16x32_bf16 v[52:55], a[40:43], a[60:63], v[52:55]
 ds_read_b64_tr_b16 a[4:5], v222 offset:8
 v_mfma_f32_16x16x32_bf16 v[68:71], a[40:43], a[64:67], v[68:71]
 ds_read_b64_tr_b16 a[6:7], v222 offset:1032
 buffer_load_dwordx4 v98, s[20:23], s52 offen offset:2048  lds
 v_mfma_f32_16x16x32_bf16 v[84:87], a[40:43], a[68:71], v[84:87]
 ds_read_b64_tr_b16 a[8:9], v223 offset:0
 v_mfma_f32_16x16x32_bf16 v[24:27], a[44:47], a[52:55], v[24:27]
 ds_read_b64_tr_b16 a[10:11], v223 offset:1024
 v_mfma_f32_16x16x32_bf16 v[40:43], a[44:47], a[56:59], v[40:43]
 ds_read_b64_tr_b16 a[12:13], v223 offset:8
 v_mfma_f32_16x16x32_bf16 v[56:59], a[44:47], a[60:63], v[56:59]
 ds_read_b64_tr_b16 a[14:15], v223 offset:1032
 buffer_load_dwordx4 v99, s[20:23], s52 offen offset:3072  lds
 v_mfma_f32_16x16x32_bf16 v[72:75], a[44:47], a[64:67], v[72:75]
 v_mfma_f32_16x16x32_bf16 v[88:91], a[44:47], a[68:71], v[88:91]
 v_mfma_f32_16x16x32_bf16 v[28:31], a[48:51], a[52:55], v[28:31]
 v_mfma_f32_16x16x32_bf16 v[44:47], a[48:51], a[56:59], v[44:47]
 s_add_u32 m0, s43, 122880
 s_nop 0
 buffer_load_dwordx4 v100, s[20:23], s52 offen offset:0  lds
 v_mfma_f32_16x16x32_bf16 v[60:63], a[48:51], a[60:63], v[60:63]
 v_mfma_f32_16x16x32_bf16 v[76:79], a[48:51], a[64:67], v[76:79]
 v_mfma_f32_16x16x32_bf16 v[92:95], a[48:51], a[68:71], v[92:95]
 s_waitcnt lgkmcnt(0)
 v_mfma_f32_16x16x32_bf16 v[16:19], a[0:3], a[16:19], v[16:19]
 ds_read_b64_tr_b16 a[36:37], v222 offset:8192
 s_add_u32 m0, s44, 81920
 s_add_u32 s52, s52, 128
 buffer_load_dwordx4 v101, s[24:27], s53 offen offset:0  lds
 v_mfma_f32_16x16x32_bf16 v[32:35], a[0:3], a[20:23], v[32:35]
 ds_read_b64_tr_b16 a[38:39], v222 offset:9216
 v_mfma_f32_16x16x32_bf16 v[48:51], a[0:3], a[24:27], v[48:51]
 ds_read_b128 a[52:55], v221 offset:0
 v_mfma_f32_16x16x32_bf16 v[64:67], a[0:3], a[28:31], v[64:67]
 ds_read_b128 a[56:59], v221 offset:2048
 v_mfma_f32_16x16x32_bf16 v[80:83], a[0:3], a[32:35], v[80:83]
 ds_read_b128 a[60:63], v221 offset:4096
 buffer_load_dwordx4 v102, s[24:27], s53 offen offset:1024  lds
 v_mfma_f32_16x16x32_bf16 v[20:23], a[4:7], a[16:19], v[20:23]
 ds_read_b128 a[64:67], v221 offset:6144
 v_mfma_f32_16x16x32_bf16 v[36:39], a[4:7], a[20:23], v[36:39]
 ds_read_b128 a[68:71], v221 offset:8192
 v_mfma_f32_16x16x32_bf16 v[52:55], a[4:7], a[24:27], v[52:55]
 ds_read_b64_tr_b16 a[40:41], v222 offset:8200
 v_mfma_f32_16x16x32_bf16 v[68:71], a[4:7], a[28:31], v[68:71]
 ds_read_b64_tr_b16 a[42:43], v222 offset:9224
 buffer_load_dwordx4 v103, s[24:27], s53 offen offset:2048  lds
 v_mfma_f32_16x16x32_bf16 v[84:87], a[4:7], a[32:35], v[84:87]
 ds_read_b64_tr_b16 a[44:45], v223 offset:8192
 v_mfma_f32_16x16x32_bf16 v[24:27], a[8:11], a[16:19], v[24:27]
 ds_read_b64_tr_b16 a[46:47], v223 offset:9216
 v_mfma_f32_16x16x32_bf16 v[40:43], a[8:11], a[20:23], v[40:43]
 ds_read_b64_tr_b16 a[48:49], v223 offset:8200
 v_mfma_f32_16x16x32_bf16 v[56:59], a[8:11], a[24:27], v[56:59]
 ds_read_b64_tr_b16 a[50:51], v223 offset:9224
 buffer_load_dwordx4 v104, s[24:27], s53 offen offset:3072  lds
 s_cmp_eq_u32 s52, 1280
 s_cselect_b32 s52, 0, s52
 s_lshl_b32 s53, s52, 12
 v_mfma_f32_16x16x32_bf16 v[72:75], a[8:11], a[28:31], v[72:75]
 v_mfma_f32_16x16x32_bf16 v[88:91], a[8:11], a[32:35], v[88:91]
 v_mfma_f32_16x16x32_bf16 v[28:31], a[12:15], a[16:19], v[28:31]
 v_mfma_f32_16x16x32_bf16 v[44:47], a[12:15], a[20:23], v[44:47]
 v_mfma_f32_16x16x32_bf16 v[60:63], a[12:15], a[24:27], v[60:63]
 v_mfma_f32_16x16x32_bf16 v[76:79], a[12:15], a[28:31], v[76:79]
 v_mfma_f32_16x16x32_bf16 v[92:95], a[12:15], a[32:35], v[92:95]
 s_waitcnt vmcnt(9) lgkmcnt(0)
 s_barrier
 v_mfma_f32_16x16x32_bf16 v[16:19], a[36:39], a[52:55], v[16:19]
 ds_read_b64_tr_b16 a[0:1], v222 offset:16384
 s_add_u32 m0, s44, 32768
 s_mov_b32 s46, 32768
 buffer_load_dwordx4 v214, s[28:31], s46 offen offset:0 nt lds
 v_mfma_f32_16x16x32_bf16 v[32:35], a[36:39], a[56:59], v[32:35]
 ds_read_b64_tr_b16 a[2:3], v222 offset:17408
 v_mfma_f32_16x16x32_bf16 v[48:51], a[36:39], a[60:63], v[48:51]
 ds_read_b128 a[16:19], v220 offset:45056
 v_mfma_f32_16x16x32_bf16 v[64:67], a[36:39], a[64:67], v[64:67]
 ds_read_b128 a[20:23], v220 offset:47104
 v_mfma_f32_16x16x32_bf16 v[80:83], a[36:39], a[68:71], v[80:83]
 ds_read_b128 a[24:27], v220 offset:49152
 buffer_load_dwordx4 v215, s[28:31], s46 offen offset:1024 nt lds
 v_mfma_f32_16x16x32_bf16 v[20:23], a[40:43], a[52:55], v[20:23]
 ds_read_b128 a[28:31], v220 offset:51200
 v_mfma_f32_16x16x32_bf16 v[36:39], a[40:43], a[56:59], v[36:39]
 ds_read_b128 a[32:35], v220 offset:53248
 v_mfma_f32_16x16x32_bf16 v[52:55], a[40:43], a[60:63], v[52:55]
 ds_read_b64_tr_b16 a[4:5], v222 offset:16392
 v_mfma_f32_16x16x32_bf16 v[68:71], a[40:43], a[64:67], v[68:71]
 ds_read_b64_tr_b16 a[6:7], v222 offset:17416
 v_mfma_f32_16x16x32_bf16 v[84:87], a[40:43], a[68:71], v[84:87]
 ds_read_b64_tr_b16 a[8:9], v223 offset:16384
 buffer_load_dwordx4 v216, s[28:31], s46 offen offset:2048 nt lds
 v_mfma_f32_16x16x32_bf16 v[24:27], a[44:47], a[52:55], v[24:27]
 ds_read_b64_tr_b16 a[10:11], v223 offset:17408
 v_mfma_f32_16x16x32_bf16 v[40:43], a[44:47], a[56:59], v[40:43]
 ds_read_b64_tr_b16 a[12:13], v223 offset:16392
 v_mfma_f32_16x16x32_bf16 v[56:59], a[44:47], a[60:63], v[56:59]
 ds_read_b64_tr_b16 a[14:15], v223 offset:17416
 v_mfma_f32_16x16x32_bf16 v[72:75], a[44:47], a[64:67], v[72:75]
 buffer_load_dwordx4 v217, s[28:31], s46 offen offset:3072 nt lds
 v_mfma_f32_16x16x32_bf16 v[88:91], a[44:47], a[68:71], v[88:91]
 v_mfma_f32_16x16x32_bf16 v[28:31], a[48:51], a[52:55], v[28:31]
 v_mfma_f32_16x16x32_bf16 v[44:47], a[48:51], a[56:59], v[44:47]
 v_mfma_f32_16x16x32_bf16 v[60:63], a[48:51], a[60:63], v[60:63]
 v_mfma_f32_16x16x32_bf16 v[76:79], a[48:51], a[64:67], v[76:79]
 s_add_u32 m0, s44, 98304
 s_mov_b32 s46, 16384
 buffer_load_dwordx4 v218, s[32:35], s46 offen offset:0 nt lds
 v_mfma_f32_16x16x32_bf16 v[92:95], a[48:51], a[68:71], v[92:95]
 s_waitcnt lgkmcnt(0)
 v_mfma_f32_16x16x32_bf16 v[16:19], a[0:3], a[16:19], v[16:19]
 ds_read_b64_tr_b16 a[36:37], v222 offset:24576
 v_mfma_f32_16x16x32_bf16 v[32:35], a[0:3], a[20:23], v[32:35]
 ds_read_b64_tr_b16 a[38:39], v222 offset:25600
 v_mfma_f32_16x16x32_bf16 v[48:51], a[0:3], a[24:27], v[48:51]
 ds_read_b128 a[52:55], v221 offset:45056
 buffer_load_dwordx4 v219, s[32:35], s46 offen offset:1024 nt lds
 v_mfma_f32_16x16x32_bf16 v[64:67], a[0:3], a[28:31], v[64:67]
 ds_read_b128 a[56:59], v221 offset:47104
 v_mfma_f32_16x16x32_bf16 v[80:83], a[0:3], a[32:35], v[80:83]
 ds_read_b128 a[60:63], v221 offset:49152
 v_mfma_f32_16x16x32_bf16 v[20:23], a[4:7], a[16:19], v[20:23]
 ds_read_b128 a[64:67], v221 offset:51200
 v_mfma_f32_16x16x32_bf16 v[36:39], a[4:7], a[20:23], v[36:39]
 ds_read_b128 a[68:71], v221 offset:53248
 v_mfma_f32_16x16x32_bf16 v[52:55], a[4:7], a[24:27], v[52:55]
 ds_read_b64_tr_b16 a[40:41], v222 offset:24584
 buffer_load_dwordx4 v218, s[32:35], s46 offen offset:2048 nt lds
 v_mfma_f32_16x16x32_bf16 v[68:71], a[4:7], a[28:31], v[68:71]
 ds_read_b64_tr_b16 a[42:43], v222 offset:25608
 v_mfma_f32_16x16x32_bf16 v[84:87], a[4:7], a[32:35], v[84:87]
 ds_read_b64_tr_b16 a[44:45], v223 offset:24576
 v_mfma_f32_16x16x32_bf16 v[24:27], a[8:11], a[16:19], v[24:27]
 ds_read_b64_tr_b16 a[46:47], v223 offset:25600
 v_mfma_f32_16x16x32_bf16 v[40:43], a[8:11], a[20:23], v[40:43]
 ds_read_b64_tr_b16 a[48:49], v223 offset:24584
 buffer_load_dwordx4 v219, s[32:35], s46 offen offset:3072 nt lds
 v_mfma_f32_16x16x32_bf16 v[56:59], a[8:11], a[24:27], v[56:59]
 ds_read_b64_tr_b16 a[50:51], v223 offset:25608
 v_mfma_f32_16x16x32_bf16 v[72:75], a[8:11], a[28:31], v[72:75]
 v_mfma_f32_16x16x32_bf16 v[88:91], a[8:11], a[32:35], v[88:91]
 v_mfma_f32_16x16x32_bf16 v[28:31], a[12:15], a[16:19], v[28:31]
 v_mfma_f32_16x16x32_bf16 v[44:47], a[12:15], a[20:23], v[44:47]
 v_mfma_f32_16x16x32_bf16 v[60:63], a[12:15], a[24:27], v[60:63]
 v_mfma_f32_16x16x32_bf16 v[76:79], a[12:15], a[28:31], v[76:79]
 v_mfma_f32_16x16x32_bf16 v[92:95], a[12:15], a[32:35], v[92:95]
 s_waitcnt vmcnt(8) lgkmcnt(0)
 s_barrier
 v_mfma_f32_16x16x32_bf16 v[16:19], a[36:39], a[52:55], v[16:19]
 ds_read_b64_tr_b16 a[0:1], v222 offset:49152
 s_add_u32 m0, s44, 49152
 s_mov_b32 s46, 49152
 buffer_load_dwordx4 v214, s[28:31], s46 offen offset:0 nt lds
 v_mfma_f32_16x16x32_bf16 v[32:35], a[36:39], a[56:59], v[32:35]
 ds_read_b64_tr_b16 a[2:3], v222 offset:50176
 v_mfma_f32_16x16x32_bf16 v[48:51], a[36:39], a[60:63], v[48:51]
 ds_read_b128 a[16:19], v220 offset:20480
 v_mfma_f32_16x16x32_bf16 v[64:67], a[36:39], a[64:67], v[64:67]
 ds_read_b128 a[20:23], v220 offset:22528
 v_mfma_f32_16x16x32_bf16 v[80:83], a[36:39], a[68:71], v[80:83]
 ds_read_b128 a[24:27], v220 offset:24576
 v_mfma_f32_16x16x32_bf16 v[20:23], a[40:43], a[52:55], v[20:23]
 ds_read_b128 a[28:31], v220 offset:26624
 v_mfma_f32_16x16x32_bf16 v[36:39], a[40:43], a[56:59], v[36:39]
 ds_read_b128 a[32:35], v220 offset:28672
 v_mfma_f32_16x16x32_bf16 v[52:55], a[40:43], a[60:63], v[52:55]
 ds_read_b64_tr_b16 a[4:5], v222 offset:49160
 buffer_load_dwordx4 v215, s[28:31], s46 offen offset:1024 nt lds
 v_mfma_f32_16x16x32_bf16 v[68:71], a[40:43], a[64:67], v[68:71]
 ds_read_b64_tr_b16 a[6:7], v222 offset:50184
 v_mfma_f32_16x16x32_bf16 v[84:87], a[40:43], a[68:71], v[84:87]
 ds_read_b64_tr_b16 a[8:9], v223 offset:49152
 v_mfma_f32_16x16x32_bf16 v[24:27], a[44:47], a[52:55], v[24:27]
 ds_read_b64_tr_b16 a[10:11], v223 offset:50176
 v_mfma_f32_16x16x32_bf16 v[40:43], a[44:47], a[56:59], v[40:43]
 ds_read_b64_tr_b16 a[12:13], v223 offset:49160
 v_mfma_f32_16x16x32_bf16 v[56:59], a[44:47], a[60:63], v[56:59]
 ds_read_b64_tr_b16 a[14:15], v223 offset:50184
 v_mfma_f32_16x16x32_bf16 v[72:75], a[44:47], a[64:67], v[72:75]
 v_mfma_f32_16x16x32_bf16 v[88:91], a[44:47], a[68:71], v[88:91]
 buffer_load_dwordx4 v216, s[28:31], s46 offen offset:2048 nt lds
 v_mfma_f32_16x16x32_bf16 v[28:31], a[48:51], a[52:55], v[28:31]
 v_mfma_f32_16x16x32_bf16 v[44:47], a[48:51], a[56:59], v[44:47]
 v_mfma_f32_16x16x32_bf16 v[60:63], a[48:51], a[60:63], v[60:63]
 v_mfma_f32_16x16x32_bf16 v[76:79], a[48:51], a[64:67], v[76:79]
 v_mfma_f32_16x16x32_bf16 v[92:95], a[48:51], a[68:71], v[92:95]
 s_waitcnt lgkmcnt(0)
 v_mfma_f32_16x16x32_bf16 v[16:19], a[0:3], a[16:19], v[16:19]
 ds_read_b64_tr_b16 a[36:37], v222 offset:57344
 v_mfma_f32_16x16x32_bf16 v[32:35], a[0:3], a[20:23], v[32:35]
 ds_read_b64_tr_b16 a[38:39], v222 offset:58368
 buffer_load_dwordx4 v217, s[28:31], s46 offen offset:3072 nt lds
 v_mfma_f32_16x16x32_bf16 v[48:51], a[0:3], a[24:27], v[48:51]
 ds_read_b128 a[52:55], v221 offset:20480
 v_mfma_f32_16x16x32_bf16 v[64:67], a[0:3], a[28:31], v[64:67]
 ds_read_b128 a[56:59], v221 offset:22528
 v_mfma_f32_16x16x32_bf16 v[80:83], a[0:3], a[32:35], v[80:83]
 ds_read_b128 a[60:63], v221 offset:24576
 v_mfma_f32_16x16x32_bf16 v[20:23], a[4:7], a[16:19], v[20:23]
 ds_read_b128 a[64:67], v221 offset:26624
 v_mfma_f32_16x16x32_bf16 v[36:39], a[4:7], a[20:23], v[36:39]
 ds_read_b128 a[68:71], v221 offset:28672
 v_mfma_f32_16x16x32_bf16 v[52:55], a[4:7], a[24:27], v[52:55]
 ds_read_b64_tr_b16 a[40:41], v222 offset:57352
 v_mfma_f32_16x16x32_bf16 v[68:71], a[4:7], a[28:31], v[68:71]
 ds_read_b64_tr_b16 a[42:43], v222 offset:58376
 s_add_u32 m0, s44, 147456
 s_mov_b32 s46, 32768
 buffer_load_dwordx4 v218, s[32:35], s46 offen offset:0 nt lds
 v_mfma_f32_16x16x32_bf16 v[84:87], a[4:7], a[32:35], v[84:87]
 ds_read_b64_tr_b16 a[44:45], v223 offset:57344
 v_mfma_f32_16x16x32_bf16 v[24:27], a[8:11], a[16:19], v[24:27]
 ds_read_b64_tr_b16 a[46:47], v223 offset:58368
 v_mfma_f32_16x16x32_bf16 v[40:43], a[8:11], a[20:23], v[40:43]
 ds_read_b64_tr_b16 a[48:49], v223 offset:57352
 v_mfma_f32_16x16x32_bf16 v[56:59], a[8:11], a[24:27], v[56:59]
 ds_read_b64_tr_b16 a[50:51], v223 offset:58376
 v_mfma_f32_16x16x32_bf16 v[72:75], a[8:11], a[28:31], v[72:75]
 v_mfma_f32_16x16x32_bf16 v[88:91], a[8:11], a[32:35], v[88:91]
 v_mfma_f32_16x16x32_bf16 v[28:31], a[12:15], a[16:19], v[28:31]
 buffer_load_dwordx4 v219, s[32:35], s46 offen offset:1024 nt lds
 v_mfma_f32_16x16x32_bf16 v[44:47], a[12:15], a[20:23], v[44:47]
 v_mfma_f32_16x16x32_bf16 v[60:63], a[12:15], a[24:27], v[60:63]
 v_mfma_f32_16x16x32_bf16 v[76:79], a[12:15], a[28:31], v[76:79]
 v_mfma_f32_16x16x32_bf16 v[92:95], a[12:15], a[32:35], v[92:95]
 s_waitcnt lgkmcnt(0)
 s_barrier
 v_mov_b32 v14, 0x3e0293ee
 v_xor_b32 v9, 2, v1
 v_add_u32 v12, 114688, v189
 v_add_u32 v13, 81920, v189
 v_lshl_add_u32 v10, v1, 13, v12
 v_lshl_add_u32 v11, v9, 13, v12
 v_lshl_add_u32 v12, v1, 11, v13
 v_lshl_add_u32 v13, v9, 11, v13
 v_mfma_f32_16x16x32_bf16 v[16:19], a[36:39], a[52:55], v[16:19]
 buffer_load_dwordx4 v218, s[32:35], s46 offen offset:2048 nt lds
 v_mfma_f32_16x16x32_bf16 v[20:23], a[40:43], a[52:55], v[20:23]
 buffer_load_dwordx4 v219, s[32:35], s46 offen offset:3072 nt lds
 v_mfma_f32_16x16x32_bf16 v[24:27], a[44:47], a[52:55], v[24:27]
 v_mfma_f32_16x16x32_bf16 v[28:31], a[48:51], a[52:55], v[28:31]
 v_mfma_f32_16x16x32_bf16 v[32:35], a[36:39], a[56:59], v[32:35]
 v_mfma_f32_16x16x32_bf16 v[36:39], a[40:43], a[56:59], v[36:39]
 v_mfma_f32_16x16x32_bf16 v[40:43], a[44:47], a[56:59], v[40:43]
 v_mfma_f32_16x16x32_bf16 v[44:47], a[48:51], a[56:59], v[44:47]
 v_mfma_f32_16x16x32_bf16 v[48:51], a[36:39], a[60:63], v[48:51]
 v_mfma_f32_16x16x32_bf16 v[52:55], a[40:43], a[60:63], v[52:55]
 v_mfma_f32_16x16x32_bf16 v[56:59], a[44:47], a[60:63], v[56:59]
 v_mfma_f32_16x16x32_bf16 v[60:63], a[48:51], a[60:63], v[60:63]
 v_mul_f32 v16, v14, v16
 v_mul_f32 v17, v14, v17
 v_mul_f32 v18, v14, v18
 v_mul_f32 v19, v14, v19
 v_mul_f32 v20, v14, v20
 v_mul_f32 v21, v14, v21
 v_mul_f32 v22, v14, v22
 v_mul_f32 v23, v14, v23
 v_mul_f32 v24, v14, v24
 v_mul_f32 v25, v14, v25
 v_mul_f32 v26, v14, v26
 v_mul_f32 v27, v14, v27
 v_mul_f32 v28, v14, v28
 v_mul_f32 v29, v14, v29
 v_mul_f32 v30, v14, v30
 v_mul_f32 v31, v14, v31
 v_cvt_pk_bf16_f32 v96, v16, v17
 v_cvt_pk_bf16_f32 v97, v18, v19
 v_cvt_pk_bf16_f32 v98, v20, v21
 v_cvt_pk_bf16_f32 v99, v22, v23
 v_cvt_pk_bf16_f32 v100, v24, v25
 v_cvt_pk_bf16_f32 v101, v26, v27
 v_cvt_pk_bf16_f32 v102, v28, v29
 v_cvt_pk_bf16_f32 v103, v30, v31
 ds_write_b128 v10, v[96:99] offset:0
 ds_write_b128 v10, v[100:103] offset:1024
 v_mfma_f32_16x16x32_bf16 v[64:67], a[36:39], a[64:67], v[64:67]
 v_mfma_f32_16x16x32_bf16 v[68:71], a[40:43], a[64:67], v[68:71]
 v_mfma_f32_16x16x32_bf16 v[72:75], a[44:47], a[64:67], v[72:75]
 v_mfma_f32_16x16x32_bf16 v[76:79], a[48:51], a[64:67], v[76:79]
 v_mul_f32 v32, v14, v32
 v_mul_f32 v33, v14, v33
 v_mul_f32 v34, v14, v34
 v_mul_f32 v35, v14, v35
 v_mul_f32 v36, v14, v36
 v_mul_f32 v37, v14, v37
 v_mul_f32 v38, v14, v38
 v_mul_f32 v39, v14, v39
 v_mul_f32 v40, v14, v40
 v_mul_f32 v41, v14, v41
 v_mul_f32 v42, v14, v42
 v_mul_f32 v43, v14, v43
 v_mul_f32 v44, v14, v44
 v_mul_f32 v45, v14, v45
 v_mul_f32 v46, v14, v46
 v_mul_f32 v47, v14, v47
 v_cvt_pk_bf16_f32 v104, v32, v33
 v_cvt_pk_bf16_f32 v105, v34, v35
 v_cvt_pk_bf16_f32 v106, v36, v37
 v_cvt_pk_bf16_f32 v107, v38, v39
 v_cvt_pk_bf16_f32 v108, v40, v41
 v_cvt_pk_bf16_f32 v109, v42, v43
 v_cvt_pk_bf16_f32 v110, v44, v45
 v_cvt_pk_bf16_f32 v111, v46, v47
 ds_write_b128 v10, v[104:107] offset:2048
 ds_write_b128 v10, v[108:111] offset:3072
 v_mfma_f32_16x16x32_bf16 v[80:83], a[36:39], a[68:71], v[80:83]
 v_mfma_f32_16x16x32_bf16 v[84:87], a[40:43], a[68:71], v[84:87]
 v_mfma_f32_16x16x32_bf16 v[88:91], a[44:47], a[68:71], v[88:91]
 v_mfma_f32_16x16x32_bf16 v[92:95], a[48:51], a[68:71], v[92:95]
 v_mul_f32 v48, v14, v48
 v_mul_f32 v49, v14, v49
 v_mul_f32 v50, v14, v50
 v_mul_f32 v51, v14, v51
 v_mul_f32 v52, v14, v52
 v_mul_f32 v53, v14, v53
 v_mul_f32 v54, v14, v54
 v_mul_f32 v55, v14, v55
 v_mul_f32 v56, v14, v56
 v_mul_f32 v57, v14, v57
 v_mul_f32 v58, v14, v58
 v_mul_f32 v59, v14, v59
 v_mul_f32 v60, v14, v60
 v_mul_f32 v61, v14, v61
 v_mul_f32 v62, v14, v62
 v_mul_f32 v63, v14, v63
 v_cvt_pk_bf16_f32 v112, v48, v49
 v_cvt_pk_bf16_f32 v113, v50, v51
 v_cvt_pk_bf16_f32 v114, v52, v53
 v_cvt_pk_bf16_f32 v115, v54, v55
 v_cvt_pk_bf16_f32 v116, v56, v57
 v_cvt_pk_bf16_f32 v117, v58, v59
 v_cvt_pk_bf16_f32 v118, v60, v61
 v_cvt_pk_bf16_f32 v119, v62, v63
 ds_write_b128 v10, v[112:115] offset:4096
 ds_write_b128 v10, v[116:119] offset:5120
 v_mul_f32 v64, v14, v64
 v_mul_f32 v65, v14, v65
 v_mul_f32 v66, v14, v66
 v_mul_f32 v67, v14, v67
 v_mul_f32 v68, v14, v68
 v_mul_f32 v69, v14, v69
 v_mul_f32 v70, v14, v70
 v_mul_f32 v71, v14, v71
 v_mul_f32 v72, v14, v72
 v_mul_f32 v73, v14, v73
 v_mul_f32 v74, v14, v74
 v_mul_f32 v75, v14, v75
 v_mul_f32 v76, v14, v76
 v_mul_f32 v77, v14, v77
 v_mul_f32 v78, v14, v78
 v_mul_f32 v79, v14, v79
 v_cvt_pk_bf16_f32 v120, v64, v65
 v_cvt_pk_bf16_f32 v121, v66, v67
 v_cvt_pk_bf16_f32 v122, v68, v69
 v_cvt_pk_bf16_f32 v123, v70, v71
 v_cvt_pk_bf16_f32 v124, v72, v73
 v_cvt_pk_bf16_f32 v125, v74, v75
 v_cvt_pk_bf16_f32 v126, v76, v77
 v_cvt_pk_bf16_f32 v127, v78, v79
 ds_write_b128 v10, v[120:123] offset:6144
 ds_write_b128 v10, v[124:127] offset:7168
 v_mul_f32 v80, v14, v80
 v_mul_f32 v81, v14, v81
 v_mul_f32 v82, v14, v82
 v_mul_f32 v83, v14, v83
 v_mul_f32 v84, v14, v84
 v_mul_f32 v85, v14, v85
 v_mul_f32 v86, v14, v86
 v_mul_f32 v87, v14, v87
 v_mul_f32 v88, v14, v88
 v_mul_f32 v89, v14, v89
 v_mul_f32 v90, v14, v90
 v_mul_f32 v91, v14, v91
 v_mul_f32 v92, v14, v92
 v_mul_f32 v93, v14, v93
 v_mul_f32 v94, v14, v94
 v_mul_f32 v95, v14, v95
 v_cvt_pk_bf16_f32 v128, v80, v81
 v_cvt_pk_bf16_f32 v129, v82, v83
 v_cvt_pk_bf16_f32 v130, v84, v85
 v_cvt_pk_bf16_f32 v131, v86, v87
 v_cvt_pk_bf16_f32 v132, v88, v89
 v_cvt_pk_bf16_f32 v133, v90, v91
 v_cvt_pk_bf16_f32 v134, v92, v93
 v_cvt_pk_bf16_f32 v135, v94, v95
 ds_write_b128 v12, v[128:131] offset:0
 ds_write_b128 v12, v[132:135] offset:1024
 v_accvgpr_write_b32 a160, v96
 v_accvgpr_write_b32 a161, v97
 v_accvgpr_write_b32 a162, v98
 v_accvgpr_write_b32 a163, v99
 v_accvgpr_write_b32 a164, v100
 v_accvgpr_write_b32 a165, v101
 v_accvgpr_write_b32 a166, v102
 v_accvgpr_write_b32 a167, v103
 v_accvgpr_write_b32 a176, v104
 v_accvgpr_write_b32 a177, v105
 v_accvgpr_write_b32 a178, v106
 v_accvgpr_write_b32 a179, v107
 v_accvgpr_write_b32 a180, v108
 v_accvgpr_write_b32 a181, v109
 v_accvgpr_write_b32 a182, v110
 v_accvgpr_write_b32 a183, v111
 v_accvgpr_write_b32 a192, v112
 v_accvgpr_write_b32 a193, v113
 v_accvgpr_write_b32 a194, v114
 v_accvgpr_write_b32 a195, v115
 v_accvgpr_write_b32 a196, v116
 v_accvgpr_write_b32 a197, v117
 v_accvgpr_write_b32 a198, v118
 v_accvgpr_write_b32 a199, v119
 v_accvgpr_write_b32 a208, v120
 v_accvgpr_write_b32 a209, v121
 v_accvgpr_write_b32 a210, v122
 v_accvgpr_write_b32 a211, v123
 v_accvgpr_write_b32 a212, v124
 v_accvgpr_write_b32 a213, v125
 v_accvgpr_write_b32 a214, v126
 v_accvgpr_write_b32 a215, v127
 v_accvgpr_write_b32 a224, v128
 v_accvgpr_write_b32 a225, v129
 v_accvgpr_write_b32 a226, v130
 v_accvgpr_write_b32 a227, v131
 v_accvgpr_write_b32 a228, v132
 v_accvgpr_write_b32 a229, v133
 v_accvgpr_write_b32 a230, v134
 v_accvgpr_write_b32 a231, v135
 s_waitcnt lgkmcnt(0)
 s_barrier
 ds_read_b128 a[240:243], v190 offset:0
 ds_read_b128 a[244:247], v191 offset:0
 ds_read_b128 a[248:251], v192 offset:0
 ds_read_b128 a[168:171], v11 offset:0
 ds_read_b128 a[172:175], v11 offset:1024
 ds_read_b128 a[184:187], v11 offset:2048
 ds_read_b128 a[188:191], v11 offset:3072
 ds_read_b128 a[200:203], v11 offset:4096
 ds_read_b128 a[204:207], v11 offset:5120
 ds_read_b128 a[216:219], v11 offset:6144
 ds_read_b128 a[220:223], v11 offset:7168
 ds_read_b128 a[232:235], v13 offset:0
 ds_read_b128 a[236:239], v13 offset:1024
 v_mov_b32 v14, 0
 global_load_dword v232, v14, s[16:17] sc1
 s_cmp_ge_u32 s2, 200
 s_cbranch_scc1 L_late
 s_waitcnt lgkmcnt(11)
 v_mfma_f32_16x16x32_bf16 v[16:19], a[240:243], a[160:163], v[136:139]
 v_accvgpr_write_b32 a0, 0
 v_accvgpr_write_b32 a1, 0
 v_mfma_f32_16x16x32_bf16 v[24:27], a[240:243], a[176:179], v[140:143]
 v_accvgpr_write_b32 a2, 0
 v_accvgpr_write_b32 a3, 0
 v_mfma_f32_16x16x32_bf16 v[32:35], a[240:243], a[192:195], v[144:147]
 v_accvgpr_write_b32 a4, 0
 v_accvgpr_write_b32 a5, 0
 v_mfma_f32_16x16x32_bf16 v[40:43], a[240:243], a[208:211], v[148:151]
 v_accvgpr_write_b32 a6, 0
 v_accvgpr_write_b32 a7, 0
 v_mfma_f32_16x16x32_bf16 v[48:51], a[240:243], a[224:227], v[152:155]
 v_accvgpr_write_b32 a8, 0
 v_accvgpr_write_b32 a9, 0
 v_mfma_f32_16x16x32_bf16 v[16:19], a[244:247], a[164:167], v[16:19]
 ds_read_b128 a[252:255], v193 offset:0
 v_accvgpr_write_b32 a10, 0
 v_accvgpr_write_b32 a11, 0
 v_mfma_f32_16x16x32_bf16 v[24:27], a[244:247], a[180:183], v[24:27]
 v_accvgpr_write_b32 a12, 0
 v_accvgpr_write_b32 a13, 0
 v_mfma_f32_16x16x32_bf16 v[32:35], a[244:247], a[196:199], v[32:35]
 v_accvgpr_write_b32 a14, 0
 v_accvgpr_write_b32 a15, 0
 v_mfma_f32_16x16x32_bf16 v[40:43], a[244:247], a[212:215], v[40:43]
 v_accvgpr_write_b32 a16, 0
 v_accvgpr_write_b32 a17, 0
 v_mfma_f32_16x16x32_bf16 v[48:51], a[244:247], a[228:231], v[48:51]
 v_accvgpr_write_b32 a18, 0
 v_accvgpr_write_b32 a19, 0
 s_waitcnt lgkmcnt(0)
 v_mfma_f32_16x16x32_bf16 v[16:19], a[248:251], a[168:171], v[16:19]
 v_accvgpr_write_b32 a20, 0
 v_accvgpr_write_b32 a21, 0
 v_mfma_f32_16x16x32_bf16 v[24:27], a[248:251], a[184:187], v[24:27]
 v_accvgpr_write_b32 a22, 0
 v_accvgpr_write_b32 a23, 0
 v_mfma_f32_16x16x32_bf16 v[32:35], a[248:251], a[200:203], v[32:35]
 v_accvgpr_write_b32 a24, 0
 v_accvgpr_write_b32 a25, 0
 v_mfma_f32_16x16x32_bf16 v[40:43], a[248:251], a[216:219], v[40:43]
 v_accvgpr_write_b32 a26, 0
 v_accvgpr_write_b32 a27, 0
 v_mfma_f32_16x16x32_bf16 v[48:51], a[248:251], a[232:235], v[48:51]
 v_accvgpr_write_b32 a28, 0
 v_accvgpr_write_b32 a29, 0
 v_mfma_f32_16x16x32_bf16 v[16:19], a[252:255], a[172:175], v[16:19]
 ds_read_b128 a[240:243], v190 offset:4096
 ds_read_b128 a[244:247], v191 offset:4096
 v_accvgpr_write_b32 a30, 0
 v_accvgpr_write_b32 a31, 0
 v_mfma_f32_16x16x32_bf16 v[24:27], a[252:255], a[188:191], v[24:27]
 v_accvgpr_write_b32 a32, 0
 v_accvgpr_write_b32 a33, 0
 v_mfma_f32_16x16x32_bf16 v[32:35], a[252:255], a[204:207], v[32:35]
 v_accvgpr_write_b32 a34, 0
 v_accvgpr_write_b32 a35, 0
 v_mfma_f32_16x16x32_bf16 v[40:43], a[252:255], a[220:223], v[40:43]
 v_accvgpr_write_b32 a36, 0
 v_accvgpr_write_b32 a37, 0
 v_mfma_f32_16x16x32_bf16 v[48:51], a[252:255], a[236:239], v[48:51]
 v_accvgpr_write_b32 a38, 0
 v_accvgpr_write_b32 a39, 0
 s_waitcnt lgkmcnt(0)
 v_mfma_f32_16x16x32_bf16 v[20:23], a[240:243], a[160:163], v[136:139]
 v_accvgpr_write_b32 a40, 0
 v_accvgpr_write_b32 a41, 0
 v_mfma_f32_16x16x32_bf16 v[28:31], a[240:243], a[176:179], v[140:143]
 v_accvgpr_write_b32 a42, 0
 v_accvgpr_write_b32 a43, 0
 v_mfma_f32_16x16x32_bf16 v[36:39], a[240:243], a[192:195], v[144:147]
 v_accvgpr_write_b32 a44, 0
 v_accvgpr_write_b32 a45, 0
 v_mfma_f32_16x16x32_bf16 v[44:47], a[240:243], a[208:211], v[148:151]
 v_accvgpr_write_b32 a46, 0
 v_accvgpr_write_b32 a47, 0
 v_mfma_f32_16x16x32_bf16 v[52:55], a[240:243], a[224:227], v[152:155]
 v_accvgpr_write_b32 a48, 0
 v_accvgpr_write_b32 a49, 0
 s_barrier
 v_mfma_f32_16x16x32_bf16 v[20:23], a[244:247], a[164:167], v[20:23]
 ds_read_b128 a[248:251], v192 offset:4096
 ds_read_b128 a[252:255], v193 offset:4096
 v_accvgpr_write_b32 a50, 0
 v_accvgpr_write_b32 a51, 0
 v_mfma_f32_16x16x32_bf16 v[28:31], a[244:247], a[180:183], v[28:31]
 v_accvgpr_write_b32 a52, 0
 v_accvgpr_write_b32 a53, 0
 v_mfma_f32_16x16x32_bf16 v[36:39], a[244:247], a[196:199], v[36:39]
 v_accvgpr_write_b32 a54, 0
 v_accvgpr_write_b32 a55, 0
 v_mfma_f32_16x16x32_bf16 v[44:47], a[244:247], a[212:215], v[44:47]
 v_accvgpr_write_b32 a56, 0
 v_accvgpr_write_b32 a57, 0
 v_mfma_f32_16x16x32_bf16 v[52:55], a[244:247], a[228:231], v[52:55]
 v_accvgpr_write_b32 a58, 0
 v_accvgpr_write_b32 a59, 0
 s_waitcnt lgkmcnt(0)
 v_mfma_f32_16x16x32_bf16 v[20:23], a[248:251], a[168:171], v[20:23]
 s_waitcnt vmcnt(7)
 s_add_u32 m0, s44, 131072
 s_mov_b32 s46, 65536
 buffer_load_dwordx4 v214, s[28:31], s46 offen offset:0 nt lds
 v_accvgpr_write_b32 a60, 0
 v_accvgpr_write_b32 a61, 0
 v_mfma_f32_16x16x32_bf16 v[28:31], a[248:251], a[184:187], v[28:31]
 v_accvgpr_write_b32 a62, 0
 v_accvgpr_write_b32 a63, 0
 v_mfma_f32_16x16x32_bf16 v[36:39], a[248:251], a[200:203], v[36:39]
 v_accvgpr_write_b32 a64, 0
 v_accvgpr_write_b32 a65, 0
 v_mfma_f32_16x16x32_bf16 v[44:47], a[248:251], a[216:219], v[44:47]
 v_accvgpr_write_b32 a66, 0
 v_accvgpr_write_b32 a67, 0
 v_mfma_f32_16x16x32_bf16 v[52:55], a[248:251], a[232:235], v[52:55]
 v_accvgpr_write_b32 a68, 0
 v_accvgpr_write_b32 a69, 0
 v_mfma_f32_16x16x32_bf16 v[20:23], a[252:255], a[172:175], v[20:23]
 v_accvgpr_write_b32 a70, 0
 v_accvgpr_write_b32 a71, 0
 v_mfma_f32_16x16x32_bf16 v[28:31], a[252:255], a[188:191], v[28:31]
 v_mfma_f32_16x16x32_bf16 v[36:39], a[252:255], a[204:207], v[36:39]
 v_mfma_f32_16x16x32_bf16 v[44:47], a[252:255], a[220:223], v[44:47]
 s_waitcnt vmcnt(7)
 v_mfma_f32_16x16x32_bf16 v[52:55], a[252:255], a[236:239], v[52:55]
 buffer_load_dwordx4 v215, s[28:31], s46 offen offset:1024 nt lds
 s_nop 1
 v_max3_f32 v220, v16, v17, v18
 v_max3_f32 v220, v220, v19, v20
 v_max3_f32 v220, v220, v21, v22
 v_max_f32 v220, v220, v23
 v_max3_f32 v221, v24, v25, v26
 v_max3_f32 v221, v221, v27, v28
 v_max3_f32 v221, v221, v29, v30
 v_max_f32 v221, v221, v31
 v_max3_f32 v222, v32, v33, v34
 v_max3_f32 v222, v222, v35, v36
 v_max3_f32 v222, v222, v37, v38
 v_max_f32 v222, v222, v39
 v_max3_f32 v223, v40, v41, v42
 v_max3_f32 v223, v223, v43, v44
 v_max3_f32 v223, v223, v45, v46
 v_max_f32 v223, v223, v47
 v_max3_f32 v224, v48, v49, v50
 v_max3_f32 v224, v224, v51, v52
 v_max3_f32 v224, v224, v53, v54
 v_max_f32 v224, v224, v55
 v_mov_b32 v225, v220
 v_mov_b32 v226, v221
 v_mov_b32 v227, v222
 v_mov_b32 v228, v223
 v_mov_b32 v229, v224
 s_nop 0
 v_permlane16_swap_b32 v220, v225
 v_permlane16_swap_b32 v221, v226
 v_permlane16_swap_b32 v222, v227
 v_permlane16_swap_b32 v223, v228
 v_permlane16_swap_b32 v224, v229
 v_max_f32 v220, v220, v225
 v_max_f32 v221, v221, v226
 v_max_f32 v222, v222, v227
 v_max_f32 v223, v223, v228
 v_max_f32 v224, v224, v229
 v_mov_b32 v225, v220
 v_mov_b32 v226, v221
 v_mov_b32 v227, v222
 v_mov_b32 v228, v223
 v_mov_b32 v229, v224
 s_nop 0
 v_permlane32_swap_b32 v220, v225
 v_permlane32_swap_b32 v221, v226
 v_permlane32_swap_b32 v222, v227
 v_permlane32_swap_b32 v223, v228
 v_permlane32_swap_b32 v224, v229
 v_max_f32 v220, v220, v225
 v_max_f32 v221, v221, v226
 v_max_f32 v222, v222, v227
 v_max_f32 v223, v223, v228
 v_max_f32 v224, v224, v229
 v_sub_f32 v136, 0xc1300000, v220
 v_mov_b32 v137, v136
 v_mov_b32 v138, v136
 v_mov_b32 v139, v136
 v_pk_add_f32 v[16:17], v[16:17], v[136:137]
 v_pk_add_f32 v[18:19], v[18:19], v[136:137]
 v_pk_add_f32 v[20:21], v[20:21], v[136:137]
 v_pk_add_f32 v[22:23], v[22:23], v[136:137]
 v_sub_f32 v140, 0xc1300000, v221
 v_mov_b32 v141, v140
 v_mov_b32 v142, v140
 v_mov_b32 v143, v140
 v_pk_add_f32 v[24:25], v[24:25], v[140:141]
 v_pk_add_f32 v[26:27], v[26:27], v[140:141]
 v_pk_add_f32 v[28:29], v[28:29], v[140:141]
 v_pk_add_f32 v[30:31], v[30:31], v[140:141]
 v_sub_f32 v144, 0xc1300000, v222
 v_mov_b32 v145, v144
 v_mov_b32 v146, v144
 v_mov_b32 v147, v144
 v_pk_add_f32 v[32:33], v[32:33], v[144:145]
 v_pk_add_f32 v[34:35], v[34:35], v[144:145]
 v_pk_add_f32 v[36:37], v[36:37], v[144:145]
 v_pk_add_f32 v[38:39], v[38:39], v[144:145]
 v_sub_f32 v148, 0xc1300000, v223
 v_mov_b32 v149, v148
 v_mov_b32 v150, v148
 v_mov_b32 v151, v148
 v_pk_add_f32 v[40:41], v[40:41], v[148:149]
 v_pk_add_f32 v[42:43], v[42:43], v[148:149]
 v_pk_add_f32 v[44:45], v[44:45], v[148:149]
 v_pk_add_f32 v[46:47], v[46:47], v[148:149]
 v_sub_f32 v152, 0xc1300000, v224
 v_mov_b32 v153, v152
 v_mov_b32 v154, v152
 v_mov_b32 v155, v152
 v_pk_add_f32 v[48:49], v[48:49], v[152:153]
 v_pk_add_f32 v[50:51], v[50:51], v[152:153]
 v_pk_add_f32 v[52:53], v[52:53], v[152:153]
 v_pk_add_f32 v[54:55], v[54:55], v[152:153]
 v_exp_f32 v176, v16
 v_exp_f32 v177, v17
 v_exp_f32 v178, v18
 v_cvt_pk_bf16_f32 v96, v176, v177
 v_exp_f32 v179, v19
 v_exp_f32 v180, v20
 v_exp_f32 v181, v21
 v_cvt_pk_bf16_f32 v97, v178, v179
 v_cvt_pk_bf16_f32 v98, v180, v181
 v_exp_f32 v182, v22
 v_or3_b32 v188, v96, v97, v98
 v_exp_f32 v183, v23
 s_waitcnt vmcnt(7)
 v_cvt_pk_bf16_f32 v99, v182, v183
 buffer_load_dwordx4 v216, s[28:31], s46 offen offset:2048 nt lds
 v_exp_f32 v176, v24
 v_exp_f32 v177, v25
 v_exp_f32 v178, v26
 v_cvt_pk_bf16_f32 v100, v176, v177
 v_or3_b32 v188, v188, v99, v100
 v_exp_f32 v179, v27
 v_exp_f32 v180, v28
 v_cvt_pk_bf16_f32 v101, v178, v179
 v_exp_f32 v181, v29
 s_waitcnt vmcnt(7)
 v_cvt_pk_bf16_f32 v102, v180, v181
 v_or3_b32 v188, v188, v101, v102
 buffer_load_dwordx4 v217, s[28:31], s46 offen offset:3072 nt lds
 v_exp_f32 v182, v30
 v_exp_f32 v183, v31
 v_exp_f32 v176, v32
 ds_read_b128 a[240:243], v190 offset:16384
 v_cvt_pk_bf16_f32 v103, v182, v183
 v_exp_f32 v177, v33
 v_exp_f32 v178, v34
 v_cvt_pk_bf16_f32 v104, v176, v177
 v_or3_b32 v188, v188, v103, v104
 v_exp_f32 v179, v35
 ds_read_b128 a[244:247], v191 offset:16384
 v_cvt_pk_bf16_f32 v105, v178, v179
 v_exp_f32 v180, v36
 s_waitcnt vmcnt(7)
 s_add_u32 m0, s44, 81920
 s_mov_b32 s46, 49152
 buffer_load_dwordx4 v218, s[32:35], s46 offen offset:0 nt lds
 ds_read_b128 a[248:251], v192 offset:16384
 v_exp_f32 v181, v37
 v_exp_f32 v182, v38
 v_exp_f32 v183, v39
 ds_read_b128 a[252:255], v193 offset:16384
 s_waitcnt lgkmcnt(2)
 v_mfma_f32_16x16x32_bf16 v[56:59], a[240:243], a[160:163], v[136:139]
 v_exp_f32 v176, v40
 v_mfma_f32_16x16x32_bf16 v[64:67], a[240:243], a[176:179], v[140:143]
 v_exp_f32 v177, v41
 v_mfma_f32_16x16x32_bf16 v[72:75], a[240:243], a[192:195], v[144:147]
 v_exp_f32 v178, v42
 v_mfma_f32_16x16x32_bf16 v[80:83], a[240:243], a[208:211], v[148:151]
 v_cvt_pk_bf16_f32 v106, v180, v181
 v_cvt_pk_bf16_f32 v107, v182, v183
 v_mfma_f32_16x16x32_bf16 v[88:91], a[240:243], a[224:227], v[152:155]
 v_exp_f32 v179, v43
 v_mfma_f32_16x16x32_bf16 v[56:59], a[244:247], a[164:167], v[56:59]
 ds_read_b128 a[240:243], v190 offset:20480
 s_waitcnt vmcnt(7)
 v_mfma_f32_16x16x32_bf16 v[64:67], a[244:247], a[180:183], v[64:67]
 buffer_load_dwordx4 v219, s[32:35], s46 offen offset:1024 nt lds
 v_mfma_f32_16x16x32_bf16 v[72:75], a[244:247], a[196:199], v[72:75]
 v_exp_f32 v180, v44
 v_mfma_f32_16x16x32_bf16 v[80:83], a[244:247], a[212:215], v[80:83]
 v_exp_f32 v181, v45
 v_mfma_f32_16x16x32_bf16 v[88:91], a[244:247], a[228:231], v[88:91]
 ds_read_b128 a[244:247], v191 offset:20480
 s_waitcnt lgkmcnt(2)
 v_mfma_f32_16x16x32_bf16 v[56:59], a[248:251], a[168:171], v[56:59]
 v_exp_f32 v182, v46
 v_mfma_f32_16x16x32_bf16 v[64:67], a[248:251], a[184:187], v[64:67]
 v_cvt_pk_bf16_f32 v108, v176, v177
 v_cvt_pk_bf16_f32 v109, v178, v179
 v_mfma_f32_16x16x32_bf16 v[72:75], a[248:251], a[200:203], v[72:75]
 v_exp_f32 v183, v47
 v_mfma_f32_16x16x32_bf16 v[80:83], a[248:251], a[216:219], v[80:83]
 v_exp_f32 v176, v48
 v_mfma_f32_16x16x32_bf16 v[88:91], a[248:251], a[232:235], v[88:91]
 ds_read_b128 a[248:251], v192 offset:20480
 v_cvt_pk_bf16_f32 v110, v180, v181
 v_mfma_f32_16x16x32_bf16 v[56:59], a[252:255], a[172:175], v[56:59]
 v_exp_f32 v177, v49
 v_mfma_f32_16x16x32_bf16 v[64:67], a[252:255], a[188:191], v[64:67]
 v_cvt_pk_bf16_f32 v111, v182, v183
 v_cvt_pk_bf16_f32 v112, v176, v177
 v_mfma_f32_16x16x32_bf16 v[72:75], a[252:255], a[204:207], v[72:75]
 v_exp_f32 v178, v50
 v_mfma_f32_16x16x32_bf16 v[80:83], a[252:255], a[220:223], v[80:83]
 s_waitcnt vmcnt(7)
 v_or3_b32 v188, v188, v105, v106
 v_mfma_f32_16x16x32_bf16 v[88:91], a[252:255], a[236:239], v[88:91]
 buffer_load_dwordx4 v218, s[32:35], s46 offen offset:2048 nt lds
 s_waitcnt lgkmcnt(1)
 v_mfma_f32_16x16x32_bf16 v[60:63], a[240:243], a[160:163], v[136:139]
 ds_read_b128 a[252:255], v193 offset:20480
 v_or3_b32 v188, v188, v107, v108
 v_mfma_f32_16x16x32_bf16 v[68:71], a[240:243], a[176:179], v[140:143]
 v_exp_f32 v179, v51
 v_mfma_f32_16x16x32_bf16 v[76:79], a[240:243], a[192:195], v[144:147]
 v_exp_f32 v180, v52
 v_mfma_f32_16x16x32_bf16 v[84:87], a[240:243], a[208:211], v[148:151]
 v_exp_f32 v181, v53
 v_mfma_f32_16x16x32_bf16 v[92:95], a[240:243], a[224:227], v[152:155]
 v_cvt_pk_bf16_f32 v113, v178, v179
 s_barrier
 v_mfma_f32_16x16x32_bf16 v[60:63], a[244:247], a[164:167], v[60:63]
 v_exp_f32 v182, v54
 v_mfma_f32_16x16x32_bf16 v[68:71], a[244:247], a[180:183], v[68:71]
 ds_read_b64_tr_b16 a[240:241], v198 offset:0
 ds_read_b64_tr_b16 a[242:243], v198 offset:4096
 v_mfma_f32_16x16x32_bf16 v[76:79], a[244:247], a[196:199], v[76:79]
 v_exp_f32 v183, v55
 v_mfma_f32_16x16x32_bf16 v[84:87], a[244:247], a[212:215], v[84:87]
 v_cvt_pk_bf16_f32 v114, v180, v181
 v_cvt_pk_bf16_f32 v115, v182, v183
 v_mfma_f32_16x16x32_bf16 v[92:95], a[244:247], a[228:231], v[92:95]
 ds_read_b64_tr_b16 a[244:245], v199 offset:0
 s_waitcnt lgkmcnt(3)
 v_mfma_f32_16x16x32_bf16 v[60:63], a[248:251], a[168:171], v[60:63]
 ds_read_b64_tr_b16 a[246:247], v199 offset:4096
 s_waitcnt vmcnt(6)
 v_mfma_f32_16x16x32_bf16 v[68:71], a[248:251], a[184:187], v[68:71]
 buffer_load_dwordx4 v219, s[32:35], s46 offen offset:3072 nt lds
 v_mfma_f32_16x16x32_bf16 v[76:79], a[248:251], a[200:203], v[76:79]
 v_or3_b32 v188, v188, v109, v110
 v_or3_b32 v188, v188, v111, v112
 v_mfma_f32_16x16x32_bf16 v[84:87], a[248:251], a[216:219], v[84:87]
 v_or3_b32 v188, v188, v113, v114
 v_bitop3_b32 v188, v188, v115, s45 bitop3:0xa8
 v_mfma_f32_16x16x32_bf16 v[92:95], a[248:251], a[232:235], v[92:95]
 ds_read_b64_tr_b16 a[248:249], v200 offset:0
 ds_read_b64_tr_b16 a[250:251], v200 offset:4096
 v_mfma_f32_16x16x32_bf16 v[60:63], a[252:255], a[172:175], v[60:63]
 v_cmp_ne_u32 vcc, 0, v188
 v_mfma_f32_16x16x32_bf16 v[68:71], a[252:255], a[188:191], v[68:71]
 v_mfma_f32_16x16x32_bf16 v[76:79], a[252:255], a[204:207], v[76:79]
 v_mfma_f32_16x16x32_bf16 v[84:87], a[252:255], a[220:223], v[84:87]
 v_mfma_f32_16x16x32_bf16 v[92:95], a[252:255], a[236:239], v[92:95]
 s_cbranch_vccnz L_rarea1
L_rarea1_back:
 v_mfma_f32_16x16x32_bf16 v[156:159], v[184:187], v[96:99], v[156:159]
 s_waitcnt vmcnt(6)
 s_add_u32 m0, s44, 0
 v_mfma_f32_16x16x32_bf16 v[160:163], v[184:187], v[100:103], v[160:163]
 v_exp_f32 v176, v56
 v_mfma_f32_16x16x32_bf16 v[164:167], v[184:187], v[104:107], v[164:167]
 s_mov_b32 s46, 81920
 v_mfma_f32_16x16x32_bf16 v[168:171], v[184:187], v[108:111], v[168:171]
 buffer_load_dwordx4 v214, s[28:31], s46 offen offset:0 nt lds
 v_mfma_f32_16x16x32_bf16 v[172:175], v[184:187], v[112:115], v[172:175]
 ds_read_b64_tr_b16 a[252:253], v201 offset:0
 s_waitcnt lgkmcnt(3)
 v_mfma_f32_16x16x32_bf16 a[0:3], a[240:243], v[96:99], a[0:3]
 v_exp_f32 v177, v57
 v_mfma_f32_16x16x32_bf16 a[4:7], a[240:243], v[100:103], a[4:7]
 ds_read_b64_tr_b16 a[254:255], v201 offset:4096
 v_cvt_pk_bf16_f32 v116, v176, v177
 v_mfma_f32_16x16x32_bf16 a[8:11], a[240:243], v[104:107], a[8:11]
 v_exp_f32 v178, v58
 v_mfma_f32_16x16x32_bf16 a[12:15], a[240:243], v[108:111], a[12:15]
 v_exp_f32 v179, v59
 v_mfma_f32_16x16x32_bf16 a[16:19], a[240:243], v[112:115], a[16:19]
 v_exp_f32 v180, v60
 v_mfma_f32_16x16x32_bf16 a[20:23], a[244:247], v[96:99], a[20:23]
 ds_read_b64_tr_b16 a[240:241], v202 offset:0
 ds_read_b64_tr_b16 a[242:243], v202 offset:4096
 v_mfma_f32_16x16x32_bf16 a[24:27], a[244:247], v[100:103], a[24:27]
 v_exp_f32 v181, v61
 v_mfma_f32_16x16x32_bf16 a[28:31], a[244:247], v[104:107], a[28:31]
 v_exp_f32 v182, v62
 v_mfma_f32_16x16x32_bf16 a[32:35], a[244:247], v[108:111], a[32:35]
 v_exp_f32 v183, v63
 v_mfma_f32_16x16x32_bf16 a[36:39], a[244:247], v[112:115], a[36:39]
 ds_read_b64_tr_b16 a[244:245], v203 offset:0
 s_waitcnt lgkmcnt(3)
 v_mfma_f32_16x16x32_bf16 a[40:43], a[248:251], v[96:99], a[40:43]
 ds_read_b64_tr_b16 a[246:247], v203 offset:4096
 s_waitcnt vmcnt(6)
 v_mfma_f32_16x16x32_bf16 a[44:47], a[248:251], v[100:103], a[44:47]
 buffer_load_dwordx4 v215, s[28:31], s46 offen offset:1024 nt lds
 v_mfma_f32_16x16x32_bf16 a[48:51], a[248:251], v[104:107], a[48:51]
 v_exp_f32 v176, v64
 v_mfma_f32_16x16x32_bf16 a[52:55], a[248:251], v[108:111], a[52:55]
 v_cvt_pk_bf16_f32 v117, v178, v179
 v_cvt_pk_bf16_f32 v118, v180, v181
 v_mfma_f32_16x16x32_bf16 a[56:59], a[248:251], v[112:115], a[56:59]
 v_exp_f32 v177, v65
 v_mfma_f32_16x16x32_bf16 a[60:63], a[252:255], v[96:99], a[60:63]
 ds_read_b64_tr_b16 a[248:249], v204 offset:0
 ds_read_b64_tr_b16 a[250:251], v204 offset:4096
 v_mfma_f32_16x16x32_bf16 a[64:67], a[252:255], v[100:103], a[64:67]
 v_exp_f32 v178, v66
 v_mfma_f32_16x16x32_bf16 a[68:71], a[252:255], v[104:107], a[68:71]
 v_exp_f32 v179, v67
 v_mfma_f32_16x16x32_bf16 a[72:75], a[252:255], v[108:111], a[72:75]
 v_exp_f32 v180, v68
 v_mfma_f32_16x16x32_bf16 a[76:79], a[252:255], v[112:115], a[76:79]
 v_cvt_pk_bf16_f32 v119, v182, v183
 s_waitcnt lgkmcnt(2)
 v_mfma_f32_16x16x32_bf16 a[80:83], a[240:243], v[96:99], a[80:83]
 ds_read_b64_tr_b16 a[252:253], v205 offset:0
 ds_read_b64_tr_b16 a[254:255], v205 offset:4096
 v_mfma_f32_16x16x32_bf16 a[84:87], a[240:243], v[100:103], a[84:87]
 v_exp_f32 v181, v69
 v_mfma_f32_16x16x32_bf16 a[88:91], a[240:243], v[104:107], a[88:91]
 v_exp_f32 v182, v70
 v_mfma_f32_16x16x32_bf16 a[92:95], a[240:243], v[108:111], a[92:95]
 v_cvt_pk_bf16_f32 v120, v176, v177
 s_waitcnt vmcnt(6)
 v_mfma_f32_16x16x32_bf16 a[96:99], a[240:243], v[112:115], a[96:99]
 buffer_load_dwordx4 v216, s[28:31], s46 offen offset:2048 nt lds
 v_mfma_f32_16x16x32_bf16 a[100:103], a[244:247], v[96:99], a[100:103]
 ds_read_b128 a[240:243], v190 offset:32768
 v_cvt_pk_bf16_f32 v121, v178, v179
 v_mfma_f32_16x16x32_bf16 a[104:107], a[244:247], v[100:103], a[104:107]
 v_exp_f32 v183, v71
 v_mfma_f32_16x16x32_bf16 a[108:111], a[244:247], v[104:107], a[108:111]
 v_exp_f32 v176, v72
 v_mfma_f32_16x16x32_bf16 a[112:115], a[244:247], v[108:111], a[112:115]
 v_exp_f32 v177, v73
 v_mfma_f32_16x16x32_bf16 a[116:119], a[244:247], v[112:115], a[116:119]
 ds_read_b128 a[244:247], v191 offset:32768
 s_waitcnt lgkmcnt(2)
 v_mfma_f32_16x16x32_bf16 a[120:123], a[248:251], v[96:99], a[120:123]
 v_exp_f32 v178, v74
 v_mfma_f32_16x16x32_bf16 a[124:127], a[248:251], v[100:103], a[124:127]
 v_cvt_pk_bf16_f32 v122, v180, v181
 v_cvt_pk_bf16_f32 v123, v182, v183
 v_mfma_f32_16x16x32_bf16 a[128:131], a[248:251], v[104:107], a[128:131]
 v_exp_f32 v179, v75
 v_mfma_f32_16x16x32_bf16 a[132:135], a[248:251], v[108:111], a[132:135]
 v_exp_f32 v180, v76
 v_mfma_f32_16x16x32_bf16 a[136:139], a[248:251], v[112:115], a[136:139]
 v_exp_f32 v181, v77
 v_mfma_f32_16x16x32_bf16 a[140:143], a[252:255], v[96:99], a[140:143]
 ds_read_b128 a[248:251], v192 offset:32768
 s_waitcnt vmcnt(6)
 v_mfma_f32_16x16x32_bf16 a[144:147], a[252:255], v[100:103], a[144:147]
 buffer_load_dwordx4 v217, s[28:31], s46 offen offset:3072 nt lds
 v_mfma_f32_16x16x32_bf16 a[148:151], a[252:255], v[104:107], a[148:151]
 v_exp_f32 v182, v78
 v_mfma_f32_16x16x32_bf16 a[152:155], a[252:255], v[108:111], a[152:155]
 v_cvt_pk_bf16_f32 v124, v176, v177
 v_cvt_pk_bf16_f32 v125, v178, v179
 v_mfma_f32_16x16x32_bf16 a[156:159], a[252:255], v[112:115], a[156:159]
 ds_read_b128 a[252:255], v193 offset:32768
 s_waitcnt lgkmcnt(2)
 v_mfma_f32_16x16x32_bf16 v[16:19], a[240:243], a[160:163], v[136:139]
 v_exp_f32 v183, v79
 v_mfma_f32_16x16x32_bf16 v[24:27], a[240:243], a[176:179], v[140:143]
 v_exp_f32 v176, v80
 v_mfma_f32_16x16x32_bf16 v[32:35], a[240:243], a[192:195], v[144:147]
 v_exp_f32 v177, v81
 v_mfma_f32_16x16x32_bf16 v[40:43], a[240:243], a[208:211], v[148:151]
 v_exp_f32 v178, v82
 v_mfma_f32_16x16x32_bf16 v[48:51], a[240:243], a[224:227], v[152:155]
 v_cvt_pk_bf16_f32 v126, v180, v181
 ds_read_b128 a[240:243], v190 offset:36864
 v_mfma_f32_16x16x32_bf16 v[16:19], a[244:247], a[164:167], v[16:19]
 v_exp_f32 v179, v83
 v_mfma_f32_16x16x32_bf16 v[24:27], a[244:247], a[180:183], v[24:27]
 v_exp_f32 v180, v84
 v_mfma_f32_16x16x32_bf16 v[32:35], a[244:247], a[196:199], v[32:35]
 v_cvt_pk_bf16_f32 v127, v182, v183
 s_waitcnt vmcnt(6)
 v_mfma_f32_16x16x32_bf16 v[40:43], a[244:247], a[212:215], v[40:43]
 s_add_u32 m0, s44, 114688
 s_mov_b32 s46, 65536
 v_mfma_f32_16x16x32_bf16 v[48:51], a[244:247], a[228:231], v[48:51]
 buffer_load_dwordx4 v218, s[32:35], s46 offen offset:0 nt lds
 s_waitcnt lgkmcnt(1)
 v_mfma_f32_16x16x32_bf16 v[16:19], a[248:251], a[168:171], v[16:19]
 ds_read_b128 a[244:247], v191 offset:36864
 v_cvt_pk_bf16_f32 v128, v176, v177
 v_mfma_f32_16x16x32_bf16 v[24:27], a[248:251], a[184:187], v[24:27]
 v_exp_f32 v181, v85
 v_mfma_f32_16x16x32_bf16 v[32:35], a[248:251], a[200:203], v[32:35]
 v_exp_f32 v182, v86
 v_mfma_f32_16x16x32_bf16 v[40:43], a[248:251], a[216:219], v[40:43]
 v_exp_f32 v183, v87
 v_mfma_f32_16x16x32_bf16 v[48:51], a[248:251], a[232:235], v[48:51]
 v_exp_f32 v176, v88
 v_mfma_f32_16x16x32_bf16 v[16:19], a[252:255], a[172:175], v[16:19]
 v_cvt_pk_bf16_f32 v129, v178, v179
 ds_read_b128 a[248:251], v192 offset:36864
 v_mfma_f32_16x16x32_bf16 v[24:27], a[252:255], a[188:191], v[24:27]
 v_exp_f32 v177, v89
 v_mfma_f32_16x16x32_bf16 v[32:35], a[252:255], a[204:207], v[32:35]
 v_exp_f32 v178, v90
 v_mfma_f32_16x16x32_bf16 v[40:43], a[252:255], a[220:223], v[40:43]
 v_cvt_pk_bf16_f32 v130, v180, v181
 v_cvt_pk_bf16_f32 v131, v182, v183
 v_mfma_f32_16x16x32_bf16 v[48:51], a[252:255], a[236:239], v[48:51]
 ds_read_b128 a[252:255], v193 offset:36864
 s_waitcnt lgkmcnt(2)
 v_mfma_f32_16x16x32_bf16 v[20:23], a[240:243], a[160:163], v[136:139]
 v_exp_f32 v179, v91
 v_mfma_f32_16x16x32_bf16 v[28:31], a[240:243], a[176:179], v[140:143]
 s_waitcnt vmcnt(6)
 buffer_load_dwordx4 v219, s[32:35], s46 offen offset:1024 nt lds
 v_mfma_f32_16x16x32_bf16 v[36:39], a[240:243], a[192:195], v[144:147]
 v_exp_f32 v180, v92
 v_mfma_f32_16x16x32_bf16 v[44:47], a[240:243], a[208:211], v[148:151]
 v_exp_f32 v181, v93
 v_mfma_f32_16x16x32_bf16 v[52:55], a[240:243], a[224:227], v[152:155]
 v_cvt_pk_bf16_f32 v132, v176, v177
 s_barrier
 v_mfma_f32_16x16x32_bf16 v[20:23], a[244:247], a[164:167], v[20:23]
 v_exp_f32 v182, v94
 v_mfma_f32_16x16x32_bf16 v[28:31], a[244:247], a[180:183], v[28:31]
 ds_read_b64_tr_b16 a[240:241], v198 offset:32768
 ds_read_b64_tr_b16 a[242:243], v198 offset:36864
 v_mfma_f32_16x16x32_bf16 v[36:39], a[244:247], a[196:199], v[36:39]
 v_exp_f32 v183, v95
 v_mfma_f32_16x16x32_bf16 v[44:47], a[244:247], a[212:215], v[44:47]
 v_cvt_pk_bf16_f32 v133, v178, v179
 v_cvt_pk_bf16_f32 v134, v180, v181
 v_mfma_f32_16x16x32_bf16 v[52:55], a[244:247], a[228:231], v[52:55]
 ds_read_b64_tr_b16 a[244:245], v199 offset:32768
 s_waitcnt lgkmcnt(3)
 v_mfma_f32_16x16x32_bf16 v[20:23], a[248:251], a[168:171], v[20:23]
 ds_read_b64_tr_b16 a[246:247], v199 offset:36864
 v_cvt_pk_bf16_f32 v135, v182, v183
 v_mfma_f32_16x16x32_bf16 v[28:31], a[248:251], a[184:187], v[28:31]
 v_or3_b32 v188, v116, v117, v118
 v_or3_b32 v188, v188, v119, v120
 v_mfma_f32_16x16x32_bf16 v[36:39], a[248:251], a[200:203], v[36:39]
 s_waitcnt vmcnt(6)
 v_or3_b32 v188, v188, v121, v122
 v_mfma_f32_16x16x32_bf16 v[44:47], a[248:251], a[216:219], v[44:47]
 buffer_load_dwordx4 v218, s[32:35], s46 offen offset:2048 nt lds
 v_mfma_f32_16x16x32_bf16 v[52:55], a[248:251], a[232:235], v[52:55]
 ds_read_b64_tr_b16 a[248:249], v200 offset:32768
 ds_read_b64_tr_b16 a[250:251], v200 offset:36864
 v_mfma_f32_16x16x32_bf16 v[20:23], a[252:255], a[172:175], v[20:23]
 v_or3_b32 v188, v188, v123, v124
 v_or3_b32 v188, v188, v125, v126
 v_mfma_f32_16x16x32_bf16 v[28:31], a[252:255], a[188:191], v[28:31]
 v_or3_b32 v188, v188, v127, v128
 v_or3_b32 v188, v188, v129, v130
 v_mfma_f32_16x16x32_bf16 v[36:39], a[252:255], a[204:207], v[36:39]
 v_or3_b32 v188, v188, v131, v132
 v_or3_b32 v188, v188, v133, v134
 v_mfma_f32_16x16x32_bf16 v[44:47], a[252:255], a[220:223], v[44:47]
 v_bitop3_b32 v188, v188, v135, s45 bitop3:0xa8
 v_cmp_ne_u32 vcc, 0, v188
 v_mfma_f32_16x16x32_bf16 v[52:55], a[252:255], a[236:239], v[52:55]
 s_cbranch_vccnz L_rarea2
L_rarea2_back:
 v_mfma_f32_16x16x32_bf16 v[156:159], v[184:187], v[116:119], v[156:159]
 v_mfma_f32_16x16x32_bf16 v[160:163], v[184:187], v[120:123], v[160:163]
 v_exp_f32 v176, v16
 v_mfma_f32_16x16x32_bf16 v[164:167], v[184:187], v[124:127], v[164:167]
 v_exp_f32 v177, v17
 v_mfma_f32_16x16x32_bf16 v[168:171], v[184:187], v[128:131], v[168:171]
 v_exp_f32 v178, v18
 v_mfma_f32_16x16x32_bf16 v[172:175], v[184:187], v[132:135], v[172:175]
 ds_read_b64_tr_b16 a[252:253], v201 offset:32768
 s_waitcnt lgkmcnt(3)
 v_mfma_f32_16x16x32_bf16 a[0:3], a[240:243], v[116:119], a[0:3]
 ds_read_b64_tr_b16 a[254:255], v201 offset:36864
 s_waitcnt vmcnt(6)
 v_mfma_f32_16x16x32_bf16 a[4:7], a[240:243], v[120:123], a[4:7]
 buffer_load_dwordx4 v219, s[32:35], s46 offen offset:3072 nt lds
 v_mfma_f32_16x16x32_bf16 a[8:11], a[240:243], v[124:127], a[8:11]
 v_exp_f32 v179, v19
 v_mfma_f32_16x16x32_bf16 a[12:15], a[240:243], v[128:131], a[12:15]
 v_exp_f32 v180, v20
 v_mfma_f32_16x16x32_bf16 a[16:19], a[240:243], v[132:135], a[16:19]
 v_exp_f32 v181, v21
 v_mfma_f32_16x16x32_bf16 a[20:23], a[244:247], v[116:119], a[20:23]
 ds_read_b64_tr_b16 a[240:241], v202 offset:32768
 ds_read_b64_tr_b16 a[242:243], v202 offset:36864
 v_mfma_f32_16x16x32_bf16 a[24:27], a[244:247], v[120:123], a[24:27]
 v_exp_f32 v182, v22
 v_mfma_f32_16x16x32_bf16 a[28:31], a[244:247], v[124:127], a[28:31]
 v_cvt_pk_bf16_f32 v96, v176, v177
 v_cvt_pk_bf16_f32 v97, v178, v179
 v_mfma_f32_16x16x32_bf16 a[32:35], a[244:247], v[128:131], a[32:35]
 v_exp_f32 v183, v23
 v_mfma_f32_16x16x32_bf16 a[36:39], a[244:247], v[132:135], a[36:39]
 ds_read_b64_tr_b16 a[244:245], v203 offset:32768
 s_waitcnt lgkmcnt(3)
 v_mfma_f32_16x16x32_bf16 a[40:43], a[248:251], v[116:119], a[40:43]
 ds_read_b64_tr_b16 a[246:247], v203 offset:36864
 v_cvt_pk_bf16_f32 v98, v180, v181
 v_mfma_f32_16x16x32_bf16 a[44:47], a[248:251], v[120:123], a[44:47]
 v_exp_f32 v176, v24
 v_mfma_f32_16x16x32_bf16 a[48:51], a[248:251], v[124:127], a[48:51]
 v_exp_f32 v177, v25
 v_mfma_f32_16x16x32_bf16 a[52:55], a[248:251], v[128:131], a[52:55]
 s_waitcnt vmcnt(6)
 s_add_u32 m0, s44, 16384
 s_mov_b32 s46, 98304
 buffer_load_dwordx4 v214, s[28:31], s46 offen offset:0 nt lds
 v_mfma_f32_16x16x32_bf16 a[56:59], a[248:251], v[132:135], a[56:59]
 v_exp_f32 v178, v26
 v_mfma_f32_16x16x32_bf16 a[60:63], a[252:255], v[116:119], a[60:63]
 ds_read_b64_tr_b16 a[248:249], v204 offset:32768
 ds_read_b64_tr_b16 a[250:251], v204 offset:36864
 v_mfma_f32_16x16x32_bf16 a[64:67], a[252:255], v[120:123], a[64:67]
 v_exp_f32 v179, v27
 v_mfma_f32_16x16x32_bf16 a[68:71], a[252:255], v[124:127], a[68:71]
 v_exp_f32 v180, v28
 v_mfma_f32_16x16x32_bf16 a[72:75], a[252:255], v[128:131], a[72:75]
 v_cvt_pk_bf16_f32 v99, v182, v183
 v_cvt_pk_bf16_f32 v100, v176, v177
 v_mfma_f32_16x16x32_bf16 a[76:79], a[252:255], v[132:135], a[76:79]
 ds_read_b64_tr_b16 a[252:253], v205 offset:32768
 s_waitcnt lgkmcnt(3)
 v_mfma_f32_16x16x32_bf16 a[80:83], a[240:243], v[116:119], a[80:83]
 ds_read_b64_tr_b16 a[254:255], v205 offset:36864
 v_cvt_pk_bf16_f32 v101, v178, v179
 v_mfma_f32_16x16x32_bf16 a[84:87], a[240:243], v[120:123], a[84:87]
 v_exp_f32 v181, v29
 v_mfma_f32_16x16x32_bf16 a[88:91], a[240:243], v[124:127], a[88:91]
 v_exp_f32 v182, v30
 v_mfma_f32_16x16x32_bf16 a[92:95], a[240:243], v[128:131], a[92:95]
 v_exp_f32 v183, v31
 v_mfma_f32_16x16x32_bf16 a[96:99], a[240:243], v[132:135], a[96:99]
 v_exp_f32 v176, v32
 v_mfma_f32_16x16x32_bf16 a[100:103], a[244:247], v[116:119], a[100:103]
 ds_read_b128 a[240:243], v190 offset:49152
 s_waitcnt vmcnt(6)
 v_mfma_f32_16x16x32_bf16 a[104:107], a[244:247], v[120:123], a[104:107]
 buffer_load_dwordx4 v215, s[28:31], s46 offen offset:1024 nt lds
 v_mfma_f32_16x16x32_bf16 a[108:111], a[244:247], v[124:127], a[108:111]
 v_exp_f32 v177, v33
 v_mfma_f32_16x16x32_bf16 a[112:115], a[244:247], v[128:131], a[112:115]
 v_exp_f32 v178, v34
 v_mfma_f32_16x16x32_bf16 a[116:119], a[244:247], v[132:135], a[116:119]
 v_cvt_pk_bf16_f32 v102, v180, v181
 s_waitcnt lgkmcnt(1)
 v_mfma_f32_16x16x32_bf16 a[120:123], a[248:251], v[116:119], a[120:123]
 ds_read_b128 a[244:247], v191 offset:49152
 v_cvt_pk_bf16_f32 v103, v182, v183
 v_mfma_f32_16x16x32_bf16 a[124:127], a[248:251], v[120:123], a[124:127]
 v_exp_f32 v179, v35
 v_mfma_f32_16x16x32_bf16 a[128:131], a[248:251], v[124:127], a[128:131]
 v_exp_f32 v180, v36
 v_mfma_f32_16x16x32_bf16 a[132:135], a[248:251], v[128:131], a[132:135]
 v_exp_f32 v181, v37
 v_mfma_f32_16x16x32_bf16 a[136:139], a[248:251], v[132:135], a[136:139]
 v_exp_f32 v182, v38
 v_mfma_f32_16x16x32_bf16 a[140:143], a[252:255], v[116:119], a[140:143]
 v_cvt_pk_bf16_f32 v104, v176, v177
 ds_read_b128 a[248:251], v192 offset:49152
 v_mfma_f32_16x16x32_bf16 a[144:147], a[252:255], v[120:123], a[144:147]
 v_exp_f32 v183, v39
 v_mfma_f32_16x16x32_bf16 a[148:151], a[252:255], v[124:127], a[148:151]
 s_waitcnt vmcnt(6)
 v_cvt_pk_bf16_f32 v105, v178, v179
 v_mfma_f32_16x16x32_bf16 a[152:155], a[252:255], v[128:131], a[152:155]
 buffer_load_dwordx4 v216, s[28:31], s46 offen offset:2048 nt lds
 v_mfma_f32_16x16x32_bf16 a[156:159], a[252:255], v[132:135], a[156:159]
 ds_read_b128 a[252:255], v193 offset:49152
 s_waitcnt lgkmcnt(2)
 v_mfma_f32_16x16x32_bf16 v[56:59], a[240:243], a[160:163], v[136:139]
 v_exp_f32 v176, v40
 v_mfma_f32_16x16x32_bf16 v[64:67], a[240:243], a[176:179], v[140:143]
 v_exp_f32 v177, v41
 v_mfma_f32_16x16x32_bf16 v[72:75], a[240:243], a[192:195], v[144:147]
 v_exp_f32 v178, v42
 v_mfma_f32_16x16x32_bf16 v[80:83], a[240:243], a[208:211], v[148:151]
 v_cvt_pk_bf16_f32 v106, v180, v181
 v_cvt_pk_bf16_f32 v107, v182, v183
 v_mfma_f32_16x16x32_bf16 v[88:91], a[240:243], a[224:227], v[152:155]
 v_exp_f32 v179, v43
 v_mfma_f32_16x16x32_bf16 v[56:59], a[244:247], a[164:167], v[56:59]
 ds_read_b128 a[240:243], v190 offset:53248
 v_cvt_pk_bf16_f32 v108, v176, v177
 v_mfma_f32_16x16x32_bf16 v[64:67], a[244:247], a[180:183], v[64:67]
 v_exp_f32 v180, v44
 v_mfma_f32_16x16x32_bf16 v[72:75], a[244:247], a[196:199], v[72:75]
 v_cvt_pk_bf16_f32 v109, v178, v179
 s_waitcnt vmcnt(6)
 v_mfma_f32_16x16x32_bf16 v[80:83], a[244:247], a[212:215], v[80:83]
 buffer_load_dwordx4 v217, s[28:31], s46 offen offset:3072 nt lds
 v_mfma_f32_16x16x32_bf16 v[88:91], a[244:247], a[228:231], v[88:91]
 ds_read_b128 a[244:247], v191 offset:53248
 s_waitcnt lgkmcnt(2)
 v_mfma_f32_16x16x32_bf16 v[56:59], a[248:251], a[168:171], v[56:59]
 v_exp_f32 v181, v45
 v_mfma_f32_16x16x32_bf16 v[64:67], a[248:251], a[184:187], v[64:67]
 v_exp_f32 v182, v46
 v_mfma_f32_16x16x32_bf16 v[72:75], a[248:251], a[200:203], v[72:75]
 v_exp_f32 v183, v47
 v_mfma_f32_16x16x32_bf16 v[80:83], a[248:251], a[216:219], v[80:83]
 v_exp_f32 v176, v48
 v_mfma_f32_16x16x32_bf16 v[88:91], a[248:251], a[232:235], v[88:91]
 ds_read_b128 a[248:251], v192 offset:53248
 v_cvt_pk_bf16_f32 v110, v180, v181
 v_mfma_f32_16x16x32_bf16 v[56:59], a[252:255], a[172:175], v[56:59]
 v_exp_f32 v177, v49
 v_mfma_f32_16x16x32_bf16 v[64:67], a[252:255], a[188:191], v[64:67]
 v_cvt_pk_bf16_f32 v111, v182, v183
 v_cvt_pk_bf16_f32 v112, v176, v177
 v_mfma_f32_16x16x32_bf16 v[72:75], a[252:255], a[204:207], v[72:75]
 v_exp_f32 v178, v50
 v_mfma_f32_16x16x32_bf16 v[80:83], a[252:255], a[220:223], v[80:83]
 v_or3_b32 v188, v96, v97, v98
 v_or3_b32 v188, v188, v99, v100
 v_mfma_f32_16x16x32_bf16 v[88:91], a[252:255], a[236:239], v[88:91]
 ds_read_b128 a[252:255], v193 offset:53248
 s_waitcnt lgkmcnt(2)
 v_mfma_f32_16x16x32_bf16 v[60:63], a[240:243], a[160:163], v[136:139]
 v_exp_f32 v179, v51
 v_mfma_f32_16x16x32_bf16 v[68:71], a[240:243], a[176:179], v[140:143]
 v_exp_f32 v180, v52
 v_mfma_f32_16x16x32_bf16 v[76:79], a[240:243], a[192:195], v[144:147]
 s_waitcnt vmcnt(6)
 s_add_u32 m0, s44, 65536
 v_mfma_f32_16x16x32_bf16 v[84:87], a[240:243], a[208:211], v[148:151]
 s_mov_b32 s46, 81920
 buffer_load_dwordx4 v218, s[32:35], s46 offen offset:0 nt lds
 v_mfma_f32_16x16x32_bf16 v[92:95], a[240:243], a[224:227], v[152:155]
 v_cvt_pk_bf16_f32 v113, v178, v179
 s_barrier
 v_mfma_f32_16x16x32_bf16 v[60:63], a[244:247], a[164:167], v[60:63]
 v_exp_f32 v181, v53
 v_mfma_f32_16x16x32_bf16 v[68:71], a[244:247], a[180:183], v[68:71]
 ds_read_b64_tr_b16 a[240:241], v206 offset:0
 ds_read_b64_tr_b16 a[242:243], v206 offset:4096
 v_mfma_f32_16x16x32_bf16 v[76:79], a[244:247], a[196:199], v[76:79]
 v_exp_f32 v182, v54
 v_mfma_f32_16x16x32_bf16 v[84:87], a[244:247], a[212:215], v[84:87]
 v_exp_f32 v183, v55
 v_mfma_f32_16x16x32_bf16 v[92:95], a[244:247], a[228:231], v[92:95]
 ds_read_b64_tr_b16 a[244:245], v207 offset:0
 s_waitcnt lgkmcnt(3)
 v_mfma_f32_16x16x32_bf16 v[60:63], a[248:251], a[168:171], v[60:63]
 ds_read_b64_tr_b16 a[246:247], v207 offset:4096
 v_cvt_pk_bf16_f32 v114, v180, v181
 v_mfma_f32_16x16x32_bf16 v[68:71], a[248:251], a[184:187], v[68:71]
 v_cvt_pk_bf16_f32 v115, v182, v183
 v_or3_b32 v188, v188, v101, v102
 v_mfma_f32_16x16x32_bf16 v[76:79], a[248:251], a[200:203], v[76:79]
 v_or3_b32 v188, v188, v103, v104
 v_or3_b32 v188, v188, v105, v106
 v_mfma_f32_16x16x32_bf16 v[84:87], a[248:251], a[216:219], v[84:87]
 s_waitcnt vmcnt(6)
 v_or3_b32 v188, v188, v107, v108
 v_mfma_f32_16x16x32_bf16 v[92:95], a[248:251], a[232:235], v[92:95]
 buffer_load_dwordx4 v219, s[32:35], s46 offen offset:1024 nt lds
 v_mfma_f32_16x16x32_bf16 v[60:63], a[252:255], a[172:175], v[60:63]
 ds_read_b64_tr_b16 a[248:249], v208 offset:0
 ds_read_b64_tr_b16 a[250:251], v208 offset:4096
 v_mfma_f32_16x16x32_bf16 v[68:71], a[252:255], a[188:191], v[68:71]
 v_or3_b32 v188, v188, v109, v110
 v_or3_b32 v188, v188, v111, v112
 v_mfma_f32_16x16x32_bf16 v[76:79], a[252:255], a[204:207], v[76:79]
 v_or3_b32 v188, v188, v113, v114
 v_bitop3_b32 v188, v188, v115, s45 bitop3:0xa8
 v_mfma_f32_16x16x32_bf16 v[84:87], a[252:255], a[220:223], v[84:87]
 v_cmp_ne_u32 vcc, 0, v188
 v_mfma_f32_16x16x32_bf16 v[92:95], a[252:255], a[236:239], v[92:95]
 s_cbranch_vccnz L_rarea3
L_rarea3_back:
 v_mfma_f32_16x16x32_bf16 v[156:159], v[184:187], v[96:99], v[156:159]
 v_mfma_f32_16x16x32_bf16 v[160:163], v[184:187], v[100:103], v[160:163]
 v_exp_f32 v176, v56
 v_mfma_f32_16x16x32_bf16 v[164:167], v[184:187], v[104:107], v[164:167]
 v_exp_f32 v177, v57
 v_mfma_f32_16x16x32_bf16 v[168:171], v[184:187], v[108:111], v[168:171]
 v_exp_f32 v178, v58
 v_mfma_f32_16x16x32_bf16 v[172:175], v[184:187], v[112:115], v[172:175]
 ds_read_b64_tr_b16 a[252:253], v209 offset:0
 s_waitcnt lgkmcnt(3)
 v_mfma_f32_16x16x32_bf16 a[0:3], a[240:243], v[96:99], a[0:3]
 ds_read_b64_tr_b16 a[254:255], v209 offset:4096
 v_cvt_pk_bf16_f32 v116, v176, v177
 v_mfma_f32_16x16x32_bf16 a[4:7], a[240:243], v[100:103], a[4:7]
 v_exp_f32 v179, v59
 v_mfma_f32_16x16x32_bf16 a[8:11], a[240:243], v[104:107], a[8:11]
 v_exp_f32 v180, v60
 v_mfma_f32_16x16x32_bf16 a[12:15], a[240:243], v[108:111], a[12:15]
 s_waitcnt vmcnt(6)
 buffer_load_dwordx4 v218, s[32:35], s46 offen offset:2048 nt lds
 v_mfma_f32_16x16x32_bf16 a[16:19], a[240:243], v[112:115], a[16:19]
 v_exp_f32 v181, v61
 v_mfma_f32_16x16x32_bf16 a[20:23], a[244:247], v[96:99], a[20:23]
 ds_read_b64_tr_b16 a[240:241], v210 offset:0
 ds_read_b64_tr_b16 a[242:243], v210 offset:4096
 v_mfma_f32_16x16x32_bf16 a[24:27], a[244:247], v[100:103], a[24:27]
 v_exp_f32 v182, v62
 v_mfma_f32_16x16x32_bf16 a[28:31], a[244:247], v[104:107], a[28:31]
 v_exp_f32 v183, v63
 v_mfma_f32_16x16x32_bf16 a[32:35], a[244:247], v[108:111], a[32:35]
 v_exp_f32 v176, v64
 v_mfma_f32_16x16x32_bf16 a[36:39], a[244:247], v[112:115], a[36:39]
 v_cvt_pk_bf16_f32 v117, v178, v179
 s_waitcnt lgkmcnt(2)
 v_mfma_f32_16x16x32_bf16 a[40:43], a[248:251], v[96:99], a[40:43]
 ds_read_b64_tr_b16 a[244:245], v211 offset:0
 ds_read_b64_tr_b16 a[246:247], v211 offset:4096
 v_mfma_f32_16x16x32_bf16 a[44:47], a[248:251], v[100:103], a[44:47]
 v_exp_f32 v177, v65
 v_mfma_f32_16x16x32_bf16 a[48:51], a[248:251], v[104:107], a[48:51]
 v_exp_f32 v178, v66
 v_mfma_f32_16x16x32_bf16 a[52:55], a[248:251], v[108:111], a[52:55]
 v_cvt_pk_bf16_f32 v118, v180, v181
 s_waitcnt vmcnt(6)
 v_mfma_f32_16x16x32_bf16 a[56:59], a[248:251], v[112:115], a[56:59]
 buffer_load_dwordx4 v219, s[32:35], s46 offen offset:3072 nt lds
 v_mfma_f32_16x16x32_bf16 a[60:63], a[252:255], v[96:99], a[60:63]
 ds_read_b64_tr_b16 a[248:249], v212 offset:0
 ds_read_b64_tr_b16 a[250:251], v212 offset:4096
 v_mfma_f32_16x16x32_bf16 a[64:67], a[252:255], v[100:103], a[64:67]
 v_exp_f32 v179, v67
 v_mfma_f32_16x16x32_bf16 a[68:71], a[252:255], v[104:107], a[68:71]
 v_exp_f32 v180, v68
 v_mfma_f32_16x16x32_bf16 a[72:75], a[252:255], v[108:111], a[72:75]
 v_cvt_pk_bf16_f32 v119, v182, v183
 v_cvt_pk_bf16_f32 v120, v176, v177
 v_mfma_f32_16x16x32_bf16 a[76:79], a[252:255], v[112:115], a[76:79]
 ds_read_b64_tr_b16 a[252:253], v213 offset:0
 s_waitcnt lgkmcnt(3)
 v_mfma_f32_16x16x32_bf16 a[80:83], a[240:243], v[96:99], a[80:83]
 ds_read_b64_tr_b16 a[254:255], v213 offset:4096
 v_cvt_pk_bf16_f32 v121, v178, v179
 v_mfma_f32_16x16x32_bf16 a[84:87], a[240:243], v[100:103], a[84:87]
 v_exp_f32 v181, v69
 v_mfma_f32_16x16x32_bf16 a[88:91], a[240:243], v[104:107], a[88:91]
 v_exp_f32 v182, v70
 v_mfma_f32_16x16x32_bf16 a[92:95], a[240:243], v[108:111], a[92:95]
 v_exp_f32 v183, v71
 v_mfma_f32_16x16x32_bf16 a[96:99], a[240:243], v[112:115], a[96:99]
 v_exp_f32 v176, v72
 v_mfma_f32_16x16x32_bf16 a[100:103], a[244:247], v[96:99], a[100:103]
 ds_read_b128 a[240:243], v194 offset:0
 v_cvt_pk_bf16_f32 v122, v180, v181
 v_mfma_f32_16x16x32_bf16 a[104:107], a[244:247], v[100:103], a[104:107]
 v_exp_f32 v177, v73
 v_mfma_f32_16x16x32_bf16 a[108:111], a[244:247], v[104:107], a[108:111]
 v_exp_f32 v178, v74
 v_mfma_f32_16x16x32_bf16 a[112:115], a[244:247], v[108:111], a[112:115]
 s_waitcnt vmcnt(6)
 s_add_u32 m0, s44, 32768
 s_mov_b32 s46, 114688
 buffer_load_dwordx4 v214, s[28:31], s46 offen offset:0 nt lds
 v_mfma_f32_16x16x32_bf16 a[116:119], a[244:247], v[112:115], a[116:119]
 ds_read_b128 a[244:247], v195 offset:0
 s_waitcnt lgkmcnt(2)
 v_mfma_f32_16x16x32_bf16 a[120:123], a[248:251], v[96:99], a[120:123]
 v_exp_f32 v179, v75
 v_mfma_f32_16x16x32_bf16 a[124:127], a[248:251], v[100:103], a[124:127]
 v_exp_f32 v180, v76
 v_mfma_f32_16x16x32_bf16 a[128:131], a[248:251], v[104:107], a[128:131]
 v_cvt_pk_bf16_f32 v123, v182, v183
 v_cvt_pk_bf16_f32 v124, v176, v177
 v_mfma_f32_16x16x32_bf16 a[132:135], a[248:251], v[108:111], a[132:135]
 v_exp_f32 v181, v77
 v_mfma_f32_16x16x32_bf16 a[136:139], a[248:251], v[112:115], a[136:139]
 v_exp_f32 v182, v78
 v_mfma_f32_16x16x32_bf16 a[140:143], a[252:255], v[96:99], a[140:143]
 ds_read_b128 a[248:251], v196 offset:0
 v_cvt_pk_bf16_f32 v125, v178, v179
 v_mfma_f32_16x16x32_bf16 a[144:147], a[252:255], v[100:103], a[144:147]
 v_exp_f32 v183, v79
 v_mfma_f32_16x16x32_bf16 a[148:151], a[252:255], v[104:107], a[148:151]
 v_cvt_pk_bf16_f32 v126, v180, v181
 v_cvt_pk_bf16_f32 v127, v182, v183
 v_mfma_f32_16x16x32_bf16 a[152:155], a[252:255], v[108:111], a[152:155]
 v_exp_f32 v176, v80
 v_mfma_f32_16x16x32_bf16 a[156:159], a[252:255], v[112:115], a[156:159]
 ds_read_b128 a[252:255], v197 offset:0
 s_waitcnt lgkmcnt(2)
 v_mfma_f32_16x16x32_bf16 v[16:19], a[240:243], a[160:163], v[136:139]
 s_waitcnt vmcnt(5)
 buffer_load_dwordx4 v215, s[28:31], s46 offen offset:1024 nt lds
 v_mfma_f32_16x16x32_bf16 v[24:27], a[240:243], a[176:179], v[140:143]
 v_exp_f32 v177, v81
 v_mfma_f32_16x16x32_bf16 v[32:35], a[240:243], a[192:195], v[144:147]
 v_exp_f32 v178, v82
 v_mfma_f32_16x16x32_bf16 v[40:43], a[240:243], a[208:211], v[148:151]
 v_cvt_pk_bf16_f32 v128, v176, v177
 v_or3_b32 v188, v116, v117, v118
 v_mfma_f32_16x16x32_bf16 v[48:51], a[240:243], a[224:227], v[152:155]
 v_exp_f32 v179, v83
 v_mfma_f32_16x16x32_bf16 v[16:19], a[244:247], a[164:167], v[16:19]
 ds_read_b128 a[240:243], v194 offset:4096
 v_cvt_pk_bf16_f32 v129, v178, v179
 v_mfma_f32_16x16x32_bf16 v[24:27], a[244:247], a[180:183], v[24:27]
 v_exp_f32 v180, v84
 v_mfma_f32_16x16x32_bf16 v[32:35], a[244:247], a[196:199], v[32:35]
 v_or3_b32 v188, v188, v119, v120
 v_or3_b32 v188, v188, v121, v122
 v_mfma_f32_16x16x32_bf16 v[40:43], a[244:247], a[212:215], v[40:43]
 v_exp_f32 v181, v85
 v_mfma_f32_16x16x32_bf16 v[48:51], a[244:247], a[228:231], v[48:51]
 ds_read_b128 a[244:247], v195 offset:4096
 s_waitcnt lgkmcnt(2)
 v_mfma_f32_16x16x32_bf16 v[16:19], a[248:251], a[168:171], v[16:19]
 v_exp_f32 v182, v86
 v_mfma_f32_16x16x32_bf16 v[24:27], a[248:251], a[184:187], v[24:27]
 s_waitcnt vmcnt(5)
 v_cvt_pk_bf16_f32 v130, v180, v181
 v_mfma_f32_16x16x32_bf16 v[32:35], a[248:251], a[200:203], v[32:35]
 buffer_load_dwordx4 v216, s[28:31], s46 offen offset:2048 nt lds
 v_mfma_f32_16x16x32_bf16 v[40:43], a[248:251], a[216:219], v[40:43]
 v_exp_f32 v183, v87
 v_mfma_f32_16x16x32_bf16 v[48:51], a[248:251], a[232:235], v[48:51]
 v_exp_f32 v176, v88
 v_mfma_f32_16x16x32_bf16 v[16:19], a[252:255], a[172:175], v[16:19]
 ds_read_b128 a[248:251], v196 offset:4096
 v_cvt_pk_bf16_f32 v131, v182, v183
 v_mfma_f32_16x16x32_bf16 v[24:27], a[252:255], a[188:191], v[24:27]
 v_exp_f32 v177, v89
 v_mfma_f32_16x16x32_bf16 v[32:35], a[252:255], a[204:207], v[32:35]
 v_exp_f32 v178, v90
 v_mfma_f32_16x16x32_bf16 v[40:43], a[252:255], a[220:223], v[40:43]
 v_cvt_pk_bf16_f32 v132, v176, v177
 v_or3_b32 v188, v188, v123, v124
 v_mfma_f32_16x16x32_bf16 v[48:51], a[252:255], a[236:239], v[48:51]
 ds_read_b128 a[252:255], v197 offset:4096
 s_waitcnt lgkmcnt(2)
 v_mfma_f32_16x16x32_bf16 v[20:23], a[240:243], a[160:163], v[136:139]
 v_exp_f32 v179, v91
 v_mfma_f32_16x16x32_bf16 v[28:31], a[240:243], a[176:179], v[140:143]
 v_exp_f32 v180, v92
 v_mfma_f32_16x16x32_bf16 v[36:39], a[240:243], a[192:195], v[144:147]
 v_cvt_pk_bf16_f32 v133, v178, v179
 s_waitcnt vmcnt(5)
 v_mfma_f32_16x16x32_bf16 v[44:47], a[240:243], a[208:211], v[148:151]
 buffer_load_dwordx4 v217, s[28:31], s46 offen offset:3072 nt lds
 v_mfma_f32_16x16x32_bf16 v[52:55], a[240:243], a[224:227], v[152:155]
 v_or3_b32 v188, v188, v125, v126
 s_barrier
 v_mfma_f32_16x16x32_bf16 v[20:23], a[244:247], a[164:167], v[20:23]
 v_exp_f32 v181, v93
 v_mfma_f32_16x16x32_bf16 v[28:31], a[244:247], a[180:183], v[28:31]
 ds_read_b64_tr_b16 a[240:241], v198 offset:16384
 ds_read_b64_tr_b16 a[242:243], v198 offset:20480
 v_mfma_f32_16x16x32_bf16 v[36:39], a[244:247], a[196:199], v[36:39]
 v_exp_f32 v182, v94
 v_mfma_f32_16x16x32_bf16 v[44:47], a[244:247], a[212:215], v[44:47]
 v_exp_f32 v183, v95
 v_mfma_f32_16x16x32_bf16 v[52:55], a[244:247], a[228:231], v[52:55]
 ds_read_b64_tr_b16 a[244:245], v199 offset:16384
 s_waitcnt lgkmcnt(3)
 v_mfma_f32_16x16x32_bf16 v[20:23], a[248:251], a[168:171], v[20:23]
 ds_read_b64_tr_b16 a[246:247], v199 offset:20480
 v_cvt_pk_bf16_f32 v134, v180, v181
 v_mfma_f32_16x16x32_bf16 v[28:31], a[248:251], a[184:187], v[28:31]
 v_cvt_pk_bf16_f32 v135, v182, v183
 v_or3_b32 v188, v188, v127, v128
 v_mfma_f32_16x16x32_bf16 v[36:39], a[248:251], a[200:203], v[36:39]
 v_or3_b32 v188, v188, v129, v130
 v_or3_b32 v188, v188, v131, v132
 v_mfma_f32_16x16x32_bf16 v[44:47], a[248:251], a[216:219], v[44:47]
 v_or3_b32 v188, v188, v133, v134
 v_bitop3_b32 v188, v188, v135, s45 bitop3:0xa8
 v_mfma_f32_16x16x32_bf16 v[52:55], a[248:251], a[232:235], v[52:55]
 ds_read_b64_tr_b16 a[248:249], v200 offset:16384
 ds_read_b64_tr_b16 a[250:251], v200 offset:20480
 v_mfma_f32_16x16x32_bf16 v[20:23], a[252:255], a[172:175], v[20:23]
 s_waitcnt vmcnt(5)
 s_add_u32 m0, s44, 98304
 v_mfma_f32_16x16x32_bf16 v[28:31], a[252:255], a[188:191], v[28:31]
 s_mov_b32 s46, 98304
 v_cmp_ne_u32 vcc, 0, v188
 v_mfma_f32_16x16x32_bf16 v[36:39], a[252:255], a[204:207], v[36:39]
 buffer_load_dwordx4 v218, s[32:35], s46 offen offset:0 nt lds
 v_mfma_f32_16x16x32_bf16 v[44:47], a[252:255], a[220:223], v[44:47]
 v_mfma_f32_16x16x32_bf16 v[52:55], a[252:255], a[236:239], v[52:55]
 s_cbranch_vccnz L_rarea4
L_rarea4_back:
 v_mfma_f32_16x16x32_bf16 v[156:159], v[184:187], v[116:119], v[156:159]
 v_mfma_f32_16x16x32_bf16 v[160:163], v[184:187], v[120:123], v[160:163]
 v_exp_f32 v176, v16
 v_mfma_f32_16x16x32_bf16 v[164:167], v[184:187], v[124:127], v[164:167]
 v_exp_f32 v177, v17
 v_mfma_f32_16x16x32_bf16 v[168:171], v[184:187], v[128:131], v[168:171]
 v_exp_f32 v178, v18
 v_mfma_f32_16x16x32_bf16 v[172:175], v[184:187], v[132:135], v[172:175]
 ds_read_b64_tr_b16 a[252:253], v201 offset:16384
 s_waitcnt lgkmcnt(3)
 v_mfma_f32_16x16x32_bf16 a[0:3], a[240:243], v[116:119], a[0:3]
 ds_read_b64_tr_b16 a[254:255], v201 offset:20480
 v_cvt_pk_bf16_f32 v96, v176, v177
 v_mfma_f32_16x16x32_bf16 a[4:7], a[240:243], v[120:123], a[4:7]
 v_exp_f32 v179, v19
 v_mfma_f32_16x16x32_bf16 a[8:11], a[240:243], v[124:127], a[8:11]
 v_exp_f32 v180, v20
 v_mfma_f32_16x16x32_bf16 a[12:15], a[240:243], v[128:131], a[12:15]
 v_exp_f32 v181, v21
 v_mfma_f32_16x16x32_bf16 a[16:19], a[240:243], v[132:135], a[16:19]
 v_exp_f32 v182, v22
 v_mfma_f32_16x16x32_bf16 a[20:23], a[244:247], v[116:119], a[20:23]
 s_waitcnt vmcnt(5)
 buffer_load_dwordx4 v219, s[32:35], s46 offen offset:1024 nt lds
 v_mfma_f32_16x16x32_bf16 a[24:27], a[244:247], v[120:123], a[24:27]
 ds_read_b64_tr_b16 a[240:241], v202 offset:16384
 ds_read_b64_tr_b16 a[242:243], v202 offset:20480
 v_mfma_f32_16x16x32_bf16 a[28:31], a[244:247], v[124:127], a[28:31]
 v_exp_f32 v183, v23
 v_mfma_f32_16x16x32_bf16 a[32:35], a[244:247], v[128:131], a[32:35]
 v_exp_f32 v176, v24
 v_mfma_f32_16x16x32_bf16 a[36:39], a[244:247], v[132:135], a[36:39]
 v_cvt_pk_bf16_f32 v97, v178, v179
 s_waitcnt lgkmcnt(2)
 v_mfma_f32_16x16x32_bf16 a[40:43], a[248:251], v[116:119], a[40:43]
 ds_read_b64_tr_b16 a[244:245], v203 offset:16384
 ds_read_b64_tr_b16 a[246:247], v203 offset:20480
 v_mfma_f32_16x16x32_bf16 a[44:47], a[248:251], v[120:123], a[44:47]
 v_exp_f32 v177, v25
 v_mfma_f32_16x16x32_bf16 a[48:51], a[248:251], v[124:127], a[48:51]
 v_exp_f32 v178, v26
 v_mfma_f32_16x16x32_bf16 a[52:55], a[248:251], v[128:131], a[52:55]
 v_cvt_pk_bf16_f32 v98, v180, v181
 v_cvt_pk_bf16_f32 v99, v182, v183
 v_mfma_f32_16x16x32_bf16 a[56:59], a[248:251], v[132:135], a[56:59]
 v_exp_f32 v179, v27
 v_mfma_f32_16x16x32_bf16 a[60:63], a[252:255], v[116:119], a[60:63]
 ds_read_b64_tr_b16 a[248:249], v204 offset:16384
 ds_read_b64_tr_b16 a[250:251], v204 offset:20480
 v_mfma_f32_16x16x32_bf16 a[64:67], a[252:255], v[120:123], a[64:67]
 v_exp_f32 v180, v28
 v_mfma_f32_16x16x32_bf16 a[68:71], a[252:255], v[124:127], a[68:71]
 s_waitcnt vmcnt(5)
 buffer_load_dwordx4 v218, s[32:35], s46 offen offset:2048 nt lds
 v_mfma_f32_16x16x32_bf16 a[72:75], a[252:255], v[128:131], a[72:75]
 v_exp_f32 v181, v29
 v_mfma_f32_16x16x32_bf16 a[76:79], a[252:255], v[132:135], a[76:79]
 ds_read_b64_tr_b16 a[252:253], v205 offset:16384
 s_waitcnt lgkmcnt(3)
 v_mfma_f32_16x16x32_bf16 a[80:83], a[240:243], v[116:119], a[80:83]
 ds_read_b64_tr_b16 a[254:255], v205 offset:20480
 v_cvt_pk_bf16_f32 v100, v176, v177
 v_mfma_f32_16x16x32_bf16 a[84:87], a[240:243], v[120:123], a[84:87]
 v_exp_f32 v182, v30
 v_mfma_f32_16x16x32_bf16 a[88:91], a[240:243], v[124:127], a[88:91]
 v_exp_f32 v183, v31
 v_mfma_f32_16x16x32_bf16 a[92:95], a[240:243], v[128:131], a[92:95]
 v_exp_f32 v176, v32
 v_mfma_f32_16x16x32_bf16 a[96:99], a[240:243], v[132:135], a[96:99]
 v_cvt_pk_bf16_f32 v101, v178, v179
 ds_read_b128 a[240:243], v190 offset:0
 v_mfma_f32_16x16x32_bf16 a[100:103], a[244:247], v[116:119], a[100:103]
 v_exp_f32 v177, v33
 v_mfma_f32_16x16x32_bf16 a[104:107], a[244:247], v[120:123], a[104:107]
 v_cvt_pk_bf16_f32 v102, v180, v181
 v_cvt_pk_bf16_f32 v103, v182, v183
 v_mfma_f32_16x16x32_bf16 a[108:111], a[244:247], v[124:127], a[108:111]
 v_exp_f32 v178, v34
 v_mfma_f32_16x16x32_bf16 a[112:115], a[244:247], v[128:131], a[112:115]
 s_waitcnt vmcnt(5)
 v_cvt_pk_bf16_f32 v104, v176, v177
 v_mfma_f32_16x16x32_bf16 a[116:119], a[244:247], v[132:135], a[116:119]
 buffer_load_dwordx4 v219, s[32:35], s46 offen offset:3072 nt lds
 s_waitcnt lgkmcnt(1)
 v_mfma_f32_16x16x32_bf16 a[120:123], a[248:251], v[116:119], a[120:123]
 ds_read_b128 a[244:247], v191 offset:0
 v_or3_b32 v188, v96, v97, v98
 v_mfma_f32_16x16x32_bf16 a[124:127], a[248:251], v[120:123], a[124:127]
 v_exp_f32 v179, v35
 v_mfma_f32_16x16x32_bf16 a[128:131], a[248:251], v[124:127], a[128:131]
 v_exp_f32 v180, v36
 v_mfma_f32_16x16x32_bf16 a[132:135], a[248:251], v[128:131], a[132:135]
 v_exp_f32 v181, v37
 v_mfma_f32_16x16x32_bf16 a[136:139], a[248:251], v[132:135], a[136:139]
 v_exp_f32 v182, v38
 v_mfma_f32_16x16x32_bf16 a[140:143], a[252:255], v[116:119], a[140:143]
 ds_read_b128 a[248:251], v192 offset:0
 v_cvt_pk_bf16_f32 v105, v178, v179
 v_mfma_f32_16x16x32_bf16 a[144:147], a[252:255], v[120:123], a[144:147]
 v_exp_f32 v183, v39
 v_mfma_f32_16x16x32_bf16 a[148:151], a[252:255], v[124:127], a[148:151]
 v_cvt_pk_bf16_f32 v106, v180, v181
 v_cvt_pk_bf16_f32 v107, v182, v183
 v_mfma_f32_16x16x32_bf16 a[152:155], a[252:255], v[128:131], a[152:155]
 v_exp_f32 v176, v40
 v_mfma_f32_16x16x32_bf16 a[156:159], a[252:255], v[132:135], a[156:159]
 ds_read_b128 a[252:255], v193 offset:0
 s_waitcnt lgkmcnt(2)
 v_mfma_f32_16x16x32_bf16 v[56:59], a[240:243], a[160:163], v[136:139]
 v_exp_f32 v177, v41
 v_mfma_f32_16x16x32_bf16 v[64:67], a[240:243], a[176:179], v[140:143]
 s_waitcnt vmcnt(5)
 s_add_u32 m0, s44, 49152
 v_mfma_f32_16x16x32_bf16 v[72:75], a[240:243], a[192:195], v[144:147]
 s_mov_b32 s46, 131072
 buffer_load_dwordx4 v214, s[28:31], s46 offen offset:0 nt lds
 v_mfma_f32_16x16x32_bf16 v[80:83], a[240:243], a[208:211], v[148:151]
 v_exp_f32 v178, v42
 v_mfma_f32_16x16x32_bf16 v[88:91], a[240:243], a[224:227], v[152:155]
 v_exp_f32 v179, v43
 v_mfma_f32_16x16x32_bf16 v[56:59], a[244:247], a[164:167], v[56:59]
 ds_read_b128 a[240:243], v190 offset:4096
 v_cvt_pk_bf16_f32 v108, v176, v177
 v_mfma_f32_16x16x32_bf16 v[64:67], a[244:247], a[180:183], v[64:67]
 v_exp_f32 v180, v44
 v_mfma_f32_16x16x32_bf16 v[72:75], a[244:247], a[196:199], v[72:75]
 v_cvt_pk_bf16_f32 v109, v178, v179
 v_or3_b32 v188, v188, v99, v100
 v_mfma_f32_16x16x32_bf16 v[80:83], a[244:247], a[212:215], v[80:83]
 v_exp_f32 v181, v45
 v_mfma_f32_16x16x32_bf16 v[88:91], a[244:247], a[228:231], v[88:91]
 ds_read_b128 a[244:247], v191 offset:4096
 s_waitcnt lgkmcnt(2)
 v_mfma_f32_16x16x32_bf16 v[56:59], a[248:251], a[168:171], v[56:59]
 v_exp_f32 v182, v46
 v_mfma_f32_16x16x32_bf16 v[64:67], a[248:251], a[184:187], v[64:67]
 v_cvt_pk_bf16_f32 v110, v180, v181
 s_waitcnt vmcnt(5)
 v_mfma_f32_16x16x32_bf16 v[72:75], a[248:251], a[200:203], v[72:75]
 buffer_load_dwordx4 v215, s[28:31], s46 offen offset:1024 nt lds
 v_mfma_f32_16x16x32_bf16 v[80:83], a[248:251], a[216:219], v[80:83]
 v_exp_f32 v183, v47
 v_mfma_f32_16x16x32_bf16 v[88:91], a[248:251], a[232:235], v[88:91]
 v_exp_f32 v176, v48
 v_mfma_f32_16x16x32_bf16 v[56:59], a[252:255], a[172:175], v[56:59]
 ds_read_b128 a[248:251], v192 offset:4096
 v_cvt_pk_bf16_f32 v111, v182, v183
 v_mfma_f32_16x16x32_bf16 v[64:67], a[252:255], a[188:191], v[64:67]
 v_exp_f32 v177, v49
 v_mfma_f32_16x16x32_bf16 v[72:75], a[252:255], a[204:207], v[72:75]
 v_exp_f32 v178, v50
 v_mfma_f32_16x16x32_bf16 v[80:83], a[252:255], a[220:223], v[80:83]
 v_cvt_pk_bf16_f32 v112, v176, v177
 v_or3_b32 v188, v188, v101, v102
 v_mfma_f32_16x16x32_bf16 v[88:91], a[252:255], a[236:239], v[88:91]
 ds_read_b128 a[252:255], v193 offset:4096
 s_waitcnt lgkmcnt(2)
 v_mfma_f32_16x16x32_bf16 v[60:63], a[240:243], a[160:163], v[136:139]
 v_exp_f32 v179, v51
 v_mfma_f32_16x16x32_bf16 v[68:71], a[240:243], a[176:179], v[140:143]
 v_exp_f32 v180, v52
 v_mfma_f32_16x16x32_bf16 v[76:79], a[240:243], a[192:195], v[144:147]
 v_cvt_pk_bf16_f32 v113, v178, v179
 v_or3_b32 v188, v188, v103, v104
 v_mfma_f32_16x16x32_bf16 v[84:87], a[240:243], a[208:211], v[148:151]
 v_exp_f32 v181, v53
 v_mfma_f32_16x16x32_bf16 v[92:95], a[240:243], a[224:227], v[152:155]
 v_cvt_pk_bf16_f32 v114, v180, v181
 s_barrier
 v_mfma_f32_16x16x32_bf16 v[60:63], a[244:247], a[164:167], v[60:63]
 v_exp_f32 v182, v54
 v_mfma_f32_16x16x32_bf16 v[68:71], a[244:247], a[180:183], v[68:71]
 ds_read_b64_tr_b16 a[240:241], v198 offset:49152
 ds_read_b64_tr_b16 a[242:243], v198 offset:53248
 v_mfma_f32_16x16x32_bf16 v[76:79], a[244:247], a[196:199], v[76:79]
 s_waitcnt vmcnt(5)
 buffer_load_dwordx4 v216, s[28:31], s46 offen offset:2048 nt lds
 v_mfma_f32_16x16x32_bf16 v[84:87], a[244:247], a[212:215], v[84:87]
 v_exp_f32 v183, v55
 v_mfma_f32_16x16x32_bf16 v[92:95], a[244:247], a[228:231], v[92:95]
 ds_read_b64_tr_b16 a[244:245], v199 offset:49152
 s_waitcnt lgkmcnt(3)
 v_mfma_f32_16x16x32_bf16 v[60:63], a[248:251], a[168:171], v[60:63]
 ds_read_b64_tr_b16 a[246:247], v199 offset:53248
 v_cvt_pk_bf16_f32 v115, v182, v183
 v_mfma_f32_16x16x32_bf16 v[68:71], a[248:251], a[184:187], v[68:71]
 v_or3_b32 v188, v188, v105, v106
 v_or3_b32 v188, v188, v107, v108
 v_mfma_f32_16x16x32_bf16 v[76:79], a[248:251], a[200:203], v[76:79]
 v_or3_b32 v188, v188, v109, v110
 v_or3_b32 v188, v188, v111, v112
 v_mfma_f32_16x16x32_bf16 v[84:87], a[248:251], a[216:219], v[84:87]
 v_or3_b32 v188, v188, v113, v114
 v_bitop3_b32 v188, v188, v115, s45 bitop3:0xa8
 v_mfma_f32_16x16x32_bf16 v[92:95], a[248:251], a[232:235], v[92:95]
 ds_read_b64_tr_b16 a[248:249], v200 offset:49152
 ds_read_b64_tr_b16 a[250:251], v200 offset:53248
 v_mfma_f32_16x16x32_bf16 v[60:63], a[252:255], a[172:175], v[60:63]
 v_cmp_ne_u32 vcc, 0, v188
 s_waitcnt vmcnt(5)
 v_mfma_f32_16x16x32_bf16 v[68:71], a[252:255], a[188:191], v[68:71]
 buffer_load_dwordx4 v217, s[28:31], s46 offen offset:3072 nt lds
 v_mfma_f32_16x16x32_bf16 v[76:79], a[252:255], a[204:207], v[76:79]
 v_mfma_f32_16x16x32_bf16 v[84:87], a[252:255], a[220:223], v[84:87]
 v_mfma_f32_16x16x32_bf16 v[92:95], a[252:255], a[236:239], v[92:95]
 s_cbranch_vccnz L_rarea5
L_rarea5_back:
 v_mfma_f32_16x16x32_bf16 v[156:159], v[184:187], v[96:99], v[156:159]
 v_mfma_f32_16x16x32_bf16 v[160:163], v[184:187], v[100:103], v[160:163]
 v_exp_f32 v176, v56
 v_mfma_f32_16x16x32_bf16 v[164:167], v[184:187], v[104:107], v[164:167]
 v_exp_f32 v177, v57
 v_mfma_f32_16x16x32_bf16 v[168:171], v[184:187], v[108:111], v[168:171]
 v_exp_f32 v178, v58
 v_mfma_f32_16x16x32_bf16 v[172:175], v[184:187], v[112:115], v[172:175]
 ds_read_b64_tr_b16 a[252:253], v201 offset:49152
 s_waitcnt lgkmcnt(3)
 v_mfma_f32_16x16x32_bf16 a[0:3], a[240:243], v[96:99], a[0:3]
 ds_read_b64_tr_b16 a[254:255], v201 offset:53248
 v_cvt_pk_bf16_f32 v116, v176, v177
 v_mfma_f32_16x16x32_bf16 a[4:7], a[240:243], v[100:103], a[4:7]
 v_exp_f32 v179, v59
 v_mfma_f32_16x16x32_bf16 a[8:11], a[240:243], v[104:107], a[8:11]
 v_exp_f32 v180, v60
 v_mfma_f32_16x16x32_bf16 a[12:15], a[240:243], v[108:111], a[12:15]
 v_exp_f32 v181, v61
 v_mfma_f32_16x16x32_bf16 a[16:19], a[240:243], v[112:115], a[16:19]
 v_exp_f32 v182, v62
 v_mfma_f32_16x16x32_bf16 a[20:23], a[244:247], v[96:99], a[20:23]
 ds_read_b64_tr_b16 a[240:241], v202 offset:49152
 ds_read_b64_tr_b16 a[242:243], v202 offset:53248
 v_mfma_f32_16x16x32_bf16 a[24:27], a[244:247], v[100:103], a[24:27]
 s_waitcnt vmcnt(5)
 s_add_u32 m0, s44, 81920
 s_mov_b32 s46, 114688
 buffer_load_dwordx4 v218, s[32:35], s46 offen offset:0 nt lds
 v_mfma_f32_16x16x32_bf16 a[28:31], a[244:247], v[104:107], a[28:31]
 v_exp_f32 v183, v63
 v_mfma_f32_16x16x32_bf16 a[32:35], a[244:247], v[108:111], a[32:35]
 v_exp_f32 v176, v64
 v_mfma_f32_16x16x32_bf16 a[36:39], a[244:247], v[112:115], a[36:39]
 v_cvt_pk_bf16_f32 v117, v178, v179
 s_waitcnt lgkmcnt(2)
 v_mfma_f32_16x16x32_bf16 a[40:43], a[248:251], v[96:99], a[40:43]
 ds_read_b64_tr_b16 a[244:245], v203 offset:49152
 ds_read_b64_tr_b16 a[246:247], v203 offset:53248
 v_mfma_f32_16x16x32_bf16 a[44:47], a[248:251], v[100:103], a[44:47]
 v_exp_f32 v177, v65
 v_mfma_f32_16x16x32_bf16 a[48:51], a[248:251], v[104:107], a[48:51]
 v_exp_f32 v178, v66
 v_mfma_f32_16x16x32_bf16 a[52:55], a[248:251], v[108:111], a[52:55]
 v_cvt_pk_bf16_f32 v118, v180, v181
 v_cvt_pk_bf16_f32 v119, v182, v183
 v_mfma_f32_16x16x32_bf16 a[56:59], a[248:251], v[112:115], a[56:59]
 v_exp_f32 v179, v67
 v_mfma_f32_16x16x32_bf16 a[60:63], a[252:255], v[96:99], a[60:63]
 ds_read_b64_tr_b16 a[248:249], v204 offset:49152
 ds_read_b64_tr_b16 a[250:251], v204 offset:53248
 v_mfma_f32_16x16x32_bf16 a[64:67], a[252:255], v[100:103], a[64:67]
 v_exp_f32 v180, v68
 v_mfma_f32_16x16x32_bf16 a[68:71], a[252:255], v[104:107], a[68:71]
 v_exp_f32 v181, v69
 v_mfma_f32_16x16x32_bf16 a[72:75], a[252:255], v[108:111], a[72:75]
 s_waitcnt vmcnt(5)
 v_cvt_pk_bf16_f32 v120, v176, v177
 v_mfma_f32_16x16x32_bf16 a[76:79], a[252:255], v[112:115], a[76:79]
 buffer_load_dwordx4 v219, s[32:35], s46 offen offset:1024 nt lds
 s_waitcnt lgkmcnt(2)
 v_mfma_f32_16x16x32_bf16 a[80:83], a[240:243], v[96:99], a[80:83]
 ds_read_b64_tr_b16 a[252:253], v205 offset:49152
 ds_read_b64_tr_b16 a[254:255], v205 offset:53248
 v_mfma_f32_16x16x32_bf16 a[84:87], a[240:243], v[100:103], a[84:87]
 v_exp_f32 v182, v70
 v_mfma_f32_16x16x32_bf16 a[88:91], a[240:243], v[104:107], a[88:91]
 v_exp_f32 v183, v71
 v_mfma_f32_16x16x32_bf16 a[92:95], a[240:243], v[108:111], a[92:95]
 v_exp_f32 v176, v72
 v_mfma_f32_16x16x32_bf16 a[96:99], a[240:243], v[112:115], a[96:99]
 v_cvt_pk_bf16_f32 v121, v178, v179
 ds_read_b128 a[240:243], v190 offset:16384
 v_mfma_f32_16x16x32_bf16 a[100:103], a[244:247], v[96:99], a[100:103]
 v_exp_f32 v177, v73
 v_mfma_f32_16x16x32_bf16 a[104:107], a[244:247], v[100:103], a[104:107]
 v_cvt_pk_bf16_f32 v122, v180, v181
 v_cvt_pk_bf16_f32 v123, v182, v183
 v_mfma_f32_16x16x32_bf16 a[108:111], a[244:247], v[104:107], a[108:111]
 v_exp_f32 v178, v74
 v_mfma_f32_16x16x32_bf16 a[112:115], a[244:247], v[108:111], a[112:115]
 v_cvt_pk_bf16_f32 v124, v176, v177
 s_waitcnt vmcnt(5)
 v_mfma_f32_16x16x32_bf16 a[116:119], a[244:247], v[112:115], a[116:119]
 ds_read_b128 a[244:247], v191 offset:16384
 s_waitcnt lgkmcnt(2)
 v_mfma_f32_16x16x32_bf16 a[120:123], a[248:251], v[96:99], a[120:123]
 buffer_load_dwordx4 v218, s[32:35], s46 offen offset:2048 nt lds
 v_mfma_f32_16x16x32_bf16 a[124:127], a[248:251], v[100:103], a[124:127]
 v_exp_f32 v179, v75
 v_mfma_f32_16x16x32_bf16 a[128:131], a[248:251], v[104:107], a[128:131]
 v_exp_f32 v180, v76
 v_mfma_f32_16x16x32_bf16 a[132:135], a[248:251], v[108:111], a[132:135]
 v_exp_f32 v181, v77
 v_mfma_f32_16x16x32_bf16 a[136:139], a[248:251], v[112:115], a[136:139]
 v_exp_f32 v182, v78
 v_mfma_f32_16x16x32_bf16 a[140:143], a[252:255], v[96:99], a[140:143]
 ds_read_b128 a[248:251], v192 offset:16384
 v_cvt_pk_bf16_f32 v125, v178, v179
 v_mfma_f32_16x16x32_bf16 a[144:147], a[252:255], v[100:103], a[144:147]
 v_exp_f32 v183, v79
 v_mfma_f32_16x16x32_bf16 a[148:151], a[252:255], v[104:107], a[148:151]
 v_cvt_pk_bf16_f32 v126, v180, v181
 v_cvt_pk_bf16_f32 v127, v182, v183
 v_mfma_f32_16x16x32_bf16 a[152:155], a[252:255], v[108:111], a[152:155]
 v_exp_f32 v176, v80
 v_mfma_f32_16x16x32_bf16 a[156:159], a[252:255], v[112:115], a[156:159]
 ds_read_b128 a[252:255], v193 offset:16384
 s_waitcnt lgkmcnt(2)
 v_mfma_f32_16x16x32_bf16 v[16:19], a[240:243], a[160:163], v[136:139]
 v_exp_f32 v177, v81
 v_mfma_f32_16x16x32_bf16 v[24:27], a[240:243], a[176:179], v[140:143]
 v_cvt_pk_bf16_f32 v128, v176, v177
 s_waitcnt vmcnt(5)
 v_mfma_f32_16x16x32_bf16 v[32:35], a[240:243], a[192:195], v[144:147]
 buffer_load_dwordx4 v219, s[32:35], s46 offen offset:3072 nt lds
 v_mfma_f32_16x16x32_bf16 v[40:43], a[240:243], a[208:211], v[148:151]
 v_exp_f32 v178, v82
 v_mfma_f32_16x16x32_bf16 v[48:51], a[240:243], a[224:227], v[152:155]
 v_exp_f32 v179, v83
 v_mfma_f32_16x16x32_bf16 v[16:19], a[244:247], a[164:167], v[16:19]
 ds_read_b128 a[240:243], v190 offset:20480
 v_cvt_pk_bf16_f32 v129, v178, v179
 v_mfma_f32_16x16x32_bf16 v[24:27], a[244:247], a[180:183], v[24:27]
 v_exp_f32 v180, v84
 v_mfma_f32_16x16x32_bf16 v[32:35], a[244:247], a[196:199], v[32:35]
 v_or3_b32 v188, v116, v117, v118
 v_or3_b32 v188, v188, v119, v120
 v_mfma_f32_16x16x32_bf16 v[40:43], a[244:247], a[212:215], v[40:43]
 v_exp_f32 v181, v85
 v_mfma_f32_16x16x32_bf16 v[48:51], a[244:247], a[228:231], v[48:51]
 ds_read_b128 a[244:247], v191 offset:20480
 s_waitcnt lgkmcnt(2)
 v_mfma_f32_16x16x32_bf16 v[16:19], a[248:251], a[168:171], v[16:19]
 v_exp_f32 v182, v86
 v_mfma_f32_16x16x32_bf16 v[24:27], a[248:251], a[184:187], v[24:27]
 v_cvt_pk_bf16_f32 v130, v180, v181
 v_or3_b32 v188, v188, v121, v122
 v_mfma_f32_16x16x32_bf16 v[32:35], a[248:251], a[200:203], v[32:35]
 v_exp_f32 v183, v87
 v_mfma_f32_16x16x32_bf16 v[40:43], a[248:251], a[216:219], v[40:43]
 v_exp_f32 v176, v88
 v_mfma_f32_16x16x32_bf16 v[48:51], a[248:251], a[232:235], v[48:51]
 ds_read_b128 a[248:251], v192 offset:20480
 s_waitcnt vmcnt(5)
 v_mfma_f32_16x16x32_bf16 v[16:19], a[252:255], a[172:175], v[16:19]
 s_add_u32 m0, s44, 131072
 s_mov_b32 s46, 147456
 v_mfma_f32_16x16x32_bf16 v[24:27], a[252:255], a[188:191], v[24:27]
 buffer_load_dwordx4 v214, s[28:31], s46 offen offset:0 nt lds
 v_mfma_f32_16x16x32_bf16 v[32:35], a[252:255], a[204:207], v[32:35]
 v_exp_f32 v177, v89
 v_mfma_f32_16x16x32_bf16 v[40:43], a[252:255], a[220:223], v[40:43]
 v_exp_f32 v178, v90
 v_mfma_f32_16x16x32_bf16 v[48:51], a[252:255], a[236:239], v[48:51]
 ds_read_b128 a[252:255], v193 offset:20480
 s_waitcnt lgkmcnt(2)
 v_mfma_f32_16x16x32_bf16 v[20:23], a[240:243], a[160:163], v[136:139]
 v_exp_f32 v179, v91
 v_mfma_f32_16x16x32_bf16 v[28:31], a[240:243], a[176:179], v[140:143]
 v_exp_f32 v180, v92
 v_mfma_f32_16x16x32_bf16 v[36:39], a[240:243], a[192:195], v[144:147]
 v_cvt_pk_bf16_f32 v131, v182, v183
 v_cvt_pk_bf16_f32 v132, v176, v177
 v_mfma_f32_16x16x32_bf16 v[44:47], a[240:243], a[208:211], v[148:151]
 v_exp_f32 v181, v93
 v_mfma_f32_16x16x32_bf16 v[52:55], a[240:243], a[224:227], v[152:155]
 v_cvt_pk_bf16_f32 v133, v178, v179
 s_barrier
 v_mfma_f32_16x16x32_bf16 v[20:23], a[244:247], a[164:167], v[20:23]
 v_exp_f32 v182, v94
 v_mfma_f32_16x16x32_bf16 v[28:31], a[244:247], a[180:183], v[28:31]
 ds_read_b64_tr_b16 a[240:241], v198 offset:0
 ds_read_b64_tr_b16 a[242:243], v198 offset:4096
 v_mfma_f32_16x16x32_bf16 v[36:39], a[244:247], a[196:199], v[36:39]
 v_exp_f32 v183, v95
 v_mfma_f32_16x16x32_bf16 v[44:47], a[244:247], a[212:215], v[44:47]
 s_waitcnt vmcnt(5)
 buffer_load_dwordx4 v215, s[28:31], s46 offen offset:1024 nt lds
 v_mfma_f32_16x16x32_bf16 v[52:55], a[244:247], a[228:231], v[52:55]
 ds_read_b64_tr_b16 a[244:245], v199 offset:0
 s_waitcnt lgkmcnt(3)
 v_mfma_f32_16x16x32_bf16 v[20:23], a[248:251], a[168:171], v[20:23]
 ds_read_b64_tr_b16 a[246:247], v199 offset:4096
 v_cvt_pk_bf16_f32 v134, v180, v181
 v_mfma_f32_16x16x32_bf16 v[28:31], a[248:251], a[184:187], v[28:31]
 v_cvt_pk_bf16_f32 v135, v182, v183
 v_or3_b32 v188, v188, v123, v124
 v_mfma_f32_16x16x32_bf16 v[36:39], a[248:251], a[200:203], v[36:39]
 v_or3_b32 v188, v188, v125, v126
 v_or3_b32 v188, v188, v127, v128
 v_mfma_f32_16x16x32_bf16 v[44:47], a[248:251], a[216:219], v[44:47]
 v_or3_b32 v188, v188, v129, v130
 v_or3_b32 v188, v188, v131, v132
 v_mfma_f32_16x16x32_bf16 v[52:55], a[248:251], a[232:235], v[52:55]
 ds_read_b64_tr_b16 a[248:249], v200 offset:0
 ds_read_b64_tr_b16 a[250:251], v200 offset:4096
 v_mfma_f32_16x16x32_bf16 v[20:23], a[252:255], a[172:175], v[20:23]
 v_or3_b32 v188, v188, v133, v134
 v_bitop3_b32 v188, v188, v135, s45 bitop3:0xa8
 v_mfma_f32_16x16x32_bf16 v[28:31], a[252:255], a[188:191], v[28:31]
 v_cmp_ne_u32 vcc, 0, v188
 v_mfma_f32_16x16x32_bf16 v[36:39], a[252:255], a[204:207], v[36:39]
 s_waitcnt vmcnt(5)
 v_mfma_f32_16x16x32_bf16 v[44:47], a[252:255], a[220:223], v[44:47]
 buffer_load_dwordx4 v216, s[28:31], s46 offen offset:2048 nt lds
 v_mfma_f32_16x16x32_bf16 v[52:55], a[252:255], a[236:239], v[52:55]
 s_cbranch_vccnz L_rarea6
L_rarea6_back:
 v_mfma_f32_16x16x32_bf16 v[156:159], v[184:187], v[116:119], v[156:159]
 v_mfma_f32_16x16x32_bf16 v[160:163], v[184:187], v[120:123], v[160:163]
 v_exp_f32 v176, v16
 v_mfma_f32_16x16x32_bf16 v[164:167], v[184:187], v[124:127], v[164:167]
 v_exp_f32 v177, v17
 v_mfma_f32_16x16x32_bf16 v[168:171], v[184:187], v[128:131], v[168:171]
 v_exp_f32 v178, v18
 v_mfma_f32_16x16x32_bf16 v[172:175], v[184:187], v[132:135], v[172:175]
 ds_read_b64_tr_b16 a[252:253], v201 offset:0
 s_waitcnt lgkmcnt(3)
 v_mfma_f32_16x16x32_bf16 a[0:3], a[240:243], v[116:119], a[0:3]
 ds_read_b64_tr_b16 a[254:255], v201 offset:4096
 v_cvt_pk_bf16_f32 v96, v176, v177
 v_mfma_f32_16x16x32_bf16 a[4:7], a[240:243], v[120:123], a[4:7]
 v_exp_f32 v179, v19
 v_mfma_f32_16x16x32_bf16 a[8:11], a[240:243], v[124:127], a[8:11]
 v_exp_f32 v180, v20
 v_mfma_f32_16x16x32_bf16 a[12:15], a[240:243], v[128:131], a[12:15]
 v_exp_f32 v181, v21
 v_mfma_f32_16x16x32_bf16 a[16:19], a[240:243], v[132:135], a[16:19]
 v_exp_f32 v182, v22
 v_mfma_f32_16x16x32_bf16 a[20:23], a[244:247], v[116:119], a[20:23]
 ds_read_b64_tr_b16 a[240:241], v202 offset:0
 ds_read_b64_tr_b16 a[242:243], v202 offset:4096
 v_mfma_f32_16x16x32_bf16 a[24:27], a[244:247], v[120:123], a[24:27]
 v_exp_f32 v183, v23
 v_mfma_f32_16x16x32_bf16 a[28:31], a[244:247], v[124:127], a[28:31]
 s_waitcnt vmcnt(5)
 v_cvt_pk_bf16_f32 v97, v178, v179
 v_mfma_f32_16x16x32_bf16 a[32:35], a[244:247], v[128:131], a[32:35]
 buffer_load_dwordx4 v217, s[28:31], s46 offen offset:3072 nt lds
 v_mfma_f32_16x16x32_bf16 a[36:39], a[244:247], v[132:135], a[36:39]
 ds_read_b64_tr_b16 a[244:245], v203 offset:0
 s_waitcnt lgkmcnt(3)
 v_mfma_f32_16x16x32_bf16 a[40:43], a[248:251], v[116:119], a[40:43]
 ds_read_b64_tr_b16 a[246:247], v203 offset:4096
 v_cvt_pk_bf16_f32 v98, v180, v181
 v_mfma_f32_16x16x32_bf16 a[44:47], a[248:251], v[120:123], a[44:47]
 v_exp_f32 v176, v24
 v_mfma_f32_16x16x32_bf16 a[48:51], a[248:251], v[124:127], a[48:51]
 v_exp_f32 v177, v25
 v_mfma_f32_16x16x32_bf16 a[52:55], a[248:251], v[128:131], a[52:55]
 v_exp_f32 v178, v26
 v_mfma_f32_16x16x32_bf16 a[56:59], a[248:251], v[132:135], a[56:59]
 v_exp_f32 v179, v27
 v_mfma_f32_16x16x32_bf16 a[60:63], a[252:255], v[116:119], a[60:63]
 ds_read_b64_tr_b16 a[248:249], v204 offset:0
 ds_read_b64_tr_b16 a[250:251], v204 offset:4096
 v_mfma_f32_16x16x32_bf16 a[64:67], a[252:255], v[120:123], a[64:67]
 v_exp_f32 v180, v28
 v_mfma_f32_16x16x32_bf16 a[68:71], a[252:255], v[124:127], a[68:71]
 v_cvt_pk_bf16_f32 v99, v182, v183
 v_cvt_pk_bf16_f32 v100, v176, v177
 v_mfma_f32_16x16x32_bf16 a[72:75], a[252:255], v[128:131], a[72:75]
 v_exp_f32 v181, v29
 v_mfma_f32_16x16x32_bf16 a[76:79], a[252:255], v[132:135], a[76:79]
 ds_read_b64_tr_b16 a[252:253], v205 offset:0
 s_waitcnt lgkmcnt(3)
 v_mfma_f32_16x16x32_bf16 a[80:83], a[240:243], v[116:119], a[80:83]
 ds_read_b64_tr_b16 a[254:255], v205 offset:4096
 s_waitcnt vmcnt(5)
 v_mfma_f32_16x16x32_bf16 a[84:87], a[240:243], v[120:123], a[84:87]
 s_add_u32 m0, s44, 114688
 s_mov_b32 s46, 131072
 buffer_load_dwordx4 v218, s[32:35], s46 offen offset:0 nt lds
 v_mfma_f32_16x16x32_bf16 a[88:91], a[240:243], v[124:127], a[88:91]
 v_exp_f32 v182, v30
 v_mfma_f32_16x16x32_bf16 a[92:95], a[240:243], v[128:131], a[92:95]
 v_exp_f32 v183, v31
 v_mfma_f32_16x16x32_bf16 a[96:99], a[240:243], v[132:135], a[96:99]
 v_exp_f32 v176, v32
 v_mfma_f32_16x16x32_bf16 a[100:103], a[244:247], v[116:119], a[100:103]
 v_cvt_pk_bf16_f32 v101, v178, v179
 ds_read_b128 a[240:243], v190 offset:32768
 v_mfma_f32_16x16x32_bf16 a[104:107], a[244:247], v[120:123], a[104:107]
 v_exp_f32 v177, v33
 v_mfma_f32_16x16x32_bf16 a[108:111], a[244:247], v[124:127], a[108:111]
 v_exp_f32 v178, v34
 v_mfma_f32_16x16x32_bf16 a[112:115], a[244:247], v[128:131], a[112:115]
 v_cvt_pk_bf16_f32 v102, v180, v181
 v_cvt_pk_bf16_f32 v103, v182, v183
 v_mfma_f32_16x16x32_bf16 a[116:119], a[244:247], v[132:135], a[116:119]
 ds_read_b128 a[244:247], v191 offset:32768
 s_waitcnt lgkmcnt(2)
 v_mfma_f32_16x16x32_bf16 a[120:123], a[248:251], v[116:119], a[120:123]
 v_exp_f32 v179, v35
 v_mfma_f32_16x16x32_bf16 a[124:127], a[248:251], v[120:123], a[124:127]
 v_exp_f32 v180, v36
 v_mfma_f32_16x16x32_bf16 a[128:131], a[248:251], v[124:127], a[128:131]
 s_waitcnt vmcnt(5)
 v_cvt_pk_bf16_f32 v104, v176, v177
 v_mfma_f32_16x16x32_bf16 a[132:135], a[248:251], v[128:131], a[132:135]
 buffer_load_dwordx4 v219, s[32:35], s46 offen offset:1024 nt lds
 v_mfma_f32_16x16x32_bf16 a[136:139], a[248:251], v[132:135], a[136:139]
 v_exp_f32 v181, v37
 v_mfma_f32_16x16x32_bf16 a[140:143], a[252:255], v[116:119], a[140:143]
 ds_read_b128 a[248:251], v192 offset:32768
 v_cvt_pk_bf16_f32 v105, v178, v179
 v_mfma_f32_16x16x32_bf16 a[144:147], a[252:255], v[120:123], a[144:147]
 v_exp_f32 v182, v38
 v_mfma_f32_16x16x32_bf16 a[148:151], a[252:255], v[124:127], a[148:151]
 v_exp_f32 v183, v39
 v_mfma_f32_16x16x32_bf16 a[152:155], a[252:255], v[128:131], a[152:155]
 v_exp_f32 v176, v40
 v_mfma_f32_16x16x32_bf16 a[156:159], a[252:255], v[132:135], a[156:159]
 ds_read_b128 a[252:255], v193 offset:32768
 s_waitcnt lgkmcnt(2)
 v_mfma_f32_16x16x32_bf16 v[56:59], a[240:243], a[160:163], v[136:139]
 v_exp_f32 v177, v41
 v_mfma_f32_16x16x32_bf16 v[64:67], a[240:243], a[176:179], v[140:143]
 v_cvt_pk_bf16_f32 v106, v180, v181
 v_cvt_pk_bf16_f32 v107, v182, v183
 v_mfma_f32_16x16x32_bf16 v[72:75], a[240:243], a[192:195], v[144:147]
 v_exp_f32 v178, v42
 v_mfma_f32_16x16x32_bf16 v[80:83], a[240:243], a[208:211], v[148:151]
 s_waitcnt vmcnt(4)
 v_cvt_pk_bf16_f32 v108, v176, v177
 v_mfma_f32_16x16x32_bf16 v[88:91], a[240:243], a[224:227], v[152:155]
 buffer_load_dwordx4 v218, s[32:35], s46 offen offset:2048 nt lds
 v_mfma_f32_16x16x32_bf16 v[56:59], a[244:247], a[164:167], v[56:59]
 ds_read_b128 a[240:243], v190 offset:36864
 v_or3_b32 v188, v96, v97, v98
 v_mfma_f32_16x16x32_bf16 v[64:67], a[244:247], a[180:183], v[64:67]
 v_exp_f32 v179, v43
 v_mfma_f32_16x16x32_bf16 v[72:75], a[244:247], a[196:199], v[72:75]
 v_exp_f32 v180, v44
 v_mfma_f32_16x16x32_bf16 v[80:83], a[244:247], a[212:215], v[80:83]
 v_exp_f32 v181, v45
 v_mfma_f32_16x16x32_bf16 v[88:91], a[244:247], a[228:231], v[88:91]
 ds_read_b128 a[244:247], v191 offset:36864
 s_waitcnt lgkmcnt(2)
 v_mfma_f32_16x16x32_bf16 v[56:59], a[248:251], a[168:171], v[56:59]
 v_exp_f32 v182, v46
 v_mfma_f32_16x16x32_bf16 v[64:67], a[248:251], a[184:187], v[64:67]
 v_cvt_pk_bf16_f32 v109, v178, v179
 v_cvt_pk_bf16_f32 v110, v180, v181
 v_mfma_f32_16x16x32_bf16 v[72:75], a[248:251], a[200:203], v[72:75]
 v_exp_f32 v183, v47
 v_mfma_f32_16x16x32_bf16 v[80:83], a[248:251], a[216:219], v[80:83]
 v_exp_f32 v176, v48
 v_mfma_f32_16x16x32_bf16 v[88:91], a[248:251], a[232:235], v[88:91]
 ds_read_b128 a[248:251], v192 offset:36864
 v_cvt_pk_bf16_f32 v111, v182, v183
 v_mfma_f32_16x16x32_bf16 v[56:59], a[252:255], a[172:175], v[56:59]
 v_exp_f32 v177, v49
 v_mfma_f32_16x16x32_bf16 v[64:67], a[252:255], a[188:191], v[64:67]
 s_waitcnt vmcnt(4)
 v_cvt_pk_bf16_f32 v112, v176, v177
 v_mfma_f32_16x16x32_bf16 v[72:75], a[252:255], a[204:207], v[72:75]
 buffer_load_dwordx4 v219, s[32:35], s46 offen offset:3072 nt lds
 v_mfma_f32_16x16x32_bf16 v[80:83], a[252:255], a[220:223], v[80:83]
 v_exp_f32 v178, v50
 v_mfma_f32_16x16x32_bf16 v[88:91], a[252:255], a[236:239], v[88:91]
 ds_read_b128 a[252:255], v193 offset:36864
 s_waitcnt lgkmcnt(2)
 v_mfma_f32_16x16x32_bf16 v[60:63], a[240:243], a[160:163], v[136:139]
 v_exp_f32 v179, v51
 v_mfma_f32_16x16x32_bf16 v[68:71], a[240:243], a[176:179], v[140:143]
 v_exp_f32 v180, v52
 v_mfma_f32_16x16x32_bf16 v[76:79], a[240:243], a[192:195], v[144:147]
 v_cvt_pk_bf16_f32 v113, v178, v179
 v_or3_b32 v188, v188, v99, v100
 v_mfma_f32_16x16x32_bf16 v[84:87], a[240:243], a[208:211], v[148:151]
 v_exp_f32 v181, v53
 v_mfma_f32_16x16x32_bf16 v[92:95], a[240:243], a[224:227], v[152:155]
 v_cvt_pk_bf16_f32 v114, v180, v181
 s_barrier
 v_mfma_f32_16x16x32_bf16 v[60:63], a[244:247], a[164:167], v[60:63]
 v_exp_f32 v182, v54
 v_mfma_f32_16x16x32_bf16 v[68:71], a[244:247], a[180:183], v[68:71]
 ds_read_b64_tr_b16 a[240:241], v198 offset:32768
 ds_read_b64_tr_b16 a[242:243], v198 offset:36864
 v_mfma_f32_16x16x32_bf16 v[76:79], a[244:247], a[196:199], v[76:79]
 v_exp_f32 v183, v55
 v_mfma_f32_16x16x32_bf16 v[84:87], a[244:247], a[212:215], v[84:87]
 v_cvt_pk_bf16_f32 v115, v182, v183
 s_waitcnt vmcnt(4)
 v_mfma_f32_16x16x32_bf16 v[92:95], a[244:247], a[228:231], v[92:95]
 s_add_u32 m0, s44, 0
 s_mov_b32 s46, 163840
 s_waitcnt lgkmcnt(2)
 v_mfma_f32_16x16x32_bf16 v[60:63], a[248:251], a[168:171], v[60:63]
 buffer_load_dwordx4 v214, s[28:31], s46 offen offset:0 nt lds
 v_mfma_f32_16x16x32_bf16 v[68:71], a[248:251], a[184:187], v[68:71]
 ds_read_b64_tr_b16 a[244:245], v199 offset:32768
 ds_read_b64_tr_b16 a[246:247], v199 offset:36864
 v_mfma_f32_16x16x32_bf16 v[76:79], a[248:251], a[200:203], v[76:79]
 v_or3_b32 v188, v188, v101, v102
 v_or3_b32 v188, v188, v103, v104
 v_mfma_f32_16x16x32_bf16 v[84:87], a[248:251], a[216:219], v[84:87]
 v_or3_b32 v188, v188, v105, v106
 v_or3_b32 v188, v188, v107, v108
 v_mfma_f32_16x16x32_bf16 v[92:95], a[248:251], a[232:235], v[92:95]
 ds_read_b64_tr_b16 a[248:249], v200 offset:32768
 ds_read_b64_tr_b16 a[250:251], v200 offset:36864
 v_mfma_f32_16x16x32_bf16 v[60:63], a[252:255], a[172:175], v[60:63]
 v_or3_b32 v188, v188, v109, v110
 v_or3_b32 v188, v188, v111, v112
 v_mfma_f32_16x16x32_bf16 v[68:71], a[252:255], a[188:191], v[68:71]
 v_or3_b32 v188, v188, v113, v114
 v_bitop3_b32 v188, v188, v115, s45 bitop3:0xa8
 v_mfma_f32_16x16x32_bf16 v[76:79], a[252:255], a[204:207], v[76:79]
 v_cmp_ne_u32 vcc, 0, v188
 v_mfma_f32_16x16x32_bf16 v[84:87], a[252:255], a[220:223], v[84:87]
 v_mfma_f32_16x16x32_bf16 v[92:95], a[252:255], a[236:239], v[92:95]
 s_waitcnt vmcnt(4)
 s_cbranch_vccnz L_rarea7
L_rarea7_back:
 v_mfma_f32_16x16x32_bf16 v[156:159], v[184:187], v[96:99], v[156:159]
 buffer_load_dwordx4 v215, s[28:31], s46 offen offset:1024 nt lds
 v_mfma_f32_16x16x32_bf16 v[160:163], v[184:187], v[100:103], v[160:163]
 v_exp_f32 v176, v56
 v_mfma_f32_16x16x32_bf16 v[164:167], v[184:187], v[104:107], v[164:167]
 v_exp_f32 v177, v57
 v_mfma_f32_16x16x32_bf16 v[168:171], v[184:187], v[108:111], v[168:171]
 v_exp_f32 v178, v58
 v_mfma_f32_16x16x32_bf16 v[172:175], v[184:187], v[112:115], v[172:175]
 ds_read_b64_tr_b16 a[252:253], v201 offset:32768
 s_waitcnt lgkmcnt(3)
 v_mfma_f32_16x16x32_bf16 a[0:3], a[240:243], v[96:99], a[0:3]
 ds_read_b64_tr_b16 a[254:255], v201 offset:36864
 v_cvt_pk_bf16_f32 v116, v176, v177
 v_mfma_f32_16x16x32_bf16 a[4:7], a[240:243], v[100:103], a[4:7]
 v_exp_f32 v179, v59
 v_mfma_f32_16x16x32_bf16 a[8:11], a[240:243], v[104:107], a[8:11]
 v_exp_f32 v180, v60
 v_mfma_f32_16x16x32_bf16 a[12:15], a[240:243], v[108:111], a[12:15]
 v_exp_f32 v181, v61
 v_mfma_f32_16x16x32_bf16 a[16:19], a[240:243], v[112:115], a[16:19]
 v_exp_f32 v182, v62
 v_mfma_f32_16x16x32_bf16 a[20:23], a[244:247], v[96:99], a[20:23]
 ds_read_b64_tr_b16 a[240:241], v202 offset:32768
 ds_read_b64_tr_b16 a[242:243], v202 offset:36864
 v_mfma_f32_16x16x32_bf16 a[24:27], a[244:247], v[100:103], a[24:27]
 v_exp_f32 v183, v63
 v_mfma_f32_16x16x32_bf16 a[28:31], a[244:247], v[104:107], a[28:31]
 v_cvt_pk_bf16_f32 v117, v178, v179
 v_cvt_pk_bf16_f32 v118, v180, v181
 v_mfma_f32_16x16x32_bf16 a[32:35], a[244:247], v[108:111], a[32:35]
 v_exp_f32 v176, v64
 v_mfma_f32_16x16x32_bf16 a[36:39], a[244:247], v[112:115], a[36:39]
 ds_read_b64_tr_b16 a[244:245], v203 offset:32768
 s_waitcnt lgkmcnt(3)
 v_mfma_f32_16x16x32_bf16 a[40:43], a[248:251], v[96:99], a[40:43]
 s_waitcnt vmcnt(4)
 buffer_load_dwordx4 v216, s[28:31], s46 offen offset:2048 nt lds
 v_mfma_f32_16x16x32_bf16 a[44:47], a[248:251], v[100:103], a[44:47]
 ds_read_b64_tr_b16 a[246:247], v203 offset:36864
 v_cvt_pk_bf16_f32 v119, v182, v183
 v_mfma_f32_16x16x32_bf16 a[48:51], a[248:251], v[104:107], a[48:51]
 v_exp_f32 v177, v65
 v_mfma_f32_16x16x32_bf16 a[52:55], a[248:251], v[108:111], a[52:55]
 v_exp_f32 v178, v66
 v_mfma_f32_16x16x32_bf16 a[56:59], a[248:251], v[112:115], a[56:59]
 v_exp_f32 v179, v67
 v_mfma_f32_16x16x32_bf16 a[60:63], a[252:255], v[96:99], a[60:63]
 ds_read_b64_tr_b16 a[248:249], v204 offset:32768
 ds_read_b64_tr_b16 a[250:251], v204 offset:36864
 v_mfma_f32_16x16x32_bf16 a[64:67], a[252:255], v[100:103], a[64:67]
 v_exp_f32 v180, v68
 v_mfma_f32_16x16x32_bf16 a[68:71], a[252:255], v[104:107], a[68:71]
 v_exp_f32 v181, v69
 v_mfma_f32_16x16x32_bf16 a[72:75], a[252:255], v[108:111], a[72:75]
 v_cvt_pk_bf16_f32 v120, v176, v177
 v_cvt_pk_bf16_f32 v121, v178, v179
 v_mfma_f32_16x16x32_bf16 a[76:79], a[252:255], v[112:115], a[76:79]
 ds_read_b64_tr_b16 a[252:253], v205 offset:32768
 s_waitcnt lgkmcnt(3)
 v_mfma_f32_16x16x32_bf16 a[80:83], a[240:243], v[96:99], a[80:83]
 ds_read_b64_tr_b16 a[254:255], v205 offset:36864
 s_waitcnt vmcnt(4)
 v_mfma_f32_16x16x32_bf16 a[84:87], a[240:243], v[100:103], a[84:87]
 buffer_load_dwordx4 v217, s[28:31], s46 offen offset:3072 nt lds
 v_mfma_f32_16x16x32_bf16 a[88:91], a[240:243], v[104:107], a[88:91]
 v_exp_f32 v182, v70
 v_mfma_f32_16x16x32_bf16 a[92:95], a[240:243], v[108:111], a[92:95]
 v_exp_f32 v183, v71
 v_mfma_f32_16x16x32_bf16 a[96:99], a[240:243], v[112:115], a[96:99]
 v_exp_f32 v176, v72
 v_mfma_f32_16x16x32_bf16 a[100:103], a[244:247], v[96:99], a[100:103]
 ds_read_b128 a[240:243], v190 offset:49152
 v_cvt_pk_bf16_f32 v122, v180, v181
 v_mfma_f32_16x16x32_bf16 a[104:107], a[244:247], v[100:103], a[104:107]
 v_exp_f32 v177, v73
 v_mfma_f32_16x16x32_bf16 a[108:111], a[244:247], v[104:107], a[108:111]
 v_exp_f32 v178, v74
 v_mfma_f32_16x16x32_bf16 a[112:115], a[244:247], v[108:111], a[112:115]
 v_cvt_pk_bf16_f32 v123, v182, v183
 v_cvt_pk_bf16_f32 v124, v176, v177
 v_mfma_f32_16x16x32_bf16 a[116:119], a[244:247], v[112:115], a[116:119]
 ds_read_b128 a[244:247], v191 offset:49152
 s_waitcnt lgkmcnt(2)
 v_mfma_f32_16x16x32_bf16 a[120:123], a[248:251], v[96:99], a[120:123]
 v_exp_f32 v179, v75
 v_mfma_f32_16x16x32_bf16 a[124:127], a[248:251], v[100:103], a[124:127]
 v_exp_f32 v180, v76
 v_mfma_f32_16x16x32_bf16 a[128:131], a[248:251], v[104:107], a[128:131]
 v_cvt_pk_bf16_f32 v125, v178, v179
 s_waitcnt vmcnt(4)
 v_mfma_f32_16x16x32_bf16 a[132:135], a[248:251], v[108:111], a[132:135]
 s_add_u32 m0, s44, 65536
 s_mov_b32 s46, 147456
 v_mfma_f32_16x16x32_bf16 a[136:139], a[248:251], v[112:115], a[136:139]
 buffer_load_dwordx4 v218, s[32:35], s46 offen offset:0 nt lds
 v_mfma_f32_16x16x32_bf16 a[140:143], a[252:255], v[96:99], a[140:143]
 ds_read_b128 a[248:251], v192 offset:49152
 v_or3_b32 v188, v116, v117, v118
 v_mfma_f32_16x16x32_bf16 a[144:147], a[252:255], v[100:103], a[144:147]
 v_exp_f32 v181, v77
 v_mfma_f32_16x16x32_bf16 a[148:151], a[252:255], v[104:107], a[148:151]
 v_exp_f32 v182, v78
 v_mfma_f32_16x16x32_bf16 a[152:155], a[252:255], v[108:111], a[152:155]
 v_exp_f32 v183, v79
 v_mfma_f32_16x16x32_bf16 a[156:159], a[252:255], v[112:115], a[156:159]
 ds_read_b128 a[252:255], v193 offset:49152
 s_waitcnt lgkmcnt(2)
 v_mfma_f32_16x16x32_bf16 v[16:19], a[240:243], a[160:163], v[136:139]
 v_exp_f32 v176, v80
 v_mfma_f32_16x16x32_bf16 v[24:27], a[240:243], a[176:179], v[140:143]
 v_exp_f32 v177, v81
 v_mfma_f32_16x16x32_bf16 v[32:35], a[240:243], a[192:195], v[144:147]
 v_exp_f32 v178, v82
 v_mfma_f32_16x16x32_bf16 v[40:43], a[240:243], a[208:211], v[148:151]
 v_cvt_pk_bf16_f32 v126, v180, v181
 v_cvt_pk_bf16_f32 v127, v182, v183
 v_mfma_f32_16x16x32_bf16 v[48:51], a[240:243], a[224:227], v[152:155]
 v_exp_f32 v179, v83
 v_mfma_f32_16x16x32_bf16 v[16:19], a[244:247], a[164:167], v[16:19]
 ds_read_b128 a[240:243], v190 offset:53248
 s_waitcnt vmcnt(4)
 v_mfma_f32_16x16x32_bf16 v[24:27], a[244:247], a[180:183], v[24:27]
 buffer_load_dwordx4 v219, s[32:35], s46 offen offset:1024 nt lds
 v_mfma_f32_16x16x32_bf16 v[32:35], a[244:247], a[196:199], v[32:35]
 v_exp_f32 v180, v84
 v_mfma_f32_16x16x32_bf16 v[40:43], a[244:247], a[212:215], v[40:43]
 v_exp_f32 v181, v85
 v_mfma_f32_16x16x32_bf16 v[48:51], a[244:247], a[228:231], v[48:51]
 ds_read_b128 a[244:247], v191 offset:53248
 s_waitcnt lgkmcnt(2)
 v_mfma_f32_16x16x32_bf16 v[16:19], a[248:251], a[168:171], v[16:19]
 v_exp_f32 v182, v86
 v_mfma_f32_16x16x32_bf16 v[24:27], a[248:251], a[184:187], v[24:27]
 v_cvt_pk_bf16_f32 v128, v176, v177
 v_cvt_pk_bf16_f32 v129, v178, v179
 v_mfma_f32_16x16x32_bf16 v[32:35], a[248:251], a[200:203], v[32:35]
 v_exp_f32 v183, v87
 v_mfma_f32_16x16x32_bf16 v[40:43], a[248:251], a[216:219], v[40:43]
 v_exp_f32 v176, v88
 v_mfma_f32_16x16x32_bf16 v[48:51], a[248:251], a[232:235], v[48:51]
 ds_read_b128 a[248:251], v192 offset:53248
 v_cvt_pk_bf16_f32 v130, v180, v181
 v_mfma_f32_16x16x32_bf16 v[16:19], a[252:255], a[172:175], v[16:19]
 v_exp_f32 v177, v89
 v_mfma_f32_16x16x32_bf16 v[24:27], a[252:255], a[188:191], v[24:27]
 v_cvt_pk_bf16_f32 v131, v182, v183
 v_cvt_pk_bf16_f32 v132, v176, v177
 v_mfma_f32_16x16x32_bf16 v[32:35], a[252:255], a[204:207], v[32:35]
 v_exp_f32 v178, v90
 v_mfma_f32_16x16x32_bf16 v[40:43], a[252:255], a[220:223], v[40:43]
 s_waitcnt vmcnt(4)
 v_or3_b32 v188, v188, v119, v120
 v_mfma_f32_16x16x32_bf16 v[48:51], a[252:255], a[236:239], v[48:51]
 ds_read_b128 a[252:255], v193 offset:53248
 s_waitcnt lgkmcnt(2)
 v_mfma_f32_16x16x32_bf16 v[20:23], a[240:243], a[160:163], v[136:139]
 buffer_load_dwordx4 v218, s[32:35], s46 offen offset:2048 nt lds
 v_mfma_f32_16x16x32_bf16 v[28:31], a[240:243], a[176:179], v[140:143]
 v_exp_f32 v179, v91
 v_mfma_f32_16x16x32_bf16 v[36:39], a[240:243], a[192:195], v[144:147]
 v_exp_f32 v180, v92
 v_mfma_f32_16x16x32_bf16 v[44:47], a[240:243], a[208:211], v[148:151]
 v_exp_f32 v181, v93
 v_mfma_f32_16x16x32_bf16 v[52:55], a[240:243], a[224:227], v[152:155]
 v_cvt_pk_bf16_f32 v133, v178, v179
 s_barrier
 v_mfma_f32_16x16x32_bf16 v[20:23], a[244:247], a[164:167], v[20:23]
 v_exp_f32 v182, v94
 v_mfma_f32_16x16x32_bf16 v[28:31], a[244:247], a[180:183], v[28:31]
 ds_read_b64_tr_b16 a[240:241], v198 offset:16384
 ds_read_b64_tr_b16 a[242:243], v198 offset:20480
 v_mfma_f32_16x16x32_bf16 v[36:39], a[244:247], a[196:199], v[36:39]
 v_exp_f32 v183, v95
 v_mfma_f32_16x16x32_bf16 v[44:47], a[244:247], a[212:215], v[44:47]
 v_cvt_pk_bf16_f32 v134, v180, v181
 v_cvt_pk_bf16_f32 v135, v182, v183
 v_mfma_f32_16x16x32_bf16 v[52:55], a[244:247], a[228:231], v[52:55]
 ds_read_b64_tr_b16 a[244:245], v199 offset:16384
 s_waitcnt lgkmcnt(3)
 v_mfma_f32_16x16x32_bf16 v[20:23], a[248:251], a[168:171], v[20:23]
 ds_read_b64_tr_b16 a[246:247], v199 offset:20480
 s_waitcnt vmcnt(4)
 v_mfma_f32_16x16x32_bf16 v[28:31], a[248:251], a[184:187], v[28:31]
 buffer_load_dwordx4 v219, s[32:35], s46 offen offset:3072 nt lds
 v_mfma_f32_16x16x32_bf16 v[36:39], a[248:251], a[200:203], v[36:39]
 v_or3_b32 v188, v188, v121, v122
 v_or3_b32 v188, v188, v123, v124
 v_mfma_f32_16x16x32_bf16 v[44:47], a[248:251], a[216:219], v[44:47]
 v_or3_b32 v188, v188, v125, v126
 v_or3_b32 v188, v188, v127, v128
 v_mfma_f32_16x16x32_bf16 v[52:55], a[248:251], a[232:235], v[52:55]
 ds_read_b64_tr_b16 a[248:249], v200 offset:16384
 ds_read_b64_tr_b16 a[250:251], v200 offset:20480
 v_mfma_f32_16x16x32_bf16 v[20:23], a[252:255], a[172:175], v[20:23]
 v_or3_b32 v188, v188, v129, v130
 v_or3_b32 v188, v188, v131, v132
 v_mfma_f32_16x16x32_bf16 v[28:31], a[252:255], a[188:191], v[28:31]
 v_or3_b32 v188, v188, v133, v134
 v_bitop3_b32 v188, v188, v135, s45 bitop3:0xa8
 v_mfma_f32_16x16x32_bf16 v[36:39], a[252:255], a[204:207], v[36:39]
 v_cmp_ne_u32 vcc, 0, v188
 v_mfma_f32_16x16x32_bf16 v[44:47], a[252:255], a[220:223], v[44:47]
 v_mfma_f32_16x16x32_bf16 v[52:55], a[252:255], a[236:239], v[52:55]
 s_cbranch_vccnz L_rarea8
L_rarea8_back:
 v_mfma_f32_16x16x32_bf16 v[156:159], v[184:187], v[116:119], v[156:159]
 s_waitcnt vmcnt(4)
 s_add_u32 m0, s44, 16384
 v_mfma_f32_16x16x32_bf16 v[160:163], v[184:187], v[120:123], v[160:163]
 v_exp_f32 v176, v16
 v_mfma_f32_16x16x32_bf16 v[164:167], v[184:187], v[124:127], v[164:167]
 s_mov_b32 s46, 180224
 v_mfma_f32_16x16x32_bf16 v[168:171], v[184:187], v[128:131], v[168:171]
 buffer_load_dwordx4 v214, s[28:31], s46 offen offset:0 nt lds
 v_mfma_f32_16x16x32_bf16 v[172:175], v[184:187], v[132:135], v[172:175]
 ds_read_b64_tr_b16 a[252:253], v201 offset:16384
 s_waitcnt lgkmcnt(3)
 v_mfma_f32_16x16x32_bf16 a[0:3], a[240:243], v[116:119], a[0:3]
 v_exp_f32 v177, v17
 v_mfma_f32_16x16x32_bf16 a[4:7], a[240:243], v[120:123], a[4:7]
 ds_read_b64_tr_b16 a[254:255], v201 offset:20480
 v_cvt_pk_bf16_f32 v96, v176, v177
 v_mfma_f32_16x16x32_bf16 a[8:11], a[240:243], v[124:127], a[8:11]
 v_exp_f32 v178, v18
 v_mfma_f32_16x16x32_bf16 a[12:15], a[240:243], v[128:131], a[12:15]
 v_exp_f32 v179, v19
 v_mfma_f32_16x16x32_bf16 a[16:19], a[240:243], v[132:135], a[16:19]
 v_exp_f32 v180, v20
 v_mfma_f32_16x16x32_bf16 a[20:23], a[244:247], v[116:119], a[20:23]
 ds_read_b64_tr_b16 a[240:241], v202 offset:16384
 ds_read_b64_tr_b16 a[242:243], v202 offset:20480
 v_mfma_f32_16x16x32_bf16 a[24:27], a[244:247], v[120:123], a[24:27]
 v_exp_f32 v181, v21
 v_mfma_f32_16x16x32_bf16 a[28:31], a[244:247], v[124:127], a[28:31]
 v_exp_f32 v182, v22
 v_mfma_f32_16x16x32_bf16 a[32:35], a[244:247], v[128:131], a[32:35]
 v_exp_f32 v183, v23
 v_mfma_f32_16x16x32_bf16 a[36:39], a[244:247], v[132:135], a[36:39]
 ds_read_b64_tr_b16 a[244:245], v203 offset:16384
 s_waitcnt lgkmcnt(3)
 v_mfma_f32_16x16x32_bf16 a[40:43], a[248:251], v[116:119], a[40:43]
 ds_read_b64_tr_b16 a[246:247], v203 offset:20480
 s_waitcnt vmcnt(4)
 v_mfma_f32_16x16x32_bf16 a[44:47], a[248:251], v[120:123], a[44:47]
 buffer_load_dwordx4 v215, s[28:31], s46 offen offset:1024 nt lds
 v_mfma_f32_16x16x32_bf16 a[48:51], a[248:251], v[124:127], a[48:51]
 v_exp_f32 v176, v24
 v_mfma_f32_16x16x32_bf16 a[52:55], a[248:251], v[128:131], a[52:55]
 v_cvt_pk_bf16_f32 v97, v178, v179
 v_cvt_pk_bf16_f32 v98, v180, v181
 v_mfma_f32_16x16x32_bf16 a[56:59], a[248:251], v[132:135], a[56:59]
 v_exp_f32 v177, v25
 v_mfma_f32_16x16x32_bf16 a[60:63], a[252:255], v[116:119], a[60:63]
 ds_read_b64_tr_b16 a[248:249], v204 offset:16384
 ds_read_b64_tr_b16 a[250:251], v204 offset:20480
 v_mfma_f32_16x16x32_bf16 a[64:67], a[252:255], v[120:123], a[64:67]
 v_exp_f32 v178, v26
 v_mfma_f32_16x16x32_bf16 a[68:71], a[252:255], v[124:127], a[68:71]
 v_exp_f32 v179, v27
 v_mfma_f32_16x16x32_bf16 a[72:75], a[252:255], v[128:131], a[72:75]
 v_exp_f32 v180, v28
 v_mfma_f32_16x16x32_bf16 a[76:79], a[252:255], v[132:135], a[76:79]
 v_cvt_pk_bf16_f32 v99, v182, v183
 s_waitcnt lgkmcnt(2)
 v_mfma_f32_16x16x32_bf16 a[80:83], a[240:243], v[116:119], a[80:83]
 ds_read_b64_tr_b16 a[252:253], v205 offset:16384
 ds_read_b64_tr_b16 a[254:255], v205 offset:20480
 v_mfma_f32_16x16x32_bf16 a[84:87], a[240:243], v[120:123], a[84:87]
 v_exp_f32 v181, v29
 v_mfma_f32_16x16x32_bf16 a[88:91], a[240:243], v[124:127], a[88:91]
 v_exp_f32 v182, v30
 v_mfma_f32_16x16x32_bf16 a[92:95], a[240:243], v[128:131], a[92:95]
 v_cvt_pk_bf16_f32 v100, v176, v177
 s_waitcnt vmcnt(4)
 v_mfma_f32_16x16x32_bf16 a[96:99], a[240:243], v[132:135], a[96:99]
 buffer_load_dwordx4 v216, s[28:31], s46 offen offset:2048 nt lds
 v_mfma_f32_16x16x32_bf16 a[100:103], a[244:247], v[116:119], a[100:103]
 ds_read_b128 a[240:243], v194 offset:0
 v_cvt_pk_bf16_f32 v101, v178, v179
 v_mfma_f32_16x16x32_bf16 a[104:107], a[244:247], v[120:123], a[104:107]
 v_exp_f32 v183, v31
 v_mfma_f32_16x16x32_bf16 a[108:111], a[244:247], v[124:127], a[108:111]
 v_exp_f32 v176, v32
 v_mfma_f32_16x16x32_bf16 a[112:115], a[244:247], v[128:131], a[112:115]
 v_exp_f32 v177, v33
 v_mfma_f32_16x16x32_bf16 a[116:119], a[244:247], v[132:135], a[116:119]
 ds_read_b128 a[244:247], v195 offset:0
 s_waitcnt lgkmcnt(2)
 v_mfma_f32_16x16x32_bf16 a[120:123], a[248:251], v[116:119], a[120:123]
 v_exp_f32 v178, v34
 v_mfma_f32_16x16x32_bf16 a[124:127], a[248:251], v[120:123], a[124:127]
 v_cvt_pk_bf16_f32 v102, v180, v181
 v_cvt_pk_bf16_f32 v103, v182, v183
 v_mfma_f32_16x16x32_bf16 a[128:131], a[248:251], v[124:127], a[128:131]
 v_exp_f32 v179, v35
 v_mfma_f32_16x16x32_bf16 a[132:135], a[248:251], v[128:131], a[132:135]
 v_exp_f32 v180, v36
 v_mfma_f32_16x16x32_bf16 a[136:139], a[248:251], v[132:135], a[136:139]
 v_exp_f32 v181, v37
 v_mfma_f32_16x16x32_bf16 a[140:143], a[252:255], v[116:119], a[140:143]
 ds_read_b128 a[248:251], v196 offset:0
 s_waitcnt vmcnt(4)
 v_mfma_f32_16x16x32_bf16 a[144:147], a[252:255], v[120:123], a[144:147]
 buffer_load_dwordx4 v217, s[28:31], s46 offen offset:3072 nt lds
 v_mfma_f32_16x16x32_bf16 a[148:151], a[252:255], v[124:127], a[148:151]
 v_exp_f32 v182, v38
 v_mfma_f32_16x16x32_bf16 a[152:155], a[252:255], v[128:131], a[152:155]
 v_cvt_pk_bf16_f32 v104, v176, v177
 v_cvt_pk_bf16_f32 v105, v178, v179
 v_mfma_f32_16x16x32_bf16 a[156:159], a[252:255], v[132:135], a[156:159]
 ds_read_b128 a[252:255], v197 offset:0
 s_waitcnt lgkmcnt(2)
 v_mfma_f32_16x16x32_bf16 v[56:59], a[240:243], a[160:163], v[136:139]
 v_exp_f32 v183, v39
 v_mfma_f32_16x16x32_bf16 v[64:67], a[240:243], a[176:179], v[140:143]
 v_exp_f32 v176, v40
 v_mfma_f32_16x16x32_bf16 v[72:75], a[240:243], a[192:195], v[144:147]
 v_exp_f32 v177, v41
 v_mfma_f32_16x16x32_bf16 v[80:83], a[240:243], a[208:211], v[148:151]
 v_exp_f32 v178, v42
 v_mfma_f32_16x16x32_bf16 v[88:91], a[240:243], a[224:227], v[152:155]
 v_cvt_pk_bf16_f32 v106, v180, v181
 ds_read_b128 a[240:243], v194 offset:4096
 v_mfma_f32_16x16x32_bf16 v[56:59], a[244:247], a[164:167], v[56:59]
 v_exp_f32 v179, v43
 v_mfma_f32_16x16x32_bf16 v[64:67], a[244:247], a[180:183], v[64:67]
 v_exp_f32 v180, v44
 v_mfma_f32_16x16x32_bf16 v[72:75], a[244:247], a[196:199], v[72:75]
 v_cvt_pk_bf16_f32 v107, v182, v183
 s_waitcnt vmcnt(4)
 v_mfma_f32_16x16x32_bf16 v[80:83], a[244:247], a[212:215], v[80:83]
 s_add_u32 m0, s44, 98304
 s_mov_b32 s46, 163840
 v_mfma_f32_16x16x32_bf16 v[88:91], a[244:247], a[228:231], v[88:91]
 buffer_load_dwordx4 v218, s[32:35], s46 offen offset:0 nt lds
 s_waitcnt lgkmcnt(1)
 v_mfma_f32_16x16x32_bf16 v[56:59], a[248:251], a[168:171], v[56:59]
 ds_read_b128 a[244:247], v195 offset:4096
 v_cvt_pk_bf16_f32 v108, v176, v177
 v_mfma_f32_16x16x32_bf16 v[64:67], a[248:251], a[184:187], v[64:67]
 v_exp_f32 v181, v45
 v_mfma_f32_16x16x32_bf16 v[72:75], a[248:251], a[200:203], v[72:75]
 v_exp_f32 v182, v46
 v_mfma_f32_16x16x32_bf16 v[80:83], a[248:251], a[216:219], v[80:83]
 v_exp_f32 v183, v47
 v_mfma_f32_16x16x32_bf16 v[88:91], a[248:251], a[232:235], v[88:91]
 v_exp_f32 v176, v48
 v_mfma_f32_16x16x32_bf16 v[56:59], a[252:255], a[172:175], v[56:59]
 v_cvt_pk_bf16_f32 v109, v178, v179
 ds_read_b128 a[248:251], v196 offset:4096
 v_mfma_f32_16x16x32_bf16 v[64:67], a[252:255], a[188:191], v[64:67]
 v_exp_f32 v177, v49
 v_mfma_f32_16x16x32_bf16 v[72:75], a[252:255], a[204:207], v[72:75]
 v_exp_f32 v178, v50
 v_mfma_f32_16x16x32_bf16 v[80:83], a[252:255], a[220:223], v[80:83]
 v_cvt_pk_bf16_f32 v110, v180, v181
 v_cvt_pk_bf16_f32 v111, v182, v183
 v_mfma_f32_16x16x32_bf16 v[88:91], a[252:255], a[236:239], v[88:91]
 ds_read_b128 a[252:255], v197 offset:4096
 s_waitcnt lgkmcnt(2)
 v_mfma_f32_16x16x32_bf16 v[60:63], a[240:243], a[160:163], v[136:139]
 v_exp_f32 v179, v51
 v_mfma_f32_16x16x32_bf16 v[68:71], a[240:243], a[176:179], v[140:143]
 s_waitcnt vmcnt(4)
 buffer_load_dwordx4 v219, s[32:35], s46 offen offset:1024 nt lds
 v_mfma_f32_16x16x32_bf16 v[76:79], a[240:243], a[192:195], v[144:147]
 v_exp_f32 v180, v52
 v_mfma_f32_16x16x32_bf16 v[84:87], a[240:243], a[208:211], v[148:151]
 v_exp_f32 v181, v53
 v_mfma_f32_16x16x32_bf16 v[92:95], a[240:243], a[224:227], v[152:155]
 v_cvt_pk_bf16_f32 v112, v176, v177
 s_barrier
 v_mfma_f32_16x16x32_bf16 v[60:63], a[244:247], a[164:167], v[60:63]
 v_exp_f32 v182, v54
 v_mfma_f32_16x16x32_bf16 v[68:71], a[244:247], a[180:183], v[68:71]
 ds_read_b64_tr_b16 a[240:241], v198 offset:49152
 ds_read_b64_tr_b16 a[242:243], v198 offset:53248
 v_mfma_f32_16x16x32_bf16 v[76:79], a[244:247], a[196:199], v[76:79]
 v_exp_f32 v183, v55
 v_mfma_f32_16x16x32_bf16 v[84:87], a[244:247], a[212:215], v[84:87]
 v_cvt_pk_bf16_f32 v113, v178, v179
 v_cvt_pk_bf16_f32 v114, v180, v181
 v_mfma_f32_16x16x32_bf16 v[92:95], a[244:247], a[228:231], v[92:95]
 ds_read_b64_tr_b16 a[244:245], v199 offset:49152
 s_waitcnt lgkmcnt(3)
 v_mfma_f32_16x16x32_bf16 v[60:63], a[248:251], a[168:171], v[60:63]
 ds_read_b64_tr_b16 a[246:247], v199 offset:53248
 v_cvt_pk_bf16_f32 v115, v182, v183
 v_mfma_f32_16x16x32_bf16 v[68:71], a[248:251], a[184:187], v[68:71]
 v_or3_b32 v188, v96, v97, v98
 v_or3_b32 v188, v188, v99, v100
 v_mfma_f32_16x16x32_bf16 v[76:79], a[248:251], a[200:203], v[76:79]
 s_waitcnt vmcnt(4)
 v_or3_b32 v188, v188, v101, v102
 v_mfma_f32_16x16x32_bf16 v[84:87], a[248:251], a[216:219], v[84:87]
 buffer_load_dwordx4 v218, s[32:35], s46 offen offset:2048 nt lds
 v_mfma_f32_16x16x32_bf16 v[92:95], a[248:251], a[232:235], v[92:95]
 ds_read_b64_tr_b16 a[248:249], v200 offset:49152
 ds_read_b64_tr_b16 a[250:251], v200 offset:53248
 v_mfma_f32_16x16x32_bf16 v[60:63], a[252:255], a[172:175], v[60:63]
 v_or3_b32 v188, v188, v103, v104
 v_or3_b32 v188, v188, v105, v106
 v_mfma_f32_16x16x32_bf16 v[68:71], a[252:255], a[188:191], v[68:71]
 v_or3_b32 v188, v188, v107, v108
 v_or3_b32 v188, v188, v109, v110
 v_mfma_f32_16x16x32_bf16 v[76:79], a[252:255], a[204:207], v[76:79]
 v_or3_b32 v188, v188, v111, v112
 v_or3_b32 v188, v188, v113, v114
 v_mfma_f32_16x16x32_bf16 v[84:87], a[252:255], a[220:223], v[84:87]
 v_bitop3_b32 v188, v188, v115, s45 bitop3:0xa8
 v_cmp_ne_u32 vcc, 0, v188
 v_mfma_f32_16x16x32_bf16 v[92:95], a[252:255], a[236:239], v[92:95]
 s_cbranch_vccnz L_rarea9
L_rarea9_back:
 v_mfma_f32_16x16x32_bf16 v[156:159], v[184:187], v[96:99], v[156:159]
 v_mfma_f32_16x16x32_bf16 v[160:163], v[184:187], v[100:103], v[160:163]
 v_exp_f32 v176, v56
 v_mfma_f32_16x16x32_bf16 v[164:167], v[184:187], v[104:107], v[164:167]
 v_exp_f32 v177, v57
 v_mfma_f32_16x16x32_bf16 v[168:171], v[184:187], v[108:111], v[168:171]
 v_exp_f32 v178, v58
 v_mfma_f32_16x16x32_bf16 v[172:175], v[184:187], v[112:115], v[172:175]
 ds_read_b64_tr_b16 a[252:253], v201 offset:49152
 s_waitcnt lgkmcnt(3)
 v_mfma_f32_16x16x32_bf16 a[0:3], a[240:243], v[96:99], a[0:3]
 ds_read_b64_tr_b16 a[254:255], v201 offset:53248
 s_waitcnt vmcnt(4)
 v_mfma_f32_16x16x32_bf16 a[4:7], a[240:243], v[100:103], a[4:7]
 buffer_load_dwordx4 v219, s[32:35], s46 offen offset:3072 nt lds
 v_mfma_f32_16x16x32_bf16 a[8:11], a[240:243], v[104:107], a[8:11]
 v_exp_f32 v179, v59
 v_mfma_f32_16x16x32_bf16 a[12:15], a[240:243], v[108:111], a[12:15]
 v_exp_f32 v180, v60
 v_mfma_f32_16x16x32_bf16 a[16:19], a[240:243], v[112:115], a[16:19]
 v_exp_f32 v181, v61
 v_mfma_f32_16x16x32_bf16 a[20:23], a[244:247], v[96:99], a[20:23]
 ds_read_b64_tr_b16 a[240:241], v202 offset:49152
 ds_read_b64_tr_b16 a[242:243], v202 offset:53248
 v_mfma_f32_16x16x32_bf16 a[24:27], a[244:247], v[100:103], a[24:27]
 v_exp_f32 v182, v62
 v_mfma_f32_16x16x32_bf16 a[28:31], a[244:247], v[104:107], a[28:31]
 v_cvt_pk_bf16_f32 v116, v176, v177
 v_cvt_pk_bf16_f32 v117, v178, v179
 v_mfma_f32_16x16x32_bf16 a[32:35], a[244:247], v[108:111], a[32:35]
 v_exp_f32 v183, v63
 v_mfma_f32_16x16x32_bf16 a[36:39], a[244:247], v[112:115], a[36:39]
 ds_read_b64_tr_b16 a[244:245], v203 offset:49152
 s_waitcnt lgkmcnt(3)
 v_mfma_f32_16x16x32_bf16 a[40:43], a[248:251], v[96:99], a[40:43]
 ds_read_b64_tr_b16 a[246:247], v203 offset:53248
 v_cvt_pk_bf16_f32 v118, v180, v181
 v_mfma_f32_16x16x32_bf16 a[44:47], a[248:251], v[100:103], a[44:47]
 v_exp_f32 v176, v64
 v_mfma_f32_16x16x32_bf16 a[48:51], a[248:251], v[104:107], a[48:51]
 v_exp_f32 v177, v65
 v_mfma_f32_16x16x32_bf16 a[52:55], a[248:251], v[108:111], a[52:55]
 v_exp_f32 v178, v66
 v_mfma_f32_16x16x32_bf16 a[56:59], a[248:251], v[112:115], a[56:59]
 s_waitcnt vmcnt(4)
 s_add_u32 m0, s44, 32768
 s_mov_b32 s46, 196608
 buffer_load_dwordx4 v214, s[28:31], s46 offen offset:0 nt lds
 v_mfma_f32_16x16x32_bf16 a[60:63], a[252:255], v[96:99], a[60:63]
 ds_read_b64_tr_b16 a[248:249], v204 offset:49152
 ds_read_b64_tr_b16 a[250:251], v204 offset:53248
 v_mfma_f32_16x16x32_bf16 a[64:67], a[252:255], v[100:103], a[64:67]
 v_exp_f32 v179, v67
 v_mfma_f32_16x16x32_bf16 a[68:71], a[252:255], v[104:107], a[68:71]
 v_exp_f32 v180, v68
 v_mfma_f32_16x16x32_bf16 a[72:75], a[252:255], v[108:111], a[72:75]
 v_cvt_pk_bf16_f32 v119, v182, v183
 v_cvt_pk_bf16_f32 v120, v176, v177
 v_mfma_f32_16x16x32_bf16 a[76:79], a[252:255], v[112:115], a[76:79]
 ds_read_b64_tr_b16 a[252:253], v205 offset:49152
 s_waitcnt lgkmcnt(3)
 v_mfma_f32_16x16x32_bf16 a[80:83], a[240:243], v[96:99], a[80:83]
 ds_read_b64_tr_b16 a[254:255], v205 offset:53248
 v_cvt_pk_bf16_f32 v121, v178, v179
 v_mfma_f32_16x16x32_bf16 a[84:87], a[240:243], v[100:103], a[84:87]
 v_exp_f32 v181, v69
 v_mfma_f32_16x16x32_bf16 a[88:91], a[240:243], v[104:107], a[88:91]
 v_exp_f32 v182, v70
 v_mfma_f32_16x16x32_bf16 a[92:95], a[240:243], v[108:111], a[92:95]
 v_exp_f32 v183, v71
 v_mfma_f32_16x16x32_bf16 a[96:99], a[240:243], v[112:115], a[96:99]
 v_exp_f32 v176, v72
 v_mfma_f32_16x16x32_bf16 a[100:103], a[244:247], v[96:99], a[100:103]
 ds_read_b128 a[240:243], v190 offset:0
 s_waitcnt vmcnt(4)
 v_mfma_f32_16x16x32_bf16 a[104:107], a[244:247], v[100:103], a[104:107]
 buffer_load_dwordx4 v215, s[28:31], s46 offen offset:1024 nt lds
 v_mfma_f32_16x16x32_bf16 a[108:111], a[244:247], v[104:107], a[108:111]
 v_exp_f32 v177, v73
 v_mfma_f32_16x16x32_bf16 a[112:115], a[244:247], v[108:111], a[112:115]
 v_exp_f32 v178, v74
 v_mfma_f32_16x16x32_bf16 a[116:119], a[244:247], v[112:115], a[116:119]
 v_cvt_pk_bf16_f32 v122, v180, v181
 s_waitcnt lgkmcnt(1)
 v_mfma_f32_16x16x32_bf16 a[120:123], a[248:251], v[96:99], a[120:123]
 ds_read_b128 a[244:247], v191 offset:0
 v_cvt_pk_bf16_f32 v123, v182, v183
 v_mfma_f32_16x16x32_bf16 a[124:127], a[248:251], v[100:103], a[124:127]
 v_exp_f32 v179, v75
 v_mfma_f32_16x16x32_bf16 a[128:131], a[248:251], v[104:107], a[128:131]
 v_exp_f32 v180, v76
 v_mfma_f32_16x16x32_bf16 a[132:135], a[248:251], v[108:111], a[132:135]
 v_exp_f32 v181, v77
 v_mfma_f32_16x16x32_bf16 a[136:139], a[248:251], v[112:115], a[136:139]
 v_exp_f32 v182, v78
 v_mfma_f32_16x16x32_bf16 a[140:143], a[252:255], v[96:99], a[140:143]
 v_cvt_pk_bf16_f32 v124, v176, v177
 ds_read_b128 a[248:251], v192 offset:0
 v_mfma_f32_16x16x32_bf16 a[144:147], a[252:255], v[100:103], a[144:147]
 v_exp_f32 v183, v79
 v_mfma_f32_16x16x32_bf16 a[148:151], a[252:255], v[104:107], a[148:151]
 s_waitcnt vmcnt(4)
 v_cvt_pk_bf16_f32 v125, v178, v179
 v_mfma_f32_16x16x32_bf16 a[152:155], a[252:255], v[108:111], a[152:155]
 buffer_load_dwordx4 v216, s[28:31], s46 offen offset:2048 nt lds
 v_mfma_f32_16x16x32_bf16 a[156:159], a[252:255], v[112:115], a[156:159]
 ds_read_b128 a[252:255], v193 offset:0
 s_waitcnt lgkmcnt(2)
 v_mfma_f32_16x16x32_bf16 v[16:19], a[240:243], a[160:163], v[136:139]
 v_exp_f32 v176, v80
 v_mfma_f32_16x16x32_bf16 v[24:27], a[240:243], a[176:179], v[140:143]
 v_exp_f32 v177, v81
 v_mfma_f32_16x16x32_bf16 v[32:35], a[240:243], a[192:195], v[144:147]
 v_exp_f32 v178, v82
 v_mfma_f32_16x16x32_bf16 v[40:43], a[240:243], a[208:211], v[148:151]
 v_cvt_pk_bf16_f32 v126, v180, v181
 v_cvt_pk_bf16_f32 v127, v182, v183
 v_mfma_f32_16x16x32_bf16 v[48:51], a[240:243], a[224:227], v[152:155]
 v_exp_f32 v179, v83
 v_mfma_f32_16x16x32_bf16 v[16:19], a[244:247], a[164:167], v[16:19]
 ds_read_b128 a[240:243], v190 offset:4096
 v_cvt_pk_bf16_f32 v128, v176, v177
 v_mfma_f32_16x16x32_bf16 v[24:27], a[244:247], a[180:183], v[24:27]
 v_exp_f32 v180, v84
 v_mfma_f32_16x16x32_bf16 v[32:35], a[244:247], a[196:199], v[32:35]
 v_cvt_pk_bf16_f32 v129, v178, v179
 s_waitcnt vmcnt(4)
 v_mfma_f32_16x16x32_bf16 v[40:43], a[244:247], a[212:215], v[40:43]
 buffer_load_dwordx4 v217, s[28:31], s46 offen offset:3072 nt lds
 v_mfma_f32_16x16x32_bf16 v[48:51], a[244:247], a[228:231], v[48:51]
 ds_read_b128 a[244:247], v191 offset:4096
 s_waitcnt lgkmcnt(2)
 v_mfma_f32_16x16x32_bf16 v[16:19], a[248:251], a[168:171], v[16:19]
 v_exp_f32 v181, v85
 v_mfma_f32_16x16x32_bf16 v[24:27], a[248:251], a[184:187], v[24:27]
 v_exp_f32 v182, v86
 v_mfma_f32_16x16x32_bf16 v[32:35], a[248:251], a[200:203], v[32:35]
 v_exp_f32 v183, v87
 v_mfma_f32_16x16x32_bf16 v[40:43], a[248:251], a[216:219], v[40:43]
 v_exp_f32 v176, v88
 v_mfma_f32_16x16x32_bf16 v[48:51], a[248:251], a[232:235], v[48:51]
 ds_read_b128 a[248:251], v192 offset:4096
 v_cvt_pk_bf16_f32 v130, v180, v181
 v_mfma_f32_16x16x32_bf16 v[16:19], a[252:255], a[172:175], v[16:19]
 v_exp_f32 v177, v89
 v_mfma_f32_16x16x32_bf16 v[24:27], a[252:255], a[188:191], v[24:27]
 v_cvt_pk_bf16_f32 v131, v182, v183
 v_cvt_pk_bf16_f32 v132, v176, v177
 v_mfma_f32_16x16x32_bf16 v[32:35], a[252:255], a[204:207], v[32:35]
 v_exp_f32 v178, v90
 v_mfma_f32_16x16x32_bf16 v[40:43], a[252:255], a[220:223], v[40:43]
 v_or3_b32 v188, v116, v117, v118
 v_or3_b32 v188, v188, v119, v120
 v_mfma_f32_16x16x32_bf16 v[48:51], a[252:255], a[236:239], v[48:51]
 ds_read_b128 a[252:255], v193 offset:4096
 s_waitcnt lgkmcnt(2)
 v_mfma_f32_16x16x32_bf16 v[20:23], a[240:243], a[160:163], v[136:139]
 v_exp_f32 v179, v91
 v_mfma_f32_16x16x32_bf16 v[28:31], a[240:243], a[176:179], v[140:143]
 v_exp_f32 v180, v92
 v_mfma_f32_16x16x32_bf16 v[36:39], a[240:243], a[192:195], v[144:147]
 s_waitcnt vmcnt(4)
 s_add_u32 m0, s44, 81920
 v_mfma_f32_16x16x32_bf16 v[44:47], a[240:243], a[208:211], v[148:151]
 s_mov_b32 s46, 180224
 buffer_load_dwordx4 v218, s[32:35], s46 offen offset:0 nt lds
 v_mfma_f32_16x16x32_bf16 v[52:55], a[240:243], a[224:227], v[152:155]
 v_cvt_pk_bf16_f32 v133, v178, v179
 s_barrier
 v_mfma_f32_16x16x32_bf16 v[20:23], a[244:247], a[164:167], v[20:23]
 v_exp_f32 v181, v93
 v_mfma_f32_16x16x32_bf16 v[28:31], a[244:247], a[180:183], v[28:31]
 ds_read_b64_tr_b16 a[240:241], v198 offset:0
 ds_read_b64_tr_b16 a[242:243], v198 offset:4096
 v_mfma_f32_16x16x32_bf16 v[36:39], a[244:247], a[196:199], v[36:39]
 v_exp_f32 v182, v94
 v_mfma_f32_16x16x32_bf16 v[44:47], a[244:247], a[212:215], v[44:47]
 v_exp_f32 v183, v95
 v_mfma_f32_16x16x32_bf16 v[52:55], a[244:247], a[228:231], v[52:55]
 ds_read_b64_tr_b16 a[244:245], v199 offset:0
 s_waitcnt lgkmcnt(3)
 v_mfma_f32_16x16x32_bf16 v[20:23], a[248:251], a[168:171], v[20:23]
 ds_read_b64_tr_b16 a[246:247], v199 offset:4096
 v_cvt_pk_bf16_f32 v134, v180, v181
 v_mfma_f32_16x16x32_bf16 v[28:31], a[248:251], a[184:187], v[28:31]
 v_cvt_pk_bf16_f32 v135, v182, v183
 v_or3_b32 v188, v188, v121, v122
 v_mfma_f32_16x16x32_bf16 v[36:39], a[248:251], a[200:203], v[36:39]
 v_or3_b32 v188, v188, v123, v124
 v_or3_b32 v188, v188, v125, v126
 v_mfma_f32_16x16x32_bf16 v[44:47], a[248:251], a[216:219], v[44:47]
 v_or3_b32 v188, v188, v127, v128
 v_or3_b32 v188, v188, v129, v130
 v_mfma_f32_16x16x32_bf16 v[52:55], a[248:251], a[232:235], v[52:55]
 ds_read_b64_tr_b16 a[248:249], v200 offset:0
 ds_read_b64_tr_b16 a[250:251], v200 offset:4096
 v_mfma_f32_16x16x32_bf16 v[20:23], a[252:255], a[172:175], v[20:23]
 s_waitcnt vmcnt(4)
 v_or3_b32 v188, v188, v131, v132
 v_mfma_f32_16x16x32_bf16 v[28:31], a[252:255], a[188:191], v[28:31]
 buffer_load_dwordx4 v219, s[32:35], s46 offen offset:1024 nt lds
 v_mfma_f32_16x16x32_bf16 v[36:39], a[252:255], a[204:207], v[36:39]
 v_or3_b32 v188, v188, v133, v134
 v_bitop3_b32 v188, v188, v135, s45 bitop3:0xa8
 v_mfma_f32_16x16x32_bf16 v[44:47], a[252:255], a[220:223], v[44:47]
 v_cmp_ne_u32 vcc, 0, v188
 v_mfma_f32_16x16x32_bf16 v[52:55], a[252:255], a[236:239], v[52:55]
 s_cbranch_vccnz L_rarea10
L_rarea10_back:
 v_mfma_f32_16x16x32_bf16 v[156:159], v[184:187], v[116:119], v[156:159]
 v_mfma_f32_16x16x32_bf16 v[160:163], v[184:187], v[120:123], v[160:163]
 v_exp_f32 v176, v16
 v_mfma_f32_16x16x32_bf16 v[164:167], v[184:187], v[124:127], v[164:167]
 v_exp_f32 v177, v17
 v_mfma_f32_16x16x32_bf16 v[168:171], v[184:187], v[128:131], v[168:171]
 v_exp_f32 v178, v18
 v_mfma_f32_16x16x32_bf16 v[172:175], v[184:187], v[132:135], v[172:175]
 ds_read_b64_tr_b16 a[252:253], v201 offset:0
 s_waitcnt lgkmcnt(3)
 v_mfma_f32_16x16x32_bf16 a[0:3], a[240:243], v[116:119], a[0:3]
 ds_read_b64_tr_b16 a[254:255], v201 offset:4096
 v_cvt_pk_bf16_f32 v96, v176, v177
 v_mfma_f32_16x16x32_bf16 a[4:7], a[240:243], v[120:123], a[4:7]
 v_exp_f32 v179, v19
 v_mfma_f32_16x16x32_bf16 a[8:11], a[240:243], v[124:127], a[8:11]
 v_exp_f32 v180, v20
 v_mfma_f32_16x16x32_bf16 a[12:15], a[240:243], v[128:131], a[12:15]
 s_waitcnt vmcnt(4)
 buffer_load_dwordx4 v218, s[32:35], s46 offen offset:2048 nt lds
 v_mfma_f32_16x16x32_bf16 a[16:19], a[240:243], v[132:135], a[16:19]
 v_exp_f32 v181, v21
 v_mfma_f32_16x16x32_bf16 a[20:23], a[244:247], v[116:119], a[20:23]
 ds_read_b64_tr_b16 a[240:241], v202 offset:0
 ds_read_b64_tr_b16 a[242:243], v202 offset:4096
 v_mfma_f32_16x16x32_bf16 a[24:27], a[244:247], v[120:123], a[24:27]
 v_exp_f32 v182, v22
 v_mfma_f32_16x16x32_bf16 a[28:31], a[244:247], v[124:127], a[28:31]
 v_exp_f32 v183, v23
 v_mfma_f32_16x16x32_bf16 a[32:35], a[244:247], v[128:131], a[32:35]
 v_exp_f32 v176, v24
 v_mfma_f32_16x16x32_bf16 a[36:39], a[244:247], v[132:135], a[36:39]
 v_cvt_pk_bf16_f32 v97, v178, v179
 s_waitcnt lgkmcnt(2)
 v_mfma_f32_16x16x32_bf16 a[40:43], a[248:251], v[116:119], a[40:43]
 ds_read_b64_tr_b16 a[244:245], v203 offset:0
 ds_read_b64_tr_b16 a[246:247], v203 offset:4096
 v_mfma_f32_16x16x32_bf16 a[44:47], a[248:251], v[120:123], a[44:47]
 v_exp_f32 v177, v25
 v_mfma_f32_16x16x32_bf16 a[48:51], a[248:251], v[124:127], a[48:51]
 v_exp_f32 v178, v26
 v_mfma_f32_16x16x32_bf16 a[52:55], a[248:251], v[128:131], a[52:55]
 v_cvt_pk_bf16_f32 v98, v180, v181
 s_waitcnt vmcnt(4)
 v_mfma_f32_16x16x32_bf16 a[56:59], a[248:251], v[132:135], a[56:59]
 buffer_load_dwordx4 v219, s[32:35], s46 offen offset:3072 nt lds
 v_mfma_f32_16x16x32_bf16 a[60:63], a[252:255], v[116:119], a[60:63]
 ds_read_b64_tr_b16 a[248:249], v204 offset:0
 ds_read_b64_tr_b16 a[250:251], v204 offset:4096
 v_mfma_f32_16x16x32_bf16 a[64:67], a[252:255], v[120:123], a[64:67]
 v_exp_f32 v179, v27
 v_mfma_f32_16x16x32_bf16 a[68:71], a[252:255], v[124:127], a[68:71]
 v_exp_f32 v180, v28
 v_mfma_f32_16x16x32_bf16 a[72:75], a[252:255], v[128:131], a[72:75]
 v_cvt_pk_bf16_f32 v99, v182, v183
 v_cvt_pk_bf16_f32 v100, v176, v177
 v_mfma_f32_16x16x32_bf16 a[76:79], a[252:255], v[132:135], a[76:79]
 ds_read_b64_tr_b16 a[252:253], v205 offset:0
 s_waitcnt lgkmcnt(3)
 v_mfma_f32_16x16x32_bf16 a[80:83], a[240:243], v[116:119], a[80:83]
 ds_read_b64_tr_b16 a[254:255], v205 offset:4096
 v_cvt_pk_bf16_f32 v101, v178, v179
 v_mfma_f32_16x16x32_bf16 a[84:87], a[240:243], v[120:123], a[84:87]
 v_exp_f32 v181, v29
 v_mfma_f32_16x16x32_bf16 a[88:91], a[240:243], v[124:127], a[88:91]
 v_exp_f32 v182, v30
 v_mfma_f32_16x16x32_bf16 a[92:95], a[240:243], v[128:131], a[92:95]
 v_exp_f32 v183, v31
 v_mfma_f32_16x16x32_bf16 a[96:99], a[240:243], v[132:135], a[96:99]
 v_exp_f32 v176, v32
 v_mfma_f32_16x16x32_bf16 a[100:103], a[244:247], v[116:119], a[100:103]
 ds_read_b128 a[240:243], v190 offset:16384
 v_cvt_pk_bf16_f32 v102, v180, v181
 v_mfma_f32_16x16x32_bf16 a[104:107], a[244:247], v[120:123], a[104:107]
 v_exp_f32 v177, v33
 v_mfma_f32_16x16x32_bf16 a[108:111], a[244:247], v[124:127], a[108:111]
 v_exp_f32 v178, v34
 v_mfma_f32_16x16x32_bf16 a[112:115], a[244:247], v[128:131], a[112:115]
 s_waitcnt vmcnt(4)
 s_add_u32 m0, s44, 49152
 s_mov_b32 s46, 212992
 buffer_load_dwordx4 v214, s[28:31], s46 offen offset:0 nt lds
 v_mfma_f32_16x16x32_bf16 a[116:119], a[244:247], v[132:135], a[116:119]
 ds_read_b128 a[244:247], v191 offset:16384
 s_waitcnt lgkmcnt(2)
 v_mfma_f32_16x16x32_bf16 a[120:123], a[248:251], v[116:119], a[120:123]
 v_exp_f32 v179, v35
 v_mfma_f32_16x16x32_bf16 a[124:127], a[248:251], v[120:123], a[124:127]
 v_exp_f32 v180, v36
 v_mfma_f32_16x16x32_bf16 a[128:131], a[248:251], v[124:127], a[128:131]
 v_cvt_pk_bf16_f32 v103, v182, v183
 v_cvt_pk_bf16_f32 v104, v176, v177
 v_mfma_f32_16x16x32_bf16 a[132:135], a[248:251], v[128:131], a[132:135]
 v_exp_f32 v181, v37
 v_mfma_f32_16x16x32_bf16 a[136:139], a[248:251], v[132:135], a[136:139]
 v_exp_f32 v182, v38
 v_mfma_f32_16x16x32_bf16 a[140:143], a[252:255], v[116:119], a[140:143]
 ds_read_b128 a[248:251], v192 offset:16384
 v_cvt_pk_bf16_f32 v105, v178, v179
 v_mfma_f32_16x16x32_bf16 a[144:147], a[252:255], v[120:123], a[144:147]
 v_exp_f32 v183, v39
 v_mfma_f32_16x16x32_bf16 a[148:151], a[252:255], v[124:127], a[148:151]
 v_cvt_pk_bf16_f32 v106, v180, v181
 v_cvt_pk_bf16_f32 v107, v182, v183
 v_mfma_f32_16x16x32_bf16 a[152:155], a[252:255], v[128:131], a[152:155]
 v_exp_f32 v176, v40
 v_mfma_f32_16x16x32_bf16 a[156:159], a[252:255], v[132:135], a[156:159]
 ds_read_b128 a[252:255], v193 offset:16384
 s_waitcnt lgkmcnt(2)
 v_mfma_f32_16x16x32_bf16 v[56:59], a[240:243], a[160:163], v[136:139]
 s_waitcnt vmcnt(4)
 buffer_load_dwordx4 v215, s[28:31], s46 offen offset:1024 nt lds
 v_mfma_f32_16x16x32_bf16 v[64:67], a[240:243], a[176:179], v[140:143]
 v_exp_f32 v177, v41
 v_mfma_f32_16x16x32_bf16 v[72:75], a[240:243], a[192:195], v[144:147]
 v_exp_f32 v178, v42
 v_mfma_f32_16x16x32_bf16 v[80:83], a[240:243], a[208:211], v[148:151]
 v_cvt_pk_bf16_f32 v108, v176, v177
 v_or3_b32 v188, v96, v97, v98
 v_mfma_f32_16x16x32_bf16 v[88:91], a[240:243], a[224:227], v[152:155]
 v_exp_f32 v179, v43
 v_mfma_f32_16x16x32_bf16 v[56:59], a[244:247], a[164:167], v[56:59]
 ds_read_b128 a[240:243], v190 offset:20480
 v_cvt_pk_bf16_f32 v109, v178, v179
 v_mfma_f32_16x16x32_bf16 v[64:67], a[244:247], a[180:183], v[64:67]
 v_exp_f32 v180, v44
 v_mfma_f32_16x16x32_bf16 v[72:75], a[244:247], a[196:199], v[72:75]
 v_or3_b32 v188, v188, v99, v100
 v_or3_b32 v188, v188, v101, v102
 v_mfma_f32_16x16x32_bf16 v[80:83], a[244:247], a[212:215], v[80:83]
 v_exp_f32 v181, v45
 v_mfma_f32_16x16x32_bf16 v[88:91], a[244:247], a[228:231], v[88:91]
 ds_read_b128 a[244:247], v191 offset:20480
 s_waitcnt lgkmcnt(2)
 v_mfma_f32_16x16x32_bf16 v[56:59], a[248:251], a[168:171], v[56:59]
 v_exp_f32 v182, v46
 v_mfma_f32_16x16x32_bf16 v[64:67], a[248:251], a[184:187], v[64:67]
 s_waitcnt vmcnt(4)
 v_cvt_pk_bf16_f32 v110, v180, v181
 v_mfma_f32_16x16x32_bf16 v[72:75], a[248:251], a[200:203], v[72:75]
 buffer_load_dwordx4 v216, s[28:31], s46 offen offset:2048 nt lds
 v_mfma_f32_16x16x32_bf16 v[80:83], a[248:251], a[216:219], v[80:83]
 v_exp_f32 v183, v47
 v_mfma_f32_16x16x32_bf16 v[88:91], a[248:251], a[232:235], v[88:91]
 v_exp_f32 v176, v48
 v_mfma_f32_16x16x32_bf16 v[56:59], a[252:255], a[172:175], v[56:59]
 ds_read_b128 a[248:251], v192 offset:20480
 v_cvt_pk_bf16_f32 v111, v182, v183
 v_mfma_f32_16x16x32_bf16 v[64:67], a[252:255], a[188:191], v[64:67]
 v_exp_f32 v177, v49
 v_mfma_f32_16x16x32_bf16 v[72:75], a[252:255], a[204:207], v[72:75]
 v_exp_f32 v178, v50
 v_mfma_f32_16x16x32_bf16 v[80:83], a[252:255], a[220:223], v[80:83]
 v_cvt_pk_bf16_f32 v112, v176, v177
 v_or3_b32 v188, v188, v103, v104
 v_mfma_f32_16x16x32_bf16 v[88:91], a[252:255], a[236:239], v[88:91]
 ds_read_b128 a[252:255], v193 offset:20480
 s_waitcnt lgkmcnt(2)
 v_mfma_f32_16x16x32_bf16 v[60:63], a[240:243], a[160:163], v[136:139]
 v_exp_f32 v179, v51
 v_mfma_f32_16x16x32_bf16 v[68:71], a[240:243], a[176:179], v[140:143]
 v_exp_f32 v180, v52
 v_mfma_f32_16x16x32_bf16 v[76:79], a[240:243], a[192:195], v[144:147]
 v_cvt_pk_bf16_f32 v113, v178, v179
 s_waitcnt vmcnt(4)
 v_mfma_f32_16x16x32_bf16 v[84:87], a[240:243], a[208:211], v[148:151]
 buffer_load_dwordx4 v217, s[28:31], s46 offen offset:3072 nt lds
 v_mfma_f32_16x16x32_bf16 v[92:95], a[240:243], a[224:227], v[152:155]
 v_or3_b32 v188, v188, v105, v106
 s_barrier
 v_mfma_f32_16x16x32_bf16 v[60:63], a[244:247], a[164:167], v[60:63]
 v_exp_f32 v181, v53
 v_mfma_f32_16x16x32_bf16 v[68:71], a[244:247], a[180:183], v[68:71]
 ds_read_b64_tr_b16 a[240:241], v198 offset:32768
 ds_read_b64_tr_b16 a[242:243], v198 offset:36864
 v_mfma_f32_16x16x32_bf16 v[76:79], a[244:247], a[196:199], v[76:79]
 v_exp_f32 v182, v54
 v_mfma_f32_16x16x32_bf16 v[84:87], a[244:247], a[212:215], v[84:87]
 v_exp_f32 v183, v55
 v_mfma_f32_16x16x32_bf16 v[92:95], a[244:247], a[228:231], v[92:95]
 ds_read_b64_tr_b16 a[244:245], v199 offset:32768
 s_waitcnt lgkmcnt(3)
 v_mfma_f32_16x16x32_bf16 v[60:63], a[248:251], a[168:171], v[60:63]
 ds_read_b64_tr_b16 a[246:247], v199 offset:36864
 v_cvt_pk_bf16_f32 v114, v180, v181
 v_mfma_f32_16x16x32_bf16 v[68:71], a[248:251], a[184:187], v[68:71]
 v_cvt_pk_bf16_f32 v115, v182, v183
 v_or3_b32 v188, v188, v107, v108
 v_mfma_f32_16x16x32_bf16 v[76:79], a[248:251], a[200:203], v[76:79]
 v_or3_b32 v188, v188, v109, v110
 v_or3_b32 v188, v188, v111, v112
 v_mfma_f32_16x16x32_bf16 v[84:87], a[248:251], a[216:219], v[84:87]
 v_or3_b32 v188, v188, v113, v114
 v_bitop3_b32 v188, v188, v115, s45 bitop3:0xa8
 v_mfma_f32_16x16x32_bf16 v[92:95], a[248:251], a[232:235], v[92:95]
 ds_read_b64_tr_b16 a[248:249], v200 offset:32768
 ds_read_b64_tr_b16 a[250:251], v200 offset:36864
 v_mfma_f32_16x16x32_bf16 v[60:63], a[252:255], a[172:175], v[60:63]
 s_waitcnt vmcnt(4)
 s_add_u32 m0, s44, 114688
 v_mfma_f32_16x16x32_bf16 v[68:71], a[252:255], a[188:191], v[68:71]
 s_mov_b32 s46, 196608
 v_cmp_ne_u32 vcc, 0, v188
 v_mfma_f32_16x16x32_bf16 v[76:79], a[252:255], a[204:207], v[76:79]
 buffer_load_dwordx4 v218, s[32:35], s46 offen offset:0 nt lds
 v_mfma_f32_16x16x32_bf16 v[84:87], a[252:255], a[220:223], v[84:87]
 v_mfma_f32_16x16x32_bf16 v[92:95], a[252:255], a[236:239], v[92:95]
 s_cbranch_vccnz L_rarea11
L_rarea11_back:
 v_mfma_f32_16x16x32_bf16 v[156:159], v[184:187], v[96:99], v[156:159]
 v_mfma_f32_16x16x32_bf16 v[160:163], v[184:187], v[100:103], v[160:163]
 v_exp_f32 v176, v56
 v_mfma_f32_16x16x32_bf16 v[164:167], v[184:187], v[104:107], v[164:167]
 v_exp_f32 v177, v57
 v_mfma_f32_16x16x32_bf16 v[168:171], v[184:187], v[108:111], v[168:171]
 v_exp_f32 v178, v58
 v_mfma_f32_16x16x32_bf16 v[172:175], v[184:187], v[112:115], v[172:175]
 ds_read_b64_tr_b16 a[252:253], v201 offset:32768
 s_waitcnt lgkmcnt(3)
 v_mfma_f32_16x16x32_bf16 a[0:3], a[240:243], v[96:99], a[0:3]
 ds_read_b64_tr_b16 a[254:255], v201 offset:36864
 v_cvt_pk_bf16_f32 v116, v176, v177
 v_mfma_f32_16x16x32_bf16 a[4:7], a[240:243], v[100:103], a[4:7]
 v_exp_f32 v179, v59
 v_mfma_f32_16x16x32_bf16 a[8:11], a[240:243], v[104:107], a[8:11]
 v_exp_f32 v180, v60
 v_mfma_f32_16x16x32_bf16 a[12:15], a[240:243], v[108:111], a[12:15]
 v_exp_f32 v181, v61
 v_mfma_f32_16x16x32_bf16 a[16:19], a[240:243], v[112:115], a[16:19]
 v_exp_f32 v182, v62
 v_mfma_f32_16x16x32_bf16 a[20:23], a[244:247], v[96:99], a[20:23]
 s_waitcnt vmcnt(4)
 buffer_load_dwordx4 v219, s[32:35], s46 offen offset:1024 nt lds
 v_mfma_f32_16x16x32_bf16 a[24:27], a[244:247], v[100:103], a[24:27]
 ds_read_b64_tr_b16 a[240:241], v202 offset:32768
 ds_read_b64_tr_b16 a[242:243], v202 offset:36864
 v_mfma_f32_16x16x32_bf16 a[28:31], a[244:247], v[104:107], a[28:31]
 v_exp_f32 v183, v63
 v_mfma_f32_16x16x32_bf16 a[32:35], a[244:247], v[108:111], a[32:35]
 v_exp_f32 v176, v64
 v_mfma_f32_16x16x32_bf16 a[36:39], a[244:247], v[112:115], a[36:39]
 v_cvt_pk_bf16_f32 v117, v178, v179
 s_waitcnt lgkmcnt(2)
 v_mfma_f32_16x16x32_bf16 a[40:43], a[248:251], v[96:99], a[40:43]
 ds_read_b64_tr_b16 a[244:245], v203 offset:32768
 ds_read_b64_tr_b16 a[246:247], v203 offset:36864
 v_mfma_f32_16x16x32_bf16 a[44:47], a[248:251], v[100:103], a[44:47]
 v_exp_f32 v177, v65
 v_mfma_f32_16x16x32_bf16 a[48:51], a[248:251], v[104:107], a[48:51]
 v_exp_f32 v178, v66
 v_mfma_f32_16x16x32_bf16 a[52:55], a[248:251], v[108:111], a[52:55]
 v_cvt_pk_bf16_f32 v118, v180, v181
 v_cvt_pk_bf16_f32 v119, v182, v183
 v_mfma_f32_16x16x32_bf16 a[56:59], a[248:251], v[112:115], a[56:59]
 v_exp_f32 v179, v67
 v_mfma_f32_16x16x32_bf16 a[60:63], a[252:255], v[96:99], a[60:63]
 ds_read_b64_tr_b16 a[248:249], v204 offset:32768
 ds_read_b64_tr_b16 a[250:251], v204 offset:36864
 v_mfma_f32_16x16x32_bf16 a[64:67], a[252:255], v[100:103], a[64:67]
 v_exp_f32 v180, v68
 v_mfma_f32_16x16x32_bf16 a[68:71], a[252:255], v[104:107], a[68:71]
 s_waitcnt vmcnt(4)
 buffer_load_dwordx4 v218, s[32:35], s46 offen offset:2048 nt lds
 v_mfma_f32_16x16x32_bf16 a[72:75], a[252:255], v[108:111], a[72:75]
 v_exp_f32 v181, v69
 v_mfma_f32_16x16x32_bf16 a[76:79], a[252:255], v[112:115], a[76:79]
 ds_read_b64_tr_b16 a[252:253], v205 offset:32768
 s_waitcnt lgkmcnt(3)
 v_mfma_f32_16x16x32_bf16 a[80:83], a[240:243], v[96:99], a[80:83]
 ds_read_b64_tr_b16 a[254:255], v205 offset:36864
 v_cvt_pk_bf16_f32 v120, v176, v177
 v_mfma_f32_16x16x32_bf16 a[84:87], a[240:243], v[100:103], a[84:87]
 v_exp_f32 v182, v70
 v_mfma_f32_16x16x32_bf16 a[88:91], a[240:243], v[104:107], a[88:91]
 v_exp_f32 v183, v71
 v_mfma_f32_16x16x32_bf16 a[92:95], a[240:243], v[108:111], a[92:95]
 v_exp_f32 v176, v72
 v_mfma_f32_16x16x32_bf16 a[96:99], a[240:243], v[112:115], a[96:99]
 v_cvt_pk_bf16_f32 v121, v178, v179
 ds_read_b128 a[240:243], v190 offset:32768
 v_mfma_f32_16x16x32_bf16 a[100:103], a[244:247], v[96:99], a[100:103]
 v_exp_f32 v177, v73
 v_mfma_f32_16x16x32_bf16 a[104:107], a[244:247], v[100:103], a[104:107]
 v_cvt_pk_bf16_f32 v122, v180, v181
 v_cvt_pk_bf16_f32 v123, v182, v183
 v_mfma_f32_16x16x32_bf16 a[108:111], a[244:247], v[104:107], a[108:111]
 v_exp_f32 v178, v74
 v_mfma_f32_16x16x32_bf16 a[112:115], a[244:247], v[108:111], a[112:115]
 s_waitcnt vmcnt(4)
 v_cvt_pk_bf16_f32 v124, v176, v177
 v_mfma_f32_16x16x32_bf16 a[116:119], a[244:247], v[112:115], a[116:119]
 ds_read_b128 a[244:247], v191 offset:32768
 s_waitcnt lgkmcnt(2)
 v_mfma_f32_16x16x32_bf16 a[120:123], a[248:251], v[96:99], a[120:123]
 buffer_load_dwordx4 v219, s[32:35], s46 offen offset:3072 nt lds
 v_mfma_f32_16x16x32_bf16 a[124:127], a[248:251], v[100:103], a[124:127]
 v_exp_f32 v179, v75
 v_mfma_f32_16x16x32_bf16 a[128:131], a[248:251], v[104:107], a[128:131]
 v_exp_f32 v180, v76
 v_mfma_f32_16x16x32_bf16 a[132:135], a[248:251], v[108:111], a[132:135]
 v_exp_f32 v181, v77
 v_mfma_f32_16x16x32_bf16 a[136:139], a[248:251], v[112:115], a[136:139]
 v_exp_f32 v182, v78
 v_mfma_f32_16x16x32_bf16 a[140:143], a[252:255], v[96:99], a[140:143]
 ds_read_b128 a[248:251], v192 offset:32768
 v_cvt_pk_bf16_f32 v125, v178, v179
 v_mfma_f32_16x16x32_bf16 a[144:147], a[252:255], v[100:103], a[144:147]
 v_exp_f32 v183, v79
 v_mfma_f32_16x16x32_bf16 a[148:151], a[252:255], v[104:107], a[148:151]
 v_cvt_pk_bf16_f32 v126, v180, v181
 v_cvt_pk_bf16_f32 v127, v182, v183
 v_mfma_f32_16x16x32_bf16 a[152:155], a[252:255], v[108:111], a[152:155]
 v_exp_f32 v176, v80
 v_mfma_f32_16x16x32_bf16 a[156:159], a[252:255], v[112:115], a[156:159]
 ds_read_b128 a[252:255], v193 offset:32768
 s_waitcnt lgkmcnt(2)
 v_mfma_f32_16x16x32_bf16 v[16:19], a[240:243], a[160:163], v[136:139]
 v_exp_f32 v177, v81
 v_mfma_f32_16x16x32_bf16 v[24:27], a[240:243], a[176:179], v[140:143]
 s_waitcnt vmcnt(4)
 s_add_u32 m0, s44, 0
 v_mfma_f32_16x16x32_bf16 v[32:35], a[240:243], a[192:195], v[144:147]
 s_mov_b32 s46, 229376
 buffer_load_dwordx4 v214, s[28:31], s46 offen offset:0 nt lds
 v_mfma_f32_16x16x32_bf16 v[40:43], a[240:243], a[208:211], v[148:151]
 v_exp_f32 v178, v82
 v_mfma_f32_16x16x32_bf16 v[48:51], a[240:243], a[224:227], v[152:155]
 v_exp_f32 v179, v83
 v_mfma_f32_16x16x32_bf16 v[16:19], a[244:247], a[164:167], v[16:19]
 ds_read_b128 a[240:243], v190 offset:36864
 v_cvt_pk_bf16_f32 v128, v176, v177
 v_mfma_f32_16x16x32_bf16 v[24:27], a[244:247], a[180:183], v[24:27]
 v_exp_f32 v180, v84
 v_mfma_f32_16x16x32_bf16 v[32:35], a[244:247], a[196:199], v[32:35]
 v_cvt_pk_bf16_f32 v129, v178, v179
 v_or3_b32 v188, v116, v117, v118
 v_mfma_f32_16x16x32_bf16 v[40:43], a[244:247], a[212:215], v[40:43]
 v_exp_f32 v181, v85
 v_mfma_f32_16x16x32_bf16 v[48:51], a[244:247], a[228:231], v[48:51]
 ds_read_b128 a[244:247], v191 offset:36864
 s_waitcnt lgkmcnt(2)
 v_mfma_f32_16x16x32_bf16 v[16:19], a[248:251], a[168:171], v[16:19]
 v_exp_f32 v182, v86
 v_mfma_f32_16x16x32_bf16 v[24:27], a[248:251], a[184:187], v[24:27]
 v_cvt_pk_bf16_f32 v130, v180, v181
 s_waitcnt vmcnt(4)
 v_mfma_f32_16x16x32_bf16 v[32:35], a[248:251], a[200:203], v[32:35]
 buffer_load_dwordx4 v215, s[28:31], s46 offen offset:1024 nt lds
 v_mfma_f32_16x16x32_bf16 v[40:43], a[248:251], a[216:219], v[40:43]
 v_exp_f32 v183, v87
 v_mfma_f32_16x16x32_bf16 v[48:51], a[248:251], a[232:235], v[48:51]
 v_exp_f32 v176, v88
 v_mfma_f32_16x16x32_bf16 v[16:19], a[252:255], a[172:175], v[16:19]
 ds_read_b128 a[248:251], v192 offset:36864
 v_cvt_pk_bf16_f32 v131, v182, v183
 v_mfma_f32_16x16x32_bf16 v[24:27], a[252:255], a[188:191], v[24:27]
 v_exp_f32 v177, v89
 v_mfma_f32_16x16x32_bf16 v[32:35], a[252:255], a[204:207], v[32:35]
 v_exp_f32 v178, v90
 v_mfma_f32_16x16x32_bf16 v[40:43], a[252:255], a[220:223], v[40:43]
 v_cvt_pk_bf16_f32 v132, v176, v177
 v_or3_b32 v188, v188, v119, v120
 v_mfma_f32_16x16x32_bf16 v[48:51], a[252:255], a[236:239], v[48:51]
 ds_read_b128 a[252:255], v193 offset:36864
 s_waitcnt lgkmcnt(2)
 v_mfma_f32_16x16x32_bf16 v[20:23], a[240:243], a[160:163], v[136:139]
 v_exp_f32 v179, v91
 v_mfma_f32_16x16x32_bf16 v[28:31], a[240:243], a[176:179], v[140:143]
 v_exp_f32 v180, v92
 v_mfma_f32_16x16x32_bf16 v[36:39], a[240:243], a[192:195], v[144:147]
 v_cvt_pk_bf16_f32 v133, v178, v179
 v_or3_b32 v188, v188, v121, v122
 v_mfma_f32_16x16x32_bf16 v[44:47], a[240:243], a[208:211], v[148:151]
 v_exp_f32 v181, v93
 v_mfma_f32_16x16x32_bf16 v[52:55], a[240:243], a[224:227], v[152:155]
 v_cvt_pk_bf16_f32 v134, v180, v181
 s_barrier
 v_mfma_f32_16x16x32_bf16 v[20:23], a[244:247], a[164:167], v[20:23]
 v_exp_f32 v182, v94
 v_mfma_f32_16x16x32_bf16 v[28:31], a[244:247], a[180:183], v[28:31]
 ds_read_b64_tr_b16 a[240:241], v198 offset:16384
 ds_read_b64_tr_b16 a[242:243], v198 offset:20480
 v_mfma_f32_16x16x32_bf16 v[36:39], a[244:247], a[196:199], v[36:39]
 s_waitcnt vmcnt(4)
 buffer_load_dwordx4 v216, s[28:31], s46 offen offset:2048 nt lds
 v_mfma_f32_16x16x32_bf16 v[44:47], a[244:247], a[212:215], v[44:47]
 v_exp_f32 v183, v95
 v_mfma_f32_16x16x32_bf16 v[52:55], a[244:247], a[228:231], v[52:55]
 ds_read_b64_tr_b16 a[244:245], v199 offset:16384
 s_waitcnt lgkmcnt(3)
 v_mfma_f32_16x16x32_bf16 v[20:23], a[248:251], a[168:171], v[20:23]
 ds_read_b64_tr_b16 a[246:247], v199 offset:20480
 v_cvt_pk_bf16_f32 v135, v182, v183
 v_mfma_f32_16x16x32_bf16 v[28:31], a[248:251], a[184:187], v[28:31]
 v_or3_b32 v188, v188, v123, v124
 v_or3_b32 v188, v188, v125, v126
 v_mfma_f32_16x16x32_bf16 v[36:39], a[248:251], a[200:203], v[36:39]
 v_or3_b32 v188, v188, v127, v128
 v_or3_b32 v188, v188, v129, v130
 v_mfma_f32_16x16x32_bf16 v[44:47], a[248:251], a[216:219], v[44:47]
 v_or3_b32 v188, v188, v131, v132
 v_or3_b32 v188, v188, v133, v134
 v_mfma_f32_16x16x32_bf16 v[52:55], a[248:251], a[232:235], v[52:55]
 ds_read_b64_tr_b16 a[248:249], v200 offset:16384
 ds_read_b64_tr_b16 a[250:251], v200 offset:20480
 v_mfma_f32_16x16x32_bf16 v[20:23], a[252:255], a[172:175], v[20:23]
 v_bitop3_b32 v188, v188, v135, s45 bitop3:0xa8
 v_cmp_ne_u32 vcc, 0, v188
 v_mfma_f32_16x16x32_bf16 v[28:31], a[252:255], a[188:191], v[28:31]
 s_waitcnt vmcnt(4)
 v_mfma_f32_16x16x32_bf16 v[36:39], a[252:255], a[204:207], v[36:39]
 buffer_load_dwordx4 v217, s[28:31], s46 offen offset:3072 nt lds
 v_mfma_f32_16x16x32_bf16 v[44:47], a[252:255], a[220:223], v[44:47]
 v_mfma_f32_16x16x32_bf16 v[52:55], a[252:255], a[236:239], v[52:55]
 s_cbranch_vccnz L_rarea12
L_rarea12_back:
 v_mfma_f32_16x16x32_bf16 v[156:159], v[184:187], v[116:119], v[156:159]
 v_mfma_f32_16x16x32_bf16 v[160:163], v[184:187], v[120:123], v[160:163]
 v_exp_f32 v176, v16
 v_mfma_f32_16x16x32_bf16 v[164:167], v[184:187], v[124:127], v[164:167]
 v_exp_f32 v177, v17
 v_mfma_f32_16x16x32_bf16 v[168:171], v[184:187], v[128:131], v[168:171]
 v_exp_f32 v178, v18
 v_mfma_f32_16x16x32_bf16 v[172:175], v[184:187], v[132:135], v[172:175]
 ds_read_b64_tr_b16 a[252:253], v201 offset:16384
 s_waitcnt lgkmcnt(3)
 v_mfma_f32_16x16x32_bf16 a[0:3], a[240:243], v[116:119], a[0:3]
 s_add_u32 m0, s44, 147456
 s_add_u32 s46, s96, 0
 v_mfma_f32_16x16x32_bf16 a[4:7], a[240:243], v[120:123], a[4:7]
 buffer_load_dwordx4 v234, s[4:7], s46 offen offset:0  lds
 v_mfma_f32_16x16x32_bf16 a[8:11], a[240:243], v[124:127], a[8:11]
 buffer_load_dwordx4 v235, s[4:7], s46 offen offset:1024  lds
 v_mfma_f32_16x16x32_bf16 a[12:15], a[240:243], v[128:131], a[12:15]
 buffer_load_dwordx4 v236, s[4:7], s46 offen offset:2048  lds
 v_mfma_f32_16x16x32_bf16 a[16:19], a[240:243], v[132:135], a[16:19]
 buffer_load_dwordx4 v237, s[4:7], s46 offen offset:3072  lds
 v_mfma_f32_16x16x32_bf16 a[20:23], a[244:247], v[116:119], a[20:23]
 ds_read_b64_tr_b16 a[254:255], v201 offset:20480
 v_exp_f32 v179, v19
 v_mfma_f32_16x16x32_bf16 a[24:27], a[244:247], v[120:123], a[24:27]
 v_exp_f32 v180, v20
 v_mfma_f32_16x16x32_bf16 a[28:31], a[244:247], v[124:127], a[28:31]
 s_waitcnt vmcnt(8)
 s_add_u32 m0, s44, 65536
 s_mov_b32 s46, 212992
 buffer_load_dwordx4 v218, s[32:35], s46 offen offset:0 nt lds
 v_mfma_f32_16x16x32_bf16 a[32:35], a[244:247], v[128:131], a[32:35]
 v_exp_f32 v181, v21
 v_mfma_f32_16x16x32_bf16 a[36:39], a[244:247], v[132:135], a[36:39]
 ds_read_b64_tr_b16 a[240:241], v202 offset:16384
 s_waitcnt lgkmcnt(1)
 v_mfma_f32_16x16x32_bf16 a[40:43], a[248:251], v[116:119], a[40:43]
 v_exp_f32 v182, v22
 v_mfma_f32_16x16x32_bf16 a[44:47], a[248:251], v[120:123], a[44:47]
 v_cvt_pk_bf16_f32 v96, v176, v177
 ds_read_b64_tr_b16 a[242:243], v202 offset:20480
 v_mfma_f32_16x16x32_bf16 a[48:51], a[248:251], v[124:127], a[48:51]
 v_exp_f32 v183, v23
 v_mfma_f32_16x16x32_bf16 a[52:55], a[248:251], v[128:131], a[52:55]
 ds_read_b64_tr_b16 a[244:245], v203 offset:16384
 ds_read_b64_tr_b16 a[246:247], v203 offset:20480
 v_mfma_f32_16x16x32_bf16 a[56:59], a[248:251], v[132:135], a[56:59]
 v_exp_f32 v176, v24
 v_mfma_f32_16x16x32_bf16 a[60:63], a[252:255], v[116:119], a[60:63]
 v_cvt_pk_bf16_f32 v97, v178, v179
 v_exp_f32 v177, v25
 v_mfma_f32_16x16x32_bf16 a[64:67], a[252:255], v[120:123], a[64:67]
 ds_read_b64_tr_b16 a[248:249], v204 offset:16384
 ds_read_b64_tr_b16 a[250:251], v204 offset:20480
 v_mfma_f32_16x16x32_bf16 a[68:71], a[252:255], v[124:127], a[68:71]
 v_exp_f32 v178, v26
 v_mfma_f32_16x16x32_bf16 a[72:75], a[252:255], v[128:131], a[72:75]
 v_cvt_pk_bf16_f32 v98, v180, v181
 s_waitcnt vmcnt(8)
 v_mfma_f32_16x16x32_bf16 a[76:79], a[252:255], v[132:135], a[76:79]
 buffer_load_dwordx4 v219, s[32:35], s46 offen offset:1024 nt lds
 s_waitcnt lgkmcnt(2)
 v_mfma_f32_16x16x32_bf16 a[80:83], a[240:243], v[116:119], a[80:83]
 v_exp_f32 v179, v27
 v_mfma_f32_16x16x32_bf16 a[84:87], a[240:243], v[120:123], a[84:87]
 v_exp_f32 v180, v28
 v_mfma_f32_16x16x32_bf16 a[88:91], a[240:243], v[124:127], a[88:91]
 v_cvt_pk_bf16_f32 v99, v182, v183
 ds_read_b64_tr_b16 a[252:253], v205 offset:16384
 v_mfma_f32_16x16x32_bf16 a[92:95], a[240:243], v[128:131], a[92:95]
 v_exp_f32 v181, v29
 v_mfma_f32_16x16x32_bf16 a[96:99], a[240:243], v[132:135], a[96:99]
 ds_read_b64_tr_b16 a[254:255], v205 offset:20480
 ds_read_b128 a[240:243], v190 offset:49152
 v_mfma_f32_16x16x32_bf16 a[100:103], a[244:247], v[116:119], a[100:103]
 v_exp_f32 v182, v30
 v_mfma_f32_16x16x32_bf16 a[104:107], a[244:247], v[120:123], a[104:107]
 v_cvt_pk_bf16_f32 v100, v176, v177
 v_cvt_pk_bf16_f32 v101, v178, v179
 v_mfma_f32_16x16x32_bf16 a[108:111], a[244:247], v[124:127], a[108:111]
 v_exp_f32 v183, v31
 v_mfma_f32_16x16x32_bf16 a[112:115], a[244:247], v[128:131], a[112:115]
 v_exp_f32 v176, v32
 v_mfma_f32_16x16x32_bf16 a[116:119], a[244:247], v[132:135], a[116:119]
 ds_read_b128 a[244:247], v191 offset:49152
 s_waitcnt lgkmcnt(2)
 v_mfma_f32_16x16x32_bf16 a[120:123], a[248:251], v[116:119], a[120:123]
 v_exp_f32 v177, v33
 v_mfma_f32_16x16x32_bf16 a[124:127], a[248:251], v[120:123], a[124:127]
 s_waitcnt vmcnt(8)
 buffer_load_dwordx4 v218, s[32:35], s46 offen offset:2048 nt lds
 v_mfma_f32_16x16x32_bf16 a[128:131], a[248:251], v[124:127], a[128:131]
 v_exp_f32 v178, v34
 v_mfma_f32_16x16x32_bf16 a[132:135], a[248:251], v[128:131], a[132:135]
 v_cvt_pk_bf16_f32 v102, v180, v181
 v_cvt_pk_bf16_f32 v103, v182, v183
 v_mfma_f32_16x16x32_bf16 a[136:139], a[248:251], v[132:135], a[136:139]
 v_exp_f32 v179, v35
 v_mfma_f32_16x16x32_bf16 a[140:143], a[252:255], v[116:119], a[140:143]
 ds_read_b128 a[248:251], v192 offset:49152
 v_cvt_pk_bf16_f32 v104, v176, v177
 v_mfma_f32_16x16x32_bf16 a[144:147], a[252:255], v[120:123], a[144:147]
 v_exp_f32 v180, v36
 v_mfma_f32_16x16x32_bf16 a[148:151], a[252:255], v[124:127], a[148:151]
 v_exp_f32 v181, v37
 v_mfma_f32_16x16x32_bf16 a[152:155], a[252:255], v[128:131], a[152:155]
 v_exp_f32 v182, v38
 v_mfma_f32_16x16x32_bf16 a[156:159], a[252:255], v[132:135], a[156:159]
 ds_read_b128 a[252:255], v193 offset:49152
 s_waitcnt lgkmcnt(2)
 v_mfma_f32_16x16x32_bf16 v[56:59], a[240:243], a[160:163], v[136:139]
 v_exp_f32 v183, v39
 v_mfma_f32_16x16x32_bf16 v[64:67], a[240:243], a[176:179], v[140:143]
 v_exp_f32 v176, v40
 v_mfma_f32_16x16x32_bf16 v[72:75], a[240:243], a[192:195], v[144:147]
 v_cvt_pk_bf16_f32 v105, v178, v179
 s_waitcnt vmcnt(8)
 v_mfma_f32_16x16x32_bf16 v[80:83], a[240:243], a[208:211], v[148:151]
 buffer_load_dwordx4 v219, s[32:35], s46 offen offset:3072 nt lds
 v_mfma_f32_16x16x32_bf16 v[88:91], a[240:243], a[224:227], v[152:155]
 v_exp_f32 v177, v41
 v_mfma_f32_16x16x32_bf16 v[56:59], a[244:247], a[164:167], v[56:59]
 ds_read_b128 a[240:243], v190 offset:53248
 v_cvt_pk_bf16_f32 v106, v180, v181
 v_mfma_f32_16x16x32_bf16 v[64:67], a[244:247], a[180:183], v[64:67]
 v_exp_f32 v178, v42
 v_mfma_f32_16x16x32_bf16 v[72:75], a[244:247], a[196:199], v[72:75]
 v_exp_f32 v179, v43
 v_mfma_f32_16x16x32_bf16 v[80:83], a[244:247], a[212:215], v[80:83]
 v_exp_f32 v180, v44
 v_mfma_f32_16x16x32_bf16 v[88:91], a[244:247], a[228:231], v[88:91]
 v_cvt_pk_bf16_f32 v107, v182, v183
 s_add_u32 m0, s44, 131072
 s_add_u32 s46, s97, 0
 s_waitcnt lgkmcnt(1)
 v_mfma_f32_16x16x32_bf16 v[56:59], a[248:251], a[168:171], v[56:59]
 buffer_load_dwordx4 v234, s[4:7], s46 offen offset:0  lds
 v_mfma_f32_16x16x32_bf16 v[64:67], a[248:251], a[184:187], v[64:67]
 buffer_load_dwordx4 v235, s[4:7], s46 offen offset:1024  lds
 v_mfma_f32_16x16x32_bf16 v[72:75], a[248:251], a[200:203], v[72:75]
 buffer_load_dwordx4 v236, s[4:7], s46 offen offset:2048  lds
 v_mfma_f32_16x16x32_bf16 v[80:83], a[248:251], a[216:219], v[80:83]
 buffer_load_dwordx4 v237, s[4:7], s46 offen offset:3072  lds
 v_mfma_f32_16x16x32_bf16 v[88:91], a[248:251], a[232:235], v[88:91]
 v_exp_f32 v181, v45
 v_mfma_f32_16x16x32_bf16 v[56:59], a[252:255], a[172:175], v[56:59]
 ds_read_b128 a[244:247], v191 offset:53248
 v_exp_f32 v182, v46
 v_mfma_f32_16x16x32_bf16 v[64:67], a[252:255], a[188:191], v[64:67]
 v_cvt_pk_bf16_f32 v108, v176, v177
 s_waitcnt vmcnt(12)
 s_add_u32 m0, s44, 16384
 s_mov_b32 s46, 245760
 buffer_load_dwordx4 v214, s[28:31], s46 offen offset:0 nt lds
 v_mfma_f32_16x16x32_bf16 v[72:75], a[252:255], a[204:207], v[72:75]
 v_exp_f32 v183, v47
 v_mfma_f32_16x16x32_bf16 v[80:83], a[252:255], a[220:223], v[80:83]
 ds_read_b128 a[248:251], v192 offset:53248
 v_cvt_pk_bf16_f32 v109, v178, v179
 v_mfma_f32_16x16x32_bf16 v[88:91], a[252:255], a[236:239], v[88:91]
 v_exp_f32 v176, v48
 s_waitcnt lgkmcnt(1)
 v_mfma_f32_16x16x32_bf16 v[60:63], a[240:243], a[160:163], v[136:139]
 ds_read_b128 a[252:255], v193 offset:53248
 v_cvt_pk_bf16_f32 v110, v180, v181
 v_mfma_f32_16x16x32_bf16 v[68:71], a[240:243], a[176:179], v[140:143]
 v_exp_f32 v177, v49
 v_mfma_f32_16x16x32_bf16 v[76:79], a[240:243], a[192:195], v[144:147]
 v_exp_f32 v178, v50
 v_mfma_f32_16x16x32_bf16 v[84:87], a[240:243], a[208:211], v[148:151]
 v_exp_f32 v179, v51
 v_mfma_f32_16x16x32_bf16 v[92:95], a[240:243], a[224:227], v[152:155]
 v_cvt_pk_bf16_f32 v111, v182, v183
 s_barrier
 v_mfma_f32_16x16x32_bf16 v[60:63], a[244:247], a[164:167], v[60:63]
 v_exp_f32 v180, v52
 v_mfma_f32_16x16x32_bf16 v[68:71], a[244:247], a[180:183], v[68:71]
 ds_read_b64_tr_b16 a[240:241], v198 offset:49152
 ds_read_b64_tr_b16 a[242:243], v198 offset:53248
 v_mfma_f32_16x16x32_bf16 v[76:79], a[244:247], a[196:199], v[76:79]
 v_exp_f32 v181, v53
 v_mfma_f32_16x16x32_bf16 v[84:87], a[244:247], a[212:215], v[84:87]
 v_exp_f32 v182, v54
 v_mfma_f32_16x16x32_bf16 v[92:95], a[244:247], a[228:231], v[92:95]
 v_cvt_pk_bf16_f32 v112, v176, v177
 s_waitcnt vmcnt(8)
 buffer_load_dwordx4 v215, s[28:31], s46 offen offset:1024 nt lds
 s_waitcnt lgkmcnt(2)
 v_mfma_f32_16x16x32_bf16 v[60:63], a[248:251], a[168:171], v[60:63]
 ds_read_b64_tr_b16 a[244:245], v199 offset:49152
 ds_read_b64_tr_b16 a[246:247], v199 offset:53248
 v_mfma_f32_16x16x32_bf16 v[68:71], a[248:251], a[184:187], v[68:71]
 v_exp_f32 v183, v55
 v_mfma_f32_16x16x32_bf16 v[76:79], a[248:251], a[200:203], v[76:79]
 v_cvt_pk_bf16_f32 v113, v178, v179
 v_cvt_pk_bf16_f32 v114, v180, v181
 v_mfma_f32_16x16x32_bf16 v[84:87], a[248:251], a[216:219], v[84:87]
 v_cvt_pk_bf16_f32 v115, v182, v183
 v_or3_b32 v188, v96, v97, v98
 v_mfma_f32_16x16x32_bf16 v[92:95], a[248:251], a[232:235], v[92:95]
 ds_read_b64_tr_b16 a[248:249], v200 offset:49152
 ds_read_b64_tr_b16 a[250:251], v200 offset:53248
 v_mfma_f32_16x16x32_bf16 v[60:63], a[252:255], a[172:175], v[60:63]
 v_or3_b32 v188, v188, v99, v100
 v_or3_b32 v188, v188, v101, v102
 v_mfma_f32_16x16x32_bf16 v[68:71], a[252:255], a[188:191], v[68:71]
 v_or3_b32 v188, v188, v103, v104
 v_or3_b32 v188, v188, v105, v106
 v_mfma_f32_16x16x32_bf16 v[76:79], a[252:255], a[204:207], v[76:79]
 v_or3_b32 v188, v188, v107, v108
 v_or3_b32 v188, v188, v109, v110
 v_mfma_f32_16x16x32_bf16 v[84:87], a[252:255], a[220:223], v[84:87]
 v_or3_b32 v188, v188, v111, v112
 v_or3_b32 v188, v188, v113, v114
 v_bitop3_b32 v188, v188, v115, s45 bitop3:0xa8
 v_cmp_ne_u32 vcc, 0, v188
 v_mfma_f32_16x16x32_bf16 v[92:95], a[252:255], a[236:239], v[92:95]
 s_waitcnt vmcnt(8)
 s_cbranch_vccnz L_rarea13
L_rarea13_back:
 v_mfma_f32_16x16x32_bf16 v[156:159], v[184:187], v[96:99], v[156:159]
 buffer_load_dwordx4 v216, s[28:31], s46 offen offset:2048 nt lds
 v_mfma_f32_16x16x32_bf16 v[160:163], v[184:187], v[100:103], v[160:163]
 v_exp_f32 v176, v56
 v_mfma_f32_16x16x32_bf16 v[164:167], v[184:187], v[104:107], v[164:167]
 v_exp_f32 v177, v57
 v_mfma_f32_16x16x32_bf16 v[168:171], v[184:187], v[108:111], v[168:171]
 v_exp_f32 v178, v58
 v_mfma_f32_16x16x32_bf16 v[172:175], v[184:187], v[112:115], v[172:175]
 ds_read_b64_tr_b16 a[252:253], v201 offset:49152
 s_waitcnt lgkmcnt(3)
 v_mfma_f32_16x16x32_bf16 a[0:3], a[240:243], v[96:99], a[0:3]
 ds_read_b64_tr_b16 a[254:255], v201 offset:53248
 v_cvt_pk_bf16_f32 v116, v176, v177
 v_mfma_f32_16x16x32_bf16 a[4:7], a[240:243], v[100:103], a[4:7]
 v_exp_f32 v179, v59
 v_mfma_f32_16x16x32_bf16 a[8:11], a[240:243], v[104:107], a[8:11]
 v_exp_f32 v180, v60
 v_mfma_f32_16x16x32_bf16 a[12:15], a[240:243], v[108:111], a[12:15]
 v_exp_f32 v181, v61
 v_mfma_f32_16x16x32_bf16 a[16:19], a[240:243], v[112:115], a[16:19]
 v_exp_f32 v182, v62
 v_mfma_f32_16x16x32_bf16 a[20:23], a[244:247], v[96:99], a[20:23]
 ds_read_b64_tr_b16 a[240:241], v202 offset:49152
 ds_read_b64_tr_b16 a[242:243], v202 offset:53248
 v_mfma_f32_16x16x32_bf16 a[24:27], a[244:247], v[100:103], a[24:27]
 v_exp_f32 v183, v63
 v_mfma_f32_16x16x32_bf16 a[28:31], a[244:247], v[104:107], a[28:31]
 s_waitcnt vmcnt(8)
 v_cvt_pk_bf16_f32 v117, v178, v179
 v_mfma_f32_16x16x32_bf16 a[32:35], a[244:247], v[108:111], a[32:35]
 buffer_load_dwordx4 v217, s[28:31], s46 offen offset:3072 nt lds
 v_mfma_f32_16x16x32_bf16 a[36:39], a[244:247], v[112:115], a[36:39]
 ds_read_b64_tr_b16 a[244:245], v203 offset:49152
 s_waitcnt lgkmcnt(3)
 v_mfma_f32_16x16x32_bf16 a[40:43], a[248:251], v[96:99], a[40:43]
 ds_read_b64_tr_b16 a[246:247], v203 offset:53248
 v_cvt_pk_bf16_f32 v118, v180, v181
 v_mfma_f32_16x16x32_bf16 a[44:47], a[248:251], v[100:103], a[44:47]
 v_exp_f32 v176, v64
 v_mfma_f32_16x16x32_bf16 a[48:51], a[248:251], v[104:107], a[48:51]
 v_exp_f32 v177, v65
 v_mfma_f32_16x16x32_bf16 a[52:55], a[248:251], v[108:111], a[52:55]
 v_exp_f32 v178, v66
 v_mfma_f32_16x16x32_bf16 a[56:59], a[248:251], v[112:115], a[56:59]
 s_add_u32 m0, s44, 32768
 s_add_u32 s46, s98, 0
 v_mfma_f32_16x16x32_bf16 a[60:63], a[252:255], v[96:99], a[60:63]
 buffer_load_dwordx4 v234, s[4:7], s46 offen offset:0  lds
 v_mfma_f32_16x16x32_bf16 a[64:67], a[252:255], v[100:103], a[64:67]
 buffer_load_dwordx4 v235, s[4:7], s46 offen offset:1024  lds
 v_mfma_f32_16x16x32_bf16 a[68:71], a[252:255], v[104:107], a[68:71]
 buffer_load_dwordx4 v236, s[4:7], s46 offen offset:2048  lds
 v_mfma_f32_16x16x32_bf16 a[72:75], a[252:255], v[108:111], a[72:75]
 buffer_load_dwordx4 v237, s[4:7], s46 offen offset:3072  lds
 v_mfma_f32_16x16x32_bf16 a[76:79], a[252:255], v[112:115], a[76:79]
 v_exp_f32 v179, v67
 s_waitcnt lgkmcnt(0)
 v_mfma_f32_16x16x32_bf16 a[80:83], a[240:243], v[96:99], a[80:83]
 ds_read_b64_tr_b16 a[248:249], v204 offset:49152
 ds_read_b64_tr_b16 a[250:251], v204 offset:53248
 v_mfma_f32_16x16x32_bf16 a[84:87], a[240:243], v[100:103], a[84:87]
 s_waitcnt vmcnt(12)
 s_add_u32 m0, s44, 98304
 s_mov_b32 s46, 229376
 buffer_load_dwordx4 v218, s[32:35], s46 offen offset:0 nt lds
 v_mfma_f32_16x16x32_bf16 a[88:91], a[240:243], v[104:107], a[88:91]
 v_exp_f32 v180, v68
 v_mfma_f32_16x16x32_bf16 a[92:95], a[240:243], v[108:111], a[92:95]
 v_cvt_pk_bf16_f32 v119, v182, v183
 v_exp_f32 v181, v69
 v_mfma_f32_16x16x32_bf16 a[96:99], a[240:243], v[112:115], a[96:99]
 ds_read_b64_tr_b16 a[252:253], v205 offset:49152
 ds_read_b64_tr_b16 a[254:255], v205 offset:53248
 v_mfma_f32_16x16x32_bf16 a[100:103], a[244:247], v[96:99], a[100:103]
 v_exp_f32 v182, v70
 v_mfma_f32_16x16x32_bf16 a[104:107], a[244:247], v[100:103], a[104:107]
 v_cvt_pk_bf16_f32 v120, v176, v177
 ds_read_b128 a[240:243], v190 offset:0
 v_mfma_f32_16x16x32_bf16 a[108:111], a[244:247], v[104:107], a[108:111]
 v_exp_f32 v183, v71
 v_mfma_f32_16x16x32_bf16 a[112:115], a[244:247], v[108:111], a[112:115]
 v_exp_f32 v176, v72
 v_mfma_f32_16x16x32_bf16 a[116:119], a[244:247], v[112:115], a[116:119]
 v_cvt_pk_bf16_f32 v121, v178, v179
 s_waitcnt lgkmcnt(1)
 v_mfma_f32_16x16x32_bf16 a[120:123], a[248:251], v[96:99], a[120:123]
 ds_read_b128 a[244:247], v191 offset:0
 v_cvt_pk_bf16_f32 v122, v180, v181
 v_mfma_f32_16x16x32_bf16 a[124:127], a[248:251], v[100:103], a[124:127]
 v_exp_f32 v177, v73
 v_mfma_f32_16x16x32_bf16 a[128:131], a[248:251], v[104:107], a[128:131]
 v_exp_f32 v178, v74
 v_mfma_f32_16x16x32_bf16 a[132:135], a[248:251], v[108:111], a[132:135]
 s_waitcnt vmcnt(8)
 buffer_load_dwordx4 v219, s[32:35], s46 offen offset:1024 nt lds
 v_mfma_f32_16x16x32_bf16 a[136:139], a[248:251], v[112:115], a[136:139]
 v_exp_f32 v179, v75
 v_mfma_f32_16x16x32_bf16 a[140:143], a[252:255], v[96:99], a[140:143]
 ds_read_b128 a[248:251], v192 offset:0
 v_cvt_pk_bf16_f32 v123, v182, v183
 v_mfma_f32_16x16x32_bf16 a[144:147], a[252:255], v[100:103], a[144:147]
 v_exp_f32 v180, v76
 v_mfma_f32_16x16x32_bf16 a[148:151], a[252:255], v[104:107], a[148:151]
 v_exp_f32 v181, v77
 v_mfma_f32_16x16x32_bf16 a[152:155], a[252:255], v[108:111], a[152:155]
 v_exp_f32 v182, v78
 v_mfma_f32_16x16x32_bf16 a[156:159], a[252:255], v[112:115], a[156:159]
 v_cvt_pk_bf16_f32 v124, v176, v177
 s_waitcnt lgkmcnt(1)
 v_mfma_f32_16x16x32_bf16 v[16:19], a[240:243], a[160:163], v[136:139]
 ds_read_b128 a[252:255], v193 offset:0
 v_cvt_pk_bf16_f32 v125, v178, v179
 v_mfma_f32_16x16x32_bf16 v[24:27], a[240:243], a[176:179], v[140:143]
 v_exp_f32 v183, v79
 v_mfma_f32_16x16x32_bf16 v[32:35], a[240:243], a[192:195], v[144:147]
 v_exp_f32 v176, v80
 v_mfma_f32_16x16x32_bf16 v[40:43], a[240:243], a[208:211], v[148:151]
 v_exp_f32 v177, v81
 v_mfma_f32_16x16x32_bf16 v[48:51], a[240:243], a[224:227], v[152:155]
 v_exp_f32 v178, v82
 v_mfma_f32_16x16x32_bf16 v[16:19], a[244:247], a[164:167], v[16:19]
 v_cvt_pk_bf16_f32 v126, v180, v181
 ds_read_b128 a[240:243], v190 offset:4096
 v_mfma_f32_16x16x32_bf16 v[24:27], a[244:247], a[180:183], v[24:27]
 s_waitcnt vmcnt(8)
 buffer_load_dwordx4 v218, s[32:35], s46 offen offset:2048 nt lds
 v_mfma_f32_16x16x32_bf16 v[32:35], a[244:247], a[196:199], v[32:35]
 v_exp_f32 v179, v83
 v_mfma_f32_16x16x32_bf16 v[40:43], a[244:247], a[212:215], v[40:43]
 v_exp_f32 v180, v84
 v_mfma_f32_16x16x32_bf16 v[48:51], a[244:247], a[228:231], v[48:51]
 v_cvt_pk_bf16_f32 v127, v182, v183
 s_waitcnt lgkmcnt(1)
 v_mfma_f32_16x16x32_bf16 v[16:19], a[248:251], a[168:171], v[16:19]
 ds_read_b128 a[244:247], v191 offset:4096
 v_cvt_pk_bf16_f32 v128, v176, v177
 v_mfma_f32_16x16x32_bf16 v[24:27], a[248:251], a[184:187], v[24:27]
 v_exp_f32 v181, v85
 v_mfma_f32_16x16x32_bf16 v[32:35], a[248:251], a[200:203], v[32:35]
 v_exp_f32 v182, v86
 v_mfma_f32_16x16x32_bf16 v[40:43], a[248:251], a[216:219], v[40:43]
 v_exp_f32 v183, v87
 v_mfma_f32_16x16x32_bf16 v[48:51], a[248:251], a[232:235], v[48:51]
 v_exp_f32 v176, v88
 v_mfma_f32_16x16x32_bf16 v[16:19], a[252:255], a[172:175], v[16:19]
 v_cvt_pk_bf16_f32 v129, v178, v179
 ds_read_b128 a[248:251], v192 offset:4096
 v_mfma_f32_16x16x32_bf16 v[24:27], a[252:255], a[188:191], v[24:27]
 v_exp_f32 v177, v89
 v_mfma_f32_16x16x32_bf16 v[32:35], a[252:255], a[204:207], v[32:35]
 v_exp_f32 v178, v90
 v_mfma_f32_16x16x32_bf16 v[40:43], a[252:255], a[220:223], v[40:43]
 v_cvt_pk_bf16_f32 v130, v180, v181
 s_waitcnt vmcnt(8)
 buffer_load_dwordx4 v219, s[32:35], s46 offen offset:3072 nt lds
 v_mfma_f32_16x16x32_bf16 v[48:51], a[252:255], a[236:239], v[48:51]
 ds_read_b128 a[252:255], v193 offset:4096
 s_waitcnt lgkmcnt(2)
 v_mfma_f32_16x16x32_bf16 v[20:23], a[240:243], a[160:163], v[136:139]
 v_exp_f32 v179, v91
 v_mfma_f32_16x16x32_bf16 v[28:31], a[240:243], a[176:179], v[140:143]
 v_exp_f32 v180, v92
 v_mfma_f32_16x16x32_bf16 v[36:39], a[240:243], a[192:195], v[144:147]
 v_cvt_pk_bf16_f32 v131, v182, v183
 v_cvt_pk_bf16_f32 v132, v176, v177
 v_mfma_f32_16x16x32_bf16 v[44:47], a[240:243], a[208:211], v[148:151]
 v_exp_f32 v181, v93
 v_mfma_f32_16x16x32_bf16 v[52:55], a[240:243], a[224:227], v[152:155]
 v_cvt_pk_bf16_f32 v133, v178, v179
 s_waitcnt vmcnt(8)
 s_barrier
 v_mfma_f32_16x16x32_bf16 v[20:23], a[244:247], a[164:167], v[20:23]
 v_exp_f32 v182, v94
 v_mfma_f32_16x16x32_bf16 v[28:31], a[244:247], a[180:183], v[28:31]
 ds_read_b64_tr_b16 a[240:241], v198 offset:0
 ds_read_b64_tr_b16 a[242:243], v198 offset:4096
 v_mfma_f32_16x16x32_bf16 v[36:39], a[244:247], a[196:199], v[36:39]
 v_exp_f32 v183, v95
 v_mfma_f32_16x16x32_bf16 v[44:47], a[244:247], a[212:215], v[44:47]
 v_cvt_pk_bf16_f32 v134, v180, v181
 v_cvt_pk_bf16_f32 v135, v182, v183
 v_mfma_f32_16x16x32_bf16 v[52:55], a[244:247], a[228:231], v[52:55]
 ds_read_b64_tr_b16 a[244:245], v199 offset:0
 s_waitcnt lgkmcnt(3)
 v_mfma_f32_16x16x32_bf16 v[20:23], a[248:251], a[168:171], v[20:23]
 s_add_u32 m0, s44, 81920
 s_mov_b32 s46, 245760
 buffer_load_dwordx4 v218, s[32:35], s46 offen offset:0 nt lds
 v_mfma_f32_16x16x32_bf16 v[28:31], a[248:251], a[184:187], v[28:31]
 ds_read_b64_tr_b16 a[246:247], v199 offset:4096
 v_or3_b32 v188, v116, v117, v118
 v_mfma_f32_16x16x32_bf16 v[36:39], a[248:251], a[200:203], v[36:39]
 v_or3_b32 v188, v188, v119, v120
 v_or3_b32 v188, v188, v121, v122
 v_mfma_f32_16x16x32_bf16 v[44:47], a[248:251], a[216:219], v[44:47]
 v_or3_b32 v188, v188, v123, v124
 v_or3_b32 v188, v188, v125, v126
 v_mfma_f32_16x16x32_bf16 v[52:55], a[248:251], a[232:235], v[52:55]
 ds_read_b64_tr_b16 a[248:249], v200 offset:0
 ds_read_b64_tr_b16 a[250:251], v200 offset:4096
 v_mfma_f32_16x16x32_bf16 v[20:23], a[252:255], a[172:175], v[20:23]
 v_or3_b32 v188, v188, v127, v128
 v_or3_b32 v188, v188, v129, v130
 v_mfma_f32_16x16x32_bf16 v[28:31], a[252:255], a[188:191], v[28:31]
 v_or3_b32 v188, v188, v131, v132
 v_or3_b32 v188, v188, v133, v134
 v_mfma_f32_16x16x32_bf16 v[36:39], a[252:255], a[204:207], v[36:39]
 v_bitop3_b32 v188, v188, v135, s45 bitop3:0xa8
 v_cmp_ne_u32 vcc, 0, v188
 v_mfma_f32_16x16x32_bf16 v[44:47], a[252:255], a[220:223], v[44:47]
 v_mfma_f32_16x16x32_bf16 v[52:55], a[252:255], a[236:239], v[52:55]
 s_waitcnt vmcnt(4)
 s_cbranch_vccnz L_rarea14
L_rarea14_back:
 v_mfma_f32_16x16x32_bf16 v[156:159], v[184:187], v[116:119], v[156:159]
 buffer_load_dwordx4 v219, s[32:35], s46 offen offset:1024 nt lds
 v_mfma_f32_16x16x32_bf16 v[160:163], v[184:187], v[120:123], v[160:163]
 v_exp_f32 v176, v16
 v_mfma_f32_16x16x32_bf16 v[164:167], v[184:187], v[124:127], v[164:167]
 v_exp_f32 v177, v17
 v_mfma_f32_16x16x32_bf16 v[168:171], v[184:187], v[128:131], v[168:171]
 v_exp_f32 v178, v18
 v_mfma_f32_16x16x32_bf16 v[172:175], v[184:187], v[132:135], v[172:175]
 ds_read_b64_tr_b16 a[252:253], v201 offset:0
 s_waitcnt lgkmcnt(3)
 v_mfma_f32_16x16x32_bf16 a[0:3], a[240:243], v[116:119], a[0:3]
 ds_read_b64_tr_b16 a[254:255], v201 offset:4096
 v_cvt_pk_bf16_f32 v96, v176, v177
 v_mfma_f32_16x16x32_bf16 a[4:7], a[240:243], v[120:123], a[4:7]
 v_exp_f32 v179, v19
 v_mfma_f32_16x16x32_bf16 a[8:11], a[240:243], v[124:127], a[8:11]
 v_exp_f32 v180, v20
 v_mfma_f32_16x16x32_bf16 a[12:15], a[240:243], v[128:131], a[12:15]
 v_exp_f32 v181, v21
 v_mfma_f32_16x16x32_bf16 a[16:19], a[240:243], v[132:135], a[16:19]
 v_exp_f32 v182, v22
 v_mfma_f32_16x16x32_bf16 a[20:23], a[244:247], v[116:119], a[20:23]
 ds_read_b64_tr_b16 a[240:241], v202 offset:0
 ds_read_b64_tr_b16 a[242:243], v202 offset:4096
 v_mfma_f32_16x16x32_bf16 a[24:27], a[244:247], v[120:123], a[24:27]
 v_exp_f32 v183, v23
 v_mfma_f32_16x16x32_bf16 a[28:31], a[244:247], v[124:127], a[28:31]
 v_cvt_pk_bf16_f32 v97, v178, v179
 v_cvt_pk_bf16_f32 v98, v180, v181
 v_mfma_f32_16x16x32_bf16 a[32:35], a[244:247], v[128:131], a[32:35]
 v_exp_f32 v176, v24
 v_mfma_f32_16x16x32_bf16 a[36:39], a[244:247], v[132:135], a[36:39]
 ds_read_b64_tr_b16 a[244:245], v203 offset:0
 s_waitcnt lgkmcnt(3)
 v_mfma_f32_16x16x32_bf16 a[40:43], a[248:251], v[116:119], a[40:43]
 s_waitcnt vmcnt(4)
 buffer_load_dwordx4 v218, s[32:35], s46 offen offset:2048 nt lds
 v_mfma_f32_16x16x32_bf16 a[44:47], a[248:251], v[120:123], a[44:47]
 ds_read_b64_tr_b16 a[246:247], v203 offset:4096
 v_cvt_pk_bf16_f32 v99, v182, v183
 v_mfma_f32_16x16x32_bf16 a[48:51], a[248:251], v[124:127], a[48:51]
 v_exp_f32 v177, v25
 v_mfma_f32_16x16x32_bf16 a[52:55], a[248:251], v[128:131], a[52:55]
 v_exp_f32 v178, v26
 v_mfma_f32_16x16x32_bf16 a[56:59], a[248:251], v[132:135], a[56:59]
 v_exp_f32 v179, v27
 v_mfma_f32_16x16x32_bf16 a[60:63], a[252:255], v[116:119], a[60:63]
 ds_read_b64_tr_b16 a[248:249], v204 offset:0
 ds_read_b64_tr_b16 a[250:251], v204 offset:4096
 v_mfma_f32_16x16x32_bf16 a[64:67], a[252:255], v[120:123], a[64:67]
 v_exp_f32 v180, v28
 v_mfma_f32_16x16x32_bf16 a[68:71], a[252:255], v[124:127], a[68:71]
 v_exp_f32 v181, v29
 v_mfma_f32_16x16x32_bf16 a[72:75], a[252:255], v[128:131], a[72:75]
 v_cvt_pk_bf16_f32 v100, v176, v177
 v_cvt_pk_bf16_f32 v101, v178, v179
 v_mfma_f32_16x16x32_bf16 a[76:79], a[252:255], v[132:135], a[76:79]
 ds_read_b64_tr_b16 a[252:253], v205 offset:0
 s_waitcnt lgkmcnt(3)
 v_mfma_f32_16x16x32_bf16 a[80:83], a[240:243], v[116:119], a[80:83]
 ds_read_b64_tr_b16 a[254:255], v205 offset:4096
 v_cvt_pk_bf16_f32 v102, v180, v181
 v_mfma_f32_16x16x32_bf16 a[84:87], a[240:243], v[120:123], a[84:87]
 v_exp_f32 v182, v30
 v_mfma_f32_16x16x32_bf16 a[88:91], a[240:243], v[124:127], a[88:91]
 v_exp_f32 v183, v31
 v_mfma_f32_16x16x32_bf16 a[92:95], a[240:243], v[128:131], a[92:95]
 s_waitcnt vmcnt(4)
 buffer_load_dwordx4 v219, s[32:35], s46 offen offset:3072 nt lds
 v_mfma_f32_16x16x32_bf16 a[96:99], a[240:243], v[132:135], a[96:99]
 s_add_u32 m0, s44, 49152
 s_add_u32 s46, s99, 0
 v_mfma_f32_16x16x32_bf16 a[100:103], a[244:247], v[116:119], a[100:103]
 buffer_load_dwordx4 v234, s[4:7], s46 offen offset:0  lds
 v_mfma_f32_16x16x32_bf16 a[104:107], a[244:247], v[120:123], a[104:107]
 buffer_load_dwordx4 v235, s[4:7], s46 offen offset:1024  lds
 v_mfma_f32_16x16x32_bf16 a[108:111], a[244:247], v[124:127], a[108:111]
 buffer_load_dwordx4 v236, s[4:7], s46 offen offset:2048  lds
 v_mfma_f32_16x16x32_bf16 a[112:115], a[244:247], v[128:131], a[112:115]
 buffer_load_dwordx4 v237, s[4:7], s46 offen offset:3072  lds
 v_mfma_f32_16x16x32_bf16 a[116:119], a[244:247], v[132:135], a[116:119]
 v_exp_f32 v176, v32
 s_waitcnt lgkmcnt(0)
 v_mfma_f32_16x16x32_bf16 a[120:123], a[248:251], v[116:119], a[120:123]
 ds_read_b128 a[240:243], v190 offset:16384
 ds_read_b128 a[244:247], v191 offset:16384
 v_mfma_f32_16x16x32_bf16 a[124:127], a[248:251], v[120:123], a[124:127]
 v_exp_f32 v177, v33
 v_mfma_f32_16x16x32_bf16 a[128:131], a[248:251], v[124:127], a[128:131]
 v_exp_f32 v178, v34
 v_mfma_f32_16x16x32_bf16 a[132:135], a[248:251], v[128:131], a[132:135]
 s_add_u32 m0, s44, 114688
 s_add_u32 s46, s96, 163840
 v_mfma_f32_16x16x32_bf16 a[136:139], a[248:251], v[132:135], a[136:139]
 buffer_load_dwordx4 v234, s[4:7], s46 offen offset:0  lds
 v_mfma_f32_16x16x32_bf16 a[140:143], a[252:255], v[116:119], a[140:143]
 buffer_load_dwordx4 v235, s[4:7], s46 offen offset:1024  lds
 v_mfma_f32_16x16x32_bf16 a[144:147], a[252:255], v[120:123], a[144:147]
 buffer_load_dwordx4 v236, s[4:7], s46 offen offset:2048  lds
 v_mfma_f32_16x16x32_bf16 a[148:151], a[252:255], v[124:127], a[148:151]
 buffer_load_dwordx4 v237, s[4:7], s46 offen offset:3072  lds
 v_exp_f32 v179, v35
 v_mfma_f32_16x16x32_bf16 a[152:155], a[252:255], v[128:131], a[152:155]
 v_exp_f32 v180, v36
 v_mfma_f32_16x16x32_bf16 a[156:159], a[252:255], v[132:135], a[156:159]
 v_cvt_pk_bf16_f32 v103, v182, v183
 s_waitcnt lgkmcnt(0)
 v_mfma_f32_16x16x32_bf16 v[56:59], a[240:243], a[160:163], v[136:139]
 v_exp_f32 v181, v37
 v_mfma_f32_16x16x32_bf16 v[64:67], a[240:243], a[176:179], v[140:143]
 v_exp_f32 v182, v38
 v_mfma_f32_16x16x32_bf16 v[72:75], a[240:243], a[192:195], v[144:147]
 v_cvt_pk_bf16_f32 v104, v176, v177
 v_exp_f32 v183, v39
 v_mfma_f32_16x16x32_bf16 v[80:83], a[240:243], a[208:211], v[148:151]
 ds_read_b128 a[248:251], v192 offset:16384
 ds_read_b128 a[252:255], v193 offset:16384
 v_mfma_f32_16x16x32_bf16 v[88:91], a[240:243], a[224:227], v[152:155]
 v_exp_f32 v176, v40
 v_mfma_f32_16x16x32_bf16 v[56:59], a[244:247], a[164:167], v[56:59]
 v_cvt_pk_bf16_f32 v105, v178, v179
 ds_read_b128 a[240:243], v190 offset:20480
 v_mfma_f32_16x16x32_bf16 v[64:67], a[244:247], a[180:183], v[64:67]
 v_exp_f32 v177, v41
 v_mfma_f32_16x16x32_bf16 v[72:75], a[244:247], a[196:199], v[72:75]
 v_exp_f32 v178, v42
 v_mfma_f32_16x16x32_bf16 v[80:83], a[244:247], a[212:215], v[80:83]
 v_cvt_pk_bf16_f32 v106, v180, v181
 v_cvt_pk_bf16_f32 v107, v182, v183
 v_mfma_f32_16x16x32_bf16 v[88:91], a[244:247], a[228:231], v[88:91]
 ds_read_b128 a[244:247], v191 offset:20480
 s_waitcnt lgkmcnt(2)
 v_mfma_f32_16x16x32_bf16 v[56:59], a[248:251], a[168:171], v[56:59]
 v_exp_f32 v179, v43
 v_mfma_f32_16x16x32_bf16 v[64:67], a[248:251], a[184:187], v[64:67]
 v_exp_f32 v180, v44
 v_mfma_f32_16x16x32_bf16 v[72:75], a[248:251], a[200:203], v[72:75]
 v_exp_f32 v181, v45
 v_mfma_f32_16x16x32_bf16 v[80:83], a[248:251], a[216:219], v[80:83]
 v_exp_f32 v182, v46
 v_mfma_f32_16x16x32_bf16 v[88:91], a[248:251], a[232:235], v[88:91]
 v_cvt_pk_bf16_f32 v108, v176, v177
 ds_read_b128 a[248:251], v192 offset:20480
 v_mfma_f32_16x16x32_bf16 v[56:59], a[252:255], a[172:175], v[56:59]
 v_exp_f32 v183, v47
 v_mfma_f32_16x16x32_bf16 v[64:67], a[252:255], a[188:191], v[64:67]
 v_exp_f32 v176, v48
 v_mfma_f32_16x16x32_bf16 v[72:75], a[252:255], a[204:207], v[72:75]
 v_cvt_pk_bf16_f32 v109, v178, v179
 v_cvt_pk_bf16_f32 v110, v180, v181
 v_mfma_f32_16x16x32_bf16 v[80:83], a[252:255], a[220:223], v[80:83]
 v_exp_f32 v177, v49
 v_mfma_f32_16x16x32_bf16 v[88:91], a[252:255], a[236:239], v[88:91]
 ds_read_b128 a[252:255], v193 offset:20480
 s_waitcnt lgkmcnt(2)
 v_mfma_f32_16x16x32_bf16 v[60:63], a[240:243], a[160:163], v[136:139]
 v_exp_f32 v178, v50
 v_mfma_f32_16x16x32_bf16 v[68:71], a[240:243], a[176:179], v[140:143]
 v_exp_f32 v179, v51
 v_mfma_f32_16x16x32_bf16 v[76:79], a[240:243], a[192:195], v[144:147]
 v_exp_f32 v180, v52
 v_mfma_f32_16x16x32_bf16 v[84:87], a[240:243], a[208:211], v[148:151]
 v_cvt_pk_bf16_f32 v111, v182, v183
 v_cvt_pk_bf16_f32 v112, v176, v177
 v_mfma_f32_16x16x32_bf16 v[92:95], a[240:243], a[224:227], v[152:155]
 v_cvt_pk_bf16_f32 v113, v178, v179
 s_waitcnt vmcnt(12)
 s_barrier
 v_mfma_f32_16x16x32_bf16 v[60:63], a[244:247], a[164:167], v[60:63]
 v_exp_f32 v181, v53
 v_mfma_f32_16x16x32_bf16 v[68:71], a[244:247], a[180:183], v[68:71]
 ds_read_b64_tr_b16 a[240:241], v198 offset:32768
 ds_read_b64_tr_b16 a[242:243], v198 offset:36864
 v_mfma_f32_16x16x32_bf16 v[76:79], a[244:247], a[196:199], v[76:79]
 v_exp_f32 v182, v54
 v_mfma_f32_16x16x32_bf16 v[84:87], a[244:247], a[212:215], v[84:87]
 v_exp_f32 v183, v55
 v_mfma_f32_16x16x32_bf16 v[92:95], a[244:247], a[228:231], v[92:95]
 ds_read_b64_tr_b16 a[244:245], v199 offset:32768
 s_waitcnt lgkmcnt(3)
 v_mfma_f32_16x16x32_bf16 v[60:63], a[248:251], a[168:171], v[60:63]
 ds_read_b64_tr_b16 a[246:247], v199 offset:36864
 v_cvt_pk_bf16_f32 v114, v180, v181
 v_mfma_f32_16x16x32_bf16 v[68:71], a[248:251], a[184:187], v[68:71]
 v_cvt_pk_bf16_f32 v115, v182, v183
 v_or3_b32 v188, v96, v97, v98
 v_mfma_f32_16x16x32_bf16 v[76:79], a[248:251], a[200:203], v[76:79]
 v_or3_b32 v188, v188, v99, v100
 v_or3_b32 v188, v188, v101, v102
 v_mfma_f32_16x16x32_bf16 v[84:87], a[248:251], a[216:219], v[84:87]
 v_or3_b32 v188, v188, v103, v104
 v_or3_b32 v188, v188, v105, v106
 v_mfma_f32_16x16x32_bf16 v[92:95], a[248:251], a[232:235], v[92:95]
 ds_read_b64_tr_b16 a[248:249], v200 offset:32768
 ds_read_b64_tr_b16 a[250:251], v200 offset:36864
 v_mfma_f32_16x16x32_bf16 v[60:63], a[252:255], a[172:175], v[60:63]
 v_or3_b32 v188, v188, v107, v108
 v_or3_b32 v188, v188, v109, v110
 v_mfma_f32_16x16x32_bf16 v[68:71], a[252:255], a[188:191], v[68:71]
 v_or3_b32 v188, v188, v111, v112
 v_or3_b32 v188, v188, v113, v114
 v_mfma_f32_16x16x32_bf16 v[76:79], a[252:255], a[204:207], v[76:79]
 v_bitop3_b32 v188, v188, v115, s45 bitop3:0xa8
 v_cmp_ne_u32 vcc, 0, v188
 v_mfma_f32_16x16x32_bf16 v[84:87], a[252:255], a[220:223], v[84:87]
 v_mfma_f32_16x16x32_bf16 v[92:95], a[252:255], a[236:239], v[92:95]
 s_cbranch_vccnz L_rarea15
L_rarea15_back:
 v_mfma_f32_16x16x32_bf16 v[156:159], v[184:187], v[96:99], v[156:159]
 v_mfma_f32_16x16x32_bf16 v[160:163], v[184:187], v[100:103], v[160:163]
 v_exp_f32 v176, v56
 v_mfma_f32_16x16x32_bf16 v[164:167], v[184:187], v[104:107], v[164:167]
 v_exp_f32 v177, v57
 v_mfma_f32_16x16x32_bf16 v[168:171], v[184:187], v[108:111], v[168:171]
 v_exp_f32 v178, v58
 v_mfma_f32_16x16x32_bf16 v[172:175], v[184:187], v[112:115], v[172:175]
 ds_read_b64_tr_b16 a[252:253], v201 offset:32768
 s_waitcnt lgkmcnt(3)
 v_mfma_f32_16x16x32_bf16 a[0:3], a[240:243], v[96:99], a[0:3]
 ds_read_b64_tr_b16 a[254:255], v201 offset:36864
 v_cvt_pk_bf16_f32 v116, v176, v177
 v_mfma_f32_16x16x32_bf16 a[4:7], a[240:243], v[100:103], a[4:7]
 v_exp_f32 v179, v59
 v_mfma_f32_16x16x32_bf16 a[8:11], a[240:243], v[104:107], a[8:11]
 v_exp_f32 v180, v60
 v_mfma_f32_16x16x32_bf16 a[12:15], a[240:243], v[108:111], a[12:15]
 v_exp_f32 v181, v61
 v_mfma_f32_16x16x32_bf16 a[16:19], a[240:243], v[112:115], a[16:19]
 v_exp_f32 v182, v62
 v_mfma_f32_16x16x32_bf16 a[20:23], a[244:247], v[96:99], a[20:23]
 ds_read_b64_tr_b16 a[240:241], v202 offset:32768
 ds_read_b64_tr_b16 a[242:243], v202 offset:36864
 v_mfma_f32_16x16x32_bf16 a[24:27], a[244:247], v[100:103], a[24:27]
 v_exp_f32 v183, v63
 v_mfma_f32_16x16x32_bf16 a[28:31], a[244:247], v[104:107], a[28:31]
 v_cvt_pk_bf16_f32 v117, v178, v179
 v_cvt_pk_bf16_f32 v118, v180, v181
 v_mfma_f32_16x16x32_bf16 a[32:35], a[244:247], v[108:111], a[32:35]
 v_exp_f32 v176, v64
 v_mfma_f32_16x16x32_bf16 a[36:39], a[244:247], v[112:115], a[36:39]
 ds_read_b64_tr_b16 a[244:245], v203 offset:32768
 s_waitcnt lgkmcnt(3)
 v_mfma_f32_16x16x32_bf16 a[40:43], a[248:251], v[96:99], a[40:43]
 ds_read_b64_tr_b16 a[246:247], v203 offset:36864
 v_cvt_pk_bf16_f32 v119, v182, v183
 v_mfma_f32_16x16x32_bf16 a[44:47], a[248:251], v[100:103], a[44:47]
 v_exp_f32 v177, v65
 v_mfma_f32_16x16x32_bf16 a[48:51], a[248:251], v[104:107], a[48:51]
 v_exp_f32 v178, v66
 v_mfma_f32_16x16x32_bf16 a[52:55], a[248:251], v[108:111], a[52:55]
 v_cvt_pk_bf16_f32 v120, v176, v177
 v_or3_b32 v188, v116, v117, v118
 v_mfma_f32_16x16x32_bf16 a[56:59], a[248:251], v[112:115], a[56:59]
 v_exp_f32 v179, v67
 v_mfma_f32_16x16x32_bf16 a[60:63], a[252:255], v[96:99], a[60:63]
 ds_read_b64_tr_b16 a[248:249], v204 offset:32768
 ds_read_b64_tr_b16 a[250:251], v204 offset:36864
 v_mfma_f32_16x16x32_bf16 a[64:67], a[252:255], v[100:103], a[64:67]
 v_exp_f32 v180, v68
 v_mfma_f32_16x16x32_bf16 a[68:71], a[252:255], v[104:107], a[68:71]
 v_exp_f32 v181, v69
 v_mfma_f32_16x16x32_bf16 a[72:75], a[252:255], v[108:111], a[72:75]
 v_cvt_pk_bf16_f32 v121, v178, v179
 v_cvt_pk_bf16_f32 v122, v180, v181
 v_mfma_f32_16x16x32_bf16 a[76:79], a[252:255], v[112:115], a[76:79]
 ds_read_b64_tr_b16 a[252:253], v205 offset:32768
 s_waitcnt lgkmcnt(3)
 v_mfma_f32_16x16x32_bf16 a[80:83], a[240:243], v[96:99], a[80:83]
 ds_read_b64_tr_b16 a[254:255], v205 offset:36864
 v_or3_b32 v188, v188, v119, v120
 v_mfma_f32_16x16x32_bf16 a[84:87], a[240:243], v[100:103], a[84:87]
 v_exp_f32 v182, v70
 v_mfma_f32_16x16x32_bf16 a[88:91], a[240:243], v[104:107], a[88:91]
 v_exp_f32 v183, v71
 v_mfma_f32_16x16x32_bf16 a[92:95], a[240:243], v[108:111], a[92:95]
 v_exp_f32 v176, v72
 v_mfma_f32_16x16x32_bf16 a[96:99], a[240:243], v[112:115], a[96:99]
 v_cvt_pk_bf16_f32 v123, v182, v183
 v_or3_b32 v188, v188, v121, v122
 v_mfma_f32_16x16x32_bf16 a[100:103], a[244:247], v[96:99], a[100:103]
 v_exp_f32 v177, v73
 v_mfma_f32_16x16x32_bf16 a[104:107], a[244:247], v[100:103], a[104:107]
 v_cvt_pk_bf16_f32 v124, v176, v177
 v_or3_b32 v188, v188, v123, v124
 v_mfma_f32_16x16x32_bf16 a[108:111], a[244:247], v[104:107], a[108:111]
 v_exp_f32 v178, v74
 v_mfma_f32_16x16x32_bf16 a[112:115], a[244:247], v[108:111], a[112:115]
 ds_read_b64_tr_b16 a[160:161], v246 offset:16384
 v_mfma_f32_16x16x32_bf16 a[116:119], a[244:247], v[112:115], a[116:119]
 ds_read_b64_tr_b16 a[162:163], v246 offset:18432
 s_waitcnt lgkmcnt(2)
 v_mfma_f32_16x16x32_bf16 a[120:123], a[248:251], v[96:99], a[120:123]
 v_exp_f32 v179, v75
 v_mfma_f32_16x16x32_bf16 a[124:127], a[248:251], v[100:103], a[124:127]
 v_exp_f32 v180, v76
 v_mfma_f32_16x16x32_bf16 a[128:131], a[248:251], v[104:107], a[128:131]
 v_cvt_pk_bf16_f32 v125, v178, v179
 ds_read_b64_tr_b16 a[164:165], v247 offset:16384
 v_mfma_f32_16x16x32_bf16 a[132:135], a[248:251], v[108:111], a[132:135]
 v_exp_f32 v181, v77
 v_mfma_f32_16x16x32_bf16 a[136:139], a[248:251], v[112:115], a[136:139]
 v_exp_f32 v182, v78
 v_mfma_f32_16x16x32_bf16 a[140:143], a[252:255], v[96:99], a[140:143]
 v_cvt_pk_bf16_f32 v126, v180, v181
 v_or3_b32 v188, v188, v125, v126
 v_mfma_f32_16x16x32_bf16 a[144:147], a[252:255], v[100:103], a[144:147]
 v_exp_f32 v183, v79
 v_mfma_f32_16x16x32_bf16 a[148:151], a[252:255], v[104:107], a[148:151]
 v_cvt_pk_bf16_f32 v127, v182, v183
 ds_read_b64_tr_b16 a[166:167], v247 offset:18432
 v_mfma_f32_16x16x32_bf16 a[152:155], a[252:255], v[108:111], a[152:155]
 v_exp_f32 v176, v80
 v_mfma_f32_16x16x32_bf16 a[156:159], a[252:255], v[112:115], a[156:159]
 ds_read_b64_tr_b16 a[168:169], v248 offset:16384
 ds_read_b64_tr_b16 a[170:171], v248 offset:18432
 ds_read_b64_tr_b16 a[172:173], v249 offset:16384
 ds_read_b64_tr_b16 a[174:175], v249 offset:18432
 ds_read_b64_tr_b16 a[176:177], v246 offset:0
 ds_read_b64_tr_b16 a[178:179], v246 offset:2048
 ds_read_b64_tr_b16 a[180:181], v247 offset:0
 ds_read_b64_tr_b16 a[182:183], v247 offset:2048
 ds_read_b64_tr_b16 a[184:185], v248 offset:0
 ds_read_b64_tr_b16 a[186:187], v248 offset:2048
 ds_read_b64_tr_b16 a[188:189], v249 offset:0
 ds_read_b64_tr_b16 a[190:191], v249 offset:2048
 s_waitcnt lgkmcnt(8)
 s_add_u32 m0, s44, 147456
 s_add_u32 s46, s96, 327680
 buffer_load_dwordx4 v234, s[4:7], s46 offen offset:0  lds
 buffer_load_dwordx4 v235, s[4:7], s46 offen offset:1024  lds
 buffer_load_dwordx4 v236, s[4:7], s46 offen offset:2048  lds
 buffer_load_dwordx4 v237, s[4:7], s46 offen offset:3072  lds
 ds_read_b64_tr_b16 a[192:193], v238 offset:32768
 ds_read_b64_tr_b16 a[194:195], v238 offset:34816
 ds_read_b64_tr_b16 a[196:197], v239 offset:32768
 ds_read_b64_tr_b16 a[198:199], v239 offset:34816
 ds_read_b64_tr_b16 a[200:201], v240 offset:32768
 ds_read_b64_tr_b16 a[202:203], v240 offset:34816
 ds_read_b64_tr_b16 a[204:205], v241 offset:32768
 ds_read_b64_tr_b16 a[206:207], v241 offset:34816
 s_waitcnt lgkmcnt(8)
 s_add_u32 m0, s44, 131072
 s_add_u32 s46, s96, 491520
 buffer_load_dwordx4 v234, s[4:7], s46 offen offset:0  lds
 buffer_load_dwordx4 v235, s[4:7], s46 offen offset:1024  lds
 buffer_load_dwordx4 v236, s[4:7], s46 offen offset:2048  lds
 buffer_load_dwordx4 v237, s[4:7], s46 offen offset:3072  lds
 s_waitcnt vmcnt(12)
 ds_read_b64_tr_b16 a[208:209], v238 offset:49152
 ds_read_b64_tr_b16 a[210:211], v238 offset:51200
 ds_read_b64_tr_b16 a[212:213], v239 offset:49152
 ds_read_b64_tr_b16 a[214:215], v239 offset:51200
 ds_read_b64_tr_b16 a[216:217], v240 offset:49152
 ds_read_b64_tr_b16 a[218:219], v240 offset:51200
 ds_read_b64_tr_b16 a[220:221], v241 offset:49152
 ds_read_b64_tr_b16 a[222:223], v241 offset:51200
 s_waitcnt lgkmcnt(8)
 s_add_u32 m0, s44, 32768
 s_add_u32 s46, s96, 655360
 buffer_load_dwordx4 v234, s[4:7], s46 offen offset:0  lds
 buffer_load_dwordx4 v235, s[4:7], s46 offen offset:1024  lds
 buffer_load_dwordx4 v236, s[4:7], s46 offen offset:2048  lds
 buffer_load_dwordx4 v237, s[4:7], s46 offen offset:3072  lds
 s_waitcnt vmcnt(12)
 ds_read_b64_tr_b16 a[224:225], v242 offset:49152
 ds_read_b64_tr_b16 a[226:227], v242 offset:51200
 ds_read_b64_tr_b16 a[228:229], v243 offset:49152
 ds_read_b64_tr_b16 a[230:231], v243 offset:51200
 ds_read_b64_tr_b16 a[232:233], v244 offset:49152
 ds_read_b64_tr_b16 a[234:235], v244 offset:51200
 ds_read_b64_tr_b16 a[236:237], v245 offset:49152
 ds_read_b64_tr_b16 a[238:239], v245 offset:51200
 v_add_u32 v4, s44, v189
 v_xor_b32 v7, 0x2000, v4
 v_add_u32 v5, 0x10000, v4
 v_add_u32 v8, 0x10000, v7
 v_add_u32 v6, 0x20000, v4
 v_add_u32 v9, 0x20000, v7
 v_lshlrev_b32 v10, 2, v2
 v_lshl_add_u32 v10, v1, 12, v10
 v_xor_b32 v11, 0x2000, v10
 v_add_u32 v10, 49152, v10
 v_add_u32 v11, 49152, v11
 s_mul_i32 s56, s41, 10
 s_and_b32 s57, s40, 1
 s_mul_i32 s57, s57, 5
 s_add_u32 s56, s56, s57
 s_lshl_b32 s56, s56, 17
 s_lshl_b32 s57, s42, 12
 s_add_u32 s56, s56, s57
 s_and_b32 s57, s40, 2
 s_lshl_b32 s57, s57, 10
 s_add_u32 s56, s56, s57
 v_exp_f32 v177, v81
 v_exp_f32 v178, v82
 v_cvt_pk_bf16_f32 v128, v176, v177
 v_or3_b32 v188, v188, v127, v128
 v_exp_f32 v179, v83
 v_exp_f32 v180, v84
 v_cvt_pk_bf16_f32 v129, v178, v179
 v_exp_f32 v181, v85
 v_exp_f32 v182, v86
 v_cvt_pk_bf16_f32 v130, v180, v181
 v_or3_b32 v188, v188, v129, v130
 v_exp_f32 v183, v87
 v_exp_f32 v176, v88
 v_cvt_pk_bf16_f32 v131, v182, v183
 v_exp_f32 v177, v89
 v_exp_f32 v178, v90
 v_cvt_pk_bf16_f32 v132, v176, v177
 v_or3_b32 v188, v188, v131, v132
 v_exp_f32 v179, v91
 v_exp_f32 v180, v92
 v_cvt_pk_bf16_f32 v133, v178, v179
 v_exp_f32 v181, v93
 v_exp_f32 v182, v94
 v_cvt_pk_bf16_f32 v134, v180, v181
 v_or3_b32 v188, v188, v133, v134
 v_exp_f32 v183, v95
 s_barrier
 ds_read_b64_tr_b16 a[240:241], v202 offset:16384
 ds_read_b64_tr_b16 a[242:243], v202 offset:20480
 v_cvt_pk_bf16_f32 v135, v182, v183
 v_bitop3_b32 v188, v188, v135, s45 bitop3:0xa8
 v_cmp_ne_u32 vcc, 0, v188
 ds_read_b64_tr_b16 a[244:245], v203 offset:16384
 ds_read_b64_tr_b16 a[246:247], v203 offset:20480
 ds_read_b64_tr_b16 a[248:249], v204 offset:16384
 ds_read_b64_tr_b16 a[250:251], v204 offset:20480
 s_cbranch_vccnz L_rarea16
L_rarea16_back:
 v_mfma_f32_16x16x32_bf16 v[156:159], v[184:187], v[116:119], v[156:159]
 v_mfma_f32_16x16x32_bf16 v[160:163], v[184:187], v[120:123], v[160:163]
 ds_write_b32 v10, v136 offset:0
 v_mfma_f32_16x16x32_bf16 v[164:167], v[184:187], v[124:127], v[164:167]
 ds_write_b32 v10, v140 offset:256
 v_mfma_f32_16x16x32_bf16 v[168:171], v[184:187], v[128:131], v[168:171]
 ds_write_b32 v10, v144 offset:512
 v_mfma_f32_16x16x32_bf16 v[172:175], v[184:187], v[132:135], v[172:175]
 ds_read_b64_tr_b16 a[252:253], v205 offset:16384
 ds_write_b32 v10, v148 offset:768
 s_waitcnt lgkmcnt(7)
 v_mfma_f32_16x16x32_bf16 a[80:83], a[240:243], v[116:119], a[80:83]
 ds_read_b64_tr_b16 a[254:255], v205 offset:20480
 ds_write_b32 v10, v152 offset:1024
 v_mfma_f32_16x16x32_bf16 a[84:87], a[240:243], v[120:123], a[84:87]
 v_mfma_f32_16x16x32_bf16 a[88:91], a[240:243], v[124:127], a[88:91]
 ds_write_b32 v10, v156 offset:1280
 v_mfma_f32_16x16x32_bf16 a[92:95], a[240:243], v[128:131], a[92:95]
 ds_write_b32 v10, v160 offset:1536
 v_mfma_f32_16x16x32_bf16 a[96:99], a[240:243], v[132:135], a[96:99]
 ds_read_b64_tr_b16 a[240:241], v198 offset:16384
 ds_read_b64_tr_b16 a[242:243], v198 offset:20480
 ds_write_b32 v10, v164 offset:1792
 v_mfma_f32_16x16x32_bf16 a[100:103], a[244:247], v[116:119], a[100:103]
 ds_write_b32 v10, v168 offset:2048
 v_mfma_f32_16x16x32_bf16 a[104:107], a[244:247], v[120:123], a[104:107]
 ds_write_b32 v10, v172 offset:2304
 v_mfma_f32_16x16x32_bf16 a[108:111], a[244:247], v[124:127], a[108:111]
 v_mfma_f32_16x16x32_bf16 a[112:115], a[244:247], v[128:131], a[112:115]
 s_waitcnt lgkmcnt(0)
 s_barrier
 ds_read_b32 v220, v11 offset:0
 ds_read_b32 v221, v11 offset:256
 ds_read_b32 v222, v11 offset:512
 ds_read_b32 v223, v11 offset:768
 ds_read_b32 v224, v11 offset:1024
 v_mfma_f32_16x16x32_bf16 a[116:119], a[244:247], v[132:135], a[116:119]
 ds_read_b64_tr_b16 a[244:245], v199 offset:16384
 ds_read_b32 v225, v11 offset:1280
 ds_read_b32 v226, v11 offset:1536
 ds_read_b32 v227, v11 offset:1792
 ds_read_b32 v228, v11 offset:2048
 ds_read_b32 v229, v11 offset:2304
 ds_write_b128 v5, a[80:83] offset:49152
 v_mfma_f32_16x16x32_bf16 a[120:123], a[248:251], v[116:119], a[120:123]
 ds_read_b64_tr_b16 a[246:247], v199 offset:20480
 ds_write_b128 v5, a[84:87] offset:50176
 v_mfma_f32_16x16x32_bf16 a[124:127], a[248:251], v[120:123], a[124:127]
 ds_write_b128 v5, a[88:91] offset:51200
 v_mfma_f32_16x16x32_bf16 a[128:131], a[248:251], v[124:127], a[128:131]
 ds_write_b128 v5, a[92:95] offset:52224
 v_mfma_f32_16x16x32_bf16 a[132:135], a[248:251], v[128:131], a[132:135]
 ds_write_b128 v4, a[96:99] offset:0
 v_mfma_f32_16x16x32_bf16 a[136:139], a[248:251], v[132:135], a[136:139]
 ds_read_b64_tr_b16 a[248:249], v200 offset:16384
 ds_read_b64_tr_b16 a[250:251], v200 offset:20480
 s_waitcnt lgkmcnt(8)
 v_min_f32 v139, v136, v220
 v_min_f32 v143, v140, v221
 v_min_f32 v147, v144, v222
 ds_write_b128 v4, a[100:103] offset:1024
 v_mfma_f32_16x16x32_bf16 a[140:143], a[252:255], v[116:119], a[140:143]
 v_min_f32 v151, v148, v223
 v_min_f32 v155, v152, v224
 v_sub_f32 v137, v139, v136
 ds_write_b128 v4, a[104:107] offset:2048
 v_mfma_f32_16x16x32_bf16 a[144:147], a[252:255], v[120:123], a[144:147]
 v_sub_f32 v138, v139, v220
 v_sub_f32 v141, v143, v140
 v_sub_f32 v142, v143, v221
 ds_write_b128 v4, a[108:111] offset:3072
 v_mfma_f32_16x16x32_bf16 a[148:151], a[252:255], v[124:127], a[148:151]
 v_sub_f32 v145, v147, v144
 v_sub_f32 v146, v147, v222
 v_sub_f32 v149, v151, v148
 ds_write_b128 v5, a[112:115] offset:0
 v_mfma_f32_16x16x32_bf16 a[152:155], a[252:255], v[128:131], a[152:155]
 v_sub_f32 v150, v151, v223
 v_sub_f32 v153, v155, v152
 v_sub_f32 v154, v155, v224
 ds_write_b128 v5, a[116:119] offset:1024
 v_mfma_f32_16x16x32_bf16 a[156:159], a[252:255], v[132:135], a[156:159]
 ds_read_b64_tr_b16 a[252:253], v201 offset:16384
 v_exp_f32 v137, v137
 v_exp_f32 v138, v138
 v_exp_f32 v141, v141
 ds_write_b128 v5, a[120:123] offset:2048
 s_waitcnt lgkmcnt(13)
 v_mfma_f32_16x16x32_bf16 a[0:3], a[240:243], v[116:119], a[0:3]
 ds_read_b64_tr_b16 a[254:255], v201 offset:20480
 v_exp_f32 v142, v142
 v_exp_f32 v145, v145
 v_exp_f32 v146, v146
 ds_write_b128 v5, a[124:127] offset:3072
 v_mfma_f32_16x16x32_bf16 a[4:7], a[240:243], v[120:123], a[4:7]
 v_exp_f32 v149, v149
 v_exp_f32 v150, v150
 v_exp_f32 v153, v153
 ds_write_b128 v4, a[128:131] offset:16384
 v_mfma_f32_16x16x32_bf16 a[8:11], a[240:243], v[124:127], a[8:11]
 v_exp_f32 v154, v154
 v_mul_f32 v156, v156, v137
 v_mul_f32 v160, v160, v141
 ds_write_b128 v4, a[132:135] offset:17408
 v_mfma_f32_16x16x32_bf16 a[12:15], a[240:243], v[128:131], a[12:15]
 v_mul_f32 v164, v164, v145
 v_mul_f32 v168, v168, v149
 v_mul_f32 v172, v172, v153
 ds_write_b128 v4, a[136:139] offset:18432
 v_mfma_f32_16x16x32_bf16 a[16:19], a[240:243], v[132:135], a[16:19]
 v_fmac_f32 v156, v225, v138
 v_fmac_f32 v160, v226, v142
 v_fmac_f32 v164, v227, v146
 ds_write_b128 v4, a[140:143] offset:19456
 v_mfma_f32_16x16x32_bf16 a[20:23], a[244:247], v[116:119], a[20:23]
 v_fmac_f32 v168, v228, v150
 v_fmac_f32 v172, v229, v154
 v_rcp_f32 v156, v156
 ds_write_b128 v5, a[144:147] offset:32768
 v_mfma_f32_16x16x32_bf16 a[24:27], a[244:247], v[120:123], a[24:27]
 v_rcp_f32 v160, v160
 v_rcp_f32 v164, v164
 v_rcp_f32 v168, v168
 ds_write_b128 v5, a[148:151] offset:33792
 v_mfma_f32_16x16x32_bf16 a[28:31], a[244:247], v[124:127], a[28:31]
 v_rcp_f32 v172, v172
 v_mul_f32 v137, v137, v156
 v_mul_f32 v138, v138, v156
 ds_write_b128 v5, a[152:155] offset:34816
 v_accvgpr_read_b32 v16, a0
 v_accvgpr_read_b32 v17, a1
 v_accvgpr_read_b32 v18, a2
 v_accvgpr_read_b32 v19, a3
 v_mfma_f32_16x16x32_bf16 a[32:35], a[244:247], v[128:131], a[32:35]
 v_mul_f32 v141, v141, v160
 v_mul_f32 v142, v142, v160
 v_mul_f32 v145, v145, v164
 ds_write_b128 v5, a[156:159] offset:35840
 v_accvgpr_read_b32 v20, a4
 v_accvgpr_read_b32 v21, a5
 v_accvgpr_read_b32 v22, a6
 v_accvgpr_read_b32 v23, a7
 v_mfma_f32_16x16x32_bf16 a[36:39], a[244:247], v[132:135], a[36:39]
 v_mul_f32 v146, v146, v164
 v_mul_f32 v149, v149, v168
 v_mul_f32 v150, v150, v168
 v_accvgpr_read_b32 v24, a8
 v_accvgpr_read_b32 v25, a9
 v_accvgpr_read_b32 v26, a10
 v_accvgpr_read_b32 v27, a11
 s_waitcnt lgkmcnt(9)
 v_mfma_f32_16x16x32_bf16 a[40:43], a[248:251], v[116:119], a[40:43]
 v_mul_f32 v153, v153, v172
 v_mul_f32 v154, v154, v172
 v_accvgpr_read_b32 v28, a12
 v_accvgpr_read_b32 v29, a13
 v_accvgpr_read_b32 v30, a14
 v_accvgpr_read_b32 v31, a15
 v_mfma_f32_16x16x32_bf16 a[44:47], a[248:251], v[120:123], a[44:47]
 v_accvgpr_read_b32 v32, a16
 v_accvgpr_read_b32 v33, a17
 v_accvgpr_read_b32 v34, a18
 v_accvgpr_read_b32 v35, a19
 v_mfma_f32_16x16x32_bf16 a[48:51], a[248:251], v[124:127], a[48:51]
 v_accvgpr_read_b32 v36, a20
 v_accvgpr_read_b32 v37, a21
 v_accvgpr_read_b32 v38, a22
 v_accvgpr_read_b32 v39, a23
 v_mfma_f32_16x16x32_bf16 a[52:55], a[248:251], v[128:131], a[52:55]
 v_accvgpr_read_b32 v40, a24
 v_accvgpr_read_b32 v41, a25
 v_accvgpr_read_b32 v42, a26
 v_accvgpr_read_b32 v43, a27
 v_mfma_f32_16x16x32_bf16 a[56:59], a[248:251], v[132:135], a[56:59]
 v_accvgpr_read_b32 v44, a28
 v_accvgpr_read_b32 v45, a29
 v_accvgpr_read_b32 v46, a30
 v_accvgpr_read_b32 v47, a31
 v_mfma_f32_16x16x32_bf16 a[60:63], a[252:255], v[116:119], a[60:63]
 v_accvgpr_read_b32 v48, a32
 v_accvgpr_read_b32 v49, a33
 v_accvgpr_read_b32 v50, a34
 v_accvgpr_read_b32 v51, a35
 v_mfma_f32_16x16x32_bf16 a[64:67], a[252:255], v[120:123], a[64:67]
 v_accvgpr_read_b32 v52, a36
 v_accvgpr_read_b32 v53, a37
 v_accvgpr_read_b32 v54, a38
 v_accvgpr_read_b32 v55, a39
 v_mfma_f32_16x16x32_bf16 a[68:71], a[252:255], v[124:127], a[68:71]
 v_accvgpr_read_b32 v56, a40
 v_accvgpr_read_b32 v57, a41
 v_accvgpr_read_b32 v58, a42
 v_accvgpr_read_b32 v59, a43
 v_mfma_f32_16x16x32_bf16 a[72:75], a[252:255], v[128:131], a[72:75]
 v_accvgpr_read_b32 v60, a44
 v_accvgpr_read_b32 v61, a45
 v_accvgpr_read_b32 v62, a46
 v_accvgpr_read_b32 v63, a47
 v_mfma_f32_16x16x32_bf16 a[76:79], a[252:255], v[132:135], a[76:79]
 v_accvgpr_read_b32 v64, a48
 v_accvgpr_read_b32 v65, a49
 v_accvgpr_read_b32 v66, a50
 v_accvgpr_read_b32 v67, a51
 v_accvgpr_read_b32 v68, a52
 v_accvgpr_read_b32 v69, a53
 v_accvgpr_read_b32 v70, a54
 v_accvgpr_read_b32 v71, a55
 v_accvgpr_read_b32 v72, a56
 v_accvgpr_read_b32 v73, a57
 v_accvgpr_read_b32 v74, a58
 v_accvgpr_read_b32 v75, a59
 s_waitcnt lgkmcnt(0)
 s_barrier
 ds_read_b128 v[96:99], v8 offset:49152
 ds_read_b128 v[116:119], v7 offset:1024
 ds_read_b128 v[176:179], v8 offset:2048
 ds_read_b128 v[214:217], v7 offset:19456
 ds_read_b128 v[100:103], v8 offset:50176
 ds_read_b128 v[120:123], v7 offset:2048
 ds_read_b128 v[180:183], v8 offset:3072
 ds_read_b128 v[250:253], v8 offset:32768
 ds_read_b128 v[104:107], v8 offset:51200
 ds_read_b128 v[124:127], v7 offset:3072
 ds_read_b128 v[184:187], v7 offset:16384
 ds_read_b128 v[218:221], v8 offset:33792
 s_add_u32 m0, s44, 81920
 s_add_u32 s46, s96, 819200
 buffer_load_dwordx4 v234, s[4:7], s46 offen offset:0  lds
 buffer_load_dwordx4 v235, s[4:7], s46 offen offset:1024  lds
 buffer_load_dwordx4 v236, s[4:7], s46 offen offset:2048  lds
 buffer_load_dwordx4 v237, s[4:7], s46 offen offset:3072  lds
 v_accvgpr_read_b32 v76, a60
 v_accvgpr_read_b32 v77, a61
 v_accvgpr_read_b32 v78, a62
 v_accvgpr_read_b32 v79, a63
 v_accvgpr_read_b32 v80, a64
 v_accvgpr_read_b32 v81, a65
 v_accvgpr_read_b32 v82, a66
 v_accvgpr_read_b32 v83, a67
 v_accvgpr_read_b32 v84, a68
 v_accvgpr_read_b32 v85, a69
 v_accvgpr_read_b32 v86, a70
 v_accvgpr_read_b32 v87, a71
 v_accvgpr_read_b32 v88, a72
 v_accvgpr_read_b32 v89, a73
 v_accvgpr_read_b32 v90, a74
 v_accvgpr_read_b32 v91, a75
 v_accvgpr_read_b32 v92, a76
 v_accvgpr_read_b32 v93, a77
 v_accvgpr_read_b32 v94, a78
 v_accvgpr_read_b32 v95, a79
 v_pk_mul_f32 v[16:17], v[16:17], v[136:137] op_sel:[0,1] op_sel_hi:[1,1]
 v_pk_mul_f32 v[18:19], v[18:19], v[136:137] op_sel:[0,1] op_sel_hi:[1,1]
 v_pk_mul_f32 v[36:37], v[36:37], v[136:137] op_sel:[0,1] op_sel_hi:[1,1]
 v_pk_mul_f32 v[38:39], v[38:39], v[136:137] op_sel:[0,1] op_sel_hi:[1,1]
 v_pk_mul_f32 v[56:57], v[56:57], v[136:137] op_sel:[0,1] op_sel_hi:[1,1]
 v_pk_mul_f32 v[58:59], v[58:59], v[136:137] op_sel:[0,1] op_sel_hi:[1,1]
 v_pk_mul_f32 v[76:77], v[76:77], v[136:137] op_sel:[0,1] op_sel_hi:[1,1]
 v_pk_mul_f32 v[78:79], v[78:79], v[136:137] op_sel:[0,1] op_sel_hi:[1,1]
 s_waitcnt lgkmcnt(8)
 ds_read_b128 v[108:111], v8 offset:52224
 ds_read_b128 v[128:131], v8 offset:0
 ds_read_b128 v[206:209], v7 offset:17408
 ds_read_b128 v[222:225], v8 offset:34816
 v_pk_fma_f32 v[16:17], v[96:97], v[138:139], v[16:17] op_sel_hi:[1,0,1]
 v_pk_fma_f32 v[18:19], v[98:99], v[138:139], v[18:19] op_sel_hi:[1,0,1]
 v_pk_fma_f32 v[36:37], v[116:117], v[138:139], v[36:37] op_sel_hi:[1,0,1]
 v_pk_fma_f32 v[38:39], v[118:119], v[138:139], v[38:39] op_sel_hi:[1,0,1]
 v_pk_fma_f32 v[56:57], v[176:177], v[138:139], v[56:57] op_sel_hi:[1,0,1]
 v_pk_fma_f32 v[58:59], v[178:179], v[138:139], v[58:59] op_sel_hi:[1,0,1]
 v_pk_fma_f32 v[76:77], v[214:215], v[138:139], v[76:77] op_sel_hi:[1,0,1]
 v_pk_fma_f32 v[78:79], v[216:217], v[138:139], v[78:79] op_sel_hi:[1,0,1]
 v_cvt_pk_bf16_f32 v190, v16, v17
 v_cvt_pk_bf16_f32 v191, v18, v19
 v_cvt_pk_bf16_f32 v192, v36, v37
 v_cvt_pk_bf16_f32 v193, v38, v39
 v_cvt_pk_bf16_f32 v194, v56, v57
 v_cvt_pk_bf16_f32 v195, v58, v59
 v_cvt_pk_bf16_f32 v196, v76, v77
 v_cvt_pk_bf16_f32 v197, v78, v79
 buffer_store_dwordx4 v[190:193], v189, s[36:39], s56 offen offset:0 sc1
 buffer_store_dwordx4 v[194:197], v189, s[36:39], s56 offen offset:1024 sc1
 s_add_u32 s56, s56, 131072
 v_pk_mul_f32 v[20:21], v[20:21], v[140:141] op_sel:[0,1] op_sel_hi:[1,1]
 v_pk_mul_f32 v[22:23], v[22:23], v[140:141] op_sel:[0,1] op_sel_hi:[1,1]
 v_pk_mul_f32 v[40:41], v[40:41], v[140:141] op_sel:[0,1] op_sel_hi:[1,1]
 v_pk_mul_f32 v[42:43], v[42:43], v[140:141] op_sel:[0,1] op_sel_hi:[1,1]
 v_pk_mul_f32 v[60:61], v[60:61], v[140:141] op_sel:[0,1] op_sel_hi:[1,1]
 v_pk_mul_f32 v[62:63], v[62:63], v[140:141] op_sel:[0,1] op_sel_hi:[1,1]
 v_pk_mul_f32 v[80:81], v[80:81], v[140:141] op_sel:[0,1] op_sel_hi:[1,1]
 v_pk_mul_f32 v[82:83], v[82:83], v[140:141] op_sel:[0,1] op_sel_hi:[1,1]
 s_waitcnt lgkmcnt(8)
 ds_read_b128 v[112:115], v7 offset:0
 ds_read_b128 v[132:135], v8 offset:1024
 ds_read_b128 v[210:213], v7 offset:18432
 ds_read_b128 v[226:229], v8 offset:35840
 v_pk_fma_f32 v[20:21], v[100:101], v[142:143], v[20:21] op_sel_hi:[1,0,1]
 v_pk_fma_f32 v[22:23], v[102:103], v[142:143], v[22:23] op_sel_hi:[1,0,1]
 v_pk_fma_f32 v[40:41], v[120:121], v[142:143], v[40:41] op_sel_hi:[1,0,1]
 v_pk_fma_f32 v[42:43], v[122:123], v[142:143], v[42:43] op_sel_hi:[1,0,1]
 v_pk_fma_f32 v[60:61], v[180:181], v[142:143], v[60:61] op_sel_hi:[1,0,1]
 v_pk_fma_f32 v[62:63], v[182:183], v[142:143], v[62:63] op_sel_hi:[1,0,1]
 v_pk_fma_f32 v[80:81], v[250:251], v[142:143], v[80:81] op_sel_hi:[1,0,1]
 v_pk_fma_f32 v[82:83], v[252:253], v[142:143], v[82:83] op_sel_hi:[1,0,1]
 v_cvt_pk_bf16_f32 v198, v20, v21
 v_cvt_pk_bf16_f32 v199, v22, v23
 v_cvt_pk_bf16_f32 v200, v40, v41
 v_cvt_pk_bf16_f32 v201, v42, v43
 v_cvt_pk_bf16_f32 v202, v60, v61
 v_cvt_pk_bf16_f32 v203, v62, v63
 v_cvt_pk_bf16_f32 v204, v80, v81
 v_cvt_pk_bf16_f32 v205, v82, v83
 buffer_store_dwordx4 v[198:201], v189, s[36:39], s56 offen offset:0 sc1
 buffer_store_dwordx4 v[202:205], v189, s[36:39], s56 offen offset:1024 sc1
 s_add_u32 s56, s56, 131072
 v_pk_mul_f32 v[24:25], v[24:25], v[144:145] op_sel:[0,1] op_sel_hi:[1,1]
 v_pk_mul_f32 v[26:27], v[26:27], v[144:145] op_sel:[0,1] op_sel_hi:[1,1]
 v_pk_mul_f32 v[44:45], v[44:45], v[144:145] op_sel:[0,1] op_sel_hi:[1,1]
 v_pk_mul_f32 v[46:47], v[46:47], v[144:145] op_sel:[0,1] op_sel_hi:[1,1]
 v_pk_mul_f32 v[64:65], v[64:65], v[144:145] op_sel:[0,1] op_sel_hi:[1,1]
 v_pk_mul_f32 v[66:67], v[66:67], v[144:145] op_sel:[0,1] op_sel_hi:[1,1]
 v_pk_mul_f32 v[84:85], v[84:85], v[144:145] op_sel:[0,1] op_sel_hi:[1,1]
 v_pk_mul_f32 v[86:87], v[86:87], v[144:145] op_sel:[0,1] op_sel_hi:[1,1]
 s_waitcnt lgkmcnt(8)
 v_pk_fma_f32 v[24:25], v[104:105], v[146:147], v[24:25] op_sel_hi:[1,0,1]
 v_pk_fma_f32 v[26:27], v[106:107], v[146:147], v[26:27] op_sel_hi:[1,0,1]
 v_pk_fma_f32 v[44:45], v[124:125], v[146:147], v[44:45] op_sel_hi:[1,0,1]
 v_pk_fma_f32 v[46:47], v[126:127], v[146:147], v[46:47] op_sel_hi:[1,0,1]
 v_pk_fma_f32 v[64:65], v[184:185], v[146:147], v[64:65] op_sel_hi:[1,0,1]
 v_pk_fma_f32 v[66:67], v[186:187], v[146:147], v[66:67] op_sel_hi:[1,0,1]
 v_pk_fma_f32 v[84:85], v[218:219], v[146:147], v[84:85] op_sel_hi:[1,0,1]
 v_pk_fma_f32 v[86:87], v[220:221], v[146:147], v[86:87] op_sel_hi:[1,0,1]
 v_cvt_pk_bf16_f32 v190, v24, v25
 v_cvt_pk_bf16_f32 v191, v26, v27
 v_cvt_pk_bf16_f32 v192, v44, v45
 v_cvt_pk_bf16_f32 v193, v46, v47
 v_cvt_pk_bf16_f32 v194, v64, v65
 v_cvt_pk_bf16_f32 v195, v66, v67
 v_cvt_pk_bf16_f32 v196, v84, v85
 v_cvt_pk_bf16_f32 v197, v86, v87
 buffer_store_dwordx4 v[190:193], v189, s[36:39], s56 offen offset:0 sc1
 buffer_store_dwordx4 v[194:197], v189, s[36:39], s56 offen offset:1024 sc1
 s_add_u32 s56, s56, 131072
 v_pk_mul_f32 v[28:29], v[28:29], v[148:149] op_sel:[0,1] op_sel_hi:[1,1]
 v_pk_mul_f32 v[30:31], v[30:31], v[148:149] op_sel:[0,1] op_sel_hi:[1,1]
 v_pk_mul_f32 v[48:49], v[48:49], v[148:149] op_sel:[0,1] op_sel_hi:[1,1]
 v_pk_mul_f32 v[50:51], v[50:51], v[148:149] op_sel:[0,1] op_sel_hi:[1,1]
 v_pk_mul_f32 v[68:69], v[68:69], v[148:149] op_sel:[0,1] op_sel_hi:[1,1]
 v_pk_mul_f32 v[70:71], v[70:71], v[148:149] op_sel:[0,1] op_sel_hi:[1,1]
 v_pk_mul_f32 v[88:89], v[88:89], v[148:149] op_sel:[0,1] op_sel_hi:[1,1]
 v_pk_mul_f32 v[90:91], v[90:91], v[148:149] op_sel:[0,1] op_sel_hi:[1,1]
 s_waitcnt lgkmcnt(4)
 v_pk_fma_f32 v[28:29], v[108:109], v[150:151], v[28:29] op_sel_hi:[1,0,1]
 v_pk_fma_f32 v[30:31], v[110:111], v[150:151], v[30:31] op_sel_hi:[1,0,1]
 v_pk_fma_f32 v[48:49], v[128:129], v[150:151], v[48:49] op_sel_hi:[1,0,1]
 v_pk_fma_f32 v[50:51], v[130:131], v[150:151], v[50:51] op_sel_hi:[1,0,1]
 v_pk_fma_f32 v[68:69], v[206:207], v[150:151], v[68:69] op_sel_hi:[1,0,1]
 v_pk_fma_f32 v[70:71], v[208:209], v[150:151], v[70:71] op_sel_hi:[1,0,1]
 v_pk_fma_f32 v[88:89], v[222:223], v[150:151], v[88:89] op_sel_hi:[1,0,1]
 v_pk_fma_f32 v[90:91], v[224:225], v[150:151], v[90:91] op_sel_hi:[1,0,1]
 v_cvt_pk_bf16_f32 v198, v28, v29
 v_cvt_pk_bf16_f32 v199, v30, v31
 v_cvt_pk_bf16_f32 v200, v48, v49
 v_cvt_pk_bf16_f32 v201, v50, v51
 v_cvt_pk_bf16_f32 v202, v68, v69
 v_cvt_pk_bf16_f32 v203, v70, v71
 v_cvt_pk_bf16_f32 v204, v88, v89
 v_cvt_pk_bf16_f32 v205, v90, v91
 buffer_store_dwordx4 v[198:201], v189, s[36:39], s56 offen offset:0 sc1
 buffer_store_dwordx4 v[202:205], v189, s[36:39], s56 offen offset:1024 sc1
 s_add_u32 s56, s56, 131072
 v_pk_mul_f32 v[32:33], v[32:33], v[152:153] op_sel:[0,1] op_sel_hi:[1,1]
 v_pk_mul_f32 v[34:35], v[34:35], v[152:153] op_sel:[0,1] op_sel_hi:[1,1]
 v_pk_mul_f32 v[52:53], v[52:53], v[152:153] op_sel:[0,1] op_sel_hi:[1,1]
 v_pk_mul_f32 v[54:55], v[54:55], v[152:153] op_sel:[0,1] op_sel_hi:[1,1]
 v_pk_mul_f32 v[72:73], v[72:73], v[152:153] op_sel:[0,1] op_sel_hi:[1,1]
 v_pk_mul_f32 v[74:75], v[74:75], v[152:153] op_sel:[0,1] op_sel_hi:[1,1]
 v_pk_mul_f32 v[92:93], v[92:93], v[152:153] op_sel:[0,1] op_sel_hi:[1,1]
 v_pk_mul_f32 v[94:95], v[94:95], v[152:153] op_sel:[0,1] op_sel_hi:[1,1]
 s_waitcnt lgkmcnt(0)
 v_pk_fma_f32 v[32:33], v[112:113], v[154:155], v[32:33] op_sel_hi:[1,0,1]
 v_pk_fma_f32 v[34:35], v[114:115], v[154:155], v[34:35] op_sel_hi:[1,0,1]
 v_pk_fma_f32 v[52:53], v[132:133], v[154:155], v[52:53] op_sel_hi:[1,0,1]
 v_pk_fma_f32 v[54:55], v[134:135], v[154:155], v[54:55] op_sel_hi:[1,0,1]
 v_pk_fma_f32 v[72:73], v[210:211], v[154:155], v[72:73] op_sel_hi:[1,0,1]
 v_pk_fma_f32 v[74:75], v[212:213], v[154:155], v[74:75] op_sel_hi:[1,0,1]
 v_pk_fma_f32 v[92:93], v[226:227], v[154:155], v[92:93] op_sel_hi:[1,0,1]
 v_pk_fma_f32 v[94:95], v[228:229], v[154:155], v[94:95] op_sel_hi:[1,0,1]
 v_cvt_pk_bf16_f32 v190, v32, v33
 v_cvt_pk_bf16_f32 v191, v34, v35
 v_cvt_pk_bf16_f32 v192, v52, v53
 v_cvt_pk_bf16_f32 v193, v54, v55
 v_cvt_pk_bf16_f32 v194, v72, v73
 v_cvt_pk_bf16_f32 v195, v74, v75
 v_cvt_pk_bf16_f32 v196, v92, v93
 v_cvt_pk_bf16_f32 v197, v94, v95
 buffer_store_dwordx4 v[190:193], v189, s[36:39], s56 offen offset:0 sc1
 buffer_store_dwordx4 v[194:197], v189, s[36:39], s56 offen offset:1024 sc1
 s_add_u32 s56, s56, 131072
 s_waitcnt vmcnt(14)
 ds_read_b64_tr_b16 a[80:81], v246 offset:16384
 ds_read_b64_tr_b16 a[82:83], v246 offset:18432
 ds_read_b64_tr_b16 a[84:85], v247 offset:16384
 ds_read_b64_tr_b16 a[86:87], v247 offset:18432
 ds_read_b64_tr_b16 a[88:89], v248 offset:16384
 ds_read_b64_tr_b16 a[90:91], v248 offset:18432
 ds_read_b64_tr_b16 a[92:93], v249 offset:16384
 ds_read_b64_tr_b16 a[94:95], v249 offset:18432
 ds_read_b64_tr_b16 a[96:97], v246 offset:0
 ds_read_b64_tr_b16 a[98:99], v246 offset:2048
 ds_read_b64_tr_b16 a[100:101], v247 offset:0
 ds_read_b64_tr_b16 a[102:103], v247 offset:2048
 ds_read_b64_tr_b16 a[104:105], v248 offset:0
 ds_read_b64_tr_b16 a[106:107], v248 offset:2048
 v_mov_b32 v14, 0
 s_mov_b32 s49, 0
L_tagwaita:
 v_cmp_eq_u32 vcc, 0, v232
 s_cbranch_vccz L_tagoka
 global_load_dword v232, v14, s[16:17] sc1
 s_add_u32 s49, s49, 1
 s_cmp_lt_u32 s49, 0x40000
 s_waitcnt vmcnt(0)
 s_cbranch_scc1 L_tagwaita
L_tagoka:
 s_lshl_b32 s3, s41, 5
 s_add_u32 s3, s3, s42
 s_lshl_b32 s3, s3, 7
 s_add_u32 s58, s3, 16777216
 s_mul_i32 s3, s54, 410
 s_lshr_b32 s3, s3, 10
 s_mul_i32 s46, s54, 64
 s_add_u32 s46, s46, 63
 s_mul_i32 s46, s46, 409
 s_lshr_b32 s46, s46, 16
 v_mov_b32 v10, s3
 v_mov_b32 v11, s46
 v_and_b32 v12, 8, v2
 v_cmp_eq_u32 vcc, 0, v12
 v_and_b32 v12, 7, v2
 v_min_u32 v13, 5, v12
 v_or_b32 v12, 6, v12
 v_lshl_add_u32 v12, v1, 3, v12
 v_lshl_add_u32 v13, v1, 3, v13
 v_cndmask_b32 v10, v11, v10, vcc
 v_lshl_add_u32 v11, v10, 5, v12
 v_lshl_add_u32 v10, v10, 5, v13
 v_lshlrev_b32 v30, 7, v10
 v_lshlrev_b32 v31, 7, v11
 s_mov_b32 s59, 16777216
 v_xor_b32 v10, 0, v1
 v_lshl_add_u32 v26, v10, 17, v189
 v_xor_b32 v10, 1, v1
 v_lshl_add_u32 v27, v10, 17, v189
 v_xor_b32 v10, 2, v1
 v_lshl_add_u32 v28, v10, 17, v189
 v_xor_b32 v10, 3, v1
 v_lshl_add_u32 v29, v10, 17, v189
 s_waitcnt lgkmcnt(0)
 ds_read_b64_tr_b16 a[108:109], v249 offset:0
 ds_read_b64_tr_b16 a[110:111], v249 offset:2048
 ds_read_b64_tr_b16 a[112:113], v238 offset:32768
 ds_read_b64_tr_b16 a[114:115], v238 offset:34816
 ds_read_b64_tr_b16 a[116:117], v239 offset:32768
 ds_read_b64_tr_b16 a[118:119], v239 offset:34816
 ds_read_b64_tr_b16 a[120:121], v240 offset:32768
 ds_read_b64_tr_b16 a[122:123], v240 offset:34816
 ds_read_b64_tr_b16 a[124:125], v241 offset:32768
 ds_read_b64_tr_b16 a[126:127], v241 offset:34816
 s_add_u32 m0, s44, 147456
 s_add_u32 s46, s97, 163840
 buffer_load_dwordx4 v234, s[4:7], s46 offen offset:0  lds
 buffer_load_dwordx4 v235, s[4:7], s46 offen offset:1024  lds
 buffer_load_dwordx4 v236, s[4:7], s46 offen offset:2048  lds
 buffer_load_dwordx4 v237, s[4:7], s46 offen offset:3072  lds
 s_waitcnt lgkmcnt(0)
 s_add_u32 m0, s44, 131072
 s_add_u32 s46, s98, 163840
 buffer_load_dwordx4 v234, s[4:7], s46 offen offset:0  lds
 buffer_load_dwordx4 v235, s[4:7], s46 offen offset:1024  lds
 buffer_load_dwordx4 v236, s[4:7], s46 offen offset:2048  lds
 buffer_load_dwordx4 v237, s[4:7], s46 offen offset:3072  lds
 s_add_u32 m0, s44, 32768
 s_add_u32 s46, s99, 163840
 buffer_load_dwordx4 v234, s[4:7], s46 offen offset:0  lds
 buffer_load_dwordx4 v235, s[4:7], s46 offen offset:1024  lds
 buffer_load_dwordx4 v236, s[4:7], s46 offen offset:2048  lds
 buffer_load_dwordx4 v237, s[4:7], s46 offen offset:3072  lds
 v_accvgpr_write_b32 a0, 0
 v_accvgpr_write_b32 a1, 0
 v_accvgpr_write_b32 a2, 0
 v_accvgpr_write_b32 a3, 0
 v_accvgpr_write_b32 a4, 0
 v_accvgpr_write_b32 a5, 0
 v_accvgpr_write_b32 a6, 0
 v_accvgpr_write_b32 a7, 0
 v_accvgpr_write_b32 a8, 0
 v_accvgpr_write_b32 a9, 0
 v_accvgpr_write_b32 a10, 0
 v_accvgpr_write_b32 a11, 0
 v_accvgpr_write_b32 a12, 0
 v_accvgpr_write_b32 a13, 0
 v_accvgpr_write_b32 a14, 0
 v_accvgpr_write_b32 a15, 0
 v_accvgpr_write_b32 a16, 0
 v_accvgpr_write_b32 a17, 0
 v_accvgpr_write_b32 a18, 0
 v_accvgpr_write_b32 a19, 0
 v_accvgpr_write_b32 a20, 0
 v_accvgpr_write_b32 a21, 0
 v_accvgpr_write_b32 a22, 0
 v_accvgpr_write_b32 a23, 0
 v_accvgpr_write_b32 a24, 0
 v_accvgpr_write_b32 a25, 0
 v_accvgpr_write_b32 a26, 0
 v_accvgpr_write_b32 a27, 0
 v_accvgpr_write_b32 a28, 0
 v_accvgpr_write_b32 a29, 0
 v_accvgpr_write_b32 a30, 0
 v_accvgpr_write_b32 a31, 0
 v_accvgpr_write_b32 a32, 0
 v_accvgpr_write_b32 a33, 0
 v_accvgpr_write_b32 a34, 0
 v_accvgpr_write_b32 a35, 0
 v_accvgpr_write_b32 a36, 0
 v_accvgpr_write_b32 a37, 0
 v_accvgpr_write_b32 a38, 0
 v_accvgpr_write_b32 a39, 0
 v_accvgpr_write_b32 a40, 0
 v_accvgpr_write_b32 a41, 0
 v_accvgpr_write_b32 a42, 0
 v_accvgpr_write_b32 a43, 0
 v_accvgpr_write_b32 a44, 0
 v_accvgpr_write_b32 a45, 0
 v_accvgpr_write_b32 a46, 0
 v_accvgpr_write_b32 a47, 0
 v_accvgpr_write_b32 a48, 0
 v_accvgpr_write_b32 a49, 0
 v_accvgpr_write_b32 a50, 0
 v_accvgpr_write_b32 a51, 0
 v_accvgpr_write_b32 a52, 0
 v_accvgpr_write_b32 a53, 0
 v_accvgpr_write_b32 a54, 0
 v_accvgpr_write_b32 a55, 0
 v_accvgpr_write_b32 a56, 0
 v_accvgpr_write_b32 a57, 0
 v_accvgpr_write_b32 a58, 0
 v_accvgpr_write_b32 a59, 0
 v_accvgpr_write_b32 a60, 0
 v_accvgpr_write_b32 a61, 0
 v_accvgpr_write_b32 a62, 0
 v_accvgpr_write_b32 a63, 0
 s_waitcnt vmcnt(0) lgkmcnt(0)
 s_barrier
 s_cmp_lg_u32 s40, 0
 s_cbranch_scc1 L_noflaga
 buffer_store_dword v232, v14, s[36:39], s58 offen sc1
L_noflaga:
 ds_read_b64_tr_b16 a[128:129], v242 offset:16384
 ds_read_b64_tr_b16 a[130:131], v242 offset:18432
 ds_read_b64_tr_b16 a[132:133], v243 offset:16384
 ds_read_b64_tr_b16 a[134:135], v243 offset:18432
 ds_read_b64_tr_b16 a[136:137], v244 offset:16384
 ds_read_b64_tr_b16 a[138:139], v244 offset:18432
 ds_read_b64_tr_b16 a[140:141], v245 offset:16384
 ds_read_b64_tr_b16 a[142:143], v245 offset:18432
 s_add_u32 m0, s44, 49152
 s_add_u32 s46, s97, 327680
 buffer_load_dwordx4 v234, s[4:7], s46 offen offset:0  lds
 buffer_load_dwordx4 v235, s[4:7], s46 offen offset:1024  lds
 buffer_load_dwordx4 v236, s[4:7], s46 offen offset:2048  lds
 buffer_load_dwordx4 v237, s[4:7], s46 offen offset:3072  lds
 s_add_u32 m0, s44, 114688
 s_add_u32 s46, s98, 327680
 buffer_load_dwordx4 v234, s[4:7], s46 offen offset:0  lds
 buffer_load_dwordx4 v235, s[4:7], s46 offen offset:1024  lds
 buffer_load_dwordx4 v236, s[4:7], s46 offen offset:2048  lds
 buffer_load_dwordx4 v237, s[4:7], s46 offen offset:3072  lds
 s_add_u32 m0, s44, 0
 s_add_u32 s46, s99, 327680
 buffer_load_dwordx4 v234, s[4:7], s46 offen offset:0  lds
 buffer_load_dwordx4 v235, s[4:7], s46 offen offset:1024  lds
 buffer_load_dwordx4 v236, s[4:7], s46 offen offset:2048  lds
 buffer_load_dwordx4 v237, s[4:7], s46 offen offset:3072  lds
 s_add_u32 m0, s44, 65536
 s_add_u32 s46, s97, 491520
 buffer_load_dwordx4 v234, s[4:7], s46 offen offset:0  lds
 buffer_load_dwordx4 v235, s[4:7], s46 offen offset:1024  lds
 buffer_load_dwordx4 v236, s[4:7], s46 offen offset:2048  lds
 buffer_load_dwordx4 v237, s[4:7], s46 offen offset:3072  lds
 s_add_u32 m0, s44, 16384
 s_add_u32 s46, s98, 491520
 buffer_load_dwordx4 v234, s[4:7], s46 offen offset:0  lds
 buffer_load_dwordx4 v235, s[4:7], s46 offen offset:1024  lds
 buffer_load_dwordx4 v236, s[4:7], s46 offen offset:2048  lds
 buffer_load_dwordx4 v237, s[4:7], s46 offen offset:3072  lds
 s_add_u32 m0, s44, 98304
 s_add_u32 s46, s99, 491520
 buffer_load_dwordx4 v234, s[4:7], s46 offen offset:0  lds
 buffer_load_dwordx4 v235, s[4:7], s46 offen offset:1024  lds
 buffer_load_dwordx4 v236, s[4:7], s46 offen offset:2048  lds
 buffer_load_dwordx4 v237, s[4:7], s46 offen offset:3072  lds
 s_waitcnt lgkmcnt(0)
 ds_read_b64_tr_b16 a[144:145], v246 offset:16384
 ds_read_b64_tr_b16 a[146:147], v246 offset:18432
 ds_read_b64_tr_b16 a[148:149], v247 offset:16384
 ds_read_b64_tr_b16 a[150:151], v247 offset:18432
 ds_read_b64_tr_b16 a[152:153], v248 offset:16384
 ds_read_b64_tr_b16 a[154:155], v248 offset:18432
 ds_read_b64_tr_b16 a[156:157], v249 offset:16384
 ds_read_b64_tr_b16 a[158:159], v249 offset:18432
 s_add_u32 m0, s44, 81920
 s_add_u32 s46, s97, 655360
 buffer_load_dwordx4 v234, s[4:7], s46 offen offset:0  lds
 buffer_load_dwordx4 v235, s[4:7], s46 offen offset:1024  lds
 buffer_load_dwordx4 v236, s[4:7], s46 offen offset:2048  lds
 buffer_load_dwordx4 v237, s[4:7], s46 offen offset:3072  lds
 s_waitcnt lgkmcnt(0)
 ds_read_b64_tr_b16 a[240:241], v246 offset:0
 ds_read_b64_tr_b16 a[242:243], v246 offset:2048
 ds_read_b64_tr_b16 a[244:245], v247 offset:0
 ds_read_b64_tr_b16 a[246:247], v247 offset:2048
 ds_read_b64_tr_b16 a[248:249], v248 offset:0
 ds_read_b64_tr_b16 a[250:251], v248 offset:2048
 ds_read_b64_tr_b16 a[252:253], v249 offset:0
 ds_read_b64_tr_b16 a[254:255], v249 offset:2048
 s_add_u32 m0, s44, 147456
 s_add_u32 s46, s98, 655360
 buffer_load_dwordx4 v234, s[4:7], s46 offen offset:0  lds
 buffer_load_dwordx4 v235, s[4:7], s46 offen offset:1024  lds
 buffer_load_dwordx4 v236, s[4:7], s46 offen offset:2048  lds
 buffer_load_dwordx4 v237, s[4:7], s46 offen offset:3072  lds
 s_waitcnt lgkmcnt(0)
 s_add_u32 m0, s44, 131072
 s_add_u32 s46, s99, 655360
 buffer_load_dwordx4 v234, s[4:7], s46 offen offset:0  lds
 buffer_load_dwordx4 v235, s[4:7], s46 offen offset:1024  lds
 buffer_load_dwordx4 v236, s[4:7], s46 offen offset:2048  lds
 buffer_load_dwordx4 v237, s[4:7], s46 offen offset:3072  lds
 s_mov_b32 s49, 0
L_poll:
 buffer_load_dword v10, v30, s[36:39], s59 offen sc1
 s_add_u32 s49, s49, 1
 s_cmp_ge_u32 s49, 0x40000
 s_waitcnt vmcnt(0)
 v_cmp_ne_u32 vcc, v10, v232
 s_cbranch_scc1 L_go
 s_cbranch_vccnz L_poll
L_go:
 s_add_u32 s56, s92, 0
 buffer_load_dwordx4 v[96:99], v26, s[36:39], s56 offen sc1
 buffer_load_dwordx4 v[100:103], v27, s[36:39], s56 offen sc1
 buffer_load_dwordx4 v[104:107], v28, s[36:39], s56 offen sc1
 buffer_load_dwordx4 v[108:111], v29, s[36:39], s56 offen sc1
 s_add_u32 s56, s93, 0
 buffer_load_dwordx4 v[112:115], v26, s[36:39], s56 offen sc1
 buffer_load_dwordx4 v[116:119], v27, s[36:39], s56 offen sc1
 buffer_load_dwordx4 v[120:123], v28, s[36:39], s56 offen sc1
 buffer_load_dwordx4 v[124:127], v29, s[36:39], s56 offen sc1
 s_add_u32 s56, s94, 0
 buffer_load_dwordx4 v[128:131], v26, s[36:39], s56 offen sc1
 buffer_load_dwordx4 v[132:135], v27, s[36:39], s56 offen sc1
 buffer_load_dwordx4 v[136:139], v28, s[36:39], s56 offen sc1
 buffer_load_dwordx4 v[140:143], v29, s[36:39], s56 offen sc1
 s_waitcnt vmcnt(8)
 v_mfma_f32_16x16x32_bf16 a[0:3], a[160:163], v[96:99], a[0:3]
 v_mfma_f32_16x16x32_bf16 a[16:19], a[160:163], v[100:103], a[16:19]
 v_mfma_f32_16x16x32_bf16 a[32:35], a[160:163], v[104:107], a[32:35]
 s_add_u32 s56, s95, 0
 buffer_load_dwordx4 v[144:147], v26, s[36:39], s56 offen sc1
 v_mfma_f32_16x16x32_bf16 a[48:51], a[160:163], v[108:111], a[48:51]
 v_mfma_f32_16x16x32_bf16 a[4:7], a[164:167], v[96:99], a[4:7]
 buffer_load_dwordx4 v[148:151], v27, s[36:39], s56 offen sc1
 v_mfma_f32_16x16x32_bf16 a[20:23], a[164:167], v[100:103], a[20:23]
 v_mfma_f32_16x16x32_bf16 a[36:39], a[164:167], v[104:107], a[36:39]
 buffer_load_dwordx4 v[152:155], v28, s[36:39], s56 offen sc1
 v_mfma_f32_16x16x32_bf16 a[52:55], a[164:167], v[108:111], a[52:55]
 v_mfma_f32_16x16x32_bf16 a[8:11], a[168:171], v[96:99], a[8:11]
 buffer_load_dwordx4 v[156:159], v29, s[36:39], s56 offen sc1
 v_mfma_f32_16x16x32_bf16 a[24:27], a[168:171], v[100:103], a[24:27]
 v_mfma_f32_16x16x32_bf16 a[40:43], a[168:171], v[104:107], a[40:43]
 v_mfma_f32_16x16x32_bf16 a[56:59], a[168:171], v[108:111], a[56:59]
 v_mfma_f32_16x16x32_bf16 a[12:15], a[172:175], v[96:99], a[12:15]
 v_mfma_f32_16x16x32_bf16 a[28:31], a[172:175], v[100:103], a[28:31]
 v_mfma_f32_16x16x32_bf16 a[44:47], a[172:175], v[104:107], a[44:47]
 v_mfma_f32_16x16x32_bf16 a[60:63], a[172:175], v[108:111], a[60:63]
 s_waitcnt vmcnt(8)
 v_mfma_f32_16x16x32_bf16 a[0:3], a[176:179], v[112:115], a[0:3]
 v_mfma_f32_16x16x32_bf16 a[16:19], a[176:179], v[116:119], a[16:19]
 v_mfma_f32_16x16x32_bf16 a[32:35], a[176:179], v[120:123], a[32:35]
 s_add_u32 s56, s92, 4096
 buffer_load_dwordx4 v[96:99], v26, s[36:39], s56 offen sc1
 v_mfma_f32_16x16x32_bf16 a[48:51], a[176:179], v[124:127], a[48:51]
 v_mfma_f32_16x16x32_bf16 a[4:7], a[180:183], v[112:115], a[4:7]
 buffer_load_dwordx4 v[100:103], v27, s[36:39], s56 offen sc1
 v_mfma_f32_16x16x32_bf16 a[20:23], a[180:183], v[116:119], a[20:23]
 v_mfma_f32_16x16x32_bf16 a[36:39], a[180:183], v[120:123], a[36:39]
 buffer_load_dwordx4 v[104:107], v28, s[36:39], s56 offen sc1
 v_mfma_f32_16x16x32_bf16 a[52:55], a[180:183], v[124:127], a[52:55]
 v_mfma_f32_16x16x32_bf16 a[8:11], a[184:187], v[112:115], a[8:11]
 buffer_load_dwordx4 v[108:111], v29, s[36:39], s56 offen sc1
 v_mfma_f32_16x16x32_bf16 a[24:27], a[184:187], v[116:119], a[24:27]
 v_mfma_f32_16x16x32_bf16 a[40:43], a[184:187], v[120:123], a[40:43]
 v_mfma_f32_16x16x32_bf16 a[56:59], a[184:187], v[124:127], a[56:59]
 v_mfma_f32_16x16x32_bf16 a[12:15], a[188:191], v[112:115], a[12:15]
 v_mfma_f32_16x16x32_bf16 a[28:31], a[188:191], v[116:119], a[28:31]
 v_mfma_f32_16x16x32_bf16 a[44:47], a[188:191], v[120:123], a[44:47]
 v_mfma_f32_16x16x32_bf16 a[60:63], a[188:191], v[124:127], a[60:63]
 s_waitcnt vmcnt(8)
 v_mfma_f32_16x16x32_bf16 a[0:3], a[192:195], v[128:131], a[0:3]
 v_mfma_f32_16x16x32_bf16 a[16:19], a[192:195], v[132:135], a[16:19]
 v_mfma_f32_16x16x32_bf16 a[32:35], a[192:195], v[136:139], a[32:35]
 s_add_u32 s56, s93, 4096
 buffer_load_dwordx4 v[112:115], v26, s[36:39], s56 offen sc1
 v_mfma_f32_16x16x32_bf16 a[48:51], a[192:195], v[140:143], a[48:51]
 v_mfma_f32_16x16x32_bf16 a[4:7], a[196:199], v[128:131], a[4:7]
 buffer_load_dwordx4 v[116:119], v27, s[36:39], s56 offen sc1
 v_mfma_f32_16x16x32_bf16 a[20:23], a[196:199], v[132:135], a[20:23]
 v_mfma_f32_16x16x32_bf16 a[36:39], a[196:199], v[136:139], a[36:39]
 buffer_load_dwordx4 v[120:123], v28, s[36:39], s56 offen sc1
 v_mfma_f32_16x16x32_bf16 a[52:55], a[196:199], v[140:143], a[52:55]
 v_mfma_f32_16x16x32_bf16 a[8:11], a[200:203], v[128:131], a[8:11]
 buffer_load_dwordx4 v[124:127], v29, s[36:39], s56 offen sc1
 v_mfma_f32_16x16x32_bf16 a[24:27], a[200:203], v[132:135], a[24:27]
 v_mfma_f32_16x16x32_bf16 a[40:43], a[200:203], v[136:139], a[40:43]
 v_mfma_f32_16x16x32_bf16 a[56:59], a[200:203], v[140:143], a[56:59]
 v_mfma_f32_16x16x32_bf16 a[12:15], a[204:207], v[128:131], a[12:15]
 v_mfma_f32_16x16x32_bf16 a[28:31], a[204:207], v[132:135], a[28:31]
 v_mfma_f32_16x16x32_bf16 a[44:47], a[204:207], v[136:139], a[44:47]
 v_mfma_f32_16x16x32_bf16 a[60:63], a[204:207], v[140:143], a[60:63]
 s_waitcnt vmcnt(8)
 v_mfma_f32_16x16x32_bf16 a[0:3], a[208:211], v[144:147], a[0:3]
 v_mfma_f32_16x16x32_bf16 a[16:19], a[208:211], v[148:151], a[16:19]
 v_mfma_f32_16x16x32_bf16 a[32:35], a[208:211], v[152:155], a[32:35]
 s_add_u32 s56, s94, 4096
 buffer_load_dwordx4 v[128:131], v26, s[36:39], s56 offen sc1
 v_mfma_f32_16x16x32_bf16 a[48:51], a[208:211], v[156:159], a[48:51]
 v_mfma_f32_16x16x32_bf16 a[4:7], a[212:215], v[144:147], a[4:7]
 buffer_load_dwordx4 v[132:135], v27, s[36:39], s56 offen sc1
 v_mfma_f32_16x16x32_bf16 a[20:23], a[212:215], v[148:151], a[20:23]
 v_mfma_f32_16x16x32_bf16 a[36:39], a[212:215], v[152:155], a[36:39]
 buffer_load_dwordx4 v[136:139], v28, s[36:39], s56 offen sc1
 v_mfma_f32_16x16x32_bf16 a[52:55], a[212:215], v[156:159], a[52:55]
 v_mfma_f32_16x16x32_bf16 a[8:11], a[216:219], v[144:147], a[8:11]
 buffer_load_dwordx4 v[140:143], v29, s[36:39], s56 offen sc1
 v_mfma_f32_16x16x32_bf16 a[24:27], a[216:219], v[148:151], a[24:27]
 v_mfma_f32_16x16x32_bf16 a[40:43], a[216:219], v[152:155], a[40:43]
 v_mfma_f32_16x16x32_bf16 a[56:59], a[216:219], v[156:159], a[56:59]
 v_mfma_f32_16x16x32_bf16 a[12:15], a[220:223], v[144:147], a[12:15]
 v_mfma_f32_16x16x32_bf16 a[28:31], a[220:223], v[148:151], a[28:31]
 v_mfma_f32_16x16x32_bf16 a[44:47], a[220:223], v[152:155], a[44:47]
 v_mfma_f32_16x16x32_bf16 a[60:63], a[220:223], v[156:159], a[60:63]
 s_waitcnt vmcnt(8)
 v_mfma_f32_16x16x32_bf16 a[0:3], a[224:227], v[96:99], a[0:3]
 v_mfma_f32_16x16x32_bf16 a[16:19], a[224:227], v[100:103], a[16:19]
 v_mfma_f32_16x16x32_bf16 a[32:35], a[224:227], v[104:107], a[32:35]
 s_add_u32 s56, s95, 4096
 buffer_load_dwordx4 v[144:147], v26, s[36:39], s56 offen sc1
 v_mfma_f32_16x16x32_bf16 a[48:51], a[224:227], v[108:111], a[48:51]
 v_mfma_f32_16x16x32_bf16 a[4:7], a[228:231], v[96:99], a[4:7]
 buffer_load_dwordx4 v[148:151], v27, s[36:39], s56 offen sc1
 v_mfma_f32_16x16x32_bf16 a[20:23], a[228:231], v[100:103], a[20:23]
 v_mfma_f32_16x16x32_bf16 a[36:39], a[228:231], v[104:107], a[36:39]
 buffer_load_dwordx4 v[152:155], v28, s[36:39], s56 offen sc1
 v_mfma_f32_16x16x32_bf16 a[52:55], a[228:231], v[108:111], a[52:55]
 v_mfma_f32_16x16x32_bf16 a[8:11], a[232:235], v[96:99], a[8:11]
 buffer_load_dwordx4 v[156:159], v29, s[36:39], s56 offen sc1
 v_mfma_f32_16x16x32_bf16 a[24:27], a[232:235], v[100:103], a[24:27]
 v_mfma_f32_16x16x32_bf16 a[40:43], a[232:235], v[104:107], a[40:43]
 v_mfma_f32_16x16x32_bf16 a[56:59], a[232:235], v[108:111], a[56:59]
 v_mfma_f32_16x16x32_bf16 a[12:15], a[236:239], v[96:99], a[12:15]
 v_mfma_f32_16x16x32_bf16 a[28:31], a[236:239], v[100:103], a[28:31]
 v_mfma_f32_16x16x32_bf16 a[44:47], a[236:239], v[104:107], a[44:47]
 v_mfma_f32_16x16x32_bf16 a[60:63], a[236:239], v[108:111], a[60:63]
 s_waitcnt vmcnt(8)
 v_mfma_f32_16x16x32_bf16 a[0:3], a[144:147], v[112:115], a[0:3]
 v_mfma_f32_16x16x32_bf16 a[16:19], a[144:147], v[116:119], a[16:19]
 v_mfma_f32_16x16x32_bf16 a[32:35], a[144:147], v[120:123], a[32:35]
 s_add_u32 s56, s92, 8192
 buffer_load_dwordx4 v[96:99], v26, s[36:39], s56 offen sc1
 v_mfma_f32_16x16x32_bf16 a[48:51], a[144:147], v[124:127], a[48:51]
 v_mfma_f32_16x16x32_bf16 a[4:7], a[148:151], v[112:115], a[4:7]
 buffer_load_dwordx4 v[100:103], v27, s[36:39], s56 offen sc1
 v_mfma_f32_16x16x32_bf16 a[20:23], a[148:151], v[116:119], a[20:23]
 v_mfma_f32_16x16x32_bf16 a[36:39], a[148:151], v[120:123], a[36:39]
 buffer_load_dwordx4 v[104:107], v28, s[36:39], s56 offen sc1
 v_mfma_f32_16x16x32_bf16 a[52:55], a[148:151], v[124:127], a[52:55]
 v_mfma_f32_16x16x32_bf16 a[8:11], a[152:155], v[112:115], a[8:11]
 buffer_load_dwordx4 v[108:111], v29, s[36:39], s56 offen sc1
 v_mfma_f32_16x16x32_bf16 a[24:27], a[152:155], v[116:119], a[24:27]
 v_mfma_f32_16x16x32_bf16 a[40:43], a[152:155], v[120:123], a[40:43]
 v_mfma_f32_16x16x32_bf16 a[56:59], a[152:155], v[124:127], a[56:59]
 v_mfma_f32_16x16x32_bf16 a[12:15], a[156:159], v[112:115], a[12:15]
 v_mfma_f32_16x16x32_bf16 a[28:31], a[156:159], v[116:119], a[28:31]
 v_mfma_f32_16x16x32_bf16 a[44:47], a[156:159], v[120:123], a[44:47]
 v_mfma_f32_16x16x32_bf16 a[60:63], a[156:159], v[124:127], a[60:63]
 s_waitcnt vmcnt(8)
 v_mfma_f32_16x16x32_bf16 a[0:3], a[240:243], v[128:131], a[0:3]
 ds_read_b64_tr_b16 v[48:49], v238 offset:32768
 v_mfma_f32_16x16x32_bf16 a[16:19], a[240:243], v[132:135], a[16:19]
 ds_read_b64_tr_b16 v[50:51], v238 offset:34816
 v_mfma_f32_16x16x32_bf16 a[32:35], a[240:243], v[136:139], a[32:35]
 ds_read_b64_tr_b16 v[52:53], v239 offset:32768
 s_add_u32 s56, s93, 8192
 buffer_load_dwordx4 v[112:115], v26, s[36:39], s56 offen sc1
 v_mfma_f32_16x16x32_bf16 a[48:51], a[240:243], v[140:143], a[48:51]
 ds_read_b64_tr_b16 v[54:55], v239 offset:34816
 v_mfma_f32_16x16x32_bf16 a[4:7], a[244:247], v[128:131], a[4:7]
 ds_read_b64_tr_b16 v[56:57], v240 offset:32768
 buffer_load_dwordx4 v[116:119], v27, s[36:39], s56 offen sc1
 v_mfma_f32_16x16x32_bf16 a[20:23], a[244:247], v[132:135], a[20:23]
 ds_read_b64_tr_b16 v[58:59], v240 offset:34816
 v_mfma_f32_16x16x32_bf16 a[36:39], a[244:247], v[136:139], a[36:39]
 ds_read_b64_tr_b16 v[60:61], v241 offset:32768
 buffer_load_dwordx4 v[120:123], v28, s[36:39], s56 offen sc1
 v_mfma_f32_16x16x32_bf16 a[52:55], a[244:247], v[140:143], a[52:55]
 ds_read_b64_tr_b16 v[62:63], v241 offset:34816
 v_mfma_f32_16x16x32_bf16 a[8:11], a[248:251], v[128:131], a[8:11]
 buffer_load_dwordx4 v[124:127], v29, s[36:39], s56 offen sc1
 v_mfma_f32_16x16x32_bf16 a[24:27], a[248:251], v[132:135], a[24:27]
 v_mfma_f32_16x16x32_bf16 a[40:43], a[248:251], v[136:139], a[40:43]
 v_mfma_f32_16x16x32_bf16 a[56:59], a[248:251], v[140:143], a[56:59]
 v_mfma_f32_16x16x32_bf16 a[12:15], a[252:255], v[128:131], a[12:15]
 v_mfma_f32_16x16x32_bf16 a[28:31], a[252:255], v[132:135], a[28:31]
 v_mfma_f32_16x16x32_bf16 a[44:47], a[252:255], v[136:139], a[44:47]
 v_mfma_f32_16x16x32_bf16 a[60:63], a[252:255], v[140:143], a[60:63]
 s_waitcnt vmcnt(8) lgkmcnt(0)
 v_mfma_f32_16x16x32_bf16 a[0:3], v[48:51], v[144:147], a[0:3]
 v_mfma_f32_16x16x32_bf16 a[16:19], v[48:51], v[148:151], a[16:19]
 v_mfma_f32_16x16x32_bf16 a[32:35], v[48:51], v[152:155], a[32:35]
 s_add_u32 s56, s94, 8192
 buffer_load_dwordx4 v[128:131], v26, s[36:39], s56 offen sc1
 v_mfma_f32_16x16x32_bf16 a[48:51], v[48:51], v[156:159], a[48:51]
 v_mfma_f32_16x16x32_bf16 a[4:7], v[52:55], v[144:147], a[4:7]
 s_add_u32 m0, s44, 32768
 s_add_u32 s46, s97, 819200
 buffer_load_dwordx4 v234, s[4:7], s46 offen offset:0  lds
 v_mfma_f32_16x16x32_bf16 a[20:23], v[52:55], v[148:151], a[20:23]
 v_mfma_f32_16x16x32_bf16 a[36:39], v[52:55], v[152:155], a[36:39]
 buffer_load_dwordx4 v[132:135], v27, s[36:39], s56 offen sc1
 v_mfma_f32_16x16x32_bf16 a[52:55], v[52:55], v[156:159], a[52:55]
 v_mfma_f32_16x16x32_bf16 a[8:11], v[56:59], v[144:147], a[8:11]
 buffer_load_dwordx4 v235, s[4:7], s46 offen offset:1024  lds
 v_mfma_f32_16x16x32_bf16 a[24:27], v[56:59], v[148:151], a[24:27]
 v_mfma_f32_16x16x32_bf16 a[40:43], v[56:59], v[152:155], a[40:43]
 buffer_load_dwordx4 v[136:139], v28, s[36:39], s56 offen sc1
 v_mfma_f32_16x16x32_bf16 a[56:59], v[56:59], v[156:159], a[56:59]
 v_mfma_f32_16x16x32_bf16 a[12:15], v[60:63], v[144:147], a[12:15]
 buffer_load_dwordx4 v236, s[4:7], s46 offen offset:2048  lds
 v_mfma_f32_16x16x32_bf16 a[28:31], v[60:63], v[148:151], a[28:31]
 v_mfma_f32_16x16x32_bf16 a[44:47], v[60:63], v[152:155], a[44:47]
 buffer_load_dwordx4 v[140:143], v29, s[36:39], s56 offen sc1
 v_mfma_f32_16x16x32_bf16 a[60:63], v[60:63], v[156:159], a[60:63]
 buffer_load_dwordx4 v237, s[4:7], s46 offen offset:3072  lds
 s_waitcnt vmcnt(12)
 v_mfma_f32_16x16x32_bf16 a[0:3], a[80:83], v[96:99], a[0:3]
 ds_read_b64_tr_b16 v[48:49], v238 offset:49152
 v_mfma_f32_16x16x32_bf16 a[16:19], a[80:83], v[100:103], a[16:19]
 ds_read_b64_tr_b16 v[50:51], v238 offset:51200
 v_mfma_f32_16x16x32_bf16 a[32:35], a[80:83], v[104:107], a[32:35]
 ds_read_b64_tr_b16 v[52:53], v239 offset:49152
 s_add_u32 s56, s95, 8192
 buffer_load_dwordx4 v[144:147], v26, s[36:39], s56 offen sc1
 v_mfma_f32_16x16x32_bf16 a[48:51], a[80:83], v[108:111], a[48:51]
 ds_read_b64_tr_b16 v[54:55], v239 offset:51200
 v_mfma_f32_16x16x32_bf16 a[4:7], a[84:87], v[96:99], a[4:7]
 ds_read_b64_tr_b16 v[56:57], v240 offset:49152
 buffer_load_dwordx4 v[148:151], v27, s[36:39], s56 offen sc1
 v_mfma_f32_16x16x32_bf16 a[20:23], a[84:87], v[100:103], a[20:23]
 ds_read_b64_tr_b16 v[58:59], v240 offset:51200
 v_mfma_f32_16x16x32_bf16 a[36:39], a[84:87], v[104:107], a[36:39]
 ds_read_b64_tr_b16 v[60:61], v241 offset:49152
 buffer_load_dwordx4 v[152:155], v28, s[36:39], s56 offen sc1
 v_mfma_f32_16x16x32_bf16 a[52:55], a[84:87], v[108:111], a[52:55]
 ds_read_b64_tr_b16 v[62:63], v241 offset:51200
 v_mfma_f32_16x16x32_bf16 a[8:11], a[88:91], v[96:99], a[8:11]
 buffer_load_dwordx4 v[156:159], v29, s[36:39], s56 offen sc1
 v_mfma_f32_16x16x32_bf16 a[24:27], a[88:91], v[100:103], a[24:27]
 v_mfma_f32_16x16x32_bf16 a[40:43], a[88:91], v[104:107], a[40:43]
 v_mfma_f32_16x16x32_bf16 a[56:59], a[88:91], v[108:111], a[56:59]
 v_mfma_f32_16x16x32_bf16 a[12:15], a[92:95], v[96:99], a[12:15]
 v_mfma_f32_16x16x32_bf16 a[28:31], a[92:95], v[100:103], a[28:31]
 v_mfma_f32_16x16x32_bf16 a[44:47], a[92:95], v[104:107], a[44:47]
 v_mfma_f32_16x16x32_bf16 a[60:63], a[92:95], v[108:111], a[60:63]
 s_waitcnt vmcnt(12) lgkmcnt(0)
 v_mfma_f32_16x16x32_bf16 a[0:3], v[48:51], v[112:115], a[0:3]
 ds_read_b64_tr_b16 v[32:33], v242 offset:49152
 v_mfma_f32_16x16x32_bf16 a[16:19], v[48:51], v[116:119], a[16:19]
 ds_read_b64_tr_b16 v[34:35], v242 offset:51200
 v_mfma_f32_16x16x32_bf16 a[32:35], v[48:51], v[120:123], a[32:35]
 ds_read_b64_tr_b16 v[36:37], v243 offset:49152
 s_add_u32 s56, s92, 12288
 buffer_load_dwordx4 v[96:99], v26, s[36:39], s56 offen sc1
 v_mfma_f32_16x16x32_bf16 a[48:51], v[48:51], v[124:127], a[48:51]
 ds_read_b64_tr_b16 v[38:39], v243 offset:51200
 v_mfma_f32_16x16x32_bf16 a[4:7], v[52:55], v[112:115], a[4:7]
 ds_read_b64_tr_b16 v[40:41], v244 offset:49152
 s_add_u32 m0, s44, 49152
 s_add_u32 s46, s96, 983040
 buffer_load_dwordx4 v234, s[4:7], s46 offen offset:0  lds
 v_mfma_f32_16x16x32_bf16 a[20:23], v[52:55], v[116:119], a[20:23]
 ds_read_b64_tr_b16 v[42:43], v244 offset:51200
 v_mfma_f32_16x16x32_bf16 a[36:39], v[52:55], v[120:123], a[36:39]
 ds_read_b64_tr_b16 v[44:45], v245 offset:49152
 buffer_load_dwordx4 v[100:103], v27, s[36:39], s56 offen sc1
 v_mfma_f32_16x16x32_bf16 a[52:55], v[52:55], v[124:127], a[52:55]
 ds_read_b64_tr_b16 v[46:47], v245 offset:51200
 v_mfma_f32_16x16x32_bf16 a[8:11], v[56:59], v[112:115], a[8:11]
 buffer_load_dwordx4 v235, s[4:7], s46 offen offset:1024  lds
 v_mfma_f32_16x16x32_bf16 a[24:27], v[56:59], v[116:119], a[24:27]
 v_mfma_f32_16x16x32_bf16 a[40:43], v[56:59], v[120:123], a[40:43]
 buffer_load_dwordx4 v[104:107], v28, s[36:39], s56 offen sc1
 v_mfma_f32_16x16x32_bf16 a[56:59], v[56:59], v[124:127], a[56:59]
 v_mfma_f32_16x16x32_bf16 a[12:15], v[60:63], v[112:115], a[12:15]
 buffer_load_dwordx4 v236, s[4:7], s46 offen offset:2048  lds
 v_mfma_f32_16x16x32_bf16 a[28:31], v[60:63], v[116:119], a[28:31]
 v_mfma_f32_16x16x32_bf16 a[44:47], v[60:63], v[120:123], a[44:47]
 buffer_load_dwordx4 v[108:111], v29, s[36:39], s56 offen sc1
 v_mfma_f32_16x16x32_bf16 a[60:63], v[60:63], v[124:127], a[60:63]
 buffer_load_dwordx4 v237, s[4:7], s46 offen offset:3072  lds
 s_waitcnt vmcnt(13) lgkmcnt(0)
 v_mfma_f32_16x16x32_bf16 a[0:3], v[32:35], v[128:131], a[0:3]
 ds_read_b64_tr_b16 v[48:49], v238 offset:0
 v_mfma_f32_16x16x32_bf16 a[16:19], v[32:35], v[132:135], a[16:19]
 ds_read_b64_tr_b16 v[50:51], v238 offset:2048
 v_mfma_f32_16x16x32_bf16 a[32:35], v[32:35], v[136:139], a[32:35]
 ds_read_b64_tr_b16 v[52:53], v239 offset:0
 s_add_u32 s56, s93, 12288
 buffer_load_dwordx4 v[112:115], v26, s[36:39], s56 offen sc1
 v_mfma_f32_16x16x32_bf16 a[48:51], v[32:35], v[140:143], a[48:51]
 ds_read_b64_tr_b16 v[54:55], v239 offset:2048
 v_mfma_f32_16x16x32_bf16 a[4:7], v[36:39], v[128:131], a[4:7]
 ds_read_b64_tr_b16 v[56:57], v240 offset:0
 s_add_u32 m0, s44, 114688
 s_add_u32 s46, s98, 819200
 buffer_load_dwordx4 v234, s[4:7], s46 offen offset:0  lds
 v_mfma_f32_16x16x32_bf16 a[20:23], v[36:39], v[132:135], a[20:23]
 ds_read_b64_tr_b16 v[58:59], v240 offset:2048
 v_mfma_f32_16x16x32_bf16 a[36:39], v[36:39], v[136:139], a[36:39]
 ds_read_b64_tr_b16 v[60:61], v241 offset:0
 buffer_load_dwordx4 v[116:119], v27, s[36:39], s56 offen sc1
 v_mfma_f32_16x16x32_bf16 a[52:55], v[36:39], v[140:143], a[52:55]
 ds_read_b64_tr_b16 v[62:63], v241 offset:2048
 v_mfma_f32_16x16x32_bf16 a[8:11], v[40:43], v[128:131], a[8:11]
 buffer_load_dwordx4 v235, s[4:7], s46 offen offset:1024  lds
 v_mfma_f32_16x16x32_bf16 a[24:27], v[40:43], v[132:135], a[24:27]
 v_mfma_f32_16x16x32_bf16 a[40:43], v[40:43], v[136:139], a[40:43]
 buffer_load_dwordx4 v[120:123], v28, s[36:39], s56 offen sc1
 v_mfma_f32_16x16x32_bf16 a[56:59], v[40:43], v[140:143], a[56:59]
 v_mfma_f32_16x16x32_bf16 a[12:15], v[44:47], v[128:131], a[12:15]
 buffer_load_dwordx4 v236, s[4:7], s46 offen offset:2048  lds
 v_mfma_f32_16x16x32_bf16 a[28:31], v[44:47], v[132:135], a[28:31]
 v_mfma_f32_16x16x32_bf16 a[44:47], v[44:47], v[136:139], a[44:47]
 buffer_load_dwordx4 v[124:127], v29, s[36:39], s56 offen sc1
 v_mfma_f32_16x16x32_bf16 a[60:63], v[44:47], v[140:143], a[60:63]
 buffer_load_dwordx4 v237, s[4:7], s46 offen offset:3072  lds
 s_waitcnt vmcnt(16) lgkmcnt(0)
 v_mfma_f32_16x16x32_bf16 a[0:3], v[48:51], v[144:147], a[0:3]
 v_mfma_f32_16x16x32_bf16 a[16:19], v[48:51], v[148:151], a[16:19]
 v_mfma_f32_16x16x32_bf16 a[32:35], v[48:51], v[152:155], a[32:35]
 s_add_u32 s56, s94, 12288
 buffer_load_dwordx4 v[128:131], v26, s[36:39], s56 offen sc1
 v_mfma_f32_16x16x32_bf16 a[48:51], v[48:51], v[156:159], a[48:51]
 v_mfma_f32_16x16x32_bf16 a[4:7], v[52:55], v[144:147], a[4:7]
 s_add_u32 m0, s44, 0
 s_add_u32 s46, s99, 819200
 buffer_load_dwordx4 v234, s[4:7], s46 offen offset:0  lds
 v_mfma_f32_16x16x32_bf16 a[20:23], v[52:55], v[148:151], a[20:23]
 v_mfma_f32_16x16x32_bf16 a[36:39], v[52:55], v[152:155], a[36:39]
 buffer_load_dwordx4 v[132:135], v27, s[36:39], s56 offen sc1
 v_mfma_f32_16x16x32_bf16 a[52:55], v[52:55], v[156:159], a[52:55]
 v_mfma_f32_16x16x32_bf16 a[8:11], v[56:59], v[144:147], a[8:11]
 buffer_load_dwordx4 v235, s[4:7], s46 offen offset:1024  lds
 v_mfma_f32_16x16x32_bf16 a[24:27], v[56:59], v[148:151], a[24:27]
 v_mfma_f32_16x16x32_bf16 a[40:43], v[56:59], v[152:155], a[40:43]
 buffer_load_dwordx4 v[136:139], v28, s[36:39], s56 offen sc1
 v_mfma_f32_16x16x32_bf16 a[56:59], v[56:59], v[156:159], a[56:59]
 v_mfma_f32_16x16x32_bf16 a[12:15], v[60:63], v[144:147], a[12:15]
 buffer_load_dwordx4 v236, s[4:7], s46 offen offset:2048  lds
 v_mfma_f32_16x16x32_bf16 a[28:31], v[60:63], v[148:151], a[28:31]
 v_mfma_f32_16x16x32_bf16 a[44:47], v[60:63], v[152:155], a[44:47]
 buffer_load_dwordx4 v[140:143], v29, s[36:39], s56 offen sc1
 v_mfma_f32_16x16x32_bf16 a[60:63], v[60:63], v[156:159], a[60:63]
 buffer_load_dwordx4 v237, s[4:7], s46 offen offset:3072  lds
 s_waitcnt vmcnt(17)
 v_mfma_f32_16x16x32_bf16 a[0:3], a[96:99], v[96:99], a[0:3]
 ds_read_b64_tr_b16 v[48:49], v242 offset:0
 v_mfma_f32_16x16x32_bf16 a[16:19], a[96:99], v[100:103], a[16:19]
 ds_read_b64_tr_b16 v[50:51], v242 offset:2048
 v_mfma_f32_16x16x32_bf16 a[32:35], a[96:99], v[104:107], a[32:35]
 ds_read_b64_tr_b16 v[52:53], v243 offset:0
 s_add_u32 s56, s95, 12288
 buffer_load_dwordx4 v[144:147], v26, s[36:39], s56 offen sc1
 v_mfma_f32_16x16x32_bf16 a[48:51], a[96:99], v[108:111], a[48:51]
 ds_read_b64_tr_b16 v[54:55], v243 offset:2048
 v_mfma_f32_16x16x32_bf16 a[4:7], a[100:103], v[96:99], a[4:7]
 ds_read_b64_tr_b16 v[56:57], v244 offset:0
 buffer_load_dwordx4 v[148:151], v27, s[36:39], s56 offen sc1
 v_mfma_f32_16x16x32_bf16 a[20:23], a[100:103], v[100:103], a[20:23]
 ds_read_b64_tr_b16 v[58:59], v244 offset:2048
 v_mfma_f32_16x16x32_bf16 a[36:39], a[100:103], v[104:107], a[36:39]
 ds_read_b64_tr_b16 v[60:61], v245 offset:0
 buffer_load_dwordx4 v[152:155], v28, s[36:39], s56 offen sc1
 v_mfma_f32_16x16x32_bf16 a[52:55], a[100:103], v[108:111], a[52:55]
 ds_read_b64_tr_b16 v[62:63], v245 offset:2048
 v_mfma_f32_16x16x32_bf16 a[8:11], a[104:107], v[96:99], a[8:11]
 buffer_load_dwordx4 v[156:159], v29, s[36:39], s56 offen sc1
 v_mfma_f32_16x16x32_bf16 a[24:27], a[104:107], v[100:103], a[24:27]
 v_mfma_f32_16x16x32_bf16 a[40:43], a[104:107], v[104:107], a[40:43]
 v_mfma_f32_16x16x32_bf16 a[56:59], a[104:107], v[108:111], a[56:59]
 v_mfma_f32_16x16x32_bf16 a[12:15], a[108:111], v[96:99], a[12:15]
 v_mfma_f32_16x16x32_bf16 a[28:31], a[108:111], v[100:103], a[28:31]
 v_mfma_f32_16x16x32_bf16 a[44:47], a[108:111], v[104:107], a[44:47]
 v_mfma_f32_16x16x32_bf16 a[60:63], a[108:111], v[108:111], a[60:63]
 s_waitcnt vmcnt(13) lgkmcnt(0)
 v_mfma_f32_16x16x32_bf16 a[0:3], v[48:51], v[112:115], a[0:3]
 ds_read_b64_tr_b16 v[32:33], v238 offset:16384
 v_mfma_f32_16x16x32_bf16 a[16:19], v[48:51], v[116:119], a[16:19]
 ds_read_b64_tr_b16 v[34:35], v238 offset:18432
 v_mfma_f32_16x16x32_bf16 a[32:35], v[48:51], v[120:123], a[32:35]
 ds_read_b64_tr_b16 v[36:37], v239 offset:16384
 s_add_u32 s56, s92, 16384
 buffer_load_dwordx4 v[96:99], v26, s[36:39], s56 offen sc1
 v_mfma_f32_16x16x32_bf16 a[48:51], v[48:51], v[124:127], a[48:51]
 ds_read_b64_tr_b16 v[38:39], v239 offset:18432
 v_mfma_f32_16x16x32_bf16 a[4:7], v[52:55], v[112:115], a[4:7]
 ds_read_b64_tr_b16 v[40:41], v240 offset:16384
 s_add_u32 m0, s44, 65536
 s_add_u32 s46, s96, 1146880
 buffer_load_dwordx4 v234, s[4:7], s46 offen offset:0  lds
 v_mfma_f32_16x16x32_bf16 a[20:23], v[52:55], v[116:119], a[20:23]
 ds_read_b64_tr_b16 v[42:43], v240 offset:18432
 v_mfma_f32_16x16x32_bf16 a[36:39], v[52:55], v[120:123], a[36:39]
 ds_read_b64_tr_b16 v[44:45], v241 offset:16384
 buffer_load_dwordx4 v[100:103], v27, s[36:39], s56 offen sc1
 v_mfma_f32_16x16x32_bf16 a[52:55], v[52:55], v[124:127], a[52:55]
 ds_read_b64_tr_b16 v[46:47], v241 offset:18432
 v_mfma_f32_16x16x32_bf16 a[8:11], v[56:59], v[112:115], a[8:11]
 buffer_load_dwordx4 v235, s[4:7], s46 offen offset:1024  lds
 v_mfma_f32_16x16x32_bf16 a[24:27], v[56:59], v[116:119], a[24:27]
 v_mfma_f32_16x16x32_bf16 a[40:43], v[56:59], v[120:123], a[40:43]
 buffer_load_dwordx4 v[104:107], v28, s[36:39], s56 offen sc1
 v_mfma_f32_16x16x32_bf16 a[56:59], v[56:59], v[124:127], a[56:59]
 v_mfma_f32_16x16x32_bf16 a[12:15], v[60:63], v[112:115], a[12:15]
 buffer_load_dwordx4 v236, s[4:7], s46 offen offset:2048  lds
 v_mfma_f32_16x16x32_bf16 a[28:31], v[60:63], v[116:119], a[28:31]
 v_mfma_f32_16x16x32_bf16 a[44:47], v[60:63], v[120:123], a[44:47]
 buffer_load_dwordx4 v[108:111], v29, s[36:39], s56 offen sc1
 v_mfma_f32_16x16x32_bf16 a[60:63], v[60:63], v[124:127], a[60:63]
 buffer_load_dwordx4 v237, s[4:7], s46 offen offset:3072  lds
 s_waitcnt vmcnt(13) lgkmcnt(0)
 v_mfma_f32_16x16x32_bf16 a[0:3], v[32:35], v[128:131], a[0:3]
 ds_read_b64_tr_b16 v[48:49], v242 offset:32768
 v_mfma_f32_16x16x32_bf16 a[16:19], v[32:35], v[132:135], a[16:19]
 ds_read_b64_tr_b16 v[50:51], v242 offset:34816
 v_mfma_f32_16x16x32_bf16 a[32:35], v[32:35], v[136:139], a[32:35]
 ds_read_b64_tr_b16 v[52:53], v243 offset:32768
 s_add_u32 s56, s93, 16384
 buffer_load_dwordx4 v[112:115], v26, s[36:39], s56 offen sc1
 v_mfma_f32_16x16x32_bf16 a[48:51], v[32:35], v[140:143], a[48:51]
 ds_read_b64_tr_b16 v[54:55], v243 offset:34816
 v_mfma_f32_16x16x32_bf16 a[4:7], v[36:39], v[128:131], a[4:7]
 ds_read_b64_tr_b16 v[56:57], v244 offset:32768
 s_add_u32 m0, s44, 16384
 s_add_u32 s46, s97, 983040
 buffer_load_dwordx4 v234, s[4:7], s46 offen offset:0  lds
 v_mfma_f32_16x16x32_bf16 a[20:23], v[36:39], v[132:135], a[20:23]
 ds_read_b64_tr_b16 v[58:59], v244 offset:34816
 v_mfma_f32_16x16x32_bf16 a[36:39], v[36:39], v[136:139], a[36:39]
 ds_read_b64_tr_b16 v[60:61], v245 offset:32768
 buffer_load_dwordx4 v[116:119], v27, s[36:39], s56 offen sc1
 v_mfma_f32_16x16x32_bf16 a[52:55], v[36:39], v[140:143], a[52:55]
 ds_read_b64_tr_b16 v[62:63], v245 offset:34816
 v_mfma_f32_16x16x32_bf16 a[8:11], v[40:43], v[128:131], a[8:11]
 buffer_load_dwordx4 v235, s[4:7], s46 offen offset:1024  lds
 v_mfma_f32_16x16x32_bf16 a[24:27], v[40:43], v[132:135], a[24:27]
 v_mfma_f32_16x16x32_bf16 a[40:43], v[40:43], v[136:139], a[40:43]
 buffer_load_dwordx4 v[120:123], v28, s[36:39], s56 offen sc1
 v_mfma_f32_16x16x32_bf16 a[56:59], v[40:43], v[140:143], a[56:59]
 v_mfma_f32_16x16x32_bf16 a[12:15], v[44:47], v[128:131], a[12:15]
 buffer_load_dwordx4 v236, s[4:7], s46 offen offset:2048  lds
 v_mfma_f32_16x16x32_bf16 a[28:31], v[44:47], v[132:135], a[28:31]
 v_mfma_f32_16x16x32_bf16 a[44:47], v[44:47], v[136:139], a[44:47]
 buffer_load_dwordx4 v[124:127], v29, s[36:39], s56 offen sc1
 v_mfma_f32_16x16x32_bf16 a[60:63], v[44:47], v[140:143], a[60:63]
 buffer_load_dwordx4 v237, s[4:7], s46 offen offset:3072  lds
 s_waitcnt vmcnt(16) lgkmcnt(0)
 v_mfma_f32_16x16x32_bf16 a[0:3], v[48:51], v[144:147], a[0:3]
 v_mfma_f32_16x16x32_bf16 a[16:19], v[48:51], v[148:151], a[16:19]
 v_mfma_f32_16x16x32_bf16 a[32:35], v[48:51], v[152:155], a[32:35]
 s_add_u32 s56, s94, 16384
 buffer_load_dwordx4 v[128:131], v26, s[36:39], s56 offen sc1
 v_mfma_f32_16x16x32_bf16 a[48:51], v[48:51], v[156:159], a[48:51]
 v_mfma_f32_16x16x32_bf16 a[4:7], v[52:55], v[144:147], a[4:7]
 s_add_u32 m0, s44, 98304
 s_add_u32 s46, s98, 983040
 buffer_load_dwordx4 v234, s[4:7], s46 offen offset:0  lds
 v_mfma_f32_16x16x32_bf16 a[20:23], v[52:55], v[148:151], a[20:23]
 v_mfma_f32_16x16x32_bf16 a[36:39], v[52:55], v[152:155], a[36:39]
 buffer_load_dwordx4 v[132:135], v27, s[36:39], s56 offen sc1
 v_mfma_f32_16x16x32_bf16 a[52:55], v[52:55], v[156:159], a[52:55]
 v_mfma_f32_16x16x32_bf16 a[8:11], v[56:59], v[144:147], a[8:11]
 buffer_load_dwordx4 v235, s[4:7], s46 offen offset:1024  lds
 v_mfma_f32_16x16x32_bf16 a[24:27], v[56:59], v[148:151], a[24:27]
 v_mfma_f32_16x16x32_bf16 a[40:43], v[56:59], v[152:155], a[40:43]
 buffer_load_dwordx4 v[136:139], v28, s[36:39], s56 offen sc1
 v_mfma_f32_16x16x32_bf16 a[56:59], v[56:59], v[156:159], a[56:59]
 v_mfma_f32_16x16x32_bf16 a[12:15], v[60:63], v[144:147], a[12:15]
 buffer_load_dwordx4 v236, s[4:7], s46 offen offset:2048  lds
 v_mfma_f32_16x16x32_bf16 a[28:31], v[60:63], v[148:151], a[28:31]
 v_mfma_f32_16x16x32_bf16 a[44:47], v[60:63], v[152:155], a[44:47]
 buffer_load_dwordx4 v[140:143], v29, s[36:39], s56 offen sc1
 v_mfma_f32_16x16x32_bf16 a[60:63], v[60:63], v[156:159], a[60:63]
 buffer_load_dwordx4 v237, s[4:7], s46 offen offset:3072  lds
 s_waitcnt vmcnt(17)
 v_mfma_f32_16x16x32_bf16 a[0:3], a[112:115], v[96:99], a[0:3]
 ds_read_b64_tr_b16 v[48:49], v242 offset:16384
 v_mfma_f32_16x16x32_bf16 a[16:19], a[112:115], v[100:103], a[16:19]
 ds_read_b64_tr_b16 v[50:51], v242 offset:18432
 v_mfma_f32_16x16x32_bf16 a[32:35], a[112:115], v[104:107], a[32:35]
 ds_read_b64_tr_b16 v[52:53], v243 offset:16384
 s_add_u32 s56, s95, 16384
 buffer_load_dwordx4 v[144:147], v26, s[36:39], s56 offen sc1
 v_mfma_f32_16x16x32_bf16 a[48:51], a[112:115], v[108:111], a[48:51]
 ds_read_b64_tr_b16 v[54:55], v243 offset:18432
 v_mfma_f32_16x16x32_bf16 a[4:7], a[116:119], v[96:99], a[4:7]
 ds_read_b64_tr_b16 v[56:57], v244 offset:16384
 buffer_load_dwordx4 v[148:151], v27, s[36:39], s56 offen sc1
 v_mfma_f32_16x16x32_bf16 a[20:23], a[116:119], v[100:103], a[20:23]
 ds_read_b64_tr_b16 v[58:59], v244 offset:18432
 v_mfma_f32_16x16x32_bf16 a[36:39], a[116:119], v[104:107], a[36:39]
 ds_read_b64_tr_b16 v[60:61], v245 offset:16384
 buffer_load_dwordx4 v[152:155], v28, s[36:39], s56 offen sc1
 v_mfma_f32_16x16x32_bf16 a[52:55], a[116:119], v[108:111], a[52:55]
 ds_read_b64_tr_b16 v[62:63], v245 offset:18432
 v_mfma_f32_16x16x32_bf16 a[8:11], a[120:123], v[96:99], a[8:11]
 buffer_load_dwordx4 v[156:159], v29, s[36:39], s56 offen sc1
 v_mfma_f32_16x16x32_bf16 a[24:27], a[120:123], v[100:103], a[24:27]
 v_mfma_f32_16x16x32_bf16 a[40:43], a[120:123], v[104:107], a[40:43]
 v_mfma_f32_16x16x32_bf16 a[56:59], a[120:123], v[108:111], a[56:59]
 v_mfma_f32_16x16x32_bf16 a[12:15], a[124:127], v[96:99], a[12:15]
 v_mfma_f32_16x16x32_bf16 a[28:31], a[124:127], v[100:103], a[28:31]
 v_mfma_f32_16x16x32_bf16 a[44:47], a[124:127], v[104:107], a[44:47]
 v_mfma_f32_16x16x32_bf16 a[60:63], a[124:127], v[108:111], a[60:63]
 buffer_load_dword v10, v31, s[36:39], s59 offen sc1
 s_waitcnt vmcnt(14) lgkmcnt(0)
 v_mfma_f32_16x16x32_bf16 a[0:3], v[48:51], v[112:115], a[0:3]
 ds_read_b64_tr_b16 v[32:33], v246 offset:16384
 v_mfma_f32_16x16x32_bf16 a[16:19], v[48:51], v[116:119], a[16:19]
 ds_read_b64_tr_b16 v[34:35], v246 offset:18432
 v_mfma_f32_16x16x32_bf16 a[32:35], v[48:51], v[120:123], a[32:35]
 ds_read_b64_tr_b16 v[36:37], v247 offset:16384
 s_add_u32 s56, s92, 20480
 buffer_load_dwordx4 v[96:99], v26, s[36:39], s56 offen sc1
 v_mfma_f32_16x16x32_bf16 a[48:51], v[48:51], v[124:127], a[48:51]
 ds_read_b64_tr_b16 v[38:39], v247 offset:18432
 v_mfma_f32_16x16x32_bf16 a[4:7], v[52:55], v[112:115], a[4:7]
 ds_read_b64_tr_b16 v[40:41], v248 offset:16384
 s_add_u32 m0, s44, 81920
 s_add_u32 s46, s99, 983040
 buffer_load_dwordx4 v234, s[4:7], s46 offen offset:0  lds
 v_mfma_f32_16x16x32_bf16 a[20:23], v[52:55], v[116:119], a[20:23]
 ds_read_b64_tr_b16 v[42:43], v248 offset:18432
 v_mfma_f32_16x16x32_bf16 a[36:39], v[52:55], v[120:123], a[36:39]
 ds_read_b64_tr_b16 v[44:45], v249 offset:16384
 buffer_load_dwordx4 v[100:103], v27, s[36:39], s56 offen sc1
 v_mfma_f32_16x16x32_bf16 a[52:55], v[52:55], v[124:127], a[52:55]
 ds_read_b64_tr_b16 v[46:47], v249 offset:18432
 v_mfma_f32_16x16x32_bf16 a[8:11], v[56:59], v[112:115], a[8:11]
 buffer_load_dwordx4 v235, s[4:7], s46 offen offset:1024  lds
 v_mfma_f32_16x16x32_bf16 a[24:27], v[56:59], v[116:119], a[24:27]
 v_mfma_f32_16x16x32_bf16 a[40:43], v[56:59], v[120:123], a[40:43]
 buffer_load_dwordx4 v[104:107], v28, s[36:39], s56 offen sc1
 v_mfma_f32_16x16x32_bf16 a[56:59], v[56:59], v[124:127], a[56:59]
 v_mfma_f32_16x16x32_bf16 a[12:15], v[60:63], v[112:115], a[12:15]
 buffer_load_dwordx4 v236, s[4:7], s46 offen offset:2048  lds
 v_mfma_f32_16x16x32_bf16 a[28:31], v[60:63], v[116:119], a[28:31]
 v_mfma_f32_16x16x32_bf16 a[44:47], v[60:63], v[120:123], a[44:47]
 buffer_load_dwordx4 v[108:111], v29, s[36:39], s56 offen sc1
 v_mfma_f32_16x16x32_bf16 a[60:63], v[60:63], v[124:127], a[60:63]
 buffer_load_dwordx4 v237, s[4:7], s46 offen offset:3072  lds
 s_waitcnt vmcnt(14) lgkmcnt(0)
 v_mfma_f32_16x16x32_bf16 a[0:3], v[32:35], v[128:131], a[0:3]
 ds_read_b64_tr_b16 v[48:49], v246 offset:0
 v_mfma_f32_16x16x32_bf16 a[16:19], v[32:35], v[132:135], a[16:19]
 ds_read_b64_tr_b16 v[50:51], v246 offset:2048
 v_mfma_f32_16x16x32_bf16 a[32:35], v[32:35], v[136:139], a[32:35]
 ds_read_b64_tr_b16 v[52:53], v247 offset:0
 s_add_u32 s56, s93, 20480
 buffer_load_dwordx4 v[112:115], v26, s[36:39], s56 offen sc1
 v_mfma_f32_16x16x32_bf16 a[48:51], v[32:35], v[140:143], a[48:51]
 ds_read_b64_tr_b16 v[54:55], v247 offset:2048
 v_mfma_f32_16x16x32_bf16 a[4:7], v[36:39], v[128:131], a[4:7]
 ds_read_b64_tr_b16 v[56:57], v248 offset:0
 s_add_u32 m0, s44, 147456
 s_add_u32 s46, s97, 1146880
 buffer_load_dwordx4 v234, s[4:7], s46 offen offset:0  lds
 v_mfma_f32_16x16x32_bf16 a[20:23], v[36:39], v[132:135], a[20:23]
 ds_read_b64_tr_b16 v[58:59], v248 offset:2048
 v_mfma_f32_16x16x32_bf16 a[36:39], v[36:39], v[136:139], a[36:39]
 ds_read_b64_tr_b16 v[60:61], v249 offset:0
 buffer_load_dwordx4 v[116:119], v27, s[36:39], s56 offen sc1
 v_mfma_f32_16x16x32_bf16 a[52:55], v[36:39], v[140:143], a[52:55]
 ds_read_b64_tr_b16 v[62:63], v249 offset:2048
 v_mfma_f32_16x16x32_bf16 a[8:11], v[40:43], v[128:131], a[8:11]
 buffer_load_dwordx4 v235, s[4:7], s46 offen offset:1024  lds
 v_mfma_f32_16x16x32_bf16 a[24:27], v[40:43], v[132:135], a[24:27]
 v_mfma_f32_16x16x32_bf16 a[40:43], v[40:43], v[136:139], a[40:43]
 buffer_load_dwordx4 v[120:123], v28, s[36:39], s56 offen sc1
 v_mfma_f32_16x16x32_bf16 a[56:59], v[40:43], v[140:143], a[56:59]
 v_mfma_f32_16x16x32_bf16 a[12:15], v[44:47], v[128:131], a[12:15]
 buffer_load_dwordx4 v236, s[4:7], s46 offen offset:2048  lds
 v_mfma_f32_16x16x32_bf16 a[28:31], v[44:47], v[132:135], a[28:31]
 v_mfma_f32_16x16x32_bf16 a[44:47], v[44:47], v[136:139], a[44:47]
 buffer_load_dwordx4 v[124:127], v29, s[36:39], s56 offen sc1
 v_mfma_f32_16x16x32_bf16 a[60:63], v[44:47], v[140:143], a[60:63]
 buffer_load_dwordx4 v237, s[4:7], s46 offen offset:3072  lds
 s_waitcnt vmcnt(17) lgkmcnt(0)
 v_mfma_f32_16x16x32_bf16 a[0:3], v[48:51], v[144:147], a[0:3]
 v_mfma_f32_16x16x32_bf16 a[16:19], v[48:51], v[148:151], a[16:19]
 v_mfma_f32_16x16x32_bf16 a[32:35], v[48:51], v[152:155], a[32:35]
 s_add_u32 s56, s94, 20480
 buffer_load_dwordx4 v[128:131], v26, s[36:39], s56 offen sc1
 v_mfma_f32_16x16x32_bf16 a[48:51], v[48:51], v[156:159], a[48:51]
 v_mfma_f32_16x16x32_bf16 a[4:7], v[52:55], v[144:147], a[4:7]
 s_add_u32 m0, s44, 131072
 s_add_u32 s46, s98, 1146880
 buffer_load_dwordx4 v234, s[4:7], s46 offen offset:0  lds
 v_mfma_f32_16x16x32_bf16 a[20:23], v[52:55], v[148:151], a[20:23]
 v_mfma_f32_16x16x32_bf16 a[36:39], v[52:55], v[152:155], a[36:39]
 buffer_load_dwordx4 v[132:135], v27, s[36:39], s56 offen sc1
 v_mfma_f32_16x16x32_bf16 a[52:55], v[52:55], v[156:159], a[52:55]
 v_mfma_f32_16x16x32_bf16 a[8:11], v[56:59], v[144:147], a[8:11]
 buffer_load_dwordx4 v235, s[4:7], s46 offen offset:1024  lds
 v_mfma_f32_16x16x32_bf16 a[24:27], v[56:59], v[148:151], a[24:27]
 v_mfma_f32_16x16x32_bf16 a[40:43], v[56:59], v[152:155], a[40:43]
 buffer_load_dwordx4 v[136:139], v28, s[36:39], s56 offen sc1
 v_mfma_f32_16x16x32_bf16 a[56:59], v[56:59], v[156:159], a[56:59]
 v_mfma_f32_16x16x32_bf16 a[12:15], v[60:63], v[144:147], a[12:15]
 buffer_load_dwordx4 v236, s[4:7], s46 offen offset:2048  lds
 v_mfma_f32_16x16x32_bf16 a[28:31], v[60:63], v[148:151], a[28:31]
 v_mfma_f32_16x16x32_bf16 a[44:47], v[60:63], v[152:155], a[44:47]
 buffer_load_dwordx4 v[140:143], v29, s[36:39], s56 offen sc1
 v_mfma_f32_16x16x32_bf16 a[60:63], v[60:63], v[156:159], a[60:63]
 buffer_load_dwordx4 v237, s[4:7], s46 offen offset:3072  lds
 s_waitcnt vmcnt(17)
 v_mfma_f32_16x16x32_bf16 a[0:3], a[128:131], v[96:99], a[0:3]
 ds_read_b64_tr_b16 v[48:49], v238 offset:32768
 v_mfma_f32_16x16x32_bf16 a[16:19], a[128:131], v[100:103], a[16:19]
 ds_read_b64_tr_b16 v[50:51], v238 offset:34816
 v_mfma_f32_16x16x32_bf16 a[32:35], a[128:131], v[104:107], a[32:35]
 ds_read_b64_tr_b16 v[52:53], v239 offset:32768
 s_add_u32 s56, s95, 20480
 buffer_load_dwordx4 v[144:147], v26, s[36:39], s56 offen sc1
 v_mfma_f32_16x16x32_bf16 a[48:51], a[128:131], v[108:111], a[48:51]
 ds_read_b64_tr_b16 v[54:55], v239 offset:34816
 v_mfma_f32_16x16x32_bf16 a[4:7], a[132:135], v[96:99], a[4:7]
 ds_read_b64_tr_b16 v[56:57], v240 offset:32768
 buffer_load_dwordx4 v[148:151], v27, s[36:39], s56 offen sc1
 v_mfma_f32_16x16x32_bf16 a[20:23], a[132:135], v[100:103], a[20:23]
 ds_read_b64_tr_b16 v[58:59], v240 offset:34816
 v_mfma_f32_16x16x32_bf16 a[36:39], a[132:135], v[104:107], a[36:39]
 ds_read_b64_tr_b16 v[60:61], v241 offset:32768
 buffer_load_dwordx4 v[152:155], v28, s[36:39], s56 offen sc1
 v_mfma_f32_16x16x32_bf16 a[52:55], a[132:135], v[108:111], a[52:55]
 ds_read_b64_tr_b16 v[62:63], v241 offset:34816
 v_mfma_f32_16x16x32_bf16 a[8:11], a[136:139], v[96:99], a[8:11]
 buffer_load_dwordx4 v[156:159], v29, s[36:39], s56 offen sc1
 v_mfma_f32_16x16x32_bf16 a[24:27], a[136:139], v[100:103], a[24:27]
 v_mfma_f32_16x16x32_bf16 a[40:43], a[136:139], v[104:107], a[40:43]
 v_mfma_f32_16x16x32_bf16 a[56:59], a[136:139], v[108:111], a[56:59]
 v_mfma_f32_16x16x32_bf16 a[12:15], a[140:143], v[96:99], a[12:15]
 v_mfma_f32_16x16x32_bf16 a[28:31], a[140:143], v[100:103], a[28:31]
 v_mfma_f32_16x16x32_bf16 a[44:47], a[140:143], v[104:107], a[44:47]
 v_mfma_f32_16x16x32_bf16 a[60:63], a[140:143], v[108:111], a[60:63]
 s_waitcnt vmcnt(13) lgkmcnt(0)
 v_cmp_ne_u32 vcc, v10, v232
 s_cbranch_vccnz L_poll2
L_go2:
 v_mfma_f32_16x16x32_bf16 a[0:3], v[48:51], v[112:115], a[0:3]
 ds_read_b64_tr_b16 v[32:33], v242 offset:49152
 v_mfma_f32_16x16x32_bf16 a[16:19], v[48:51], v[116:119], a[16:19]
 ds_read_b64_tr_b16 v[34:35], v242 offset:51200
 v_mfma_f32_16x16x32_bf16 a[32:35], v[48:51], v[120:123], a[32:35]
 ds_read_b64_tr_b16 v[36:37], v243 offset:49152
 s_add_u32 s56, s92, 24576
 buffer_load_dwordx4 v[96:99], v26, s[36:39], s56 offen sc1
 v_mfma_f32_16x16x32_bf16 a[48:51], v[48:51], v[124:127], a[48:51]
 ds_read_b64_tr_b16 v[38:39], v243 offset:51200
 v_mfma_f32_16x16x32_bf16 a[4:7], v[52:55], v[112:115], a[4:7]
 ds_read_b64_tr_b16 v[40:41], v244 offset:49152
 s_add_u32 m0, s44, 32768
 s_add_u32 s46, s99, 1146880
 buffer_load_dwordx4 v234, s[4:7], s46 offen offset:0  lds
 v_mfma_f32_16x16x32_bf16 a[20:23], v[52:55], v[116:119], a[20:23]
 ds_read_b64_tr_b16 v[42:43], v244 offset:51200
 v_mfma_f32_16x16x32_bf16 a[36:39], v[52:55], v[120:123], a[36:39]
 ds_read_b64_tr_b16 v[44:45], v245 offset:49152
 buffer_load_dwordx4 v[100:103], v27, s[36:39], s56 offen sc1
 v_mfma_f32_16x16x32_bf16 a[52:55], v[52:55], v[124:127], a[52:55]
 ds_read_b64_tr_b16 v[46:47], v245 offset:51200
 v_mfma_f32_16x16x32_bf16 a[8:11], v[56:59], v[112:115], a[8:11]
 buffer_load_dwordx4 v235, s[4:7], s46 offen offset:1024  lds
 v_mfma_f32_16x16x32_bf16 a[24:27], v[56:59], v[116:119], a[24:27]
 v_mfma_f32_16x16x32_bf16 a[40:43], v[56:59], v[120:123], a[40:43]
 buffer_load_dwordx4 v[104:107], v28, s[36:39], s56 offen sc1
 v_mfma_f32_16x16x32_bf16 a[56:59], v[56:59], v[124:127], a[56:59]
 v_mfma_f32_16x16x32_bf16 a[12:15], v[60:63], v[112:115], a[12:15]
 buffer_load_dwordx4 v236, s[4:7], s46 offen offset:2048  lds
 v_mfma_f32_16x16x32_bf16 a[28:31], v[60:63], v[116:119], a[28:31]
 v_mfma_f32_16x16x32_bf16 a[44:47], v[60:63], v[120:123], a[44:47]
 buffer_load_dwordx4 v[108:111], v29, s[36:39], s56 offen sc1
 v_mfma_f32_16x16x32_bf16 a[60:63], v[60:63], v[124:127], a[60:63]
 buffer_load_dwordx4 v237, s[4:7], s46 offen offset:3072  lds
 s_waitcnt vmcnt(13) lgkmcnt(0)
 v_mfma_f32_16x16x32_bf16 a[0:3], v[32:35], v[128:131], a[0:3]
 ds_read_b64_tr_b16 v[48:49], v238 offset:0
 v_mfma_f32_16x16x32_bf16 a[16:19], v[32:35], v[132:135], a[16:19]
 ds_read_b64_tr_b16 v[50:51], v238 offset:2048
 v_mfma_f32_16x16x32_bf16 a[32:35], v[32:35], v[136:139], a[32:35]
 ds_read_b64_tr_b16 v[52:53], v239 offset:0
 s_add_u32 s56, s93, 24576
 buffer_load_dwordx4 v[112:115], v26, s[36:39], s56 offen sc1
 v_mfma_f32_16x16x32_bf16 a[48:51], v[32:35], v[140:143], a[48:51]
 ds_read_b64_tr_b16 v[54:55], v239 offset:2048
 v_mfma_f32_16x16x32_bf16 a[4:7], v[36:39], v[128:131], a[4:7]
 ds_read_b64_tr_b16 v[56:57], v240 offset:0
 buffer_load_dwordx4 v[116:119], v27, s[36:39], s56 offen sc1
 v_mfma_f32_16x16x32_bf16 a[20:23], v[36:39], v[132:135], a[20:23]
 ds_read_b64_tr_b16 v[58:59], v240 offset:2048
 v_mfma_f32_16x16x32_bf16 a[36:39], v[36:39], v[136:139], a[36:39]
 ds_read_b64_tr_b16 v[60:61], v241 offset:0
 buffer_load_dwordx4 v[120:123], v28, s[36:39], s56 offen sc1
 v_mfma_f32_16x16x32_bf16 a[52:55], v[36:39], v[140:143], a[52:55]
 ds_read_b64_tr_b16 v[62:63], v241 offset:2048
 v_mfma_f32_16x16x32_bf16 a[8:11], v[40:43], v[128:131], a[8:11]
 buffer_load_dwordx4 v[124:127], v29, s[36:39], s56 offen sc1
 v_mfma_f32_16x16x32_bf16 a[24:27], v[40:43], v[132:135], a[24:27]
 v_mfma_f32_16x16x32_bf16 a[40:43], v[40:43], v[136:139], a[40:43]
 v_mfma_f32_16x16x32_bf16 a[56:59], v[40:43], v[140:143], a[56:59]
 v_mfma_f32_16x16x32_bf16 a[12:15], v[44:47], v[128:131], a[12:15]
 v_mfma_f32_16x16x32_bf16 a[28:31], v[44:47], v[132:135], a[28:31]
 v_mfma_f32_16x16x32_bf16 a[44:47], v[44:47], v[136:139], a[44:47]
 v_mfma_f32_16x16x32_bf16 a[60:63], v[44:47], v[140:143], a[60:63]
 s_waitcnt vmcnt(12) lgkmcnt(0)
 v_mfma_f32_16x16x32_bf16 a[0:3], v[48:51], v[144:147], a[0:3]
 ds_read_b64_tr_b16 v[32:33], v238 offset:49152
 v_mfma_f32_16x16x32_bf16 a[16:19], v[48:51], v[148:151], a[16:19]
 ds_read_b64_tr_b16 v[34:35], v238 offset:51200
 v_mfma_f32_16x16x32_bf16 a[32:35], v[48:51], v[152:155], a[32:35]
 ds_read_b64_tr_b16 v[36:37], v239 offset:49152
 s_add_u32 s56, s94, 24576
 buffer_load_dwordx4 v[128:131], v26, s[36:39], s56 offen sc1
 v_mfma_f32_16x16x32_bf16 a[48:51], v[48:51], v[156:159], a[48:51]
 ds_read_b64_tr_b16 v[38:39], v239 offset:51200
 v_mfma_f32_16x16x32_bf16 a[4:7], v[52:55], v[144:147], a[4:7]
 ds_read_b64_tr_b16 v[40:41], v240 offset:49152
 buffer_load_dwordx4 v[132:135], v27, s[36:39], s56 offen sc1
 v_mfma_f32_16x16x32_bf16 a[20:23], v[52:55], v[148:151], a[20:23]
 ds_read_b64_tr_b16 v[42:43], v240 offset:51200
 v_mfma_f32_16x16x32_bf16 a[36:39], v[52:55], v[152:155], a[36:39]
 ds_read_b64_tr_b16 v[44:45], v241 offset:49152
 buffer_load_dwordx4 v[136:139], v28, s[36:39], s56 offen sc1
 v_mfma_f32_16x16x32_bf16 a[52:55], v[52:55], v[156:159], a[52:55]
 ds_read_b64_tr_b16 v[46:47], v241 offset:51200
 v_mfma_f32_16x16x32_bf16 a[8:11], v[56:59], v[144:147], a[8:11]
 buffer_load_dwordx4 v[140:143], v29, s[36:39], s56 offen sc1
 v_mfma_f32_16x16x32_bf16 a[24:27], v[56:59], v[148:151], a[24:27]
 v_mfma_f32_16x16x32_bf16 a[40:43], v[56:59], v[152:155], a[40:43]
 v_mfma_f32_16x16x32_bf16 a[56:59], v[56:59], v[156:159], a[56:59]
 v_mfma_f32_16x16x32_bf16 a[12:15], v[60:63], v[144:147], a[12:15]
 v_mfma_f32_16x16x32_bf16 a[28:31], v[60:63], v[148:151], a[28:31]
 v_mfma_f32_16x16x32_bf16 a[44:47], v[60:63], v[152:155], a[44:47]
 v_mfma_f32_16x16x32_bf16 a[60:63], v[60:63], v[156:159], a[60:63]
 s_waitcnt vmcnt(9) lgkmcnt(0)
 v_mfma_f32_16x16x32_bf16 a[0:3], v[32:35], v[96:99], a[0:3]
 ds_read_b64_tr_b16 v[48:49], v238 offset:16384
 v_mfma_f32_16x16x32_bf16 a[16:19], v[32:35], v[100:103], a[16:19]
 ds_read_b64_tr_b16 v[50:51], v238 offset:18432
 v_mfma_f32_16x16x32_bf16 a[32:35], v[32:35], v[104:107], a[32:35]
 ds_read_b64_tr_b16 v[52:53], v239 offset:16384
 s_add_u32 s56, s95, 24576
 buffer_load_dwordx4 v[144:147], v26, s[36:39], s56 offen sc1
 v_mfma_f32_16x16x32_bf16 a[48:51], v[32:35], v[108:111], a[48:51]
 ds_read_b64_tr_b16 v[54:55], v239 offset:18432
 v_mfma_f32_16x16x32_bf16 a[4:7], v[36:39], v[96:99], a[4:7]
 ds_read_b64_tr_b16 v[56:57], v240 offset:16384
 buffer_load_dwordx4 v[148:151], v27, s[36:39], s56 offen sc1
 v_mfma_f32_16x16x32_bf16 a[20:23], v[36:39], v[100:103], a[20:23]
 ds_read_b64_tr_b16 v[58:59], v240 offset:18432
 v_mfma_f32_16x16x32_bf16 a[36:39], v[36:39], v[104:107], a[36:39]
 ds_read_b64_tr_b16 v[60:61], v241 offset:16384
 buffer_load_dwordx4 v[152:155], v28, s[36:39], s56 offen sc1
 v_mfma_f32_16x16x32_bf16 a[52:55], v[36:39], v[108:111], a[52:55]
 ds_read_b64_tr_b16 v[62:63], v241 offset:18432
 v_mfma_f32_16x16x32_bf16 a[8:11], v[40:43], v[96:99], a[8:11]
 buffer_load_dwordx4 v[156:159], v29, s[36:39], s56 offen sc1
 v_mfma_f32_16x16x32_bf16 a[24:27], v[40:43], v[100:103], a[24:27]
 v_mfma_f32_16x16x32_bf16 a[40:43], v[40:43], v[104:107], a[40:43]
 v_mfma_f32_16x16x32_bf16 a[56:59], v[40:43], v[108:111], a[56:59]
 v_mfma_f32_16x16x32_bf16 a[12:15], v[44:47], v[96:99], a[12:15]
 v_mfma_f32_16x16x32_bf16 a[28:31], v[44:47], v[100:103], a[28:31]
 v_mfma_f32_16x16x32_bf16 a[44:47], v[44:47], v[104:107], a[44:47]
 v_mfma_f32_16x16x32_bf16 a[60:63], v[44:47], v[108:111], a[60:63]
 s_waitcnt vmcnt(8) lgkmcnt(0)
 v_mfma_f32_16x16x32_bf16 a[0:3], v[48:51], v[112:115], a[0:3]
 ds_read_b64_tr_b16 v[32:33], v242 offset:32768
 v_mfma_f32_16x16x32_bf16 a[16:19], v[48:51], v[116:119], a[16:19]
 ds_read_b64_tr_b16 v[34:35], v242 offset:34816
 v_mfma_f32_16x16x32_bf16 a[32:35], v[48:51], v[120:123], a[32:35]
 ds_read_b64_tr_b16 v[36:37], v243 offset:32768
 s_add_u32 s56, s92, 28672
 buffer_load_dwordx4 v[96:99], v26, s[36:39], s56 offen sc1
 v_mfma_f32_16x16x32_bf16 a[48:51], v[48:51], v[124:127], a[48:51]
 ds_read_b64_tr_b16 v[38:39], v243 offset:34816
 v_mfma_f32_16x16x32_bf16 a[4:7], v[52:55], v[112:115], a[4:7]
 ds_read_b64_tr_b16 v[40:41], v244 offset:32768
 buffer_load_dwordx4 v[100:103], v27, s[36:39], s56 offen sc1
 v_mfma_f32_16x16x32_bf16 a[20:23], v[52:55], v[116:119], a[20:23]
 ds_read_b64_tr_b16 v[42:43], v244 offset:34816
 v_mfma_f32_16x16x32_bf16 a[36:39], v[52:55], v[120:123], a[36:39]
 ds_read_b64_tr_b16 v[44:45], v245 offset:32768
 buffer_load_dwordx4 v[104:107], v28, s[36:39], s56 offen sc1
 v_mfma_f32_16x16x32_bf16 a[52:55], v[52:55], v[124:127], a[52:55]
 ds_read_b64_tr_b16 v[46:47], v245 offset:34816
 v_mfma_f32_16x16x32_bf16 a[8:11], v[56:59], v[112:115], a[8:11]
 buffer_load_dwordx4 v[108:111], v29, s[36:39], s56 offen sc1
 v_mfma_f32_16x16x32_bf16 a[24:27], v[56:59], v[116:119], a[24:27]
 v_mfma_f32_16x16x32_bf16 a[40:43], v[56:59], v[120:123], a[40:43]
 v_mfma_f32_16x16x32_bf16 a[56:59], v[56:59], v[124:127], a[56:59]
 v_mfma_f32_16x16x32_bf16 a[12:15], v[60:63], v[112:115], a[12:15]
 v_mfma_f32_16x16x32_bf16 a[28:31], v[60:63], v[116:119], a[28:31]
 v_mfma_f32_16x16x32_bf16 a[44:47], v[60:63], v[120:123], a[44:47]
 v_mfma_f32_16x16x32_bf16 a[60:63], v[60:63], v[124:127], a[60:63]
 s_waitcnt vmcnt(8) lgkmcnt(0)
 v_mfma_f32_16x16x32_bf16 a[0:3], v[32:35], v[128:131], a[0:3]
 ds_read_b64_tr_b16 v[48:49], v242 offset:16384
 v_mfma_f32_16x16x32_bf16 a[16:19], v[32:35], v[132:135], a[16:19]
 ds_read_b64_tr_b16 v[50:51], v242 offset:18432
 v_mfma_f32_16x16x32_bf16 a[32:35], v[32:35], v[136:139], a[32:35]
 ds_read_b64_tr_b16 v[52:53], v243 offset:16384
 s_add_u32 s56, s93, 28672
 buffer_load_dwordx4 v[112:115], v26, s[36:39], s56 offen sc1
 v_mfma_f32_16x16x32_bf16 a[48:51], v[32:35], v[140:143], a[48:51]
 ds_read_b64_tr_b16 v[54:55], v243 offset:18432
 v_mfma_f32_16x16x32_bf16 a[4:7], v[36:39], v[128:131], a[4:7]
 ds_read_b64_tr_b16 v[56:57], v244 offset:16384
 buffer_load_dwordx4 v[116:119], v27, s[36:39], s56 offen sc1
 v_mfma_f32_16x16x32_bf16 a[20:23], v[36:39], v[132:135], a[20:23]
 ds_read_b64_tr_b16 v[58:59], v244 offset:18432
 v_mfma_f32_16x16x32_bf16 a[36:39], v[36:39], v[136:139], a[36:39]
 ds_read_b64_tr_b16 v[60:61], v245 offset:16384
 buffer_load_dwordx4 v[120:123], v28, s[36:39], s56 offen sc1
 v_mfma_f32_16x16x32_bf16 a[52:55], v[36:39], v[140:143], a[52:55]
 ds_read_b64_tr_b16 v[62:63], v245 offset:18432
 v_mfma_f32_16x16x32_bf16 a[8:11], v[40:43], v[128:131], a[8:11]
 buffer_load_dwordx4 v[124:127], v29, s[36:39], s56 offen sc1
 v_mfma_f32_16x16x32_bf16 a[24:27], v[40:43], v[132:135], a[24:27]
 v_mfma_f32_16x16x32_bf16 a[40:43], v[40:43], v[136:139], a[40:43]
 v_mfma_f32_16x16x32_bf16 a[56:59], v[40:43], v[140:143], a[56:59]
 v_mfma_f32_16x16x32_bf16 a[12:15], v[44:47], v[128:131], a[12:15]
 v_mfma_f32_16x16x32_bf16 a[28:31], v[44:47], v[132:135], a[28:31]
 v_mfma_f32_16x16x32_bf16 a[44:47], v[44:47], v[136:139], a[44:47]
 v_mfma_f32_16x16x32_bf16 a[60:63], v[44:47], v[140:143], a[60:63]
 s_waitcnt vmcnt(8) lgkmcnt(0)
 v_mfma_f32_16x16x32_bf16 a[0:3], v[48:51], v[144:147], a[0:3]
 ds_read_b64_tr_b16 v[32:33], v242 offset:0
 v_mfma_f32_16x16x32_bf16 a[16:19], v[48:51], v[148:151], a[16:19]
 ds_read_b64_tr_b16 v[34:35], v242 offset:2048
 v_mfma_f32_16x16x32_bf16 a[32:35], v[48:51], v[152:155], a[32:35]
 ds_read_b64_tr_b16 v[36:37], v243 offset:0
 s_add_u32 s56, s94, 28672
 buffer_load_dwordx4 v[128:131], v26, s[36:39], s56 offen sc1
 v_mfma_f32_16x16x32_bf16 a[48:51], v[48:51], v[156:159], a[48:51]
 ds_read_b64_tr_b16 v[38:39], v243 offset:2048
 v_mfma_f32_16x16x32_bf16 a[4:7], v[52:55], v[144:147], a[4:7]
 ds_read_b64_tr_b16 v[40:41], v244 offset:0
 buffer_load_dwordx4 v[132:135], v27, s[36:39], s56 offen sc1
 v_mfma_f32_16x16x32_bf16 a[20:23], v[52:55], v[148:151], a[20:23]
 ds_read_b64_tr_b16 v[42:43], v244 offset:2048
 v_mfma_f32_16x16x32_bf16 a[36:39], v[52:55], v[152:155], a[36:39]
 ds_read_b64_tr_b16 v[44:45], v245 offset:0
 buffer_load_dwordx4 v[136:139], v28, s[36:39], s56 offen sc1
 v_mfma_f32_16x16x32_bf16 a[52:55], v[52:55], v[156:159], a[52:55]
 ds_read_b64_tr_b16 v[46:47], v245 offset:2048
 v_mfma_f32_16x16x32_bf16 a[8:11], v[56:59], v[144:147], a[8:11]
 buffer_load_dwordx4 v[140:143], v29, s[36:39], s56 offen sc1
 v_mfma_f32_16x16x32_bf16 a[24:27], v[56:59], v[148:151], a[24:27]
 v_mfma_f32_16x16x32_bf16 a[40:43], v[56:59], v[152:155], a[40:43]
 v_mfma_f32_16x16x32_bf16 a[56:59], v[56:59], v[156:159], a[56:59]
 v_mfma_f32_16x16x32_bf16 a[12:15], v[60:63], v[144:147], a[12:15]
 v_mfma_f32_16x16x32_bf16 a[28:31], v[60:63], v[148:151], a[28:31]
 v_mfma_f32_16x16x32_bf16 a[44:47], v[60:63], v[152:155], a[44:47]
 v_mfma_f32_16x16x32_bf16 a[60:63], v[60:63], v[156:159], a[60:63]
 s_waitcnt vmcnt(8) lgkmcnt(0)
 v_lshrrev_b32 v3, 4, v2
 v_and_b32 v11, 15, v2
 v_mul_u32_u24 v11, 1280, v11
 v_and_b32 v12, 1, v3
 v_lshl_add_u32 v11, v12, 5, v11
 v_lshrrev_b32 v12, 1, v3
 v_lshl_add_u32 v11, v12, 4, v11
 s_lshl_b32 s3, s54, 2
 s_add_u32 s3, s3, s40
 s_mul_i32 s3, s3, 20480
 s_lshl_b32 s57, s55, 7
 s_add_u32 s3, s3, s57
 v_add_u32 v10, s44, v189
 v_xor_b32 v13, 4096, v10
 v_xor_b32 v14, 8192, v10
 v_xor_b32 v15, 12288, v10
 v_mfma_f32_16x16x32_bf16 a[0:3], v[32:35], v[96:99], a[0:3]
 ds_read_b64_tr_b16 v[48:49], v246 offset:16384
 v_mfma_f32_16x16x32_bf16 a[16:19], v[32:35], v[100:103], a[16:19]
 ds_read_b64_tr_b16 v[50:51], v246 offset:18432
 v_mfma_f32_16x16x32_bf16 a[32:35], v[32:35], v[104:107], a[32:35]
 ds_read_b64_tr_b16 v[52:53], v247 offset:16384
 s_add_u32 s56, s95, 28672
 buffer_load_dwordx4 v[144:147], v26, s[36:39], s56 offen sc1
 v_mfma_f32_16x16x32_bf16 a[48:51], v[32:35], v[108:111], a[48:51]
 ds_read_b64_tr_b16 v[54:55], v247 offset:18432
 v_mfma_f32_16x16x32_bf16 a[4:7], v[36:39], v[96:99], a[4:7]
 ds_read_b64_tr_b16 v[56:57], v248 offset:16384
 buffer_load_dwordx4 v[148:151], v27, s[36:39], s56 offen sc1
 v_mfma_f32_16x16x32_bf16 a[20:23], v[36:39], v[100:103], a[20:23]
 ds_read_b64_tr_b16 v[58:59], v248 offset:18432
 v_mfma_f32_16x16x32_bf16 a[36:39], v[36:39], v[104:107], a[36:39]
 ds_read_b64_tr_b16 v[60:61], v249 offset:16384
 buffer_load_dwordx4 v[152:155], v28, s[36:39], s56 offen sc1
 v_mfma_f32_16x16x32_bf16 a[52:55], v[36:39], v[108:111], a[52:55]
 ds_read_b64_tr_b16 v[62:63], v249 offset:18432
 v_mfma_f32_16x16x32_bf16 a[8:11], v[40:43], v[96:99], a[8:11]
 buffer_load_dwordx4 v[156:159], v29, s[36:39], s56 offen sc1
 v_mfma_f32_16x16x32_bf16 a[24:27], v[40:43], v[100:103], a[24:27]
 v_mfma_f32_16x16x32_bf16 a[40:43], v[40:43], v[104:107], a[40:43]
 v_mfma_f32_16x16x32_bf16 a[56:59], v[40:43], v[108:111], a[56:59]
 v_mfma_f32_16x16x32_bf16 a[12:15], v[44:47], v[96:99], a[12:15]
 v_mfma_f32_16x16x32_bf16 a[28:31], v[44:47], v[100:103], a[28:31]
 v_mfma_f32_16x16x32_bf16 a[44:47], v[44:47], v[104:107], a[44:47]
 v_mfma_f32_16x16x32_bf16 a[60:63], v[44:47], v[108:111], a[60:63]
 s_waitcnt vmcnt(8) lgkmcnt(0)
 v_mfma_f32_16x16x32_bf16 a[0:3], v[48:51], v[112:115], a[0:3]
 ds_read_b64_tr_b16 v[32:33], v246 offset:0
 v_mfma_f32_16x16x32_bf16 a[16:19], v[48:51], v[116:119], a[16:19]
 ds_read_b64_tr_b16 v[34:35], v246 offset:2048
 v_mfma_f32_16x16x32_bf16 a[32:35], v[48:51], v[120:123], a[32:35]
 ds_read_b64_tr_b16 v[36:37], v247 offset:0
 v_mfma_f32_16x16x32_bf16 a[48:51], v[48:51], v[124:127], a[48:51]
 ds_read_b64_tr_b16 v[38:39], v247 offset:2048
 v_mfma_f32_16x16x32_bf16 a[4:7], v[52:55], v[112:115], a[4:7]
 ds_read_b64_tr_b16 v[40:41], v248 offset:0
 v_mfma_f32_16x16x32_bf16 a[20:23], v[52:55], v[116:119], a[20:23]
 ds_read_b64_tr_b16 v[42:43], v248 offset:2048
 v_mfma_f32_16x16x32_bf16 a[36:39], v[52:55], v[120:123], a[36:39]
 ds_read_b64_tr_b16 v[44:45], v249 offset:0
 v_mfma_f32_16x16x32_bf16 a[52:55], v[52:55], v[124:127], a[52:55]
 ds_read_b64_tr_b16 v[46:47], v249 offset:2048
 v_mfma_f32_16x16x32_bf16 a[8:11], v[56:59], v[112:115], a[8:11]
 v_mfma_f32_16x16x32_bf16 a[24:27], v[56:59], v[116:119], a[24:27]
 v_mfma_f32_16x16x32_bf16 a[40:43], v[56:59], v[120:123], a[40:43]
 v_mfma_f32_16x16x32_bf16 a[56:59], v[56:59], v[124:127], a[56:59]
 v_mfma_f32_16x16x32_bf16 a[12:15], v[60:63], v[112:115], a[12:15]
 v_mfma_f32_16x16x32_bf16 a[28:31], v[60:63], v[116:119], a[28:31]
 v_mfma_f32_16x16x32_bf16 a[44:47], v[60:63], v[120:123], a[44:47]
 v_mfma_f32_16x16x32_bf16 a[60:63], v[60:63], v[124:127], a[60:63]
 s_waitcnt vmcnt(4) lgkmcnt(0)
 v_mfma_f32_16x16x32_bf16 a[0:3], v[32:35], v[128:131], a[0:3]
 ds_read_b64_tr_b16 v[48:49], v238 offset:32768
 v_mfma_f32_16x16x32_bf16 a[16:19], v[32:35], v[132:135], a[16:19]
 ds_read_b64_tr_b16 v[50:51], v238 offset:34816
 v_mfma_f32_16x16x32_bf16 a[32:35], v[32:35], v[136:139], a[32:35]
 ds_read_b64_tr_b16 v[52:53], v239 offset:32768
 v_mfma_f32_16x16x32_bf16 a[48:51], v[32:35], v[140:143], a[48:51]
 ds_read_b64_tr_b16 v[54:55], v239 offset:34816
 v_mfma_f32_16x16x32_bf16 a[4:7], v[36:39], v[128:131], a[4:7]
 ds_read_b64_tr_b16 v[56:57], v240 offset:32768
 v_mfma_f32_16x16x32_bf16 a[20:23], v[36:39], v[132:135], a[20:23]
 ds_read_b64_tr_b16 v[58:59], v240 offset:34816
 v_mfma_f32_16x16x32_bf16 a[36:39], v[36:39], v[136:139], a[36:39]
 ds_read_b64_tr_b16 v[60:61], v241 offset:32768
 v_mfma_f32_16x16x32_bf16 a[52:55], v[36:39], v[140:143], a[52:55]
 ds_read_b64_tr_b16 v[62:63], v241 offset:34816
 v_mfma_f32_16x16x32_bf16 a[8:11], v[40:43], v[128:131], a[8:11]
 v_mfma_f32_16x16x32_bf16 a[24:27], v[40:43], v[132:135], a[24:27]
 v_mfma_f32_16x16x32_bf16 a[40:43], v[40:43], v[136:139], a[40:43]
 v_mfma_f32_16x16x32_bf16 a[56:59], v[40:43], v[140:143], a[56:59]
 v_mfma_f32_16x16x32_bf16 a[12:15], v[44:47], v[128:131], a[12:15]
 v_mfma_f32_16x16x32_bf16 a[28:31], v[44:47], v[132:135], a[28:31]
 v_mfma_f32_16x16x32_bf16 a[44:47], v[44:47], v[136:139], a[44:47]
 v_mfma_f32_16x16x32_bf16 a[60:63], v[44:47], v[140:143], a[60:63]
 s_waitcnt vmcnt(0) lgkmcnt(0)
 v_mfma_f32_16x16x32_bf16 a[16:19], v[48:51], v[148:151], a[16:19]
 v_mfma_f32_16x16x32_bf16 a[20:23], v[52:55], v[148:151], a[20:23]
 v_mfma_f32_16x16x32_bf16 a[24:27], v[56:59], v[148:151], a[24:27]
 v_mfma_f32_16x16x32_bf16 a[28:31], v[60:63], v[148:151], a[28:31]
 v_mfma_f32_16x16x32_bf16 a[32:35], v[48:51], v[152:155], a[32:35]
 v_mfma_f32_16x16x32_bf16 a[36:39], v[52:55], v[152:155], a[36:39]
 v_mfma_f32_16x16x32_bf16 a[40:43], v[56:59], v[152:155], a[40:43]
 v_mfma_f32_16x16x32_bf16 a[44:47], v[60:63], v[152:155], a[44:47]
 v_mfma_f32_16x16x32_bf16 a[48:51], v[48:51], v[156:159], a[48:51]
 ds_write_b128 v10, a[16:19] offset:0
 v_mfma_f32_16x16x32_bf16 a[52:55], v[52:55], v[156:159], a[52:55]
 ds_write_b128 v10, a[20:23] offset:1024
 v_mfma_f32_16x16x32_bf16 a[56:59], v[56:59], v[156:159], a[56:59]
 ds_write_b128 v10, a[24:27] offset:2048
 v_mfma_f32_16x16x32_bf16 a[60:63], v[60:63], v[156:159], a[60:63]
 ds_write_b128 v10, a[28:31] offset:3072
 v_mfma_f32_16x16x32_bf16 a[0:3], v[48:51], v[144:147], a[0:3]
 ds_write_b128 v10, a[32:35] offset:16384
 v_mfma_f32_16x16x32_bf16 a[4:7], v[52:55], v[144:147], a[4:7]
 ds_write_b128 v10, a[36:39] offset:17408
 v_mfma_f32_16x16x32_bf16 a[8:11], v[56:59], v[144:147], a[8:11]
 ds_write_b128 v10, a[40:43] offset:18432
 v_mfma_f32_16x16x32_bf16 a[12:15], v[60:63], v[144:147], a[12:15]
 ds_write_b128 v10, a[44:47] offset:19456
 ds_write_b128 v10, a[48:51] offset:32768
 ds_write_b128 v10, a[52:55] offset:33792
 ds_write_b128 v10, a[56:59] offset:34816
 ds_write_b128 v10, a[60:63] offset:35840
 s_nop 0
 v_accvgpr_read_b32 v64, a0
 v_accvgpr_read_b32 v65, a1
 v_accvgpr_read_b32 v66, a2
 v_accvgpr_read_b32 v67, a3
 v_accvgpr_read_b32 v68, a4
 v_accvgpr_read_b32 v69, a5
 v_accvgpr_read_b32 v70, a6
 v_accvgpr_read_b32 v71, a7
 v_accvgpr_read_b32 v72, a8
 v_accvgpr_read_b32 v73, a9
 v_accvgpr_read_b32 v74, a10
 v_accvgpr_read_b32 v75, a11
 v_accvgpr_read_b32 v76, a12
 v_accvgpr_read_b32 v77, a13
 v_accvgpr_read_b32 v78, a14
 v_accvgpr_read_b32 v79, a15
 s_waitcnt lgkmcnt(0)
 s_barrier
 ds_read_b128 v[80:83], v13 offset:0
 ds_read_b128 v[84:87], v13 offset:1024
 ds_read_b128 v[88:91], v13 offset:2048
 ds_read_b128 v[92:95], v13 offset:3072
 ds_read_b128 v[96:99], v14 offset:16384
 ds_read_b128 v[100:103], v14 offset:17408
 ds_read_b128 v[104:107], v14 offset:18432
 ds_read_b128 v[108:111], v14 offset:19456
 ds_read_b128 v[112:115], v15 offset:32768
 ds_read_b128 v[116:119], v15 offset:33792
 ds_read_b128 v[120:123], v15 offset:34816
 ds_read_b128 v[124:127], v15 offset:35840
 s_waitcnt lgkmcnt(4)
 v_pk_add_f32 v[64:65], v[64:65], v[80:81]
 v_pk_add_f32 v[66:67], v[66:67], v[82:83]
 v_pk_add_f32 v[68:69], v[68:69], v[84:85]
 v_pk_add_f32 v[70:71], v[70:71], v[86:87]
 v_pk_add_f32 v[72:73], v[72:73], v[88:89]
 v_pk_add_f32 v[74:75], v[74:75], v[90:91]
 v_pk_add_f32 v[76:77], v[76:77], v[92:93]
 v_pk_add_f32 v[78:79], v[78:79], v[94:95]
 v_pk_add_f32 v[64:65], v[64:65], v[96:97]
 v_pk_add_f32 v[66:67], v[66:67], v[98:99]
 v_pk_add_f32 v[68:69], v[68:69], v[100:101]
 v_pk_add_f32 v[70:71], v[70:71], v[102:103]
 v_pk_add_f32 v[72:73], v[72:73], v[104:105]
 v_pk_add_f32 v[74:75], v[74:75], v[106:107]
 v_pk_add_f32 v[76:77], v[76:77], v[108:109]
 v_pk_add_f32 v[78:79], v[78:79], v[110:111]
 s_waitcnt lgkmcnt(0)
 v_pk_add_f32 v[64:65], v[64:65], v[112:113]
 v_pk_add_f32 v[66:67], v[66:67], v[114:115]
 v_pk_add_f32 v[68:69], v[68:69], v[116:117]
 v_pk_add_f32 v[70:71], v[70:71], v[118:119]
 v_pk_add_f32 v[72:73], v[72:73], v[120:121]
 v_pk_add_f32 v[74:75], v[74:75], v[122:123]
 v_pk_add_f32 v[76:77], v[76:77], v[124:125]
 v_pk_add_f32 v[78:79], v[78:79], v[126:127]
 v_cvt_pk_bf16_f32 v32, v64, v65
 v_cvt_pk_bf16_f32 v33, v66, v67
 v_cvt_pk_bf16_f32 v34, v68, v69
 v_cvt_pk_bf16_f32 v35, v70, v71
 v_cvt_pk_bf16_f32 v36, v72, v73
 v_cvt_pk_bf16_f32 v37, v74, v75
 v_cvt_pk_bf16_f32 v38, v76, v77
 v_cvt_pk_bf16_f32 v39, v78, v79
 s_nop 1
 v_permlane16_swap_b32 v32, v34
 v_permlane16_swap_b32 v33, v35
 buffer_store_dwordx4 v[32:35], v11, s[8:11], s3 offen offset:0
 v_permlane16_swap_b32 v36, v38
 v_permlane16_swap_b32 v37, v39
 buffer_store_dwordx4 v[36:39], v11, s[8:11], s3 offen offset:64
L_done:
L_end:
 s_endpgm
L_poll2:
 s_mov_b32 s49, 0
L_poll2b:
 buffer_load_dword v10, v31, s[36:39], s59 offen sc1
 s_add_u32 s49, s49, 1
 s_cmp_ge_u32 s49, 0x40000
 s_waitcnt vmcnt(0)
 v_cmp_ne_u32 vcc, v10, v232
 s_cbranch_scc1 L_go2
 s_cbranch_vccnz L_poll2b
 s_branch L_go2
L_late:
 s_waitcnt lgkmcnt(11)
 v_mfma_f32_16x16x32_bf16 v[16:19], a[240:243], a[160:163], v[136:139]
 v_accvgpr_write_b32 a0, 0
 v_accvgpr_write_b32 a1, 0
 v_mfma_f32_16x16x32_bf16 v[24:27], a[240:243], a[176:179], v[140:143]
 v_accvgpr_write_b32 a2, 0
 v_accvgpr_write_b32 a3, 0
 v_mfma_f32_16x16x32_bf16 v[32:35], a[240:243], a[192:195], v[144:147]
 v_accvgpr_write_b32 a4, 0
 v_accvgpr_write_b32 a5, 0
 v_mfma_f32_16x16x32_bf16 v[40:43], a[240:243], a[208:211], v[148:151]
 v_accvgpr_write_b32 a6, 0
 v_accvgpr_write_b32 a7, 0
 v_mfma_f32_16x16x32_bf16 v[48:51], a[240:243], a[224:227], v[152:155]
 v_accvgpr_write_b32 a8, 0
 v_accvgpr_write_b32 a9, 0
 v_mfma_f32_16x16x32_bf16 v[16:19], a[244:247], a[164:167], v[16:19]
 ds_read_b128 a[252:255], v193 offset:0
 v_accvgpr_write_b32 a10, 0
 v_accvgpr_write_b32 a11, 0
 v_mfma_f32_16x16x32_bf16 v[24:27], a[244:247], a[180:183], v[24:27]
 v_accvgpr_write_b32 a12, 0
 v_accvgpr_write_b32 a13, 0
 v_mfma_f32_16x16x32_bf16 v[32:35], a[244:247], a[196:199], v[32:35]
 v_accvgpr_write_b32 a14, 0
 v_accvgpr_write_b32 a15, 0
 v_mfma_f32_16x16x32_bf16 v[40:43], a[244:247], a[212:215], v[40:43]
 v_accvgpr_write_b32 a16, 0
 v_accvgpr_write_b32 a17, 0
 v_mfma_f32_16x16x32_bf16 v[48:51], a[244:247], a[228:231], v[48:51]
 v_accvgpr_write_b32 a18, 0
 v_accvgpr_write_b32 a19, 0
 s_waitcnt lgkmcnt(0)
 v_mfma_f32_16x16x32_bf16 v[16:19], a[248:251], a[168:171], v[16:19]
 v_accvgpr_write_b32 a20, 0
 v_accvgpr_write_b32 a21, 0
 v_mfma_f32_16x16x32_bf16 v[24:27], a[248:251], a[184:187], v[24:27]
 v_accvgpr_write_b32 a22, 0
 v_accvgpr_write_b32 a23, 0
 v_mfma_f32_16x16x32_bf16 v[32:35], a[248:251], a[200:203], v[32:35]
 v_accvgpr_write_b32 a24, 0
 v_accvgpr_write_b32 a25, 0
 v_mfma_f32_16x16x32_bf16 v[40:43], a[248:251], a[216:219], v[40:43]
 v_accvgpr_write_b32 a26, 0
 v_accvgpr_write_b32 a27, 0
 v_mfma_f32_16x16x32_bf16 v[48:51], a[248:251], a[232:235], v[48:51]
 v_accvgpr_write_b32 a28, 0
 v_accvgpr_write_b32 a29, 0
 v_mfma_f32_16x16x32_bf16 v[16:19], a[252:255], a[172:175], v[16:19]
 ds_read_b128 a[240:243], v190 offset:4096
 ds_read_b128 a[244:247], v191 offset:4096
 v_accvgpr_write_b32 a30, 0
 v_accvgpr_write_b32 a31, 0
 v_mfma_f32_16x16x32_bf16 v[24:27], a[252:255], a[188:191], v[24:27]
 v_accvgpr_write_b32 a32, 0
 v_accvgpr_write_b32 a33, 0
 v_mfma_f32_16x16x32_bf16 v[32:35], a[252:255], a[204:207], v[32:35]
 v_accvgpr_write_b32 a34, 0
 v_accvgpr_write_b32 a35, 0
 v_mfma_f32_16x16x32_bf16 v[40:43], a[252:255], a[220:223], v[40:43]
 v_accvgpr_write_b32 a36, 0
 v_accvgpr_write_b32 a37, 0
 v_mfma_f32_16x16x32_bf16 v[48:51], a[252:255], a[236:239], v[48:51]
 v_accvgpr_write_b32 a38, 0
 v_accvgpr_write_b32 a39, 0
 s_waitcnt lgkmcnt(0)
 v_mfma_f32_16x16x32_bf16 v[20:23], a[240:243], a[160:163], v[136:139]
 v_accvgpr_write_b32 a40, 0
 v_accvgpr_write_b32 a41, 0
 v_mfma_f32_16x16x32_bf16 v[28:31], a[240:243], a[176:179], v[140:143]
 v_accvgpr_write_b32 a42, 0
 v_accvgpr_write_b32 a43, 0
 v_mfma_f32_16x16x32_bf16 v[36:39], a[240:243], a[192:195], v[144:147]
 v_accvgpr_write_b32 a44, 0
 v_accvgpr_write_b32 a45, 0
 v_mfma_f32_16x16x32_bf16 v[44:47], a[240:243], a[208:211], v[148:151]
 v_accvgpr_write_b32 a46, 0
 v_accvgpr_write_b32 a47, 0
 v_mfma_f32_16x16x32_bf16 v[52:55], a[240:243], a[224:227], v[152:155]
 v_accvgpr_write_b32 a48, 0
 v_accvgpr_write_b32 a49, 0
 s_barrier
 v_mfma_f32_16x16x32_bf16 v[20:23], a[244:247], a[164:167], v[20:23]
 ds_read_b128 a[248:251], v192 offset:4096
 ds_read_b128 a[252:255], v193 offset:4096
 v_accvgpr_write_b32 a50, 0
 v_accvgpr_write_b32 a51, 0
 v_mfma_f32_16x16x32_bf16 v[28:31], a[244:247], a[180:183], v[28:31]
 v_accvgpr_write_b32 a52, 0
 v_accvgpr_write_b32 a53, 0
 v_mfma_f32_16x16x32_bf16 v[36:39], a[244:247], a[196:199], v[36:39]
 v_accvgpr_write_b32 a54, 0
 v_accvgpr_write_b32 a55, 0
 v_mfma_f32_16x16x32_bf16 v[44:47], a[244:247], a[212:215], v[44:47]
 v_accvgpr_write_b32 a56, 0
 v_accvgpr_write_b32 a57, 0
 v_mfma_f32_16x16x32_bf16 v[52:55], a[244:247], a[228:231], v[52:55]
 v_accvgpr_write_b32 a58, 0
 v_accvgpr_write_b32 a59, 0
 s_waitcnt lgkmcnt(0)
 v_mfma_f32_16x16x32_bf16 v[20:23], a[248:251], a[168:171], v[20:23]
 s_waitcnt vmcnt(2)
 s_add_u32 m0, s44, 131072
 s_mov_b32 s46, 65536
 buffer_load_dwordx4 v214, s[28:31], s46 offen offset:0 nt lds
 v_accvgpr_write_b32 a60, 0
 v_accvgpr_write_b32 a61, 0
 v_mfma_f32_16x16x32_bf16 v[28:31], a[248:251], a[184:187], v[28:31]
 v_accvgpr_write_b32 a62, 0
 v_accvgpr_write_b32 a63, 0
 v_mfma_f32_16x16x32_bf16 v[36:39], a[248:251], a[200:203], v[36:39]
 v_accvgpr_write_b32 a64, 0
 v_accvgpr_write_b32 a65, 0
 v_mfma_f32_16x16x32_bf16 v[44:47], a[248:251], a[216:219], v[44:47]
 v_accvgpr_write_b32 a66, 0
 v_accvgpr_write_b32 a67, 0
 v_mfma_f32_16x16x32_bf16 v[52:55], a[248:251], a[232:235], v[52:55]
 v_accvgpr_write_b32 a68, 0
 v_accvgpr_write_b32 a69, 0
 v_mfma_f32_16x16x32_bf16 v[20:23], a[252:255], a[172:175], v[20:23]
 v_accvgpr_write_b32 a70, 0
 v_accvgpr_write_b32 a71, 0
 v_mfma_f32_16x16x32_bf16 v[28:31], a[252:255], a[188:191], v[28:31]
 v_mfma_f32_16x16x32_bf16 v[36:39], a[252:255], a[204:207], v[36:39]
 v_mfma_f32_16x16x32_bf16 v[44:47], a[252:255], a[220:223], v[44:47]
 s_waitcnt vmcnt(2)
 v_mfma_f32_16x16x32_bf16 v[52:55], a[252:255], a[236:239], v[52:55]
 buffer_load_dwordx4 v215, s[28:31], s46 offen offset:1024 nt lds
 s_nop 1
 v_max3_f32 v220, v16, v17, v18
 v_max3_f32 v220, v220, v19, v20
 v_max3_f32 v220, v220, v21, v22
 v_max_f32 v220, v220, v23
 v_max3_f32 v221, v24, v25, v26
 v_max3_f32 v221, v221, v27, v28
 v_max3_f32 v221, v221, v29, v30
 v_max_f32 v221, v221, v31
 v_max3_f32 v222, v32, v33, v34
 v_max3_f32 v222, v222, v35, v36
 v_max3_f32 v222, v222, v37, v38
 v_max_f32 v222, v222, v39
 v_max3_f32 v223, v40, v41, v42
 v_max3_f32 v223, v223, v43, v44
 v_max3_f32 v223, v223, v45, v46
 v_max_f32 v223, v223, v47
 v_max3_f32 v224, v48, v49, v50
 v_max3_f32 v224, v224, v51, v52
 v_max3_f32 v224, v224, v53, v54
 v_max_f32 v224, v224, v55
 v_mov_b32 v225, v220
 v_mov_b32 v226, v221
 v_mov_b32 v227, v222
 v_mov_b32 v228, v223
 v_mov_b32 v229, v224
 s_nop 0
 v_permlane16_swap_b32 v220, v225
 v_permlane16_swap_b32 v221, v226
 v_permlane16_swap_b32 v222, v227
 v_permlane16_swap_b32 v223, v228
 v_permlane16_swap_b32 v224, v229
 v_max_f32 v220, v220, v225
 v_max_f32 v221, v221, v226
 v_max_f32 v222, v222, v227
 v_max_f32 v223, v223, v228
 v_max_f32 v224, v224, v229
 v_mov_b32 v225, v220
 v_mov_b32 v226, v221
 v_mov_b32 v227, v222
 v_mov_b32 v228, v223
 v_mov_b32 v229, v224
 s_nop 0
 v_permlane32_swap_b32 v220, v225
 v_permlane32_swap_b32 v221, v226
 v_permlane32_swap_b32 v222, v227
 v_permlane32_swap_b32 v223, v228
 v_permlane32_swap_b32 v224, v229
 v_max_f32 v220, v220, v225
 v_max_f32 v221, v221, v226
 v_max_f32 v222, v222, v227
 v_max_f32 v223, v223, v228
 v_max_f32 v224, v224, v229
 v_sub_f32 v136, 0xc1300000, v220
 v_mov_b32 v137, v136
 v_mov_b32 v138, v136
 v_mov_b32 v139, v136
 v_pk_add_f32 v[16:17], v[16:17], v[136:137]
 v_pk_add_f32 v[18:19], v[18:19], v[136:137]
 v_pk_add_f32 v[20:21], v[20:21], v[136:137]
 v_pk_add_f32 v[22:23], v[22:23], v[136:137]
 v_sub_f32 v140, 0xc1300000, v221
 v_mov_b32 v141, v140
 v_mov_b32 v142, v140
 v_mov_b32 v143, v140
 v_pk_add_f32 v[24:25], v[24:25], v[140:141]
 v_pk_add_f32 v[26:27], v[26:27], v[140:141]
 v_pk_add_f32 v[28:29], v[28:29], v[140:141]
 v_pk_add_f32 v[30:31], v[30:31], v[140:141]
 v_sub_f32 v144, 0xc1300000, v222
 v_mov_b32 v145, v144
 v_mov_b32 v146, v144
 v_mov_b32 v147, v144
 v_pk_add_f32 v[32:33], v[32:33], v[144:145]
 v_pk_add_f32 v[34:35], v[34:35], v[144:145]
 v_pk_add_f32 v[36:37], v[36:37], v[144:145]
 v_pk_add_f32 v[38:39], v[38:39], v[144:145]
 v_sub_f32 v148, 0xc1300000, v223
 v_mov_b32 v149, v148
 v_mov_b32 v150, v148
 v_mov_b32 v151, v148
 v_pk_add_f32 v[40:41], v[40:41], v[148:149]
 v_pk_add_f32 v[42:43], v[42:43], v[148:149]
 v_pk_add_f32 v[44:45], v[44:45], v[148:149]
 v_pk_add_f32 v[46:47], v[46:47], v[148:149]
 v_sub_f32 v152, 0xc1300000, v224
 v_mov_b32 v153, v152
 v_mov_b32 v154, v152
 v_mov_b32 v155, v152
 v_pk_add_f32 v[48:49], v[48:49], v[152:153]
 v_pk_add_f32 v[50:51], v[50:51], v[152:153]
 v_pk_add_f32 v[52:53], v[52:53], v[152:153]
 v_pk_add_f32 v[54:55], v[54:55], v[152:153]
 v_exp_f32 v176, v16
 v_exp_f32 v177, v17
 v_exp_f32 v178, v18
 v_cvt_pk_bf16_f32 v96, v176, v177
 v_exp_f32 v179, v19
 v_exp_f32 v180, v20
 v_exp_f32 v181, v21
 v_cvt_pk_bf16_f32 v97, v178, v179
 v_cvt_pk_bf16_f32 v98, v180, v181
 v_exp_f32 v182, v22
 s_waitcnt vmcnt(1)
 v_or3_b32 v188, v96, v97, v98
 buffer_load_dwordx4 v216, s[28:31], s46 offen offset:2048 nt lds
 v_exp_f32 v183, v23
 v_exp_f32 v176, v24
 v_cvt_pk_bf16_f32 v99, v182, v183
 v_exp_f32 v177, v25
 v_exp_f32 v178, v26
 v_cvt_pk_bf16_f32 v100, v176, v177
 v_or3_b32 v188, v188, v99, v100
 v_exp_f32 v179, v27
 v_exp_f32 v180, v28
 v_cvt_pk_bf16_f32 v101, v178, v179
 v_exp_f32 v181, v29
 v_exp_f32 v182, v30
 v_cvt_pk_bf16_f32 v102, v180, v181
 s_waitcnt vmcnt(1)
 v_or3_b32 v188, v188, v101, v102
 buffer_load_dwordx4 v217, s[28:31], s46 offen offset:3072 nt lds
 v_exp_f32 v183, v31
 v_exp_f32 v176, v32
 v_cvt_pk_bf16_f32 v103, v182, v183
 ds_read_b128 a[240:243], v190 offset:16384
 v_exp_f32 v177, v33
 v_exp_f32 v178, v34
 v_cvt_pk_bf16_f32 v104, v176, v177
 v_or3_b32 v188, v188, v103, v104
 v_exp_f32 v179, v35
 ds_read_b128 a[244:247], v191 offset:16384
 v_cvt_pk_bf16_f32 v105, v178, v179
 s_waitcnt vmcnt(1)
 v_exp_f32 v180, v36
 s_add_u32 m0, s44, 81920
 s_mov_b32 s46, 49152
 buffer_load_dwordx4 v218, s[32:35], s46 offen offset:0 nt lds
 v_exp_f32 v181, v37
 ds_read_b128 a[248:251], v192 offset:16384
 v_cvt_pk_bf16_f32 v106, v180, v181
 v_exp_f32 v182, v38
 v_exp_f32 v183, v39
 v_exp_f32 v176, v40
 ds_read_b128 a[252:255], v193 offset:16384
 s_waitcnt lgkmcnt(2)
 v_mfma_f32_16x16x32_bf16 v[56:59], a[240:243], a[160:163], v[136:139]
 v_exp_f32 v177, v41
 v_mfma_f32_16x16x32_bf16 v[64:67], a[240:243], a[176:179], v[140:143]
 v_cvt_pk_bf16_f32 v107, v182, v183
 v_cvt_pk_bf16_f32 v108, v176, v177
 v_mfma_f32_16x16x32_bf16 v[72:75], a[240:243], a[192:195], v[144:147]
 v_exp_f32 v178, v42
 v_mfma_f32_16x16x32_bf16 v[80:83], a[240:243], a[208:211], v[148:151]
 s_waitcnt vmcnt(1)
 v_or3_b32 v188, v188, v105, v106
 v_mfma_f32_16x16x32_bf16 v[88:91], a[240:243], a[224:227], v[152:155]
 buffer_load_dwordx4 v219, s[32:35], s46 offen offset:1024 nt lds
 v_mfma_f32_16x16x32_bf16 v[56:59], a[244:247], a[164:167], v[56:59]
 ds_read_b128 a[240:243], v190 offset:20480
 v_or3_b32 v188, v188, v107, v108
 v_mfma_f32_16x16x32_bf16 v[64:67], a[244:247], a[180:183], v[64:67]
 v_exp_f32 v179, v43
 v_mfma_f32_16x16x32_bf16 v[72:75], a[244:247], a[196:199], v[72:75]
 v_exp_f32 v180, v44
 v_mfma_f32_16x16x32_bf16 v[80:83], a[244:247], a[212:215], v[80:83]
 v_exp_f32 v181, v45
 v_mfma_f32_16x16x32_bf16 v[88:91], a[244:247], a[228:231], v[88:91]
 ds_read_b128 a[244:247], v191 offset:20480
 s_waitcnt lgkmcnt(2)
 v_mfma_f32_16x16x32_bf16 v[56:59], a[248:251], a[168:171], v[56:59]
 v_exp_f32 v182, v46
 v_mfma_f32_16x16x32_bf16 v[64:67], a[248:251], a[184:187], v[64:67]
 v_cvt_pk_bf16_f32 v109, v178, v179
 v_cvt_pk_bf16_f32 v110, v180, v181
 v_mfma_f32_16x16x32_bf16 v[72:75], a[248:251], a[200:203], v[72:75]
 v_exp_f32 v183, v47
 v_mfma_f32_16x16x32_bf16 v[80:83], a[248:251], a[216:219], v[80:83]
 v_exp_f32 v176, v48
 v_mfma_f32_16x16x32_bf16 v[88:91], a[248:251], a[232:235], v[88:91]
 ds_read_b128 a[248:251], v192 offset:20480
 v_cvt_pk_bf16_f32 v111, v182, v183
 v_mfma_f32_16x16x32_bf16 v[56:59], a[252:255], a[172:175], v[56:59]
 v_exp_f32 v177, v49
 v_mfma_f32_16x16x32_bf16 v[64:67], a[252:255], a[188:191], v[64:67]
 s_waitcnt vmcnt(1)
 v_cvt_pk_bf16_f32 v112, v176, v177
 v_mfma_f32_16x16x32_bf16 v[72:75], a[252:255], a[204:207], v[72:75]
 buffer_load_dwordx4 v218, s[32:35], s46 offen offset:2048 nt lds
 v_mfma_f32_16x16x32_bf16 v[80:83], a[252:255], a[220:223], v[80:83]
 v_exp_f32 v178, v50
 v_mfma_f32_16x16x32_bf16 v[88:91], a[252:255], a[236:239], v[88:91]
 ds_read_b128 a[252:255], v193 offset:20480
 s_waitcnt lgkmcnt(2)
 v_mfma_f32_16x16x32_bf16 v[60:63], a[240:243], a[160:163], v[136:139]
 v_exp_f32 v179, v51
 v_mfma_f32_16x16x32_bf16 v[68:71], a[240:243], a[176:179], v[140:143]
 v_exp_f32 v180, v52
 v_mfma_f32_16x16x32_bf16 v[76:79], a[240:243], a[192:195], v[144:147]
 v_cvt_pk_bf16_f32 v113, v178, v179
 v_or3_b32 v188, v188, v109, v110
 v_mfma_f32_16x16x32_bf16 v[84:87], a[240:243], a[208:211], v[148:151]
 v_exp_f32 v181, v53
 v_mfma_f32_16x16x32_bf16 v[92:95], a[240:243], a[224:227], v[152:155]
 v_cvt_pk_bf16_f32 v114, v180, v181
 s_barrier
 v_mfma_f32_16x16x32_bf16 v[60:63], a[244:247], a[164:167], v[60:63]
 v_exp_f32 v182, v54
 v_mfma_f32_16x16x32_bf16 v[68:71], a[244:247], a[180:183], v[68:71]
 ds_read_b64_tr_b16 a[240:241], v198 offset:0
 ds_read_b64_tr_b16 a[242:243], v198 offset:4096
 v_mfma_f32_16x16x32_bf16 v[76:79], a[244:247], a[196:199], v[76:79]
 v_exp_f32 v183, v55
 v_mfma_f32_16x16x32_bf16 v[84:87], a[244:247], a[212:215], v[84:87]
 v_cvt_pk_bf16_f32 v115, v182, v183
 s_waitcnt vmcnt(1)
 v_mfma_f32_16x16x32_bf16 v[92:95], a[244:247], a[228:231], v[92:95]
 ds_read_b64_tr_b16 a[244:245], v199 offset:0
 s_waitcnt lgkmcnt(3)
 v_mfma_f32_16x16x32_bf16 v[60:63], a[248:251], a[168:171], v[60:63]
 buffer_load_dwordx4 v219, s[32:35], s46 offen offset:3072 nt lds
 v_mfma_f32_16x16x32_bf16 v[68:71], a[248:251], a[184:187], v[68:71]
 ds_read_b64_tr_b16 a[246:247], v199 offset:4096
 v_or3_b32 v188, v188, v111, v112
 v_mfma_f32_16x16x32_bf16 v[76:79], a[248:251], a[200:203], v[76:79]
 v_or3_b32 v188, v188, v113, v114
 v_bitop3_b32 v188, v188, v115, s45 bitop3:0xa8
 v_mfma_f32_16x16x32_bf16 v[84:87], a[248:251], a[216:219], v[84:87]
 v_cmp_ne_u32 vcc, 0, v188
 v_mfma_f32_16x16x32_bf16 v[92:95], a[248:251], a[232:235], v[92:95]
 ds_read_b64_tr_b16 a[248:249], v200 offset:0
 ds_read_b64_tr_b16 a[250:251], v200 offset:4096
 v_mfma_f32_16x16x32_bf16 v[60:63], a[252:255], a[172:175], v[60:63]
 v_mfma_f32_16x16x32_bf16 v[68:71], a[252:255], a[188:191], v[68:71]
 v_mfma_f32_16x16x32_bf16 v[76:79], a[252:255], a[204:207], v[76:79]
 v_mfma_f32_16x16x32_bf16 v[84:87], a[252:255], a[220:223], v[84:87]
 v_mfma_f32_16x16x32_bf16 v[92:95], a[252:255], a[236:239], v[92:95]
 s_waitcnt vmcnt(1)
 s_cbranch_vccnz L_rareb1
L_rareb1_back:
 v_mfma_f32_16x16x32_bf16 v[156:159], v[184:187], v[96:99], v[156:159]
 s_add_u32 m0, s44, 0
 s_mov_b32 s46, 81920
 v_mfma_f32_16x16x32_bf16 v[160:163], v[184:187], v[100:103], v[160:163]
 buffer_load_dwordx4 v214, s[28:31], s46 offen offset:0 nt lds
 v_mfma_f32_16x16x32_bf16 v[164:167], v[184:187], v[104:107], v[164:167]
 v_exp_f32 v176, v56
 v_mfma_f32_16x16x32_bf16 v[168:171], v[184:187], v[108:111], v[168:171]
 v_exp_f32 v177, v57
 v_mfma_f32_16x16x32_bf16 v[172:175], v[184:187], v[112:115], v[172:175]
 ds_read_b64_tr_b16 a[252:253], v201 offset:0
 s_waitcnt lgkmcnt(3)
 v_mfma_f32_16x16x32_bf16 a[0:3], a[240:243], v[96:99], a[0:3]
 ds_read_b64_tr_b16 a[254:255], v201 offset:4096
 v_cvt_pk_bf16_f32 v116, v176, v177
 v_mfma_f32_16x16x32_bf16 a[4:7], a[240:243], v[100:103], a[4:7]
 v_exp_f32 v178, v58
 v_mfma_f32_16x16x32_bf16 a[8:11], a[240:243], v[104:107], a[8:11]
 v_exp_f32 v179, v59
 v_mfma_f32_16x16x32_bf16 a[12:15], a[240:243], v[108:111], a[12:15]
 v_exp_f32 v180, v60
 v_mfma_f32_16x16x32_bf16 a[16:19], a[240:243], v[112:115], a[16:19]
 v_exp_f32 v181, v61
 v_mfma_f32_16x16x32_bf16 a[20:23], a[244:247], v[96:99], a[20:23]
 ds_read_b64_tr_b16 a[240:241], v202 offset:0
 ds_read_b64_tr_b16 a[242:243], v202 offset:4096
 v_mfma_f32_16x16x32_bf16 a[24:27], a[244:247], v[100:103], a[24:27]
 v_exp_f32 v182, v62
 v_mfma_f32_16x16x32_bf16 a[28:31], a[244:247], v[104:107], a[28:31]
 v_exp_f32 v183, v63
 v_mfma_f32_16x16x32_bf16 a[32:35], a[244:247], v[108:111], a[32:35]
 v_exp_f32 v176, v64
 v_mfma_f32_16x16x32_bf16 a[36:39], a[244:247], v[112:115], a[36:39]
 v_cvt_pk_bf16_f32 v117, v178, v179
 s_waitcnt lgkmcnt(2)
 v_mfma_f32_16x16x32_bf16 a[40:43], a[248:251], v[96:99], a[40:43]
 s_waitcnt vmcnt(1)
 buffer_load_dwordx4 v215, s[28:31], s46 offen offset:1024 nt lds
 v_mfma_f32_16x16x32_bf16 a[44:47], a[248:251], v[100:103], a[44:47]
 ds_read_b64_tr_b16 a[244:245], v203 offset:0
 ds_read_b64_tr_b16 a[246:247], v203 offset:4096
 v_mfma_f32_16x16x32_bf16 a[48:51], a[248:251], v[104:107], a[48:51]
 v_exp_f32 v177, v65
 v_mfma_f32_16x16x32_bf16 a[52:55], a[248:251], v[108:111], a[52:55]
 v_exp_f32 v178, v66
 v_mfma_f32_16x16x32_bf16 a[56:59], a[248:251], v[112:115], a[56:59]
 v_cvt_pk_bf16_f32 v118, v180, v181
 ds_read_b64_tr_b16 a[248:249], v204 offset:0
 v_mfma_f32_16x16x32_bf16 a[60:63], a[252:255], v[96:99], a[60:63]
 ds_read_b64_tr_b16 a[250:251], v204 offset:4096
 v_cvt_pk_bf16_f32 v119, v182, v183
 v_mfma_f32_16x16x32_bf16 a[64:67], a[252:255], v[100:103], a[64:67]
 v_exp_f32 v179, v67
 v_mfma_f32_16x16x32_bf16 a[68:71], a[252:255], v[104:107], a[68:71]
 v_exp_f32 v180, v68
 v_mfma_f32_16x16x32_bf16 a[72:75], a[252:255], v[108:111], a[72:75]
 v_exp_f32 v181, v69
 v_mfma_f32_16x16x32_bf16 a[76:79], a[252:255], v[112:115], a[76:79]
 ds_read_b64_tr_b16 a[252:253], v205 offset:0
 s_waitcnt lgkmcnt(3)
 v_mfma_f32_16x16x32_bf16 a[80:83], a[240:243], v[96:99], a[80:83]
 ds_read_b64_tr_b16 a[254:255], v205 offset:4096
 s_waitcnt vmcnt(1)
 v_mfma_f32_16x16x32_bf16 a[84:87], a[240:243], v[100:103], a[84:87]
 buffer_load_dwordx4 v216, s[28:31], s46 offen offset:2048 nt lds
 v_mfma_f32_16x16x32_bf16 a[88:91], a[240:243], v[104:107], a[88:91]
 v_exp_f32 v182, v70
 v_mfma_f32_16x16x32_bf16 a[92:95], a[240:243], v[108:111], a[92:95]
 v_cvt_pk_bf16_f32 v120, v176, v177
 v_cvt_pk_bf16_f32 v121, v178, v179
 v_mfma_f32_16x16x32_bf16 a[96:99], a[240:243], v[112:115], a[96:99]
 v_exp_f32 v183, v71
 v_mfma_f32_16x16x32_bf16 a[100:103], a[244:247], v[96:99], a[100:103]
 ds_read_b128 a[240:243], v190 offset:32768
 v_cvt_pk_bf16_f32 v122, v180, v181
 v_mfma_f32_16x16x32_bf16 a[104:107], a[244:247], v[100:103], a[104:107]
 v_exp_f32 v176, v72
 v_mfma_f32_16x16x32_bf16 a[108:111], a[244:247], v[104:107], a[108:111]
 v_exp_f32 v177, v73
 v_mfma_f32_16x16x32_bf16 a[112:115], a[244:247], v[108:111], a[112:115]
 v_exp_f32 v178, v74
 v_mfma_f32_16x16x32_bf16 a[116:119], a[244:247], v[112:115], a[116:119]
 ds_read_b128 a[244:247], v191 offset:32768
 s_waitcnt lgkmcnt(2)
 v_mfma_f32_16x16x32_bf16 a[120:123], a[248:251], v[96:99], a[120:123]
 v_exp_f32 v179, v75
 v_mfma_f32_16x16x32_bf16 a[124:127], a[248:251], v[100:103], a[124:127]
 v_exp_f32 v180, v76
 v_mfma_f32_16x16x32_bf16 a[128:131], a[248:251], v[104:107], a[128:131]
 v_cvt_pk_bf16_f32 v123, v182, v183
 s_waitcnt vmcnt(1)
 v_mfma_f32_16x16x32_bf16 a[132:135], a[248:251], v[108:111], a[132:135]
 buffer_load_dwordx4 v217, s[28:31], s46 offen offset:3072 nt lds
 v_mfma_f32_16x16x32_bf16 a[136:139], a[248:251], v[112:115], a[136:139]
 v_exp_f32 v181, v77
 v_mfma_f32_16x16x32_bf16 a[140:143], a[252:255], v[96:99], a[140:143]
 ds_read_b128 a[248:251], v192 offset:32768
 v_cvt_pk_bf16_f32 v124, v176, v177
 v_mfma_f32_16x16x32_bf16 a[144:147], a[252:255], v[100:103], a[144:147]
 v_exp_f32 v182, v78
 v_mfma_f32_16x16x32_bf16 a[148:151], a[252:255], v[104:107], a[148:151]
 v_exp_f32 v183, v79
 v_mfma_f32_16x16x32_bf16 a[152:155], a[252:255], v[108:111], a[152:155]
 v_exp_f32 v176, v80
 v_mfma_f32_16x16x32_bf16 a[156:159], a[252:255], v[112:115], a[156:159]
 v_cvt_pk_bf16_f32 v125, v178, v179
 s_waitcnt lgkmcnt(1)
 v_mfma_f32_16x16x32_bf16 v[16:19], a[240:243], a[160:163], v[136:139]
 ds_read_b128 a[252:255], v193 offset:32768
 v_cvt_pk_bf16_f32 v126, v180, v181
 v_mfma_f32_16x16x32_bf16 v[24:27], a[240:243], a[176:179], v[140:143]
 v_exp_f32 v177, v81
 v_mfma_f32_16x16x32_bf16 v[32:35], a[240:243], a[192:195], v[144:147]
 v_exp_f32 v178, v82
 v_mfma_f32_16x16x32_bf16 v[40:43], a[240:243], a[208:211], v[148:151]
 v_cvt_pk_bf16_f32 v127, v182, v183
 v_cvt_pk_bf16_f32 v128, v176, v177
 v_mfma_f32_16x16x32_bf16 v[48:51], a[240:243], a[224:227], v[152:155]
 v_exp_f32 v179, v83
 v_mfma_f32_16x16x32_bf16 v[16:19], a[244:247], a[164:167], v[16:19]
 ds_read_b128 a[240:243], v190 offset:36864
 s_waitcnt vmcnt(1)
 v_mfma_f32_16x16x32_bf16 v[24:27], a[244:247], a[180:183], v[24:27]
 s_add_u32 m0, s44, 114688
 s_mov_b32 s46, 65536
 buffer_load_dwordx4 v218, s[32:35], s46 offen offset:0 nt lds
 v_mfma_f32_16x16x32_bf16 v[32:35], a[244:247], a[196:199], v[32:35]
 v_exp_f32 v180, v84
 v_mfma_f32_16x16x32_bf16 v[40:43], a[244:247], a[212:215], v[40:43]
 v_exp_f32 v181, v85
 v_mfma_f32_16x16x32_bf16 v[48:51], a[244:247], a[228:231], v[48:51]
 ds_read_b128 a[244:247], v191 offset:36864
 s_waitcnt lgkmcnt(2)
 v_mfma_f32_16x16x32_bf16 v[16:19], a[248:251], a[168:171], v[16:19]
 v_exp_f32 v182, v86
 v_mfma_f32_16x16x32_bf16 v[24:27], a[248:251], a[184:187], v[24:27]
 v_cvt_pk_bf16_f32 v129, v178, v179
 v_cvt_pk_bf16_f32 v130, v180, v181
 v_mfma_f32_16x16x32_bf16 v[32:35], a[248:251], a[200:203], v[32:35]
 v_exp_f32 v183, v87
 v_mfma_f32_16x16x32_bf16 v[40:43], a[248:251], a[216:219], v[40:43]
 v_exp_f32 v176, v88
 v_mfma_f32_16x16x32_bf16 v[48:51], a[248:251], a[232:235], v[48:51]
 ds_read_b128 a[248:251], v192 offset:36864
 v_cvt_pk_bf16_f32 v131, v182, v183
 v_mfma_f32_16x16x32_bf16 v[16:19], a[252:255], a[172:175], v[16:19]
 v_exp_f32 v177, v89
 v_mfma_f32_16x16x32_bf16 v[24:27], a[252:255], a[188:191], v[24:27]
 v_cvt_pk_bf16_f32 v132, v176, v177
 s_waitcnt vmcnt(1)
 v_mfma_f32_16x16x32_bf16 v[32:35], a[252:255], a[204:207], v[32:35]
 buffer_load_dwordx4 v219, s[32:35], s46 offen offset:1024 nt lds
 v_mfma_f32_16x16x32_bf16 v[40:43], a[252:255], a[220:223], v[40:43]
 v_exp_f32 v178, v90
 v_mfma_f32_16x16x32_bf16 v[48:51], a[252:255], a[236:239], v[48:51]
 ds_read_b128 a[252:255], v193 offset:36864
 s_waitcnt lgkmcnt(2)
 v_mfma_f32_16x16x32_bf16 v[20:23], a[240:243], a[160:163], v[136:139]
 v_exp_f32 v179, v91
 v_mfma_f32_16x16x32_bf16 v[28:31], a[240:243], a[176:179], v[140:143]
 v_exp_f32 v180, v92
 v_mfma_f32_16x16x32_bf16 v[36:39], a[240:243], a[192:195], v[144:147]
 v_cvt_pk_bf16_f32 v133, v178, v179
 v_or3_b32 v188, v116, v117, v118
 v_mfma_f32_16x16x32_bf16 v[44:47], a[240:243], a[208:211], v[148:151]
 v_exp_f32 v181, v93
 v_mfma_f32_16x16x32_bf16 v[52:55], a[240:243], a[224:227], v[152:155]
 v_cvt_pk_bf16_f32 v134, v180, v181
 s_barrier
 v_mfma_f32_16x16x32_bf16 v[20:23], a[244:247], a[164:167], v[20:23]
 v_exp_f32 v182, v94
 v_mfma_f32_16x16x32_bf16 v[28:31], a[244:247], a[180:183], v[28:31]
 ds_read_b64_tr_b16 a[240:241], v198 offset:32768
 ds_read_b64_tr_b16 a[242:243], v198 offset:36864
 v_mfma_f32_16x16x32_bf16 v[36:39], a[244:247], a[196:199], v[36:39]
 v_exp_f32 v183, v95
 v_mfma_f32_16x16x32_bf16 v[44:47], a[244:247], a[212:215], v[44:47]
 v_cvt_pk_bf16_f32 v135, v182, v183
 v_or3_b32 v188, v188, v119, v120
 v_mfma_f32_16x16x32_bf16 v[52:55], a[244:247], a[228:231], v[52:55]
 ds_read_b64_tr_b16 a[244:245], v199 offset:32768
 s_waitcnt lgkmcnt(3)
 v_mfma_f32_16x16x32_bf16 v[20:23], a[248:251], a[168:171], v[20:23]
 ds_read_b64_tr_b16 a[246:247], v199 offset:36864
 s_waitcnt vmcnt(1)
 v_mfma_f32_16x16x32_bf16 v[28:31], a[248:251], a[184:187], v[28:31]
 buffer_load_dwordx4 v218, s[32:35], s46 offen offset:2048 nt lds
 v_mfma_f32_16x16x32_bf16 v[36:39], a[248:251], a[200:203], v[36:39]
 v_or3_b32 v188, v188, v121, v122
 v_or3_b32 v188, v188, v123, v124
 v_mfma_f32_16x16x32_bf16 v[44:47], a[248:251], a[216:219], v[44:47]
 v_or3_b32 v188, v188, v125, v126
 v_or3_b32 v188, v188, v127, v128
 v_mfma_f32_16x16x32_bf16 v[52:55], a[248:251], a[232:235], v[52:55]
 ds_read_b64_tr_b16 a[248:249], v200 offset:32768
 ds_read_b64_tr_b16 a[250:251], v200 offset:36864
 v_mfma_f32_16x16x32_bf16 v[20:23], a[252:255], a[172:175], v[20:23]
 v_or3_b32 v188, v188, v129, v130
 v_or3_b32 v188, v188, v131, v132
 v_mfma_f32_16x16x32_bf16 v[28:31], a[252:255], a[188:191], v[28:31]
 v_or3_b32 v188, v188, v133, v134
 v_bitop3_b32 v188, v188, v135, s45 bitop3:0xa8
 v_mfma_f32_16x16x32_bf16 v[36:39], a[252:255], a[204:207], v[36:39]
 v_cmp_ne_u32 vcc, 0, v188
 v_mfma_f32_16x16x32_bf16 v[44:47], a[252:255], a[220:223], v[44:47]
 v_mfma_f32_16x16x32_bf16 v[52:55], a[252:255], a[236:239], v[52:55]
 s_waitcnt vmcnt(1)
 s_cbranch_vccnz L_rareb2
L_rareb2_back:
 v_mfma_f32_16x16x32_bf16 v[156:159], v[184:187], v[116:119], v[156:159]
 buffer_load_dwordx4 v219, s[32:35], s46 offen offset:3072 nt lds
 v_mfma_f32_16x16x32_bf16 v[160:163], v[184:187], v[120:123], v[160:163]
 v_exp_f32 v176, v16
 v_mfma_f32_16x16x32_bf16 v[164:167], v[184:187], v[124:127], v[164:167]
 v_exp_f32 v177, v17
 v_mfma_f32_16x16x32_bf16 v[168:171], v[184:187], v[128:131], v[168:171]
 v_exp_f32 v178, v18
 v_mfma_f32_16x16x32_bf16 v[172:175], v[184:187], v[132:135], v[172:175]
 ds_read_b64_tr_b16 a[252:253], v201 offset:32768
 s_waitcnt lgkmcnt(3)
 v_mfma_f32_16x16x32_bf16 a[0:3], a[240:243], v[116:119], a[0:3]
 ds_read_b64_tr_b16 a[254:255], v201 offset:36864
 v_cvt_pk_bf16_f32 v96, v176, v177
 v_mfma_f32_16x16x32_bf16 a[4:7], a[240:243], v[120:123], a[4:7]
 v_exp_f32 v179, v19
 v_mfma_f32_16x16x32_bf16 a[8:11], a[240:243], v[124:127], a[8:11]
 v_exp_f32 v180, v20
 v_mfma_f32_16x16x32_bf16 a[12:15], a[240:243], v[128:131], a[12:15]
 v_exp_f32 v181, v21
 v_mfma_f32_16x16x32_bf16 a[16:19], a[240:243], v[132:135], a[16:19]
 v_exp_f32 v182, v22
 v_mfma_f32_16x16x32_bf16 a[20:23], a[244:247], v[116:119], a[20:23]
 ds_read_b64_tr_b16 a[240:241], v202 offset:32768
 ds_read_b64_tr_b16 a[242:243], v202 offset:36864
 v_mfma_f32_16x16x32_bf16 a[24:27], a[244:247], v[120:123], a[24:27]
 v_exp_f32 v183, v23
 v_mfma_f32_16x16x32_bf16 a[28:31], a[244:247], v[124:127], a[28:31]
 v_cvt_pk_bf16_f32 v97, v178, v179
 v_cvt_pk_bf16_f32 v98, v180, v181
 v_mfma_f32_16x16x32_bf16 a[32:35], a[244:247], v[128:131], a[32:35]
 v_exp_f32 v176, v24
 v_mfma_f32_16x16x32_bf16 a[36:39], a[244:247], v[132:135], a[36:39]
 ds_read_b64_tr_b16 a[244:245], v203 offset:32768
 s_waitcnt lgkmcnt(3)
 v_mfma_f32_16x16x32_bf16 a[40:43], a[248:251], v[116:119], a[40:43]
 s_waitcnt vmcnt(1)
 s_add_u32 m0, s44, 16384
 s_mov_b32 s46, 98304
 buffer_load_dwordx4 v214, s[28:31], s46 offen offset:0 nt lds
 v_mfma_f32_16x16x32_bf16 a[44:47], a[248:251], v[120:123], a[44:47]
 ds_read_b64_tr_b16 a[246:247], v203 offset:36864
 v_cvt_pk_bf16_f32 v99, v182, v183
 v_mfma_f32_16x16x32_bf16 a[48:51], a[248:251], v[124:127], a[48:51]
 v_exp_f32 v177, v25
 v_mfma_f32_16x16x32_bf16 a[52:55], a[248:251], v[128:131], a[52:55]
 v_exp_f32 v178, v26
 v_mfma_f32_16x16x32_bf16 a[56:59], a[248:251], v[132:135], a[56:59]
 v_exp_f32 v179, v27
 v_mfma_f32_16x16x32_bf16 a[60:63], a[252:255], v[116:119], a[60:63]
 ds_read_b64_tr_b16 a[248:249], v204 offset:32768
 ds_read_b64_tr_b16 a[250:251], v204 offset:36864
 v_mfma_f32_16x16x32_bf16 a[64:67], a[252:255], v[120:123], a[64:67]
 v_exp_f32 v180, v28
 v_mfma_f32_16x16x32_bf16 a[68:71], a[252:255], v[124:127], a[68:71]
 v_exp_f32 v181, v29
 v_mfma_f32_16x16x32_bf16 a[72:75], a[252:255], v[128:131], a[72:75]
 v_cvt_pk_bf16_f32 v100, v176, v177
 v_cvt_pk_bf16_f32 v101, v178, v179
 v_mfma_f32_16x16x32_bf16 a[76:79], a[252:255], v[132:135], a[76:79]
 ds_read_b64_tr_b16 a[252:253], v205 offset:32768
 s_waitcnt lgkmcnt(3)
 v_mfma_f32_16x16x32_bf16 a[80:83], a[240:243], v[116:119], a[80:83]
 ds_read_b64_tr_b16 a[254:255], v205 offset:36864
 s_waitcnt vmcnt(1)
 v_mfma_f32_16x16x32_bf16 a[84:87], a[240:243], v[120:123], a[84:87]
 buffer_load_dwordx4 v215, s[28:31], s46 offen offset:1024 nt lds
 v_mfma_f32_16x16x32_bf16 a[88:91], a[240:243], v[124:127], a[88:91]
 v_exp_f32 v182, v30
 v_mfma_f32_16x16x32_bf16 a[92:95], a[240:243], v[128:131], a[92:95]
 v_exp_f32 v183, v31
 v_mfma_f32_16x16x32_bf16 a[96:99], a[240:243], v[132:135], a[96:99]
 v_exp_f32 v176, v32
 v_mfma_f32_16x16x32_bf16 a[100:103], a[244:247], v[116:119], a[100:103]
 ds_read_b128 a[240:243], v190 offset:49152
 v_cvt_pk_bf16_f32 v102, v180, v181
 v_mfma_f32_16x16x32_bf16 a[104:107], a[244:247], v[120:123], a[104:107]
 v_exp_f32 v177, v33
 v_mfma_f32_16x16x32_bf16 a[108:111], a[244:247], v[124:127], a[108:111]
 v_exp_f32 v178, v34
 v_mfma_f32_16x16x32_bf16 a[112:115], a[244:247], v[128:131], a[112:115]
 v_cvt_pk_bf16_f32 v103, v182, v183
 v_cvt_pk_bf16_f32 v104, v176, v177
 v_mfma_f32_16x16x32_bf16 a[116:119], a[244:247], v[132:135], a[116:119]
 ds_read_b128 a[244:247], v191 offset:49152
 s_waitcnt lgkmcnt(2)
 v_mfma_f32_16x16x32_bf16 a[120:123], a[248:251], v[116:119], a[120:123]
 v_exp_f32 v179, v35
 v_mfma_f32_16x16x32_bf16 a[124:127], a[248:251], v[120:123], a[124:127]
 v_exp_f32 v180, v36
 v_mfma_f32_16x16x32_bf16 a[128:131], a[248:251], v[124:127], a[128:131]
 v_cvt_pk_bf16_f32 v105, v178, v179
 s_waitcnt vmcnt(1)
 v_mfma_f32_16x16x32_bf16 a[132:135], a[248:251], v[128:131], a[132:135]
 buffer_load_dwordx4 v216, s[28:31], s46 offen offset:2048 nt lds
 v_mfma_f32_16x16x32_bf16 a[136:139], a[248:251], v[132:135], a[136:139]
 v_exp_f32 v181, v37
 v_mfma_f32_16x16x32_bf16 a[140:143], a[252:255], v[116:119], a[140:143]
 ds_read_b128 a[248:251], v192 offset:49152
 v_cvt_pk_bf16_f32 v106, v180, v181
 v_mfma_f32_16x16x32_bf16 a[144:147], a[252:255], v[120:123], a[144:147]
 v_exp_f32 v182, v38
 v_mfma_f32_16x16x32_bf16 a[148:151], a[252:255], v[124:127], a[148:151]
 v_exp_f32 v183, v39
 v_mfma_f32_16x16x32_bf16 a[152:155], a[252:255], v[128:131], a[152:155]
 v_exp_f32 v176, v40
 v_mfma_f32_16x16x32_bf16 a[156:159], a[252:255], v[132:135], a[156:159]
 ds_read_b128 a[252:255], v193 offset:49152
 s_waitcnt lgkmcnt(2)
 v_mfma_f32_16x16x32_bf16 v[56:59], a[240:243], a[160:163], v[136:139]
 v_exp_f32 v177, v41
 v_mfma_f32_16x16x32_bf16 v[64:67], a[240:243], a[176:179], v[140:143]
 v_cvt_pk_bf16_f32 v107, v182, v183
 v_cvt_pk_bf16_f32 v108, v176, v177
 v_mfma_f32_16x16x32_bf16 v[72:75], a[240:243], a[192:195], v[144:147]
 v_exp_f32 v178, v42
 v_mfma_f32_16x16x32_bf16 v[80:83], a[240:243], a[208:211], v[148:151]
 v_or3_b32 v188, v96, v97, v98
 v_mfma_f32_16x16x32_bf16 v[88:91], a[240:243], a[224:227], v[152:155]
 buffer_load_dwordx4 v217, s[28:31], s46 offen offset:3072 nt lds
 v_mfma_f32_16x16x32_bf16 v[56:59], a[244:247], a[164:167], v[56:59]
 ds_read_b128 a[240:243], v190 offset:53248
 v_or3_b32 v188, v188, v99, v100
 v_mfma_f32_16x16x32_bf16 v[64:67], a[244:247], a[180:183], v[64:67]
 v_exp_f32 v179, v43
 v_mfma_f32_16x16x32_bf16 v[72:75], a[244:247], a[196:199], v[72:75]
 v_exp_f32 v180, v44
 v_mfma_f32_16x16x32_bf16 v[80:83], a[244:247], a[212:215], v[80:83]
 v_exp_f32 v181, v45
 v_mfma_f32_16x16x32_bf16 v[88:91], a[244:247], a[228:231], v[88:91]
 ds_read_b128 a[244:247], v191 offset:53248
 s_waitcnt lgkmcnt(2)
 v_mfma_f32_16x16x32_bf16 v[56:59], a[248:251], a[168:171], v[56:59]
 v_exp_f32 v182, v46
 v_mfma_f32_16x16x32_bf16 v[64:67], a[248:251], a[184:187], v[64:67]
 v_cvt_pk_bf16_f32 v109, v178, v179
 v_cvt_pk_bf16_f32 v110, v180, v181
 v_mfma_f32_16x16x32_bf16 v[72:75], a[248:251], a[200:203], v[72:75]
 v_exp_f32 v183, v47
 v_mfma_f32_16x16x32_bf16 v[80:83], a[248:251], a[216:219], v[80:83]
 v_exp_f32 v176, v48
 v_mfma_f32_16x16x32_bf16 v[88:91], a[248:251], a[232:235], v[88:91]
 ds_read_b128 a[248:251], v192 offset:53248
 v_cvt_pk_bf16_f32 v111, v182, v183
 v_mfma_f32_16x16x32_bf16 v[56:59], a[252:255], a[172:175], v[56:59]
 v_exp_f32 v177, v49
 v_mfma_f32_16x16x32_bf16 v[64:67], a[252:255], a[188:191], v[64:67]
 v_cvt_pk_bf16_f32 v112, v176, v177
 s_waitcnt vmcnt(2)
 v_mfma_f32_16x16x32_bf16 v[72:75], a[252:255], a[204:207], v[72:75]
 s_add_u32 m0, s44, 65536
 s_mov_b32 s46, 81920
 v_mfma_f32_16x16x32_bf16 v[80:83], a[252:255], a[220:223], v[80:83]
 buffer_load_dwordx4 v218, s[32:35], s46 offen offset:0 nt lds
 v_mfma_f32_16x16x32_bf16 v[88:91], a[252:255], a[236:239], v[88:91]
 ds_read_b128 a[252:255], v193 offset:53248
 s_waitcnt lgkmcnt(2)
 v_mfma_f32_16x16x32_bf16 v[60:63], a[240:243], a[160:163], v[136:139]
 v_exp_f32 v178, v50
 v_mfma_f32_16x16x32_bf16 v[68:71], a[240:243], a[176:179], v[140:143]
 v_exp_f32 v179, v51
 v_mfma_f32_16x16x32_bf16 v[76:79], a[240:243], a[192:195], v[144:147]
 v_exp_f32 v180, v52
 v_mfma_f32_16x16x32_bf16 v[84:87], a[240:243], a[208:211], v[148:151]
 v_exp_f32 v181, v53
 v_mfma_f32_16x16x32_bf16 v[92:95], a[240:243], a[224:227], v[152:155]
 v_cvt_pk_bf16_f32 v113, v178, v179
 s_barrier
 v_mfma_f32_16x16x32_bf16 v[60:63], a[244:247], a[164:167], v[60:63]
 v_exp_f32 v182, v54
 v_mfma_f32_16x16x32_bf16 v[68:71], a[244:247], a[180:183], v[68:71]
 ds_read_b64_tr_b16 a[240:241], v206 offset:0
 ds_read_b64_tr_b16 a[242:243], v206 offset:4096
 v_mfma_f32_16x16x32_bf16 v[76:79], a[244:247], a[196:199], v[76:79]
 v_exp_f32 v183, v55
 v_mfma_f32_16x16x32_bf16 v[84:87], a[244:247], a[212:215], v[84:87]
 v_cvt_pk_bf16_f32 v114, v180, v181
 v_cvt_pk_bf16_f32 v115, v182, v183
 v_mfma_f32_16x16x32_bf16 v[92:95], a[244:247], a[228:231], v[92:95]
 ds_read_b64_tr_b16 a[244:245], v207 offset:0
 s_waitcnt lgkmcnt(3)
 v_mfma_f32_16x16x32_bf16 v[60:63], a[248:251], a[168:171], v[60:63]
 ds_read_b64_tr_b16 a[246:247], v207 offset:4096
 s_waitcnt vmcnt(2)
 v_mfma_f32_16x16x32_bf16 v[68:71], a[248:251], a[184:187], v[68:71]
 buffer_load_dwordx4 v219, s[32:35], s46 offen offset:1024 nt lds
 v_mfma_f32_16x16x32_bf16 v[76:79], a[248:251], a[200:203], v[76:79]
 v_or3_b32 v188, v188, v101, v102
 v_or3_b32 v188, v188, v103, v104
 v_mfma_f32_16x16x32_bf16 v[84:87], a[248:251], a[216:219], v[84:87]
 v_or3_b32 v188, v188, v105, v106
 v_or3_b32 v188, v188, v107, v108
 v_mfma_f32_16x16x32_bf16 v[92:95], a[248:251], a[232:235], v[92:95]
 ds_read_b64_tr_b16 a[248:249], v208 offset:0
 ds_read_b64_tr_b16 a[250:251], v208 offset:4096
 v_mfma_f32_16x16x32_bf16 v[60:63], a[252:255], a[172:175], v[60:63]
 v_or3_b32 v188, v188, v109, v110
 v_or3_b32 v188, v188, v111, v112
 v_mfma_f32_16x16x32_bf16 v[68:71], a[252:255], a[188:191], v[68:71]
 v_or3_b32 v188, v188, v113, v114
 v_bitop3_b32 v188, v188, v115, s45 bitop3:0xa8
 v_mfma_f32_16x16x32_bf16 v[76:79], a[252:255], a[204:207], v[76:79]
 v_cmp_ne_u32 vcc, 0, v188
 v_mfma_f32_16x16x32_bf16 v[84:87], a[252:255], a[220:223], v[84:87]
 v_mfma_f32_16x16x32_bf16 v[92:95], a[252:255], a[236:239], v[92:95]
 s_waitcnt vmcnt(2)
 s_cbranch_vccnz L_rareb3
L_rareb3_back:
 v_mfma_f32_16x16x32_bf16 v[156:159], v[184:187], v[96:99], v[156:159]
 buffer_load_dwordx4 v218, s[32:35], s46 offen offset:2048 nt lds
 v_mfma_f32_16x16x32_bf16 v[160:163], v[184:187], v[100:103], v[160:163]
 v_exp_f32 v176, v56
 v_mfma_f32_16x16x32_bf16 v[164:167], v[184:187], v[104:107], v[164:167]
 v_exp_f32 v177, v57
 v_mfma_f32_16x16x32_bf16 v[168:171], v[184:187], v[108:111], v[168:171]
 v_exp_f32 v178, v58
 v_mfma_f32_16x16x32_bf16 v[172:175], v[184:187], v[112:115], v[172:175]
 ds_read_b64_tr_b16 a[252:253], v209 offset:0
 s_waitcnt lgkmcnt(3)
 v_mfma_f32_16x16x32_bf16 a[0:3], a[240:243], v[96:99], a[0:3]
 ds_read_b64_tr_b16 a[254:255], v209 offset:4096
 v_cvt_pk_bf16_f32 v116, v176, v177
 v_mfma_f32_16x16x32_bf16 a[4:7], a[240:243], v[100:103], a[4:7]
 v_exp_f32 v179, v59
 v_mfma_f32_16x16x32_bf16 a[8:11], a[240:243], v[104:107], a[8:11]
 v_exp_f32 v180, v60
 v_mfma_f32_16x16x32_bf16 a[12:15], a[240:243], v[108:111], a[12:15]
 v_exp_f32 v181, v61
 v_mfma_f32_16x16x32_bf16 a[16:19], a[240:243], v[112:115], a[16:19]
 v_exp_f32 v182, v62
 v_mfma_f32_16x16x32_bf16 a[20:23], a[244:247], v[96:99], a[20:23]
 ds_read_b64_tr_b16 a[240:241], v210 offset:0
 ds_read_b64_tr_b16 a[242:243], v210 offset:4096
 v_mfma_f32_16x16x32_bf16 a[24:27], a[244:247], v[100:103], a[24:27]
 v_exp_f32 v183, v63
 v_mfma_f32_16x16x32_bf16 a[28:31], a[244:247], v[104:107], a[28:31]
 v_cvt_pk_bf16_f32 v117, v178, v179
 v_cvt_pk_bf16_f32 v118, v180, v181
 v_mfma_f32_16x16x32_bf16 a[32:35], a[244:247], v[108:111], a[32:35]
 v_exp_f32 v176, v64
 v_mfma_f32_16x16x32_bf16 a[36:39], a[244:247], v[112:115], a[36:39]
 ds_read_b64_tr_b16 a[244:245], v211 offset:0
 s_waitcnt lgkmcnt(3)
 v_mfma_f32_16x16x32_bf16 a[40:43], a[248:251], v[96:99], a[40:43]
 ds_read_b64_tr_b16 a[246:247], v211 offset:4096
 s_waitcnt vmcnt(2)
 v_mfma_f32_16x16x32_bf16 a[44:47], a[248:251], v[100:103], a[44:47]
 buffer_load_dwordx4 v219, s[32:35], s46 offen offset:3072 nt lds
 v_mfma_f32_16x16x32_bf16 a[48:51], a[248:251], v[104:107], a[48:51]
 v_exp_f32 v177, v65
 v_mfma_f32_16x16x32_bf16 a[52:55], a[248:251], v[108:111], a[52:55]
 v_exp_f32 v178, v66
 v_mfma_f32_16x16x32_bf16 a[56:59], a[248:251], v[112:115], a[56:59]
 v_exp_f32 v179, v67
 v_mfma_f32_16x16x32_bf16 a[60:63], a[252:255], v[96:99], a[60:63]
 ds_read_b64_tr_b16 a[248:249], v212 offset:0
 ds_read_b64_tr_b16 a[250:251], v212 offset:4096
 v_mfma_f32_16x16x32_bf16 a[64:67], a[252:255], v[100:103], a[64:67]
 v_exp_f32 v180, v68
 v_mfma_f32_16x16x32_bf16 a[68:71], a[252:255], v[104:107], a[68:71]
 v_cvt_pk_bf16_f32 v119, v182, v183
 v_cvt_pk_bf16_f32 v120, v176, v177
 v_mfma_f32_16x16x32_bf16 a[72:75], a[252:255], v[108:111], a[72:75]
 v_exp_f32 v181, v69
 v_mfma_f32_16x16x32_bf16 a[76:79], a[252:255], v[112:115], a[76:79]
 ds_read_b64_tr_b16 a[252:253], v213 offset:0
 s_waitcnt lgkmcnt(3)
 v_mfma_f32_16x16x32_bf16 a[80:83], a[240:243], v[96:99], a[80:83]
 ds_read_b64_tr_b16 a[254:255], v213 offset:4096
 v_cvt_pk_bf16_f32 v121, v178, v179
 v_mfma_f32_16x16x32_bf16 a[84:87], a[240:243], v[100:103], a[84:87]
 v_exp_f32 v182, v70
 v_mfma_f32_16x16x32_bf16 a[88:91], a[240:243], v[104:107], a[88:91]
 v_exp_f32 v183, v71
 v_mfma_f32_16x16x32_bf16 a[92:95], a[240:243], v[108:111], a[92:95]
 s_waitcnt vmcnt(2)
 s_add_u32 m0, s44, 32768
 s_mov_b32 s46, 114688
 buffer_load_dwordx4 v214, s[28:31], s46 offen offset:0 nt lds
 v_mfma_f32_16x16x32_bf16 a[96:99], a[240:243], v[112:115], a[96:99]
 v_exp_f32 v176, v72
 v_mfma_f32_16x16x32_bf16 a[100:103], a[244:247], v[96:99], a[100:103]
 ds_read_b128 a[240:243], v194 offset:0
 v_cvt_pk_bf16_f32 v122, v180, v181
 v_mfma_f32_16x16x32_bf16 a[104:107], a[244:247], v[100:103], a[104:107]
 v_exp_f32 v177, v73
 v_mfma_f32_16x16x32_bf16 a[108:111], a[244:247], v[104:107], a[108:111]
 v_exp_f32 v178, v74
 v_mfma_f32_16x16x32_bf16 a[112:115], a[244:247], v[108:111], a[112:115]
 v_cvt_pk_bf16_f32 v123, v182, v183
 v_cvt_pk_bf16_f32 v124, v176, v177
 v_mfma_f32_16x16x32_bf16 a[116:119], a[244:247], v[112:115], a[116:119]
 ds_read_b128 a[244:247], v195 offset:0
 s_waitcnt lgkmcnt(2)
 v_mfma_f32_16x16x32_bf16 a[120:123], a[248:251], v[96:99], a[120:123]
 v_exp_f32 v179, v75
 v_mfma_f32_16x16x32_bf16 a[124:127], a[248:251], v[100:103], a[124:127]
 v_exp_f32 v180, v76
 v_mfma_f32_16x16x32_bf16 a[128:131], a[248:251], v[104:107], a[128:131]
 v_cvt_pk_bf16_f32 v125, v178, v179
 s_waitcnt vmcnt(2)
 v_mfma_f32_16x16x32_bf16 a[132:135], a[248:251], v[108:111], a[132:135]
 buffer_load_dwordx4 v215, s[28:31], s46 offen offset:1024 nt lds
 v_mfma_f32_16x16x32_bf16 a[136:139], a[248:251], v[112:115], a[136:139]
 v_exp_f32 v181, v77
 v_mfma_f32_16x16x32_bf16 a[140:143], a[252:255], v[96:99], a[140:143]
 ds_read_b128 a[248:251], v196 offset:0
 v_cvt_pk_bf16_f32 v126, v180, v181
 v_mfma_f32_16x16x32_bf16 a[144:147], a[252:255], v[100:103], a[144:147]
 v_exp_f32 v182, v78
 v_mfma_f32_16x16x32_bf16 a[148:151], a[252:255], v[104:107], a[148:151]
 v_exp_f32 v183, v79
 v_mfma_f32_16x16x32_bf16 a[152:155], a[252:255], v[108:111], a[152:155]
 v_exp_f32 v176, v80
 v_mfma_f32_16x16x32_bf16 a[156:159], a[252:255], v[112:115], a[156:159]
 ds_read_b128 a[252:255], v197 offset:0
 s_waitcnt lgkmcnt(2)
 v_mfma_f32_16x16x32_bf16 v[16:19], a[240:243], a[160:163], v[136:139]
 v_exp_f32 v177, v81
 v_mfma_f32_16x16x32_bf16 v[24:27], a[240:243], a[176:179], v[140:143]
 v_cvt_pk_bf16_f32 v127, v182, v183
 v_cvt_pk_bf16_f32 v128, v176, v177
 v_mfma_f32_16x16x32_bf16 v[32:35], a[240:243], a[192:195], v[144:147]
 v_exp_f32 v178, v82
 v_mfma_f32_16x16x32_bf16 v[40:43], a[240:243], a[208:211], v[148:151]
 s_waitcnt vmcnt(2)
 v_or3_b32 v188, v116, v117, v118
 v_mfma_f32_16x16x32_bf16 v[48:51], a[240:243], a[224:227], v[152:155]
 buffer_load_dwordx4 v216, s[28:31], s46 offen offset:2048 nt lds
 v_mfma_f32_16x16x32_bf16 v[16:19], a[244:247], a[164:167], v[16:19]
 ds_read_b128 a[240:243], v194 offset:4096
 v_or3_b32 v188, v188, v119, v120
 v_mfma_f32_16x16x32_bf16 v[24:27], a[244:247], a[180:183], v[24:27]
 v_exp_f32 v179, v83
 v_mfma_f32_16x16x32_bf16 v[32:35], a[244:247], a[196:199], v[32:35]
 v_exp_f32 v180, v84
 v_mfma_f32_16x16x32_bf16 v[40:43], a[244:247], a[212:215], v[40:43]
 v_exp_f32 v181, v85
 v_mfma_f32_16x16x32_bf16 v[48:51], a[244:247], a[228:231], v[48:51]
 ds_read_b128 a[244:247], v195 offset:4096
 s_waitcnt lgkmcnt(2)
 v_mfma_f32_16x16x32_bf16 v[16:19], a[248:251], a[168:171], v[16:19]
 v_exp_f32 v182, v86
 v_mfma_f32_16x16x32_bf16 v[24:27], a[248:251], a[184:187], v[24:27]
 v_cvt_pk_bf16_f32 v129, v178, v179
 v_cvt_pk_bf16_f32 v130, v180, v181
 v_mfma_f32_16x16x32_bf16 v[32:35], a[248:251], a[200:203], v[32:35]
 v_exp_f32 v183, v87
 v_mfma_f32_16x16x32_bf16 v[40:43], a[248:251], a[216:219], v[40:43]
 v_exp_f32 v176, v88
 v_mfma_f32_16x16x32_bf16 v[48:51], a[248:251], a[232:235], v[48:51]
 ds_read_b128 a[248:251], v196 offset:4096
 v_cvt_pk_bf16_f32 v131, v182, v183
 v_mfma_f32_16x16x32_bf16 v[16:19], a[252:255], a[172:175], v[16:19]
 v_exp_f32 v177, v89
 v_mfma_f32_16x16x32_bf16 v[24:27], a[252:255], a[188:191], v[24:27]
 v_cvt_pk_bf16_f32 v132, v176, v177
 s_waitcnt vmcnt(2)
 v_mfma_f32_16x16x32_bf16 v[32:35], a[252:255], a[204:207], v[32:35]
 buffer_load_dwordx4 v217, s[28:31], s46 offen offset:3072 nt lds
 v_mfma_f32_16x16x32_bf16 v[40:43], a[252:255], a[220:223], v[40:43]
 v_exp_f32 v178, v90
 v_mfma_f32_16x16x32_bf16 v[48:51], a[252:255], a[236:239], v[48:51]
 ds_read_b128 a[252:255], v197 offset:4096
 s_waitcnt lgkmcnt(2)
 v_mfma_f32_16x16x32_bf16 v[20:23], a[240:243], a[160:163], v[136:139]
 v_exp_f32 v179, v91
 v_mfma_f32_16x16x32_bf16 v[28:31], a[240:243], a[176:179], v[140:143]
 v_exp_f32 v180, v92
 v_mfma_f32_16x16x32_bf16 v[36:39], a[240:243], a[192:195], v[144:147]
 v_cvt_pk_bf16_f32 v133, v178, v179
 v_or3_b32 v188, v188, v121, v122
 v_mfma_f32_16x16x32_bf16 v[44:47], a[240:243], a[208:211], v[148:151]
 v_exp_f32 v181, v93
 v_mfma_f32_16x16x32_bf16 v[52:55], a[240:243], a[224:227], v[152:155]
 v_cvt_pk_bf16_f32 v134, v180, v181
 s_barrier
 v_mfma_f32_16x16x32_bf16 v[20:23], a[244:247], a[164:167], v[20:23]
 v_exp_f32 v182, v94
 v_mfma_f32_16x16x32_bf16 v[28:31], a[244:247], a[180:183], v[28:31]
 ds_read_b64_tr_b16 a[240:241], v198 offset:16384
 ds_read_b64_tr_b16 a[242:243], v198 offset:20480
 v_mfma_f32_16x16x32_bf16 v[36:39], a[244:247], a[196:199], v[36:39]
 v_exp_f32 v183, v95
 v_mfma_f32_16x16x32_bf16 v[44:47], a[244:247], a[212:215], v[44:47]
 v_cvt_pk_bf16_f32 v135, v182, v183
 v_or3_b32 v188, v188, v123, v124
 v_mfma_f32_16x16x32_bf16 v[52:55], a[244:247], a[228:231], v[52:55]
 ds_read_b64_tr_b16 a[244:245], v199 offset:16384
 s_waitcnt lgkmcnt(3)
 v_mfma_f32_16x16x32_bf16 v[20:23], a[248:251], a[168:171], v[20:23]
 ds_read_b64_tr_b16 a[246:247], v199 offset:20480
 s_waitcnt vmcnt(2)
 v_mfma_f32_16x16x32_bf16 v[28:31], a[248:251], a[184:187], v[28:31]
 s_add_u32 m0, s44, 98304
 s_mov_b32 s46, 98304
 v_mfma_f32_16x16x32_bf16 v[36:39], a[248:251], a[200:203], v[36:39]
 buffer_load_dwordx4 v218, s[32:35], s46 offen offset:0 nt lds
 v_mfma_f32_16x16x32_bf16 v[44:47], a[248:251], a[216:219], v[44:47]
 v_or3_b32 v188, v188, v125, v126
 v_or3_b32 v188, v188, v127, v128
 v_mfma_f32_16x16x32_bf16 v[52:55], a[248:251], a[232:235], v[52:55]
 ds_read_b64_tr_b16 a[248:249], v200 offset:16384
 ds_read_b64_tr_b16 a[250:251], v200 offset:20480
 v_mfma_f32_16x16x32_bf16 v[20:23], a[252:255], a[172:175], v[20:23]
 v_or3_b32 v188, v188, v129, v130
 v_or3_b32 v188, v188, v131, v132
 v_mfma_f32_16x16x32_bf16 v[28:31], a[252:255], a[188:191], v[28:31]
 v_or3_b32 v188, v188, v133, v134
 v_bitop3_b32 v188, v188, v135, s45 bitop3:0xa8
 v_mfma_f32_16x16x32_bf16 v[36:39], a[252:255], a[204:207], v[36:39]
 v_cmp_ne_u32 vcc, 0, v188
 v_mfma_f32_16x16x32_bf16 v[44:47], a[252:255], a[220:223], v[44:47]
 v_mfma_f32_16x16x32_bf16 v[52:55], a[252:255], a[236:239], v[52:55]
 s_cbranch_vccnz L_rareb4
L_rareb4_back:
 v_mfma_f32_16x16x32_bf16 v[156:159], v[184:187], v[116:119], v[156:159]
 s_waitcnt vmcnt(2)
 v_mfma_f32_16x16x32_bf16 v[160:163], v[184:187], v[120:123], v[160:163]
 buffer_load_dwordx4 v219, s[32:35], s46 offen offset:1024 nt lds
 v_mfma_f32_16x16x32_bf16 v[164:167], v[184:187], v[124:127], v[164:167]
 v_exp_f32 v176, v16
 v_mfma_f32_16x16x32_bf16 v[168:171], v[184:187], v[128:131], v[168:171]
 v_exp_f32 v177, v17
 v_mfma_f32_16x16x32_bf16 v[172:175], v[184:187], v[132:135], v[172:175]
 ds_read_b64_tr_b16 a[252:253], v201 offset:16384
 s_waitcnt lgkmcnt(3)
 v_mfma_f32_16x16x32_bf16 a[0:3], a[240:243], v[116:119], a[0:3]
 ds_read_b64_tr_b16 a[254:255], v201 offset:20480
 v_cvt_pk_bf16_f32 v96, v176, v177
 v_mfma_f32_16x16x32_bf16 a[4:7], a[240:243], v[120:123], a[4:7]
 v_exp_f32 v178, v18
 v_mfma_f32_16x16x32_bf16 a[8:11], a[240:243], v[124:127], a[8:11]
 v_exp_f32 v179, v19
 v_mfma_f32_16x16x32_bf16 a[12:15], a[240:243], v[128:131], a[12:15]
 v_exp_f32 v180, v20
 v_mfma_f32_16x16x32_bf16 a[16:19], a[240:243], v[132:135], a[16:19]
 v_exp_f32 v181, v21
 v_mfma_f32_16x16x32_bf16 a[20:23], a[244:247], v[116:119], a[20:23]
 ds_read_b64_tr_b16 a[240:241], v202 offset:16384
 ds_read_b64_tr_b16 a[242:243], v202 offset:20480
 v_mfma_f32_16x16x32_bf16 a[24:27], a[244:247], v[120:123], a[24:27]
 v_exp_f32 v182, v22
 v_mfma_f32_16x16x32_bf16 a[28:31], a[244:247], v[124:127], a[28:31]
 v_exp_f32 v183, v23
 v_mfma_f32_16x16x32_bf16 a[32:35], a[244:247], v[128:131], a[32:35]
 v_exp_f32 v176, v24
 v_mfma_f32_16x16x32_bf16 a[36:39], a[244:247], v[132:135], a[36:39]
 v_cvt_pk_bf16_f32 v97, v178, v179
 s_waitcnt lgkmcnt(2)
 v_mfma_f32_16x16x32_bf16 a[40:43], a[248:251], v[116:119], a[40:43]
 ds_read_b64_tr_b16 a[244:245], v203 offset:16384
 ds_read_b64_tr_b16 a[246:247], v203 offset:20480
 v_mfma_f32_16x16x32_bf16 a[44:47], a[248:251], v[120:123], a[44:47]
 s_waitcnt vmcnt(2)
 buffer_load_dwordx4 v218, s[32:35], s46 offen offset:2048 nt lds
 v_mfma_f32_16x16x32_bf16 a[48:51], a[248:251], v[124:127], a[48:51]
 v_exp_f32 v177, v25
 v_mfma_f32_16x16x32_bf16 a[52:55], a[248:251], v[128:131], a[52:55]
 v_exp_f32 v178, v26
 v_mfma_f32_16x16x32_bf16 a[56:59], a[248:251], v[132:135], a[56:59]
 v_cvt_pk_bf16_f32 v98, v180, v181
 ds_read_b64_tr_b16 a[248:249], v204 offset:16384
 v_mfma_f32_16x16x32_bf16 a[60:63], a[252:255], v[116:119], a[60:63]
 ds_read_b64_tr_b16 a[250:251], v204 offset:20480
 v_cvt_pk_bf16_f32 v99, v182, v183
 v_mfma_f32_16x16x32_bf16 a[64:67], a[252:255], v[120:123], a[64:67]
 v_exp_f32 v179, v27
 v_mfma_f32_16x16x32_bf16 a[68:71], a[252:255], v[124:127], a[68:71]
 v_exp_f32 v180, v28
 v_mfma_f32_16x16x32_bf16 a[72:75], a[252:255], v[128:131], a[72:75]
 v_exp_f32 v181, v29
 v_mfma_f32_16x16x32_bf16 a[76:79], a[252:255], v[132:135], a[76:79]
 ds_read_b64_tr_b16 a[252:253], v205 offset:16384
 s_waitcnt lgkmcnt(3)
 v_mfma_f32_16x16x32_bf16 a[80:83], a[240:243], v[116:119], a[80:83]
 ds_read_b64_tr_b16 a[254:255], v205 offset:20480
 v_cvt_pk_bf16_f32 v100, v176, v177
 v_mfma_f32_16x16x32_bf16 a[84:87], a[240:243], v[120:123], a[84:87]
 v_exp_f32 v182, v30
 v_mfma_f32_16x16x32_bf16 a[88:91], a[240:243], v[124:127], a[88:91]
 v_exp_f32 v183, v31
 v_mfma_f32_16x16x32_bf16 a[92:95], a[240:243], v[128:131], a[92:95]
 s_waitcnt vmcnt(2)
 buffer_load_dwordx4 v219, s[32:35], s46 offen offset:3072 nt lds
 v_mfma_f32_16x16x32_bf16 a[96:99], a[240:243], v[132:135], a[96:99]
 v_exp_f32 v176, v32
 v_mfma_f32_16x16x32_bf16 a[100:103], a[244:247], v[116:119], a[100:103]
 v_cvt_pk_bf16_f32 v101, v178, v179
 ds_read_b128 a[240:243], v190 offset:0
 v_mfma_f32_16x16x32_bf16 a[104:107], a[244:247], v[120:123], a[104:107]
 v_exp_f32 v177, v33
 v_mfma_f32_16x16x32_bf16 a[108:111], a[244:247], v[124:127], a[108:111]
 v_exp_f32 v178, v34
 v_mfma_f32_16x16x32_bf16 a[112:115], a[244:247], v[128:131], a[112:115]
 v_cvt_pk_bf16_f32 v102, v180, v181
 v_cvt_pk_bf16_f32 v103, v182, v183
 v_mfma_f32_16x16x32_bf16 a[116:119], a[244:247], v[132:135], a[116:119]
 ds_read_b128 a[244:247], v191 offset:0
 s_waitcnt lgkmcnt(2)
 v_mfma_f32_16x16x32_bf16 a[120:123], a[248:251], v[116:119], a[120:123]
 v_exp_f32 v179, v35
 v_mfma_f32_16x16x32_bf16 a[124:127], a[248:251], v[120:123], a[124:127]
 v_exp_f32 v180, v36
 v_mfma_f32_16x16x32_bf16 a[128:131], a[248:251], v[124:127], a[128:131]
 v_cvt_pk_bf16_f32 v104, v176, v177
 v_cvt_pk_bf16_f32 v105, v178, v179
 v_mfma_f32_16x16x32_bf16 a[132:135], a[248:251], v[128:131], a[132:135]
 v_exp_f32 v181, v37
 v_mfma_f32_16x16x32_bf16 a[136:139], a[248:251], v[132:135], a[136:139]
 v_exp_f32 v182, v38
 v_mfma_f32_16x16x32_bf16 a[140:143], a[252:255], v[116:119], a[140:143]
 s_waitcnt vmcnt(2)
 s_add_u32 m0, s44, 49152
 s_mov_b32 s46, 131072
 buffer_load_dwordx4 v214, s[28:31], s46 offen offset:0 nt lds
 v_mfma_f32_16x16x32_bf16 a[144:147], a[252:255], v[120:123], a[144:147]
 ds_read_b128 a[248:251], v192 offset:0
 v_cvt_pk_bf16_f32 v106, v180, v181
 v_mfma_f32_16x16x32_bf16 a[148:151], a[252:255], v[124:127], a[148:151]
 v_exp_f32 v183, v39
 v_mfma_f32_16x16x32_bf16 a[152:155], a[252:255], v[128:131], a[152:155]
 v_exp_f32 v176, v40
 v_mfma_f32_16x16x32_bf16 a[156:159], a[252:255], v[132:135], a[156:159]
 ds_read_b128 a[252:255], v193 offset:0
 s_waitcnt lgkmcnt(2)
 v_mfma_f32_16x16x32_bf16 v[56:59], a[240:243], a[160:163], v[136:139]
 v_exp_f32 v177, v41
 v_mfma_f32_16x16x32_bf16 v[64:67], a[240:243], a[176:179], v[140:143]
 v_cvt_pk_bf16_f32 v107, v182, v183
 v_cvt_pk_bf16_f32 v108, v176, v177
 v_mfma_f32_16x16x32_bf16 v[72:75], a[240:243], a[192:195], v[144:147]
 v_exp_f32 v178, v42
 v_mfma_f32_16x16x32_bf16 v[80:83], a[240:243], a[208:211], v[148:151]
 v_or3_b32 v188, v96, v97, v98
 v_or3_b32 v188, v188, v99, v100
 v_mfma_f32_16x16x32_bf16 v[88:91], a[240:243], a[224:227], v[152:155]
 v_exp_f32 v179, v43
 v_mfma_f32_16x16x32_bf16 v[56:59], a[244:247], a[164:167], v[56:59]
 ds_read_b128 a[240:243], v190 offset:4096
 v_cvt_pk_bf16_f32 v109, v178, v179
 v_mfma_f32_16x16x32_bf16 v[64:67], a[244:247], a[180:183], v[64:67]
 v_exp_f32 v180, v44
 v_mfma_f32_16x16x32_bf16 v[72:75], a[244:247], a[196:199], v[72:75]
 v_or3_b32 v188, v188, v101, v102
 v_mfma_f32_16x16x32_bf16 v[80:83], a[244:247], a[212:215], v[80:83]
 buffer_load_dwordx4 v215, s[28:31], s46 offen offset:1024 nt lds
 v_mfma_f32_16x16x32_bf16 v[88:91], a[244:247], a[228:231], v[88:91]
 ds_read_b128 a[244:247], v191 offset:4096
 s_waitcnt lgkmcnt(2)
 v_mfma_f32_16x16x32_bf16 v[56:59], a[248:251], a[168:171], v[56:59]
 v_exp_f32 v181, v45
 v_mfma_f32_16x16x32_bf16 v[64:67], a[248:251], a[184:187], v[64:67]
 v_exp_f32 v182, v46
 v_mfma_f32_16x16x32_bf16 v[72:75], a[248:251], a[200:203], v[72:75]
 v_exp_f32 v183, v47
 v_mfma_f32_16x16x32_bf16 v[80:83], a[248:251], a[216:219], v[80:83]
 v_exp_f32 v176, v48
 v_mfma_f32_16x16x32_bf16 v[88:91], a[248:251], a[232:235], v[88:91]
 ds_read_b128 a[248:251], v192 offset:4096
 v_cvt_pk_bf16_f32 v110, v180, v181
 v_mfma_f32_16x16x32_bf16 v[56:59], a[252:255], a[172:175], v[56:59]
 v_exp_f32 v177, v49
 v_mfma_f32_16x16x32_bf16 v[64:67], a[252:255], a[188:191], v[64:67]
 v_cvt_pk_bf16_f32 v111, v182, v183
 v_cvt_pk_bf16_f32 v112, v176, v177
 v_mfma_f32_16x16x32_bf16 v[72:75], a[252:255], a[204:207], v[72:75]
 v_exp_f32 v178, v50
 v_mfma_f32_16x16x32_bf16 v[80:83], a[252:255], a[220:223], v[80:83]
 v_or3_b32 v188, v188, v103, v104
 v_mfma_f32_16x16x32_bf16 v[88:91], a[252:255], a[236:239], v[88:91]
 ds_read_b128 a[252:255], v193 offset:4096
 s_waitcnt lgkmcnt(2)
 v_mfma_f32_16x16x32_bf16 v[60:63], a[240:243], a[160:163], v[136:139]
 buffer_load_dwordx4 v216, s[28:31], s46 offen offset:2048 nt lds
 v_mfma_f32_16x16x32_bf16 v[68:71], a[240:243], a[176:179], v[140:143]
 v_exp_f32 v179, v51
 v_mfma_f32_16x16x32_bf16 v[76:79], a[240:243], a[192:195], v[144:147]
 v_exp_f32 v180, v52
 v_mfma_f32_16x16x32_bf16 v[84:87], a[240:243], a[208:211], v[148:151]
 v_exp_f32 v181, v53
 v_mfma_f32_16x16x32_bf16 v[92:95], a[240:243], a[224:227], v[152:155]
 v_cvt_pk_bf16_f32 v113, v178, v179
 s_barrier
 v_mfma_f32_16x16x32_bf16 v[60:63], a[244:247], a[164:167], v[60:63]
 v_exp_f32 v182, v54
 v_mfma_f32_16x16x32_bf16 v[68:71], a[244:247], a[180:183], v[68:71]
 ds_read_b64_tr_b16 a[240:241], v198 offset:49152
 ds_read_b64_tr_b16 a[242:243], v198 offset:53248
 v_mfma_f32_16x16x32_bf16 v[76:79], a[244:247], a[196:199], v[76:79]
 v_exp_f32 v183, v55
 v_mfma_f32_16x16x32_bf16 v[84:87], a[244:247], a[212:215], v[84:87]
 v_cvt_pk_bf16_f32 v114, v180, v181
 v_cvt_pk_bf16_f32 v115, v182, v183
 v_mfma_f32_16x16x32_bf16 v[92:95], a[244:247], a[228:231], v[92:95]
 ds_read_b64_tr_b16 a[244:245], v199 offset:49152
 s_waitcnt lgkmcnt(3)
 v_mfma_f32_16x16x32_bf16 v[60:63], a[248:251], a[168:171], v[60:63]
 ds_read_b64_tr_b16 a[246:247], v199 offset:53248
 s_waitcnt vmcnt(4)
 v_mfma_f32_16x16x32_bf16 v[68:71], a[248:251], a[184:187], v[68:71]
 buffer_load_dwordx4 v217, s[28:31], s46 offen offset:3072 nt lds
 v_mfma_f32_16x16x32_bf16 v[76:79], a[248:251], a[200:203], v[76:79]
 v_or3_b32 v188, v188, v105, v106
 v_or3_b32 v188, v188, v107, v108
 v_mfma_f32_16x16x32_bf16 v[84:87], a[248:251], a[216:219], v[84:87]
 v_or3_b32 v188, v188, v109, v110
 v_or3_b32 v188, v188, v111, v112
 v_mfma_f32_16x16x32_bf16 v[92:95], a[248:251], a[232:235], v[92:95]
 ds_read_b64_tr_b16 a[248:249], v200 offset:49152
 ds_read_b64_tr_b16 a[250:251], v200 offset:53248
 v_mfma_f32_16x16x32_bf16 v[60:63], a[252:255], a[172:175], v[60:63]
 v_or3_b32 v188, v188, v113, v114
 v_bitop3_b32 v188, v188, v115, s45 bitop3:0xa8
 v_mfma_f32_16x16x32_bf16 v[68:71], a[252:255], a[188:191], v[68:71]
 v_cmp_ne_u32 vcc, 0, v188
 v_mfma_f32_16x16x32_bf16 v[76:79], a[252:255], a[204:207], v[76:79]
 v_mfma_f32_16x16x32_bf16 v[84:87], a[252:255], a[220:223], v[84:87]
 v_mfma_f32_16x16x32_bf16 v[92:95], a[252:255], a[236:239], v[92:95]
 s_cbranch_vccnz L_rareb5
L_rareb5_back:
 v_mfma_f32_16x16x32_bf16 v[156:159], v[184:187], v[96:99], v[156:159]
 s_waitcnt vmcnt(4)
 s_add_u32 m0, s44, 81920
 v_mfma_f32_16x16x32_bf16 v[160:163], v[184:187], v[100:103], v[160:163]
 v_exp_f32 v176, v56
 v_mfma_f32_16x16x32_bf16 v[164:167], v[184:187], v[104:107], v[164:167]
 s_mov_b32 s46, 114688
 v_mfma_f32_16x16x32_bf16 v[168:171], v[184:187], v[108:111], v[168:171]
 buffer_load_dwordx4 v218, s[32:35], s46 offen offset:0 nt lds
 v_mfma_f32_16x16x32_bf16 v[172:175], v[184:187], v[112:115], v[172:175]
 ds_read_b64_tr_b16 a[252:253], v201 offset:49152
 s_waitcnt lgkmcnt(3)
 v_mfma_f32_16x16x32_bf16 a[0:3], a[240:243], v[96:99], a[0:3]
 v_exp_f32 v177, v57
 v_mfma_f32_16x16x32_bf16 a[4:7], a[240:243], v[100:103], a[4:7]
 ds_read_b64_tr_b16 a[254:255], v201 offset:53248
 v_cvt_pk_bf16_f32 v116, v176, v177
 v_mfma_f32_16x16x32_bf16 a[8:11], a[240:243], v[104:107], a[8:11]
 v_exp_f32 v178, v58
 v_mfma_f32_16x16x32_bf16 a[12:15], a[240:243], v[108:111], a[12:15]
 v_exp_f32 v179, v59
 v_mfma_f32_16x16x32_bf16 a[16:19], a[240:243], v[112:115], a[16:19]
 v_exp_f32 v180, v60
 v_mfma_f32_16x16x32_bf16 a[20:23], a[244:247], v[96:99], a[20:23]
 ds_read_b64_tr_b16 a[240:241], v202 offset:49152
 ds_read_b64_tr_b16 a[242:243], v202 offset:53248
 v_mfma_f32_16x16x32_bf16 a[24:27], a[244:247], v[100:103], a[24:27]
 v_exp_f32 v181, v61
 v_mfma_f32_16x16x32_bf16 a[28:31], a[244:247], v[104:107], a[28:31]
 v_exp_f32 v182, v62
 v_mfma_f32_16x16x32_bf16 a[32:35], a[244:247], v[108:111], a[32:35]
 v_exp_f32 v183, v63
 v_mfma_f32_16x16x32_bf16 a[36:39], a[244:247], v[112:115], a[36:39]
 ds_read_b64_tr_b16 a[244:245], v203 offset:49152
 s_waitcnt lgkmcnt(3)
 v_mfma_f32_16x16x32_bf16 a[40:43], a[248:251], v[96:99], a[40:43]
 ds_read_b64_tr_b16 a[246:247], v203 offset:53248
 s_waitcnt vmcnt(4)
 v_mfma_f32_16x16x32_bf16 a[44:47], a[248:251], v[100:103], a[44:47]
 buffer_load_dwordx4 v219, s[32:35], s46 offen offset:1024 nt lds
 v_mfma_f32_16x16x32_bf16 a[48:51], a[248:251], v[104:107], a[48:51]
 v_exp_f32 v176, v64
 v_mfma_f32_16x16x32_bf16 a[52:55], a[248:251], v[108:111], a[52:55]
 v_cvt_pk_bf16_f32 v117, v178, v179
 v_cvt_pk_bf16_f32 v118, v180, v181
 v_mfma_f32_16x16x32_bf16 a[56:59], a[248:251], v[112:115], a[56:59]
 v_exp_f32 v177, v65
 v_mfma_f32_16x16x32_bf16 a[60:63], a[252:255], v[96:99], a[60:63]
 ds_read_b64_tr_b16 a[248:249], v204 offset:49152
 ds_read_b64_tr_b16 a[250:251], v204 offset:53248
 v_mfma_f32_16x16x32_bf16 a[64:67], a[252:255], v[100:103], a[64:67]
 v_exp_f32 v178, v66
 v_mfma_f32_16x16x32_bf16 a[68:71], a[252:255], v[104:107], a[68:71]
 v_exp_f32 v179, v67
 v_mfma_f32_16x16x32_bf16 a[72:75], a[252:255], v[108:111], a[72:75]
 v_exp_f32 v180, v68
 v_mfma_f32_16x16x32_bf16 a[76:79], a[252:255], v[112:115], a[76:79]
 v_cvt_pk_bf16_f32 v119, v182, v183
 s_waitcnt lgkmcnt(2)
 v_mfma_f32_16x16x32_bf16 a[80:83], a[240:243], v[96:99], a[80:83]
 ds_read_b64_tr_b16 a[252:253], v205 offset:49152
 ds_read_b64_tr_b16 a[254:255], v205 offset:53248
 v_mfma_f32_16x16x32_bf16 a[84:87], a[240:243], v[100:103], a[84:87]
 v_exp_f32 v181, v69
 v_mfma_f32_16x16x32_bf16 a[88:91], a[240:243], v[104:107], a[88:91]
 v_exp_f32 v182, v70
 v_mfma_f32_16x16x32_bf16 a[92:95], a[240:243], v[108:111], a[92:95]
 v_cvt_pk_bf16_f32 v120, v176, v177
 s_waitcnt vmcnt(4)
 v_mfma_f32_16x16x32_bf16 a[96:99], a[240:243], v[112:115], a[96:99]
 buffer_load_dwordx4 v218, s[32:35], s46 offen offset:2048 nt lds
 v_mfma_f32_16x16x32_bf16 a[100:103], a[244:247], v[96:99], a[100:103]
 ds_read_b128 a[240:243], v190 offset:16384
 v_cvt_pk_bf16_f32 v121, v178, v179
 v_mfma_f32_16x16x32_bf16 a[104:107], a[244:247], v[100:103], a[104:107]
 v_exp_f32 v183, v71
 v_mfma_f32_16x16x32_bf16 a[108:111], a[244:247], v[104:107], a[108:111]
 v_exp_f32 v176, v72
 v_mfma_f32_16x16x32_bf16 a[112:115], a[244:247], v[108:111], a[112:115]
 v_exp_f32 v177, v73
 v_mfma_f32_16x16x32_bf16 a[116:119], a[244:247], v[112:115], a[116:119]
 ds_read_b128 a[244:247], v191 offset:16384
 s_waitcnt lgkmcnt(2)
 v_mfma_f32_16x16x32_bf16 a[120:123], a[248:251], v[96:99], a[120:123]
 v_exp_f32 v178, v74
 v_mfma_f32_16x16x32_bf16 a[124:127], a[248:251], v[100:103], a[124:127]
 v_cvt_pk_bf16_f32 v122, v180, v181
 v_cvt_pk_bf16_f32 v123, v182, v183
 v_mfma_f32_16x16x32_bf16 a[128:131], a[248:251], v[104:107], a[128:131]
 v_exp_f32 v179, v75
 v_mfma_f32_16x16x32_bf16 a[132:135], a[248:251], v[108:111], a[132:135]
 v_exp_f32 v180, v76
 v_mfma_f32_16x16x32_bf16 a[136:139], a[248:251], v[112:115], a[136:139]
 v_exp_f32 v181, v77
 v_mfma_f32_16x16x32_bf16 a[140:143], a[252:255], v[96:99], a[140:143]
 ds_read_b128 a[248:251], v192 offset:16384
 s_waitcnt vmcnt(4)
 v_mfma_f32_16x16x32_bf16 a[144:147], a[252:255], v[100:103], a[144:147]
 buffer_load_dwordx4 v219, s[32:35], s46 offen offset:3072 nt lds
 v_mfma_f32_16x16x32_bf16 a[148:151], a[252:255], v[104:107], a[148:151]
 v_exp_f32 v182, v78
 v_mfma_f32_16x16x32_bf16 a[152:155], a[252:255], v[108:111], a[152:155]
 v_cvt_pk_bf16_f32 v124, v176, v177
 v_cvt_pk_bf16_f32 v125, v178, v179
 v_mfma_f32_16x16x32_bf16 a[156:159], a[252:255], v[112:115], a[156:159]
 ds_read_b128 a[252:255], v193 offset:16384
 s_waitcnt lgkmcnt(2)
 v_mfma_f32_16x16x32_bf16 v[16:19], a[240:243], a[160:163], v[136:139]
 v_exp_f32 v183, v79
 v_mfma_f32_16x16x32_bf16 v[24:27], a[240:243], a[176:179], v[140:143]
 v_exp_f32 v176, v80
 v_mfma_f32_16x16x32_bf16 v[32:35], a[240:243], a[192:195], v[144:147]
 v_exp_f32 v177, v81
 v_mfma_f32_16x16x32_bf16 v[40:43], a[240:243], a[208:211], v[148:151]
 v_exp_f32 v178, v82
 v_mfma_f32_16x16x32_bf16 v[48:51], a[240:243], a[224:227], v[152:155]
 v_cvt_pk_bf16_f32 v126, v180, v181
 ds_read_b128 a[240:243], v190 offset:20480
 v_mfma_f32_16x16x32_bf16 v[16:19], a[244:247], a[164:167], v[16:19]
 v_exp_f32 v179, v83
 v_mfma_f32_16x16x32_bf16 v[24:27], a[244:247], a[180:183], v[24:27]
 v_exp_f32 v180, v84
 v_mfma_f32_16x16x32_bf16 v[32:35], a[244:247], a[196:199], v[32:35]
 v_cvt_pk_bf16_f32 v127, v182, v183
 v_mfma_f32_16x16x32_bf16 v[40:43], a[244:247], a[212:215], v[40:43]
 s_add_u32 m0, s44, 131072
 s_mov_b32 s46, 147456
 buffer_load_dwordx4 v214, s[28:31], s46 offen offset:0 nt lds
 v_mfma_f32_16x16x32_bf16 v[48:51], a[244:247], a[228:231], v[48:51]
 ds_read_b128 a[244:247], v191 offset:20480
 s_waitcnt lgkmcnt(2)
 v_mfma_f32_16x16x32_bf16 v[16:19], a[248:251], a[168:171], v[16:19]
 v_exp_f32 v181, v85
 v_mfma_f32_16x16x32_bf16 v[24:27], a[248:251], a[184:187], v[24:27]
 v_exp_f32 v182, v86
 v_mfma_f32_16x16x32_bf16 v[32:35], a[248:251], a[200:203], v[32:35]
 v_cvt_pk_bf16_f32 v128, v176, v177
 v_cvt_pk_bf16_f32 v129, v178, v179
 v_mfma_f32_16x16x32_bf16 v[40:43], a[248:251], a[216:219], v[40:43]
 v_exp_f32 v183, v87
 v_mfma_f32_16x16x32_bf16 v[48:51], a[248:251], a[232:235], v[48:51]
 v_exp_f32 v176, v88
 v_mfma_f32_16x16x32_bf16 v[16:19], a[252:255], a[172:175], v[16:19]
 ds_read_b128 a[248:251], v192 offset:20480
 v_cvt_pk_bf16_f32 v130, v180, v181
 v_mfma_f32_16x16x32_bf16 v[24:27], a[252:255], a[188:191], v[24:27]
 v_exp_f32 v177, v89
 v_mfma_f32_16x16x32_bf16 v[32:35], a[252:255], a[204:207], v[32:35]
 v_exp_f32 v178, v90
 v_mfma_f32_16x16x32_bf16 v[40:43], a[252:255], a[220:223], v[40:43]
 v_cvt_pk_bf16_f32 v131, v182, v183
 v_mfma_f32_16x16x32_bf16 v[48:51], a[252:255], a[236:239], v[48:51]
 ds_read_b128 a[252:255], v193 offset:20480
 s_waitcnt lgkmcnt(2)
 v_mfma_f32_16x16x32_bf16 v[20:23], a[240:243], a[160:163], v[136:139]
 buffer_load_dwordx4 v215, s[28:31], s46 offen offset:1024 nt lds
 v_mfma_f32_16x16x32_bf16 v[28:31], a[240:243], a[176:179], v[140:143]
 v_exp_f32 v179, v91
 v_mfma_f32_16x16x32_bf16 v[36:39], a[240:243], a[192:195], v[144:147]
 v_exp_f32 v180, v92
 v_mfma_f32_16x16x32_bf16 v[44:47], a[240:243], a[208:211], v[148:151]
 v_exp_f32 v181, v93
 v_mfma_f32_16x16x32_bf16 v[52:55], a[240:243], a[224:227], v[152:155]
 v_cvt_pk_bf16_f32 v132, v176, v177
 s_barrier
 v_mfma_f32_16x16x32_bf16 v[20:23], a[244:247], a[164:167], v[20:23]
 v_exp_f32 v182, v94
 v_mfma_f32_16x16x32_bf16 v[28:31], a[244:247], a[180:183], v[28:31]
 ds_read_b64_tr_b16 a[240:241], v198 offset:0
 ds_read_b64_tr_b16 a[242:243], v198 offset:4096
 v_mfma_f32_16x16x32_bf16 v[36:39], a[244:247], a[196:199], v[36:39]
 v_exp_f32 v183, v95
 v_mfma_f32_16x16x32_bf16 v[44:47], a[244:247], a[212:215], v[44:47]
 v_cvt_pk_bf16_f32 v133, v178, v179
 v_cvt_pk_bf16_f32 v134, v180, v181
 v_mfma_f32_16x16x32_bf16 v[52:55], a[244:247], a[228:231], v[52:55]
 ds_read_b64_tr_b16 a[244:245], v199 offset:0
 s_waitcnt lgkmcnt(3)
 v_mfma_f32_16x16x32_bf16 v[20:23], a[248:251], a[168:171], v[20:23]
 ds_read_b64_tr_b16 a[246:247], v199 offset:4096
 v_cvt_pk_bf16_f32 v135, v182, v183
 v_mfma_f32_16x16x32_bf16 v[28:31], a[248:251], a[184:187], v[28:31]
 s_waitcnt vmcnt(6)
 v_or3_b32 v188, v116, v117, v118
 v_mfma_f32_16x16x32_bf16 v[36:39], a[248:251], a[200:203], v[36:39]
 buffer_load_dwordx4 v216, s[28:31], s46 offen offset:2048 nt lds
 v_mfma_f32_16x16x32_bf16 v[44:47], a[248:251], a[216:219], v[44:47]
 v_or3_b32 v188, v188, v119, v120
 v_or3_b32 v188, v188, v121, v122
 v_mfma_f32_16x16x32_bf16 v[52:55], a[248:251], a[232:235], v[52:55]
 ds_read_b64_tr_b16 a[248:249], v200 offset:0
 ds_read_b64_tr_b16 a[250:251], v200 offset:4096
 v_mfma_f32_16x16x32_bf16 v[20:23], a[252:255], a[172:175], v[20:23]
 v_or3_b32 v188, v188, v123, v124
 v_or3_b32 v188, v188, v125, v126
 v_mfma_f32_16x16x32_bf16 v[28:31], a[252:255], a[188:191], v[28:31]
 v_or3_b32 v188, v188, v127, v128
 v_or3_b32 v188, v188, v129, v130
 v_mfma_f32_16x16x32_bf16 v[36:39], a[252:255], a[204:207], v[36:39]
 v_or3_b32 v188, v188, v131, v132
 v_or3_b32 v188, v188, v133, v134
 v_mfma_f32_16x16x32_bf16 v[44:47], a[252:255], a[220:223], v[44:47]
 v_bitop3_b32 v188, v188, v135, s45 bitop3:0xa8
 v_cmp_ne_u32 vcc, 0, v188
 v_mfma_f32_16x16x32_bf16 v[52:55], a[252:255], a[236:239], v[52:55]
 s_cbranch_vccnz L_rareb6
L_rareb6_back:
 v_mfma_f32_16x16x32_bf16 v[156:159], v[184:187], v[116:119], v[156:159]
 v_mfma_f32_16x16x32_bf16 v[160:163], v[184:187], v[120:123], v[160:163]
 v_exp_f32 v176, v16
 v_mfma_f32_16x16x32_bf16 v[164:167], v[184:187], v[124:127], v[164:167]
 v_exp_f32 v177, v17
 v_mfma_f32_16x16x32_bf16 v[168:171], v[184:187], v[128:131], v[168:171]
 v_exp_f32 v178, v18
 v_mfma_f32_16x16x32_bf16 v[172:175], v[184:187], v[132:135], v[172:175]
 ds_read_b64_tr_b16 a[252:253], v201 offset:0
 s_waitcnt lgkmcnt(3)
 v_mfma_f32_16x16x32_bf16 a[0:3], a[240:243], v[116:119], a[0:3]
 s_waitcnt vmcnt(6)
 buffer_load_dwordx4 v217, s[28:31], s46 offen offset:3072 nt lds
 v_mfma_f32_16x16x32_bf16 a[4:7], a[240:243], v[120:123], a[4:7]
 ds_read_b64_tr_b16 a[254:255], v201 offset:4096
 v_cvt_pk_bf16_f32 v96, v176, v177
 v_mfma_f32_16x16x32_bf16 a[8:11], a[240:243], v[124:127], a[8:11]
 v_exp_f32 v179, v19
 v_mfma_f32_16x16x32_bf16 a[12:15], a[240:243], v[128:131], a[12:15]
 v_exp_f32 v180, v20
 v_mfma_f32_16x16x32_bf16 a[16:19], a[240:243], v[132:135], a[16:19]
 v_exp_f32 v181, v21
 v_mfma_f32_16x16x32_bf16 a[20:23], a[244:247], v[116:119], a[20:23]
 ds_read_b64_tr_b16 a[240:241], v202 offset:0
 ds_read_b64_tr_b16 a[242:243], v202 offset:4096
 v_mfma_f32_16x16x32_bf16 a[24:27], a[244:247], v[120:123], a[24:27]
 v_exp_f32 v182, v22
 v_mfma_f32_16x16x32_bf16 a[28:31], a[244:247], v[124:127], a[28:31]
 v_exp_f32 v183, v23
 v_mfma_f32_16x16x32_bf16 a[32:35], a[244:247], v[128:131], a[32:35]
 v_exp_f32 v176, v24
 v_mfma_f32_16x16x32_bf16 a[36:39], a[244:247], v[132:135], a[36:39]
 v_cvt_pk_bf16_f32 v97, v178, v179
 s_waitcnt lgkmcnt(2)
 v_mfma_f32_16x16x32_bf16 a[40:43], a[248:251], v[116:119], a[40:43]
 ds_read_b64_tr_b16 a[244:245], v203 offset:0
 ds_read_b64_tr_b16 a[246:247], v203 offset:4096
 v_mfma_f32_16x16x32_bf16 a[44:47], a[248:251], v[120:123], a[44:47]
 v_exp_f32 v177, v25
 v_mfma_f32_16x16x32_bf16 a[48:51], a[248:251], v[124:127], a[48:51]
 s_waitcnt vmcnt(6)
 s_add_u32 m0, s44, 114688
 s_mov_b32 s46, 131072
 buffer_load_dwordx4 v218, s[32:35], s46 offen offset:0 nt lds
 v_mfma_f32_16x16x32_bf16 a[52:55], a[248:251], v[128:131], a[52:55]
 v_exp_f32 v178, v26
 v_mfma_f32_16x16x32_bf16 a[56:59], a[248:251], v[132:135], a[56:59]
 v_cvt_pk_bf16_f32 v98, v180, v181
 ds_read_b64_tr_b16 a[248:249], v204 offset:0
 v_mfma_f32_16x16x32_bf16 a[60:63], a[252:255], v[116:119], a[60:63]
 ds_read_b64_tr_b16 a[250:251], v204 offset:4096
 v_cvt_pk_bf16_f32 v99, v182, v183
 v_mfma_f32_16x16x32_bf16 a[64:67], a[252:255], v[120:123], a[64:67]
 v_exp_f32 v179, v27
 v_mfma_f32_16x16x32_bf16 a[68:71], a[252:255], v[124:127], a[68:71]
 v_exp_f32 v180, v28
 v_mfma_f32_16x16x32_bf16 a[72:75], a[252:255], v[128:131], a[72:75]
 v_exp_f32 v181, v29
 v_mfma_f32_16x16x32_bf16 a[76:79], a[252:255], v[132:135], a[76:79]
 ds_read_b64_tr_b16 a[252:253], v205 offset:0
 s_waitcnt lgkmcnt(3)
 v_mfma_f32_16x16x32_bf16 a[80:83], a[240:243], v[116:119], a[80:83]
 ds_read_b64_tr_b16 a[254:255], v205 offset:4096
 v_cvt_pk_bf16_f32 v100, v176, v177
 v_mfma_f32_16x16x32_bf16 a[84:87], a[240:243], v[120:123], a[84:87]
 v_exp_f32 v182, v30
 v_mfma_f32_16x16x32_bf16 a[88:91], a[240:243], v[124:127], a[88:91]
 v_exp_f32 v183, v31
 v_mfma_f32_16x16x32_bf16 a[92:95], a[240:243], v[128:131], a[92:95]
 v_exp_f32 v176, v32
 v_mfma_f32_16x16x32_bf16 a[96:99], a[240:243], v[132:135], a[96:99]
 v_cvt_pk_bf16_f32 v101, v178, v179
 s_waitcnt vmcnt(6)
 buffer_load_dwordx4 v219, s[32:35], s46 offen offset:1024 nt lds
 v_mfma_f32_16x16x32_bf16 a[100:103], a[244:247], v[116:119], a[100:103]
 ds_read_b128 a[240:243], v190 offset:32768
 v_cvt_pk_bf16_f32 v102, v180, v181
 v_mfma_f32_16x16x32_bf16 a[104:107], a[244:247], v[120:123], a[104:107]
 v_exp_f32 v177, v33
 v_mfma_f32_16x16x32_bf16 a[108:111], a[244:247], v[124:127], a[108:111]
 v_exp_f32 v178, v34
 v_mfma_f32_16x16x32_bf16 a[112:115], a[244:247], v[128:131], a[112:115]
 v_cvt_pk_bf16_f32 v103, v182, v183
 v_cvt_pk_bf16_f32 v104, v176, v177
 v_mfma_f32_16x16x32_bf16 a[116:119], a[244:247], v[132:135], a[116:119]
 ds_read_b128 a[244:247], v191 offset:32768
 s_waitcnt lgkmcnt(2)
 v_mfma_f32_16x16x32_bf16 a[120:123], a[248:251], v[116:119], a[120:123]
 v_exp_f32 v179, v35
 v_mfma_f32_16x16x32_bf16 a[124:127], a[248:251], v[120:123], a[124:127]
 v_exp_f32 v180, v36
 v_mfma_f32_16x16x32_bf16 a[128:131], a[248:251], v[124:127], a[128:131]
 v_cvt_pk_bf16_f32 v105, v178, v179
 s_waitcnt vmcnt(6)
 v_mfma_f32_16x16x32_bf16 a[132:135], a[248:251], v[128:131], a[132:135]
 buffer_load_dwordx4 v218, s[32:35], s46 offen offset:2048 nt lds
 v_mfma_f32_16x16x32_bf16 a[136:139], a[248:251], v[132:135], a[136:139]
 v_exp_f32 v181, v37
 v_mfma_f32_16x16x32_bf16 a[140:143], a[252:255], v[116:119], a[140:143]
 ds_read_b128 a[248:251], v192 offset:32768
 v_cvt_pk_bf16_f32 v106, v180, v181
 v_mfma_f32_16x16x32_bf16 a[144:147], a[252:255], v[120:123], a[144:147]
 v_exp_f32 v182, v38
 v_mfma_f32_16x16x32_bf16 a[148:151], a[252:255], v[124:127], a[148:151]
 v_exp_f32 v183, v39
 v_mfma_f32_16x16x32_bf16 a[152:155], a[252:255], v[128:131], a[152:155]
 v_exp_f32 v176, v40
 v_mfma_f32_16x16x32_bf16 a[156:159], a[252:255], v[132:135], a[156:159]
 ds_read_b128 a[252:255], v193 offset:32768
 s_waitcnt lgkmcnt(2)
 v_mfma_f32_16x16x32_bf16 v[56:59], a[240:243], a[160:163], v[136:139]
 v_exp_f32 v177, v41
 v_mfma_f32_16x16x32_bf16 v[64:67], a[240:243], a[176:179], v[140:143]
 v_cvt_pk_bf16_f32 v107, v182, v183
 v_cvt_pk_bf16_f32 v108, v176, v177
 v_mfma_f32_16x16x32_bf16 v[72:75], a[240:243], a[192:195], v[144:147]
 v_exp_f32 v178, v42
 v_mfma_f32_16x16x32_bf16 v[80:83], a[240:243], a[208:211], v[148:151]
 v_or3_b32 v188, v96, v97, v98
 v_or3_b32 v188, v188, v99, v100
 v_mfma_f32_16x16x32_bf16 v[88:91], a[240:243], a[224:227], v[152:155]
 v_exp_f32 v179, v43
 v_mfma_f32_16x16x32_bf16 v[56:59], a[244:247], a[164:167], v[56:59]
 ds_read_b128 a[240:243], v190 offset:36864
 v_cvt_pk_bf16_f32 v109, v178, v179
 v_mfma_f32_16x16x32_bf16 v[64:67], a[244:247], a[180:183], v[64:67]
 v_exp_f32 v180, v44
 v_mfma_f32_16x16x32_bf16 v[72:75], a[244:247], a[196:199], v[72:75]
 s_waitcnt vmcnt(6)
 v_or3_b32 v188, v188, v101, v102
 v_mfma_f32_16x16x32_bf16 v[80:83], a[244:247], a[212:215], v[80:83]
 buffer_load_dwordx4 v219, s[32:35], s46 offen offset:3072 nt lds
 v_mfma_f32_16x16x32_bf16 v[88:91], a[244:247], a[228:231], v[88:91]
 ds_read_b128 a[244:247], v191 offset:36864
 s_waitcnt lgkmcnt(2)
 v_mfma_f32_16x16x32_bf16 v[56:59], a[248:251], a[168:171], v[56:59]
 v_exp_f32 v181, v45
 v_mfma_f32_16x16x32_bf16 v[64:67], a[248:251], a[184:187], v[64:67]
 v_exp_f32 v182, v46
 v_mfma_f32_16x16x32_bf16 v[72:75], a[248:251], a[200:203], v[72:75]
 v_exp_f32 v183, v47
 v_mfma_f32_16x16x32_bf16 v[80:83], a[248:251], a[216:219], v[80:83]
 v_exp_f32 v176, v48
 v_mfma_f32_16x16x32_bf16 v[88:91], a[248:251], a[232:235], v[88:91]
 ds_read_b128 a[248:251], v192 offset:36864
 v_cvt_pk_bf16_f32 v110, v180, v181
 v_mfma_f32_16x16x32_bf16 v[56:59], a[252:255], a[172:175], v[56:59]
 v_exp_f32 v177, v49
 v_mfma_f32_16x16x32_bf16 v[64:67], a[252:255], a[188:191], v[64:67]
 v_cvt_pk_bf16_f32 v111, v182, v183
 v_cvt_pk_bf16_f32 v112, v176, v177
 v_mfma_f32_16x16x32_bf16 v[72:75], a[252:255], a[204:207], v[72:75]
 v_exp_f32 v178, v50
 v_mfma_f32_16x16x32_bf16 v[80:83], a[252:255], a[220:223], v[80:83]
 s_waitcnt vmcnt(6)
 s_add_u32 m0, s44, 0
 v_mfma_f32_16x16x32_bf16 v[88:91], a[252:255], a[236:239], v[88:91]
 s_mov_b32 s46, 163840
 s_waitcnt lgkmcnt(1)
 v_mfma_f32_16x16x32_bf16 v[60:63], a[240:243], a[160:163], v[136:139]
 buffer_load_dwordx4 v214, s[28:31], s46 offen offset:0 nt lds
 v_mfma_f32_16x16x32_bf16 v[68:71], a[240:243], a[176:179], v[140:143]
 ds_read_b128 a[252:255], v193 offset:36864
 v_or3_b32 v188, v188, v103, v104
 v_mfma_f32_16x16x32_bf16 v[76:79], a[240:243], a[192:195], v[144:147]
 v_exp_f32 v179, v51
 v_mfma_f32_16x16x32_bf16 v[84:87], a[240:243], a[208:211], v[148:151]
 v_exp_f32 v180, v52
 v_mfma_f32_16x16x32_bf16 v[92:95], a[240:243], a[224:227], v[152:155]
 v_cvt_pk_bf16_f32 v113, v178, v179
 s_barrier
 v_mfma_f32_16x16x32_bf16 v[60:63], a[244:247], a[164:167], v[60:63]
 v_exp_f32 v181, v53
 v_mfma_f32_16x16x32_bf16 v[68:71], a[244:247], a[180:183], v[68:71]
 ds_read_b64_tr_b16 a[240:241], v198 offset:32768
 ds_read_b64_tr_b16 a[242:243], v198 offset:36864
 v_mfma_f32_16x16x32_bf16 v[76:79], a[244:247], a[196:199], v[76:79]
 v_exp_f32 v182, v54
 v_mfma_f32_16x16x32_bf16 v[84:87], a[244:247], a[212:215], v[84:87]
 v_exp_f32 v183, v55
 v_mfma_f32_16x16x32_bf16 v[92:95], a[244:247], a[228:231], v[92:95]
 ds_read_b64_tr_b16 a[244:245], v199 offset:32768
 s_waitcnt lgkmcnt(3)
 v_mfma_f32_16x16x32_bf16 v[60:63], a[248:251], a[168:171], v[60:63]
 ds_read_b64_tr_b16 a[246:247], v199 offset:36864
 v_cvt_pk_bf16_f32 v114, v180, v181
 v_mfma_f32_16x16x32_bf16 v[68:71], a[248:251], a[184:187], v[68:71]
 v_cvt_pk_bf16_f32 v115, v182, v183
 s_waitcnt vmcnt(6)
 v_mfma_f32_16x16x32_bf16 v[76:79], a[248:251], a[200:203], v[76:79]
 buffer_load_dwordx4 v215, s[28:31], s46 offen offset:1024 nt lds
 v_mfma_f32_16x16x32_bf16 v[84:87], a[248:251], a[216:219], v[84:87]
 v_or3_b32 v188, v188, v105, v106
 v_or3_b32 v188, v188, v107, v108
 v_mfma_f32_16x16x32_bf16 v[92:95], a[248:251], a[232:235], v[92:95]
 ds_read_b64_tr_b16 a[248:249], v200 offset:32768
 ds_read_b64_tr_b16 a[250:251], v200 offset:36864
 v_mfma_f32_16x16x32_bf16 v[60:63], a[252:255], a[172:175], v[60:63]
 v_or3_b32 v188, v188, v109, v110
 v_or3_b32 v188, v188, v111, v112
 v_mfma_f32_16x16x32_bf16 v[68:71], a[252:255], a[188:191], v[68:71]
 v_or3_b32 v188, v188, v113, v114
 v_bitop3_b32 v188, v188, v115, s45 bitop3:0xa8
 v_mfma_f32_16x16x32_bf16 v[76:79], a[252:255], a[204:207], v[76:79]
 v_cmp_ne_u32 vcc, 0, v188
 v_mfma_f32_16x16x32_bf16 v[84:87], a[252:255], a[220:223], v[84:87]
 v_mfma_f32_16x16x32_bf16 v[92:95], a[252:255], a[236:239], v[92:95]
 s_cbranch_vccnz L_rareb7
L_rareb7_back:
 v_mfma_f32_16x16x32_bf16 v[156:159], v[184:187], v[96:99], v[156:159]
 v_mfma_f32_16x16x32_bf16 v[160:163], v[184:187], v[100:103], v[160:163]
 v_exp_f32 v176, v56
 v_mfma_f32_16x16x32_bf16 v[164:167], v[184:187], v[104:107], v[164:167]
 v_exp_f32 v177, v57
 v_mfma_f32_16x16x32_bf16 v[168:171], v[184:187], v[108:111], v[168:171]
 v_exp_f32 v178, v58
 v_mfma_f32_16x16x32_bf16 v[172:175], v[184:187], v[112:115], v[172:175]
 ds_read_b64_tr_b16 a[252:253], v201 offset:32768
 s_waitcnt lgkmcnt(3)
 v_mfma_f32_16x16x32_bf16 a[0:3], a[240:243], v[96:99], a[0:3]
 s_waitcnt vmcnt(6)
 buffer_load_dwordx4 v216, s[28:31], s46 offen offset:2048 nt lds
 v_mfma_f32_16x16x32_bf16 a[4:7], a[240:243], v[100:103], a[4:7]
 ds_read_b64_tr_b16 a[254:255], v201 offset:36864
 v_cvt_pk_bf16_f32 v116, v176, v177
 v_mfma_f32_16x16x32_bf16 a[8:11], a[240:243], v[104:107], a[8:11]
 v_exp_f32 v179, v59
 v_mfma_f32_16x16x32_bf16 a[12:15], a[240:243], v[108:111], a[12:15]
 v_exp_f32 v180, v60
 v_mfma_f32_16x16x32_bf16 a[16:19], a[240:243], v[112:115], a[16:19]
 v_exp_f32 v181, v61
 v_mfma_f32_16x16x32_bf16 a[20:23], a[244:247], v[96:99], a[20:23]
 ds_read_b64_tr_b16 a[240:241], v202 offset:32768
 ds_read_b64_tr_b16 a[242:243], v202 offset:36864
 v_mfma_f32_16x16x32_bf16 a[24:27], a[244:247], v[100:103], a[24:27]
 v_exp_f32 v182, v62
 v_mfma_f32_16x16x32_bf16 a[28:31], a[244:247], v[104:107], a[28:31]
 v_exp_f32 v183, v63
 v_mfma_f32_16x16x32_bf16 a[32:35], a[244:247], v[108:111], a[32:35]
 v_exp_f32 v176, v64
 v_mfma_f32_16x16x32_bf16 a[36:39], a[244:247], v[112:115], a[36:39]
 v_cvt_pk_bf16_f32 v117, v178, v179
 s_waitcnt lgkmcnt(2)
 v_mfma_f32_16x16x32_bf16 a[40:43], a[248:251], v[96:99], a[40:43]
 ds_read_b64_tr_b16 a[244:245], v203 offset:32768
 ds_read_b64_tr_b16 a[246:247], v203 offset:36864
 v_mfma_f32_16x16x32_bf16 a[44:47], a[248:251], v[100:103], a[44:47]
 v_exp_f32 v177, v65
 v_mfma_f32_16x16x32_bf16 a[48:51], a[248:251], v[104:107], a[48:51]
 s_waitcnt vmcnt(6)
 buffer_load_dwordx4 v217, s[28:31], s46 offen offset:3072 nt lds
 v_mfma_f32_16x16x32_bf16 a[52:55], a[248:251], v[108:111], a[52:55]
 v_exp_f32 v178, v66
 v_mfma_f32_16x16x32_bf16 a[56:59], a[248:251], v[112:115], a[56:59]
 v_cvt_pk_bf16_f32 v118, v180, v181
 ds_read_b64_tr_b16 a[248:249], v204 offset:32768
 v_mfma_f32_16x16x32_bf16 a[60:63], a[252:255], v[96:99], a[60:63]
 ds_read_b64_tr_b16 a[250:251], v204 offset:36864
 v_cvt_pk_bf16_f32 v119, v182, v183
 v_mfma_f32_16x16x32_bf16 a[64:67], a[252:255], v[100:103], a[64:67]
 v_exp_f32 v179, v67
 v_mfma_f32_16x16x32_bf16 a[68:71], a[252:255], v[104:107], a[68:71]
 v_exp_f32 v180, v68
 v_mfma_f32_16x16x32_bf16 a[72:75], a[252:255], v[108:111], a[72:75]
 v_exp_f32 v181, v69
 v_mfma_f32_16x16x32_bf16 a[76:79], a[252:255], v[112:115], a[76:79]
 ds_read_b64_tr_b16 a[252:253], v205 offset:32768
 s_waitcnt lgkmcnt(3)
 v_mfma_f32_16x16x32_bf16 a[80:83], a[240:243], v[96:99], a[80:83]
 ds_read_b64_tr_b16 a[254:255], v205 offset:36864
 v_cvt_pk_bf16_f32 v120, v176, v177
 v_mfma_f32_16x16x32_bf16 a[84:87], a[240:243], v[100:103], a[84:87]
 v_exp_f32 v182, v70
 v_mfma_f32_16x16x32_bf16 a[88:91], a[240:243], v[104:107], a[88:91]
 v_exp_f32 v183, v71
 v_mfma_f32_16x16x32_bf16 a[92:95], a[240:243], v[108:111], a[92:95]
 v_exp_f32 v176, v72
 v_mfma_f32_16x16x32_bf16 a[96:99], a[240:243], v[112:115], a[96:99]
 v_cvt_pk_bf16_f32 v121, v178, v179
 s_waitcnt vmcnt(6)
 s_add_u32 m0, s44, 65536
 s_mov_b32 s46, 147456
 buffer_load_dwordx4 v218, s[32:35], s46 offen offset:0 nt lds
 v_mfma_f32_16x16x32_bf16 a[100:103], a[244:247], v[96:99], a[100:103]
 ds_read_b128 a[240:243], v190 offset:49152
 v_cvt_pk_bf16_f32 v122, v180, v181
 v_mfma_f32_16x16x32_bf16 a[104:107], a[244:247], v[100:103], a[104:107]
 v_exp_f32 v177, v73
 v_mfma_f32_16x16x32_bf16 a[108:111], a[244:247], v[104:107], a[108:111]
 v_exp_f32 v178, v74
 v_mfma_f32_16x16x32_bf16 a[112:115], a[244:247], v[108:111], a[112:115]
 v_cvt_pk_bf16_f32 v123, v182, v183
 v_cvt_pk_bf16_f32 v124, v176, v177
 v_mfma_f32_16x16x32_bf16 a[116:119], a[244:247], v[112:115], a[116:119]
 ds_read_b128 a[244:247], v191 offset:49152
 s_waitcnt lgkmcnt(2)
 v_mfma_f32_16x16x32_bf16 a[120:123], a[248:251], v[96:99], a[120:123]
 v_exp_f32 v179, v75
 v_mfma_f32_16x16x32_bf16 a[124:127], a[248:251], v[100:103], a[124:127]
 v_exp_f32 v180, v76
 v_mfma_f32_16x16x32_bf16 a[128:131], a[248:251], v[104:107], a[128:131]
 v_cvt_pk_bf16_f32 v125, v178, v179
 v_or3_b32 v188, v116, v117, v118
 v_mfma_f32_16x16x32_bf16 a[132:135], a[248:251], v[108:111], a[132:135]
 v_exp_f32 v181, v77
 v_mfma_f32_16x16x32_bf16 a[136:139], a[248:251], v[112:115], a[136:139]
 v_exp_f32 v182, v78
 v_mfma_f32_16x16x32_bf16 a[140:143], a[252:255], v[96:99], a[140:143]
 ds_read_b128 a[248:251], v192 offset:49152
 s_waitcnt vmcnt(6)
 v_mfma_f32_16x16x32_bf16 a[144:147], a[252:255], v[100:103], a[144:147]
 buffer_load_dwordx4 v219, s[32:35], s46 offen offset:1024 nt lds
 v_mfma_f32_16x16x32_bf16 a[148:151], a[252:255], v[104:107], a[148:151]
 v_exp_f32 v183, v79
 v_mfma_f32_16x16x32_bf16 a[152:155], a[252:255], v[108:111], a[152:155]
 v_exp_f32 v176, v80
 v_mfma_f32_16x16x32_bf16 a[156:159], a[252:255], v[112:115], a[156:159]
 ds_read_b128 a[252:255], v193 offset:49152
 s_waitcnt lgkmcnt(2)
 v_mfma_f32_16x16x32_bf16 v[16:19], a[240:243], a[160:163], v[136:139]
 v_exp_f32 v177, v81
 v_mfma_f32_16x16x32_bf16 v[24:27], a[240:243], a[176:179], v[140:143]
 v_cvt_pk_bf16_f32 v126, v180, v181
 v_cvt_pk_bf16_f32 v127, v182, v183
 v_mfma_f32_16x16x32_bf16 v[32:35], a[240:243], a[192:195], v[144:147]
 v_exp_f32 v178, v82
 v_mfma_f32_16x16x32_bf16 v[40:43], a[240:243], a[208:211], v[148:151]
 v_cvt_pk_bf16_f32 v128, v176, v177
 v_or3_b32 v188, v188, v119, v120
 v_mfma_f32_16x16x32_bf16 v[48:51], a[240:243], a[224:227], v[152:155]
 v_exp_f32 v179, v83
 v_mfma_f32_16x16x32_bf16 v[16:19], a[244:247], a[164:167], v[16:19]
 ds_read_b128 a[240:243], v190 offset:53248
 v_cvt_pk_bf16_f32 v129, v178, v179
 v_mfma_f32_16x16x32_bf16 v[24:27], a[244:247], a[180:183], v[24:27]
 v_exp_f32 v180, v84
 v_mfma_f32_16x16x32_bf16 v[32:35], a[244:247], a[196:199], v[32:35]
 s_waitcnt vmcnt(6)
 v_or3_b32 v188, v188, v121, v122
 v_mfma_f32_16x16x32_bf16 v[40:43], a[244:247], a[212:215], v[40:43]
 buffer_load_dwordx4 v218, s[32:35], s46 offen offset:2048 nt lds
 v_mfma_f32_16x16x32_bf16 v[48:51], a[244:247], a[228:231], v[48:51]
 ds_read_b128 a[244:247], v191 offset:53248
 s_waitcnt lgkmcnt(2)
 v_mfma_f32_16x16x32_bf16 v[16:19], a[248:251], a[168:171], v[16:19]
 v_exp_f32 v181, v85
 v_mfma_f32_16x16x32_bf16 v[24:27], a[248:251], a[184:187], v[24:27]
 v_exp_f32 v182, v86
 v_mfma_f32_16x16x32_bf16 v[32:35], a[248:251], a[200:203], v[32:35]
 v_exp_f32 v183, v87
 v_mfma_f32_16x16x32_bf16 v[40:43], a[248:251], a[216:219], v[40:43]
 v_exp_f32 v176, v88
 v_mfma_f32_16x16x32_bf16 v[48:51], a[248:251], a[232:235], v[48:51]
 ds_read_b128 a[248:251], v192 offset:53248
 v_cvt_pk_bf16_f32 v130, v180, v181
 v_mfma_f32_16x16x32_bf16 v[16:19], a[252:255], a[172:175], v[16:19]
 v_exp_f32 v177, v89
 v_mfma_f32_16x16x32_bf16 v[24:27], a[252:255], a[188:191], v[24:27]
 v_cvt_pk_bf16_f32 v131, v182, v183
 v_cvt_pk_bf16_f32 v132, v176, v177
 v_mfma_f32_16x16x32_bf16 v[32:35], a[252:255], a[204:207], v[32:35]
 v_exp_f32 v178, v90
 v_mfma_f32_16x16x32_bf16 v[40:43], a[252:255], a[220:223], v[40:43]
 s_waitcnt vmcnt(6)
 v_or3_b32 v188, v188, v123, v124
 v_mfma_f32_16x16x32_bf16 v[48:51], a[252:255], a[236:239], v[48:51]
 ds_read_b128 a[252:255], v193 offset:53248
 s_waitcnt lgkmcnt(2)
 v_mfma_f32_16x16x32_bf16 v[20:23], a[240:243], a[160:163], v[136:139]
 buffer_load_dwordx4 v219, s[32:35], s46 offen offset:3072 nt lds
 v_mfma_f32_16x16x32_bf16 v[28:31], a[240:243], a[176:179], v[140:143]
 v_exp_f32 v179, v91
 v_mfma_f32_16x16x32_bf16 v[36:39], a[240:243], a[192:195], v[144:147]
 v_exp_f32 v180, v92
 v_mfma_f32_16x16x32_bf16 v[44:47], a[240:243], a[208:211], v[148:151]
 v_exp_f32 v181, v93
 v_mfma_f32_16x16x32_bf16 v[52:55], a[240:243], a[224:227], v[152:155]
 v_cvt_pk_bf16_f32 v133, v178, v179
 s_barrier
 v_mfma_f32_16x16x32_bf16 v[20:23], a[244:247], a[164:167], v[20:23]
 v_exp_f32 v182, v94
 v_mfma_f32_16x16x32_bf16 v[28:31], a[244:247], a[180:183], v[28:31]
 ds_read_b64_tr_b16 a[240:241], v198 offset:16384
 ds_read_b64_tr_b16 a[242:243], v198 offset:20480
 v_mfma_f32_16x16x32_bf16 v[36:39], a[244:247], a[196:199], v[36:39]
 v_exp_f32 v183, v95
 v_mfma_f32_16x16x32_bf16 v[44:47], a[244:247], a[212:215], v[44:47]
 v_cvt_pk_bf16_f32 v134, v180, v181
 v_cvt_pk_bf16_f32 v135, v182, v183
 v_mfma_f32_16x16x32_bf16 v[52:55], a[244:247], a[228:231], v[52:55]
 ds_read_b64_tr_b16 a[244:245], v199 offset:16384
 s_waitcnt lgkmcnt(3)
 v_mfma_f32_16x16x32_bf16 v[20:23], a[248:251], a[168:171], v[20:23]
 ds_read_b64_tr_b16 a[246:247], v199 offset:20480
 v_or3_b32 v188, v188, v125, v126
 v_mfma_f32_16x16x32_bf16 v[28:31], a[248:251], a[184:187], v[28:31]
 s_waitcnt vmcnt(6)
 s_add_u32 m0, s44, 16384
 v_mfma_f32_16x16x32_bf16 v[36:39], a[248:251], a[200:203], v[36:39]
 s_mov_b32 s46, 180224
 v_or3_b32 v188, v188, v127, v128
 v_mfma_f32_16x16x32_bf16 v[44:47], a[248:251], a[216:219], v[44:47]
 buffer_load_dwordx4 v214, s[28:31], s46 offen offset:0 nt lds
 v_mfma_f32_16x16x32_bf16 v[52:55], a[248:251], a[232:235], v[52:55]
 ds_read_b64_tr_b16 a[248:249], v200 offset:16384
 ds_read_b64_tr_b16 a[250:251], v200 offset:20480
 v_mfma_f32_16x16x32_bf16 v[20:23], a[252:255], a[172:175], v[20:23]
 v_or3_b32 v188, v188, v129, v130
 v_or3_b32 v188, v188, v131, v132
 v_mfma_f32_16x16x32_bf16 v[28:31], a[252:255], a[188:191], v[28:31]
 v_or3_b32 v188, v188, v133, v134
 v_bitop3_b32 v188, v188, v135, s45 bitop3:0xa8
 v_mfma_f32_16x16x32_bf16 v[36:39], a[252:255], a[204:207], v[36:39]
 v_cmp_ne_u32 vcc, 0, v188
 v_mfma_f32_16x16x32_bf16 v[44:47], a[252:255], a[220:223], v[44:47]
 v_mfma_f32_16x16x32_bf16 v[52:55], a[252:255], a[236:239], v[52:55]
 s_cbranch_vccnz L_rareb8
L_rareb8_back:
 v_mfma_f32_16x16x32_bf16 v[156:159], v[184:187], v[116:119], v[156:159]
 v_mfma_f32_16x16x32_bf16 v[160:163], v[184:187], v[120:123], v[160:163]
 v_exp_f32 v176, v16
 v_mfma_f32_16x16x32_bf16 v[164:167], v[184:187], v[124:127], v[164:167]
 v_exp_f32 v177, v17
 v_mfma_f32_16x16x32_bf16 v[168:171], v[184:187], v[128:131], v[168:171]
 v_exp_f32 v178, v18
 v_mfma_f32_16x16x32_bf16 v[172:175], v[184:187], v[132:135], v[172:175]
 ds_read_b64_tr_b16 a[252:253], v201 offset:16384
 s_waitcnt lgkmcnt(3)
 v_mfma_f32_16x16x32_bf16 a[0:3], a[240:243], v[116:119], a[0:3]
 s_waitcnt vmcnt(6)
 buffer_load_dwordx4 v215, s[28:31], s46 offen offset:1024 nt lds
 v_mfma_f32_16x16x32_bf16 a[4:7], a[240:243], v[120:123], a[4:7]
 ds_read_b64_tr_b16 a[254:255], v201 offset:20480
 v_cvt_pk_bf16_f32 v96, v176, v177
 v_mfma_f32_16x16x32_bf16 a[8:11], a[240:243], v[124:127], a[8:11]
 v_exp_f32 v179, v19
 v_mfma_f32_16x16x32_bf16 a[12:15], a[240:243], v[128:131], a[12:15]
 v_exp_f32 v180, v20
 v_mfma_f32_16x16x32_bf16 a[16:19], a[240:243], v[132:135], a[16:19]
 v_exp_f32 v181, v21
 v_mfma_f32_16x16x32_bf16 a[20:23], a[244:247], v[116:119], a[20:23]
 ds_read_b64_tr_b16 a[240:241], v202 offset:16384
 ds_read_b64_tr_b16 a[242:243], v202 offset:20480
 v_mfma_f32_16x16x32_bf16 a[24:27], a[244:247], v[120:123], a[24:27]
 v_exp_f32 v182, v22
 v_mfma_f32_16x16x32_bf16 a[28:31], a[244:247], v[124:127], a[28:31]
 v_exp_f32 v183, v23
 v_mfma_f32_16x16x32_bf16 a[32:35], a[244:247], v[128:131], a[32:35]
 v_exp_f32 v176, v24
 v_mfma_f32_16x16x32_bf16 a[36:39], a[244:247], v[132:135], a[36:39]
 v_cvt_pk_bf16_f32 v97, v178, v179
 s_waitcnt lgkmcnt(2)
 v_mfma_f32_16x16x32_bf16 a[40:43], a[248:251], v[116:119], a[40:43]
 ds_read_b64_tr_b16 a[244:245], v203 offset:16384
 ds_read_b64_tr_b16 a[246:247], v203 offset:20480
 v_mfma_f32_16x16x32_bf16 a[44:47], a[248:251], v[120:123], a[44:47]
 v_exp_f32 v177, v25
 v_mfma_f32_16x16x32_bf16 a[48:51], a[248:251], v[124:127], a[48:51]
 v_exp_f32 v178, v26
 v_mfma_f32_16x16x32_bf16 a[52:55], a[248:251], v[128:131], a[52:55]
 v_cvt_pk_bf16_f32 v98, v180, v181
 s_waitcnt vmcnt(6)
 buffer_load_dwordx4 v216, s[28:31], s46 offen offset:2048 nt lds
 v_mfma_f32_16x16x32_bf16 a[56:59], a[248:251], v[132:135], a[56:59]
 v_exp_f32 v179, v27
 v_mfma_f32_16x16x32_bf16 a[60:63], a[252:255], v[116:119], a[60:63]
 ds_read_b64_tr_b16 a[248:249], v204 offset:16384
 ds_read_b64_tr_b16 a[250:251], v204 offset:20480
 v_mfma_f32_16x16x32_bf16 a[64:67], a[252:255], v[120:123], a[64:67]
 v_exp_f32 v180, v28
 v_mfma_f32_16x16x32_bf16 a[68:71], a[252:255], v[124:127], a[68:71]
 v_cvt_pk_bf16_f32 v99, v182, v183
 v_cvt_pk_bf16_f32 v100, v176, v177
 v_mfma_f32_16x16x32_bf16 a[72:75], a[252:255], v[128:131], a[72:75]
 v_exp_f32 v181, v29
 v_mfma_f32_16x16x32_bf16 a[76:79], a[252:255], v[132:135], a[76:79]
 ds_read_b64_tr_b16 a[252:253], v205 offset:16384
 s_waitcnt lgkmcnt(3)
 v_mfma_f32_16x16x32_bf16 a[80:83], a[240:243], v[116:119], a[80:83]
 ds_read_b64_tr_b16 a[254:255], v205 offset:20480
 v_cvt_pk_bf16_f32 v101, v178, v179
 v_mfma_f32_16x16x32_bf16 a[84:87], a[240:243], v[120:123], a[84:87]
 v_exp_f32 v182, v30
 v_mfma_f32_16x16x32_bf16 a[88:91], a[240:243], v[124:127], a[88:91]
 v_exp_f32 v183, v31
 v_mfma_f32_16x16x32_bf16 a[92:95], a[240:243], v[128:131], a[92:95]
 v_exp_f32 v176, v32
 v_mfma_f32_16x16x32_bf16 a[96:99], a[240:243], v[132:135], a[96:99]
 ds_read_b128 a[240:243], v194 offset:0
 s_waitcnt vmcnt(6)
 v_mfma_f32_16x16x32_bf16 a[100:103], a[244:247], v[116:119], a[100:103]
 buffer_load_dwordx4 v217, s[28:31], s46 offen offset:3072 nt lds
 v_mfma_f32_16x16x32_bf16 a[104:107], a[244:247], v[120:123], a[104:107]
 v_exp_f32 v177, v33
 v_mfma_f32_16x16x32_bf16 a[108:111], a[244:247], v[124:127], a[108:111]
 v_exp_f32 v178, v34
 v_mfma_f32_16x16x32_bf16 a[112:115], a[244:247], v[128:131], a[112:115]
 v_cvt_pk_bf16_f32 v102, v180, v181
 v_cvt_pk_bf16_f32 v103, v182, v183
 v_mfma_f32_16x16x32_bf16 a[116:119], a[244:247], v[132:135], a[116:119]
 ds_read_b128 a[244:247], v195 offset:0
 s_waitcnt lgkmcnt(2)
 v_mfma_f32_16x16x32_bf16 a[120:123], a[248:251], v[116:119], a[120:123]
 v_exp_f32 v179, v35
 v_mfma_f32_16x16x32_bf16 a[124:127], a[248:251], v[120:123], a[124:127]
 v_exp_f32 v180, v36
 v_mfma_f32_16x16x32_bf16 a[128:131], a[248:251], v[124:127], a[128:131]
 v_cvt_pk_bf16_f32 v104, v176, v177
 v_cvt_pk_bf16_f32 v105, v178, v179
 v_mfma_f32_16x16x32_bf16 a[132:135], a[248:251], v[128:131], a[132:135]
 v_exp_f32 v181, v37
 v_mfma_f32_16x16x32_bf16 a[136:139], a[248:251], v[132:135], a[136:139]
 v_exp_f32 v182, v38
 v_mfma_f32_16x16x32_bf16 a[140:143], a[252:255], v[116:119], a[140:143]
 ds_read_b128 a[248:251], v196 offset:0
 s_waitcnt vmcnt(6)
 v_mfma_f32_16x16x32_bf16 a[144:147], a[252:255], v[120:123], a[144:147]
 s_add_u32 m0, s44, 98304
 s_mov_b32 s46, 163840
 v_mfma_f32_16x16x32_bf16 a[148:151], a[252:255], v[124:127], a[148:151]
 buffer_load_dwordx4 v218, s[32:35], s46 offen offset:0 nt lds
 v_mfma_f32_16x16x32_bf16 a[152:155], a[252:255], v[128:131], a[152:155]
 v_exp_f32 v183, v39
 v_mfma_f32_16x16x32_bf16 a[156:159], a[252:255], v[132:135], a[156:159]
 ds_read_b128 a[252:255], v197 offset:0
 s_waitcnt lgkmcnt(2)
 v_mfma_f32_16x16x32_bf16 v[56:59], a[240:243], a[160:163], v[136:139]
 v_exp_f32 v176, v40
 v_mfma_f32_16x16x32_bf16 v[64:67], a[240:243], a[176:179], v[140:143]
 v_exp_f32 v177, v41
 v_mfma_f32_16x16x32_bf16 v[72:75], a[240:243], a[192:195], v[144:147]
 v_exp_f32 v178, v42
 v_mfma_f32_16x16x32_bf16 v[80:83], a[240:243], a[208:211], v[148:151]
 v_cvt_pk_bf16_f32 v106, v180, v181
 v_cvt_pk_bf16_f32 v107, v182, v183
 v_mfma_f32_16x16x32_bf16 v[88:91], a[240:243], a[224:227], v[152:155]
 v_exp_f32 v179, v43
 v_mfma_f32_16x16x32_bf16 v[56:59], a[244:247], a[164:167], v[56:59]
 ds_read_b128 a[240:243], v194 offset:4096
 v_cvt_pk_bf16_f32 v108, v176, v177
 v_mfma_f32_16x16x32_bf16 v[64:67], a[244:247], a[180:183], v[64:67]
 v_exp_f32 v180, v44
 v_mfma_f32_16x16x32_bf16 v[72:75], a[244:247], a[196:199], v[72:75]
 s_waitcnt vmcnt(6)
 v_cvt_pk_bf16_f32 v109, v178, v179
 v_mfma_f32_16x16x32_bf16 v[80:83], a[244:247], a[212:215], v[80:83]
 buffer_load_dwordx4 v219, s[32:35], s46 offen offset:1024 nt lds
 v_mfma_f32_16x16x32_bf16 v[88:91], a[244:247], a[228:231], v[88:91]
 ds_read_b128 a[244:247], v195 offset:4096
 s_waitcnt lgkmcnt(2)
 v_mfma_f32_16x16x32_bf16 v[56:59], a[248:251], a[168:171], v[56:59]
 v_exp_f32 v181, v45
 v_mfma_f32_16x16x32_bf16 v[64:67], a[248:251], a[184:187], v[64:67]
 v_exp_f32 v182, v46
 v_mfma_f32_16x16x32_bf16 v[72:75], a[248:251], a[200:203], v[72:75]
 v_exp_f32 v183, v47
 v_mfma_f32_16x16x32_bf16 v[80:83], a[248:251], a[216:219], v[80:83]
 v_exp_f32 v176, v48
 v_mfma_f32_16x16x32_bf16 v[88:91], a[248:251], a[232:235], v[88:91]
 ds_read_b128 a[248:251], v196 offset:4096
 v_cvt_pk_bf16_f32 v110, v180, v181
 v_mfma_f32_16x16x32_bf16 v[56:59], a[252:255], a[172:175], v[56:59]
 v_exp_f32 v177, v49
 v_mfma_f32_16x16x32_bf16 v[64:67], a[252:255], a[188:191], v[64:67]
 v_cvt_pk_bf16_f32 v111, v182, v183
 v_cvt_pk_bf16_f32 v112, v176, v177
 v_mfma_f32_16x16x32_bf16 v[72:75], a[252:255], a[204:207], v[72:75]
 v_exp_f32 v178, v50
 v_mfma_f32_16x16x32_bf16 v[80:83], a[252:255], a[220:223], v[80:83]
 s_waitcnt vmcnt(6)
 v_or3_b32 v188, v96, v97, v98
 v_mfma_f32_16x16x32_bf16 v[88:91], a[252:255], a[236:239], v[88:91]
 ds_read_b128 a[252:255], v197 offset:4096
 s_waitcnt lgkmcnt(2)
 v_mfma_f32_16x16x32_bf16 v[60:63], a[240:243], a[160:163], v[136:139]
 buffer_load_dwordx4 v218, s[32:35], s46 offen offset:2048 nt lds
 v_mfma_f32_16x16x32_bf16 v[68:71], a[240:243], a[176:179], v[140:143]
 v_exp_f32 v179, v51
 v_mfma_f32_16x16x32_bf16 v[76:79], a[240:243], a[192:195], v[144:147]
 v_exp_f32 v180, v52
 v_mfma_f32_16x16x32_bf16 v[84:87], a[240:243], a[208:211], v[148:151]
 v_exp_f32 v181, v53
 v_mfma_f32_16x16x32_bf16 v[92:95], a[240:243], a[224:227], v[152:155]
 v_cvt_pk_bf16_f32 v113, v178, v179
 s_barrier
 v_mfma_f32_16x16x32_bf16 v[60:63], a[244:247], a[164:167], v[60:63]
 v_exp_f32 v182, v54
 v_mfma_f32_16x16x32_bf16 v[68:71], a[244:247], a[180:183], v[68:71]
 ds_read_b64_tr_b16 a[240:241], v198 offset:49152
 ds_read_b64_tr_b16 a[242:243], v198 offset:53248
 v_mfma_f32_16x16x32_bf16 v[76:79], a[244:247], a[196:199], v[76:79]
 v_exp_f32 v183, v55
 v_mfma_f32_16x16x32_bf16 v[84:87], a[244:247], a[212:215], v[84:87]
 v_cvt_pk_bf16_f32 v114, v180, v181
 v_cvt_pk_bf16_f32 v115, v182, v183
 v_mfma_f32_16x16x32_bf16 v[92:95], a[244:247], a[228:231], v[92:95]
 ds_read_b64_tr_b16 a[244:245], v199 offset:49152
 s_waitcnt lgkmcnt(3)
 v_mfma_f32_16x16x32_bf16 v[60:63], a[248:251], a[168:171], v[60:63]
 ds_read_b64_tr_b16 a[246:247], v199 offset:53248
 v_or3_b32 v188, v188, v99, v100
 v_mfma_f32_16x16x32_bf16 v[68:71], a[248:251], a[184:187], v[68:71]
 v_or3_b32 v188, v188, v101, v102
 v_or3_b32 v188, v188, v103, v104
 v_mfma_f32_16x16x32_bf16 v[76:79], a[248:251], a[200:203], v[76:79]
 s_waitcnt vmcnt(6)
 v_or3_b32 v188, v188, v105, v106
 v_mfma_f32_16x16x32_bf16 v[84:87], a[248:251], a[216:219], v[84:87]
 buffer_load_dwordx4 v219, s[32:35], s46 offen offset:3072 nt lds
 v_mfma_f32_16x16x32_bf16 v[92:95], a[248:251], a[232:235], v[92:95]
 ds_read_b64_tr_b16 a[248:249], v200 offset:49152
 ds_read_b64_tr_b16 a[250:251], v200 offset:53248
 v_mfma_f32_16x16x32_bf16 v[60:63], a[252:255], a[172:175], v[60:63]
 v_or3_b32 v188, v188, v107, v108
 v_or3_b32 v188, v188, v109, v110
 v_mfma_f32_16x16x32_bf16 v[68:71], a[252:255], a[188:191], v[68:71]
 v_or3_b32 v188, v188, v111, v112
 v_or3_b32 v188, v188, v113, v114
 v_mfma_f32_16x16x32_bf16 v[76:79], a[252:255], a[204:207], v[76:79]
 v_bitop3_b32 v188, v188, v115, s45 bitop3:0xa8
 v_cmp_ne_u32 vcc, 0, v188
 v_mfma_f32_16x16x32_bf16 v[84:87], a[252:255], a[220:223], v[84:87]
 v_mfma_f32_16x16x32_bf16 v[92:95], a[252:255], a[236:239], v[92:95]
 s_cbranch_vccnz L_rareb9
L_rareb9_back:
 v_mfma_f32_16x16x32_bf16 v[156:159], v[184:187], v[96:99], v[156:159]
 v_mfma_f32_16x16x32_bf16 v[160:163], v[184:187], v[100:103], v[160:163]
 v_exp_f32 v176, v56
 v_mfma_f32_16x16x32_bf16 v[164:167], v[184:187], v[104:107], v[164:167]
 v_exp_f32 v177, v57
 v_mfma_f32_16x16x32_bf16 v[168:171], v[184:187], v[108:111], v[168:171]
 v_exp_f32 v178, v58
 v_mfma_f32_16x16x32_bf16 v[172:175], v[184:187], v[112:115], v[172:175]
 ds_read_b64_tr_b16 a[252:253], v201 offset:49152
 s_waitcnt lgkmcnt(3)
 v_mfma_f32_16x16x32_bf16 a[0:3], a[240:243], v[96:99], a[0:3]
 ds_read_b64_tr_b16 a[254:255], v201 offset:53248
 s_waitcnt vmcnt(6)
 v_mfma_f32_16x16x32_bf16 a[4:7], a[240:243], v[100:103], a[4:7]
 s_add_u32 m0, s44, 32768
 s_mov_b32 s46, 196608
 buffer_load_dwordx4 v214, s[28:31], s46 offen offset:0 nt lds
 v_mfma_f32_16x16x32_bf16 a[8:11], a[240:243], v[104:107], a[8:11]
 v_exp_f32 v179, v59
 v_mfma_f32_16x16x32_bf16 a[12:15], a[240:243], v[108:111], a[12:15]
 v_exp_f32 v180, v60
 v_mfma_f32_16x16x32_bf16 a[16:19], a[240:243], v[112:115], a[16:19]
 v_exp_f32 v181, v61
 v_mfma_f32_16x16x32_bf16 a[20:23], a[244:247], v[96:99], a[20:23]
 ds_read_b64_tr_b16 a[240:241], v202 offset:49152
 ds_read_b64_tr_b16 a[242:243], v202 offset:53248
 v_mfma_f32_16x16x32_bf16 a[24:27], a[244:247], v[100:103], a[24:27]
 v_exp_f32 v182, v62
 v_mfma_f32_16x16x32_bf16 a[28:31], a[244:247], v[104:107], a[28:31]
 v_cvt_pk_bf16_f32 v116, v176, v177
 v_cvt_pk_bf16_f32 v117, v178, v179
 v_mfma_f32_16x16x32_bf16 a[32:35], a[244:247], v[108:111], a[32:35]
 v_exp_f32 v183, v63
 v_mfma_f32_16x16x32_bf16 a[36:39], a[244:247], v[112:115], a[36:39]
 ds_read_b64_tr_b16 a[244:245], v203 offset:49152
 s_waitcnt lgkmcnt(3)
 v_mfma_f32_16x16x32_bf16 a[40:43], a[248:251], v[96:99], a[40:43]
 ds_read_b64_tr_b16 a[246:247], v203 offset:53248
 v_cvt_pk_bf16_f32 v118, v180, v181
 v_mfma_f32_16x16x32_bf16 a[44:47], a[248:251], v[100:103], a[44:47]
 v_exp_f32 v176, v64
 v_mfma_f32_16x16x32_bf16 a[48:51], a[248:251], v[104:107], a[48:51]
 v_exp_f32 v177, v65
 v_mfma_f32_16x16x32_bf16 a[52:55], a[248:251], v[108:111], a[52:55]
 s_waitcnt vmcnt(6)
 buffer_load_dwordx4 v215, s[28:31], s46 offen offset:1024 nt lds
 v_mfma_f32_16x16x32_bf16 a[56:59], a[248:251], v[112:115], a[56:59]
 v_exp_f32 v178, v66
 v_mfma_f32_16x16x32_bf16 a[60:63], a[252:255], v[96:99], a[60:63]
 ds_read_b64_tr_b16 a[248:249], v204 offset:49152
 ds_read_b64_tr_b16 a[250:251], v204 offset:53248
 v_mfma_f32_16x16x32_bf16 a[64:67], a[252:255], v[100:103], a[64:67]
 v_exp_f32 v179, v67
 v_mfma_f32_16x16x32_bf16 a[68:71], a[252:255], v[104:107], a[68:71]
 v_exp_f32 v180, v68
 v_mfma_f32_16x16x32_bf16 a[72:75], a[252:255], v[108:111], a[72:75]
 v_cvt_pk_bf16_f32 v119, v182, v183
 v_cvt_pk_bf16_f32 v120, v176, v177
 v_mfma_f32_16x16x32_bf16 a[76:79], a[252:255], v[112:115], a[76:79]
 ds_read_b64_tr_b16 a[252:253], v205 offset:49152
 s_waitcnt lgkmcnt(3)
 v_mfma_f32_16x16x32_bf16 a[80:83], a[240:243], v[96:99], a[80:83]
 ds_read_b64_tr_b16 a[254:255], v205 offset:53248
 v_cvt_pk_bf16_f32 v121, v178, v179
 v_mfma_f32_16x16x32_bf16 a[84:87], a[240:243], v[100:103], a[84:87]
 v_exp_f32 v181, v69
 v_mfma_f32_16x16x32_bf16 a[88:91], a[240:243], v[104:107], a[88:91]
 v_exp_f32 v182, v70
 v_mfma_f32_16x16x32_bf16 a[92:95], a[240:243], v[108:111], a[92:95]
 v_exp_f32 v183, v71
 v_mfma_f32_16x16x32_bf16 a[96:99], a[240:243], v[112:115], a[96:99]
 v_exp_f32 v176, v72
 v_mfma_f32_16x16x32_bf16 a[100:103], a[244:247], v[96:99], a[100:103]
 s_waitcnt vmcnt(6)
 buffer_load_dwordx4 v216, s[28:31], s46 offen offset:2048 nt lds
 v_mfma_f32_16x16x32_bf16 a[104:107], a[244:247], v[100:103], a[104:107]
 ds_read_b128 a[240:243], v190 offset:0
 v_cvt_pk_bf16_f32 v122, v180, v181
 v_mfma_f32_16x16x32_bf16 a[108:111], a[244:247], v[104:107], a[108:111]
 v_exp_f32 v177, v73
 v_mfma_f32_16x16x32_bf16 a[112:115], a[244:247], v[108:111], a[112:115]
 v_exp_f32 v178, v74
 v_mfma_f32_16x16x32_bf16 a[116:119], a[244:247], v[112:115], a[116:119]
 ds_read_b128 a[244:247], v191 offset:0
 s_waitcnt lgkmcnt(2)
 v_mfma_f32_16x16x32_bf16 a[120:123], a[248:251], v[96:99], a[120:123]
 v_exp_f32 v179, v75
 v_mfma_f32_16x16x32_bf16 a[124:127], a[248:251], v[100:103], a[124:127]
 v_exp_f32 v180, v76
 v_mfma_f32_16x16x32_bf16 a[128:131], a[248:251], v[104:107], a[128:131]
 v_cvt_pk_bf16_f32 v123, v182, v183
 v_cvt_pk_bf16_f32 v124, v176, v177
 v_mfma_f32_16x16x32_bf16 a[132:135], a[248:251], v[108:111], a[132:135]
 v_exp_f32 v181, v77
 v_mfma_f32_16x16x32_bf16 a[136:139], a[248:251], v[112:115], a[136:139]
 v_exp_f32 v182, v78
 v_mfma_f32_16x16x32_bf16 a[140:143], a[252:255], v[96:99], a[140:143]
 ds_read_b128 a[248:251], v192 offset:0
 s_waitcnt vmcnt(6)
 v_mfma_f32_16x16x32_bf16 a[144:147], a[252:255], v[100:103], a[144:147]
 buffer_load_dwordx4 v217, s[28:31], s46 offen offset:3072 nt lds
 v_mfma_f32_16x16x32_bf16 a[148:151], a[252:255], v[104:107], a[148:151]
 v_exp_f32 v183, v79
 v_mfma_f32_16x16x32_bf16 a[152:155], a[252:255], v[108:111], a[152:155]
 v_exp_f32 v176, v80
 v_mfma_f32_16x16x32_bf16 a[156:159], a[252:255], v[112:115], a[156:159]
 v_cvt_pk_bf16_f32 v125, v178, v179
 s_waitcnt lgkmcnt(1)
 v_mfma_f32_16x16x32_bf16 v[16:19], a[240:243], a[160:163], v[136:139]
 ds_read_b128 a[252:255], v193 offset:0
 v_cvt_pk_bf16_f32 v126, v180, v181
 v_mfma_f32_16x16x32_bf16 v[24:27], a[240:243], a[176:179], v[140:143]
 v_exp_f32 v177, v81
 v_mfma_f32_16x16x32_bf16 v[32:35], a[240:243], a[192:195], v[144:147]
 v_exp_f32 v178, v82
 v_mfma_f32_16x16x32_bf16 v[40:43], a[240:243], a[208:211], v[148:151]
 v_cvt_pk_bf16_f32 v127, v182, v183
 v_cvt_pk_bf16_f32 v128, v176, v177
 v_mfma_f32_16x16x32_bf16 v[48:51], a[240:243], a[224:227], v[152:155]
 v_exp_f32 v179, v83
 v_mfma_f32_16x16x32_bf16 v[16:19], a[244:247], a[164:167], v[16:19]
 ds_read_b128 a[240:243], v190 offset:4096
 v_cvt_pk_bf16_f32 v129, v178, v179
 v_mfma_f32_16x16x32_bf16 v[24:27], a[244:247], a[180:183], v[24:27]
 v_exp_f32 v180, v84
 v_mfma_f32_16x16x32_bf16 v[32:35], a[244:247], a[196:199], v[32:35]
 s_waitcnt vmcnt(6)
 s_add_u32 m0, s44, 81920
 v_mfma_f32_16x16x32_bf16 v[40:43], a[244:247], a[212:215], v[40:43]
 s_mov_b32 s46, 180224
 v_or3_b32 v188, v116, v117, v118
 v_mfma_f32_16x16x32_bf16 v[48:51], a[244:247], a[228:231], v[48:51]
 ds_read_b128 a[244:247], v191 offset:4096
 s_waitcnt lgkmcnt(2)
 v_mfma_f32_16x16x32_bf16 v[16:19], a[248:251], a[168:171], v[16:19]
 buffer_load_dwordx4 v218, s[32:35], s46 offen offset:0 nt lds
 v_mfma_f32_16x16x32_bf16 v[24:27], a[248:251], a[184:187], v[24:27]
 v_exp_f32 v181, v85
 v_mfma_f32_16x16x32_bf16 v[32:35], a[248:251], a[200:203], v[32:35]
 v_exp_f32 v182, v86
 v_mfma_f32_16x16x32_bf16 v[40:43], a[248:251], a[216:219], v[40:43]
 v_exp_f32 v183, v87
 v_mfma_f32_16x16x32_bf16 v[48:51], a[248:251], a[232:235], v[48:51]
 v_exp_f32 v176, v88
 v_mfma_f32_16x16x32_bf16 v[16:19], a[252:255], a[172:175], v[16:19]
 ds_read_b128 a[248:251], v192 offset:4096
 v_cvt_pk_bf16_f32 v130, v180, v181
 v_mfma_f32_16x16x32_bf16 v[24:27], a[252:255], a[188:191], v[24:27]
 v_exp_f32 v177, v89
 v_mfma_f32_16x16x32_bf16 v[32:35], a[252:255], a[204:207], v[32:35]
 v_exp_f32 v178, v90
 v_mfma_f32_16x16x32_bf16 v[40:43], a[252:255], a[220:223], v[40:43]
 v_cvt_pk_bf16_f32 v131, v182, v183
 v_cvt_pk_bf16_f32 v132, v176, v177
 v_mfma_f32_16x16x32_bf16 v[48:51], a[252:255], a[236:239], v[48:51]
 ds_read_b128 a[252:255], v193 offset:4096
 s_waitcnt lgkmcnt(2)
 v_mfma_f32_16x16x32_bf16 v[20:23], a[240:243], a[160:163], v[136:139]
 v_exp_f32 v179, v91
 v_mfma_f32_16x16x32_bf16 v[28:31], a[240:243], a[176:179], v[140:143]
 v_exp_f32 v180, v92
 v_mfma_f32_16x16x32_bf16 v[36:39], a[240:243], a[192:195], v[144:147]
 s_waitcnt vmcnt(6)
 buffer_load_dwordx4 v219, s[32:35], s46 offen offset:1024 nt lds
 v_mfma_f32_16x16x32_bf16 v[44:47], a[240:243], a[208:211], v[148:151]
 v_exp_f32 v181, v93
 v_mfma_f32_16x16x32_bf16 v[52:55], a[240:243], a[224:227], v[152:155]
 v_cvt_pk_bf16_f32 v133, v178, v179
 s_barrier
 v_mfma_f32_16x16x32_bf16 v[20:23], a[244:247], a[164:167], v[20:23]
 v_exp_f32 v182, v94
 v_mfma_f32_16x16x32_bf16 v[28:31], a[244:247], a[180:183], v[28:31]
 ds_read_b64_tr_b16 a[240:241], v198 offset:0
 ds_read_b64_tr_b16 a[242:243], v198 offset:4096
 v_mfma_f32_16x16x32_bf16 v[36:39], a[244:247], a[196:199], v[36:39]
 v_exp_f32 v183, v95
 v_mfma_f32_16x16x32_bf16 v[44:47], a[244:247], a[212:215], v[44:47]
 v_cvt_pk_bf16_f32 v134, v180, v181
 v_cvt_pk_bf16_f32 v135, v182, v183
 v_mfma_f32_16x16x32_bf16 v[52:55], a[244:247], a[228:231], v[52:55]
 ds_read_b64_tr_b16 a[244:245], v199 offset:0
 s_waitcnt lgkmcnt(3)
 v_mfma_f32_16x16x32_bf16 v[20:23], a[248:251], a[168:171], v[20:23]
 ds_read_b64_tr_b16 a[246:247], v199 offset:4096
 v_or3_b32 v188, v188, v119, v120
 v_mfma_f32_16x16x32_bf16 v[28:31], a[248:251], a[184:187], v[28:31]
 v_or3_b32 v188, v188, v121, v122
 v_or3_b32 v188, v188, v123, v124
 v_mfma_f32_16x16x32_bf16 v[36:39], a[248:251], a[200:203], v[36:39]
 s_waitcnt vmcnt(6)
 v_or3_b32 v188, v188, v125, v126
 v_mfma_f32_16x16x32_bf16 v[44:47], a[248:251], a[216:219], v[44:47]
 buffer_load_dwordx4 v218, s[32:35], s46 offen offset:2048 nt lds
 v_mfma_f32_16x16x32_bf16 v[52:55], a[248:251], a[232:235], v[52:55]
 ds_read_b64_tr_b16 a[248:249], v200 offset:0
 ds_read_b64_tr_b16 a[250:251], v200 offset:4096
 v_mfma_f32_16x16x32_bf16 v[20:23], a[252:255], a[172:175], v[20:23]
 v_or3_b32 v188, v188, v127, v128
 v_or3_b32 v188, v188, v129, v130
 v_mfma_f32_16x16x32_bf16 v[28:31], a[252:255], a[188:191], v[28:31]
 v_or3_b32 v188, v188, v131, v132
 v_or3_b32 v188, v188, v133, v134
 v_mfma_f32_16x16x32_bf16 v[36:39], a[252:255], a[204:207], v[36:39]
 v_bitop3_b32 v188, v188, v135, s45 bitop3:0xa8
 v_cmp_ne_u32 vcc, 0, v188
 v_mfma_f32_16x16x32_bf16 v[44:47], a[252:255], a[220:223], v[44:47]
 v_mfma_f32_16x16x32_bf16 v[52:55], a[252:255], a[236:239], v[52:55]
 s_cbranch_vccnz L_rareb10
L_rareb10_back:
 v_mfma_f32_16x16x32_bf16 v[156:159], v[184:187], v[116:119], v[156:159]
 v_mfma_f32_16x16x32_bf16 v[160:163], v[184:187], v[120:123], v[160:163]
 v_exp_f32 v176, v16
 v_mfma_f32_16x16x32_bf16 v[164:167], v[184:187], v[124:127], v[164:167]
 v_exp_f32 v177, v17
 v_mfma_f32_16x16x32_bf16 v[168:171], v[184:187], v[128:131], v[168:171]
 v_exp_f32 v178, v18
 v_mfma_f32_16x16x32_bf16 v[172:175], v[184:187], v[132:135], v[172:175]
 ds_read_b64_tr_b16 a[252:253], v201 offset:0
 s_waitcnt lgkmcnt(3)
 v_mfma_f32_16x16x32_bf16 a[0:3], a[240:243], v[116:119], a[0:3]
 ds_read_b64_tr_b16 a[254:255], v201 offset:4096
 s_waitcnt vmcnt(6)
 v_mfma_f32_16x16x32_bf16 a[4:7], a[240:243], v[120:123], a[4:7]
 buffer_load_dwordx4 v219, s[32:35], s46 offen offset:3072 nt lds
 v_mfma_f32_16x16x32_bf16 a[8:11], a[240:243], v[124:127], a[8:11]
 v_exp_f32 v179, v19
 v_mfma_f32_16x16x32_bf16 a[12:15], a[240:243], v[128:131], a[12:15]
 v_exp_f32 v180, v20
 v_mfma_f32_16x16x32_bf16 a[16:19], a[240:243], v[132:135], a[16:19]
 v_exp_f32 v181, v21
 v_mfma_f32_16x16x32_bf16 a[20:23], a[244:247], v[116:119], a[20:23]
 ds_read_b64_tr_b16 a[240:241], v202 offset:0
 ds_read_b64_tr_b16 a[242:243], v202 offset:4096
 v_mfma_f32_16x16x32_bf16 a[24:27], a[244:247], v[120:123], a[24:27]
 v_exp_f32 v182, v22
 v_mfma_f32_16x16x32_bf16 a[28:31], a[244:247], v[124:127], a[28:31]
 v_cvt_pk_bf16_f32 v96, v176, v177
 v_cvt_pk_bf16_f32 v97, v178, v179
 v_mfma_f32_16x16x32_bf16 a[32:35], a[244:247], v[128:131], a[32:35]
 v_exp_f32 v183, v23
 v_mfma_f32_16x16x32_bf16 a[36:39], a[244:247], v[132:135], a[36:39]
 ds_read_b64_tr_b16 a[244:245], v203 offset:0
 s_waitcnt lgkmcnt(3)
 v_mfma_f32_16x16x32_bf16 a[40:43], a[248:251], v[116:119], a[40:43]
 ds_read_b64_tr_b16 a[246:247], v203 offset:4096
 v_cvt_pk_bf16_f32 v98, v180, v181
 v_mfma_f32_16x16x32_bf16 a[44:47], a[248:251], v[120:123], a[44:47]
 v_exp_f32 v176, v24
 v_mfma_f32_16x16x32_bf16 a[48:51], a[248:251], v[124:127], a[48:51]
 v_exp_f32 v177, v25
 v_mfma_f32_16x16x32_bf16 a[52:55], a[248:251], v[128:131], a[52:55]
 s_waitcnt vmcnt(6)
 s_add_u32 m0, s44, 49152
 s_mov_b32 s46, 212992
 buffer_load_dwordx4 v214, s[28:31], s46 offen offset:0 nt lds
 v_mfma_f32_16x16x32_bf16 a[56:59], a[248:251], v[132:135], a[56:59]
 v_exp_f32 v178, v26
 v_mfma_f32_16x16x32_bf16 a[60:63], a[252:255], v[116:119], a[60:63]
 ds_read_b64_tr_b16 a[248:249], v204 offset:0
 ds_read_b64_tr_b16 a[250:251], v204 offset:4096
 v_mfma_f32_16x16x32_bf16 a[64:67], a[252:255], v[120:123], a[64:67]
 v_exp_f32 v179, v27
 v_mfma_f32_16x16x32_bf16 a[68:71], a[252:255], v[124:127], a[68:71]
 v_exp_f32 v180, v28
 v_mfma_f32_16x16x32_bf16 a[72:75], a[252:255], v[128:131], a[72:75]
 v_cvt_pk_bf16_f32 v99, v182, v183
 v_cvt_pk_bf16_f32 v100, v176, v177
 v_mfma_f32_16x16x32_bf16 a[76:79], a[252:255], v[132:135], a[76:79]
 ds_read_b64_tr_b16 a[252:253], v205 offset:0
 s_waitcnt lgkmcnt(3)
 v_mfma_f32_16x16x32_bf16 a[80:83], a[240:243], v[116:119], a[80:83]
 ds_read_b64_tr_b16 a[254:255], v205 offset:4096
 v_cvt_pk_bf16_f32 v101, v178, v179
 v_mfma_f32_16x16x32_bf16 a[84:87], a[240:243], v[120:123], a[84:87]
 v_exp_f32 v181, v29
 v_mfma_f32_16x16x32_bf16 a[88:91], a[240:243], v[124:127], a[88:91]
 v_exp_f32 v182, v30
 v_mfma_f32_16x16x32_bf16 a[92:95], a[240:243], v[128:131], a[92:95]
 v_exp_f32 v183, v31
 v_mfma_f32_16x16x32_bf16 a[96:99], a[240:243], v[132:135], a[96:99]
 v_exp_f32 v176, v32
 v_mfma_f32_16x16x32_bf16 a[100:103], a[244:247], v[116:119], a[100:103]
 ds_read_b128 a[240:243], v190 offset:16384
 s_waitcnt vmcnt(6)
 v_mfma_f32_16x16x32_bf16 a[104:107], a[244:247], v[120:123], a[104:107]
 buffer_load_dwordx4 v215, s[28:31], s46 offen offset:1024 nt lds
 v_mfma_f32_16x16x32_bf16 a[108:111], a[244:247], v[124:127], a[108:111]
 v_exp_f32 v177, v33
 v_mfma_f32_16x16x32_bf16 a[112:115], a[244:247], v[128:131], a[112:115]
 v_exp_f32 v178, v34
 v_mfma_f32_16x16x32_bf16 a[116:119], a[244:247], v[132:135], a[116:119]
 v_cvt_pk_bf16_f32 v102, v180, v181
 s_waitcnt lgkmcnt(1)
 v_mfma_f32_16x16x32_bf16 a[120:123], a[248:251], v[116:119], a[120:123]
 ds_read_b128 a[244:247], v191 offset:16384
 v_cvt_pk_bf16_f32 v103, v182, v183
 v_mfma_f32_16x16x32_bf16 a[124:127], a[248:251], v[120:123], a[124:127]
 v_exp_f32 v179, v35
 v_mfma_f32_16x16x32_bf16 a[128:131], a[248:251], v[124:127], a[128:131]
 v_exp_f32 v180, v36
 v_mfma_f32_16x16x32_bf16 a[132:135], a[248:251], v[128:131], a[132:135]
 v_exp_f32 v181, v37
 v_mfma_f32_16x16x32_bf16 a[136:139], a[248:251], v[132:135], a[136:139]
 v_exp_f32 v182, v38
 v_mfma_f32_16x16x32_bf16 a[140:143], a[252:255], v[116:119], a[140:143]
 v_cvt_pk_bf16_f32 v104, v176, v177
 ds_read_b128 a[248:251], v192 offset:16384
 v_mfma_f32_16x16x32_bf16 a[144:147], a[252:255], v[120:123], a[144:147]
 v_exp_f32 v183, v39
 v_mfma_f32_16x16x32_bf16 a[148:151], a[252:255], v[124:127], a[148:151]
 s_waitcnt vmcnt(6)
 v_cvt_pk_bf16_f32 v105, v178, v179
 v_mfma_f32_16x16x32_bf16 a[152:155], a[252:255], v[128:131], a[152:155]
 buffer_load_dwordx4 v216, s[28:31], s46 offen offset:2048 nt lds
 v_mfma_f32_16x16x32_bf16 a[156:159], a[252:255], v[132:135], a[156:159]
 ds_read_b128 a[252:255], v193 offset:16384
 s_waitcnt lgkmcnt(2)
 v_mfma_f32_16x16x32_bf16 v[56:59], a[240:243], a[160:163], v[136:139]
 v_exp_f32 v176, v40
 v_mfma_f32_16x16x32_bf16 v[64:67], a[240:243], a[176:179], v[140:143]
 v_exp_f32 v177, v41
 v_mfma_f32_16x16x32_bf16 v[72:75], a[240:243], a[192:195], v[144:147]
 v_exp_f32 v178, v42
 v_mfma_f32_16x16x32_bf16 v[80:83], a[240:243], a[208:211], v[148:151]
 v_cvt_pk_bf16_f32 v106, v180, v181
 v_cvt_pk_bf16_f32 v107, v182, v183
 v_mfma_f32_16x16x32_bf16 v[88:91], a[240:243], a[224:227], v[152:155]
 v_exp_f32 v179, v43
 v_mfma_f32_16x16x32_bf16 v[56:59], a[244:247], a[164:167], v[56:59]
 ds_read_b128 a[240:243], v190 offset:20480
 v_cvt_pk_bf16_f32 v108, v176, v177
 v_mfma_f32_16x16x32_bf16 v[64:67], a[244:247], a[180:183], v[64:67]
 v_exp_f32 v180, v44
 v_mfma_f32_16x16x32_bf16 v[72:75], a[244:247], a[196:199], v[72:75]
 v_cvt_pk_bf16_f32 v109, v178, v179
 s_waitcnt vmcnt(6)
 v_mfma_f32_16x16x32_bf16 v[80:83], a[244:247], a[212:215], v[80:83]
 buffer_load_dwordx4 v217, s[28:31], s46 offen offset:3072 nt lds
 v_mfma_f32_16x16x32_bf16 v[88:91], a[244:247], a[228:231], v[88:91]
 ds_read_b128 a[244:247], v191 offset:20480
 s_waitcnt lgkmcnt(2)
 v_mfma_f32_16x16x32_bf16 v[56:59], a[248:251], a[168:171], v[56:59]
 v_exp_f32 v181, v45
 v_mfma_f32_16x16x32_bf16 v[64:67], a[248:251], a[184:187], v[64:67]
 v_exp_f32 v182, v46
 v_mfma_f32_16x16x32_bf16 v[72:75], a[248:251], a[200:203], v[72:75]
 v_exp_f32 v183, v47
 v_mfma_f32_16x16x32_bf16 v[80:83], a[248:251], a[216:219], v[80:83]
 v_exp_f32 v176, v48
 v_mfma_f32_16x16x32_bf16 v[88:91], a[248:251], a[232:235], v[88:91]
 ds_read_b128 a[248:251], v192 offset:20480
 v_cvt_pk_bf16_f32 v110, v180, v181
 v_mfma_f32_16x16x32_bf16 v[56:59], a[252:255], a[172:175], v[56:59]
 v_exp_f32 v177, v49
 v_mfma_f32_16x16x32_bf16 v[64:67], a[252:255], a[188:191], v[64:67]
 v_cvt_pk_bf16_f32 v111, v182, v183
 v_cvt_pk_bf16_f32 v112, v176, v177
 v_mfma_f32_16x16x32_bf16 v[72:75], a[252:255], a[204:207], v[72:75]
 v_exp_f32 v178, v50
 v_mfma_f32_16x16x32_bf16 v[80:83], a[252:255], a[220:223], v[80:83]
 s_waitcnt vmcnt(6)
 s_add_u32 m0, s44, 114688
 v_mfma_f32_16x16x32_bf16 v[88:91], a[252:255], a[236:239], v[88:91]
 ds_read_b128 a[252:255], v193 offset:20480
 s_waitcnt lgkmcnt(2)
 v_mfma_f32_16x16x32_bf16 v[60:63], a[240:243], a[160:163], v[136:139]
 s_mov_b32 s46, 196608
 v_or3_b32 v188, v96, v97, v98
 v_mfma_f32_16x16x32_bf16 v[68:71], a[240:243], a[176:179], v[140:143]
 buffer_load_dwordx4 v218, s[32:35], s46 offen offset:0 nt lds
 v_mfma_f32_16x16x32_bf16 v[76:79], a[240:243], a[192:195], v[144:147]
 v_exp_f32 v179, v51
 v_mfma_f32_16x16x32_bf16 v[84:87], a[240:243], a[208:211], v[148:151]
 v_exp_f32 v180, v52
 v_mfma_f32_16x16x32_bf16 v[92:95], a[240:243], a[224:227], v[152:155]
 v_cvt_pk_bf16_f32 v113, v178, v179
 s_barrier
 v_mfma_f32_16x16x32_bf16 v[60:63], a[244:247], a[164:167], v[60:63]
 v_exp_f32 v181, v53
 v_mfma_f32_16x16x32_bf16 v[68:71], a[244:247], a[180:183], v[68:71]
 ds_read_b64_tr_b16 a[240:241], v198 offset:32768
 ds_read_b64_tr_b16 a[242:243], v198 offset:36864
 v_mfma_f32_16x16x32_bf16 v[76:79], a[244:247], a[196:199], v[76:79]
 v_exp_f32 v182, v54
 v_mfma_f32_16x16x32_bf16 v[84:87], a[244:247], a[212:215], v[84:87]
 v_exp_f32 v183, v55
 v_mfma_f32_16x16x32_bf16 v[92:95], a[244:247], a[228:231], v[92:95]
 ds_read_b64_tr_b16 a[244:245], v199 offset:32768
 s_waitcnt lgkmcnt(3)
 v_mfma_f32_16x16x32_bf16 v[60:63], a[248:251], a[168:171], v[60:63]
 ds_read_b64_tr_b16 a[246:247], v199 offset:36864
 v_cvt_pk_bf16_f32 v114, v180, v181
 v_mfma_f32_16x16x32_bf16 v[68:71], a[248:251], a[184:187], v[68:71]
 v_cvt_pk_bf16_f32 v115, v182, v183
 v_or3_b32 v188, v188, v99, v100
 v_mfma_f32_16x16x32_bf16 v[76:79], a[248:251], a[200:203], v[76:79]
 s_waitcnt vmcnt(6)
 v_or3_b32 v188, v188, v101, v102
 v_mfma_f32_16x16x32_bf16 v[84:87], a[248:251], a[216:219], v[84:87]
 buffer_load_dwordx4 v219, s[32:35], s46 offen offset:1024 nt lds
 v_mfma_f32_16x16x32_bf16 v[92:95], a[248:251], a[232:235], v[92:95]
 ds_read_b64_tr_b16 a[248:249], v200 offset:32768
 ds_read_b64_tr_b16 a[250:251], v200 offset:36864
 v_mfma_f32_16x16x32_bf16 v[60:63], a[252:255], a[172:175], v[60:63]
 v_or3_b32 v188, v188, v103, v104
 v_or3_b32 v188, v188, v105, v106
 v_mfma_f32_16x16x32_bf16 v[68:71], a[252:255], a[188:191], v[68:71]
 v_or3_b32 v188, v188, v107, v108
 v_or3_b32 v188, v188, v109, v110
 v_mfma_f32_16x16x32_bf16 v[76:79], a[252:255], a[204:207], v[76:79]
 v_or3_b32 v188, v188, v111, v112
 v_or3_b32 v188, v188, v113, v114
 v_mfma_f32_16x16x32_bf16 v[84:87], a[252:255], a[220:223], v[84:87]
 v_bitop3_b32 v188, v188, v115, s45 bitop3:0xa8
 v_cmp_ne_u32 vcc, 0, v188
 v_mfma_f32_16x16x32_bf16 v[92:95], a[252:255], a[236:239], v[92:95]
 s_cbranch_vccnz L_rareb11
L_rareb11_back:
 v_mfma_f32_16x16x32_bf16 v[156:159], v[184:187], v[96:99], v[156:159]
 v_mfma_f32_16x16x32_bf16 v[160:163], v[184:187], v[100:103], v[160:163]
 v_exp_f32 v176, v56
 v_mfma_f32_16x16x32_bf16 v[164:167], v[184:187], v[104:107], v[164:167]
 v_exp_f32 v177, v57
 v_mfma_f32_16x16x32_bf16 v[168:171], v[184:187], v[108:111], v[168:171]
 v_exp_f32 v178, v58
 v_mfma_f32_16x16x32_bf16 v[172:175], v[184:187], v[112:115], v[172:175]
 ds_read_b64_tr_b16 a[252:253], v201 offset:32768
 s_waitcnt lgkmcnt(3)
 v_mfma_f32_16x16x32_bf16 a[0:3], a[240:243], v[96:99], a[0:3]
 ds_read_b64_tr_b16 a[254:255], v201 offset:36864
 s_waitcnt vmcnt(6)
 v_mfma_f32_16x16x32_bf16 a[4:7], a[240:243], v[100:103], a[4:7]
 buffer_load_dwordx4 v218, s[32:35], s46 offen offset:2048 nt lds
 v_mfma_f32_16x16x32_bf16 a[8:11], a[240:243], v[104:107], a[8:11]
 v_exp_f32 v179, v59
 v_mfma_f32_16x16x32_bf16 a[12:15], a[240:243], v[108:111], a[12:15]
 v_exp_f32 v180, v60
 v_mfma_f32_16x16x32_bf16 a[16:19], a[240:243], v[112:115], a[16:19]
 v_exp_f32 v181, v61
 v_mfma_f32_16x16x32_bf16 a[20:23], a[244:247], v[96:99], a[20:23]
 ds_read_b64_tr_b16 a[240:241], v202 offset:32768
 ds_read_b64_tr_b16 a[242:243], v202 offset:36864
 v_mfma_f32_16x16x32_bf16 a[24:27], a[244:247], v[100:103], a[24:27]
 v_exp_f32 v182, v62
 v_mfma_f32_16x16x32_bf16 a[28:31], a[244:247], v[104:107], a[28:31]
 v_cvt_pk_bf16_f32 v116, v176, v177
 v_cvt_pk_bf16_f32 v117, v178, v179
 v_mfma_f32_16x16x32_bf16 a[32:35], a[244:247], v[108:111], a[32:35]
 v_exp_f32 v183, v63
 v_mfma_f32_16x16x32_bf16 a[36:39], a[244:247], v[112:115], a[36:39]
 ds_read_b64_tr_b16 a[244:245], v203 offset:32768
 s_waitcnt lgkmcnt(3)
 v_mfma_f32_16x16x32_bf16 a[40:43], a[248:251], v[96:99], a[40:43]
 ds_read_b64_tr_b16 a[246:247], v203 offset:36864
 v_cvt_pk_bf16_f32 v118, v180, v181
 v_mfma_f32_16x16x32_bf16 a[44:47], a[248:251], v[100:103], a[44:47]
 v_exp_f32 v176, v64
 v_mfma_f32_16x16x32_bf16 a[48:51], a[248:251], v[104:107], a[48:51]
 v_exp_f32 v177, v65
 v_mfma_f32_16x16x32_bf16 a[52:55], a[248:251], v[108:111], a[52:55]
 v_exp_f32 v178, v66
 v_mfma_f32_16x16x32_bf16 a[56:59], a[248:251], v[112:115], a[56:59]
 s_waitcnt vmcnt(6)
 buffer_load_dwordx4 v219, s[32:35], s46 offen offset:3072 nt lds
 v_mfma_f32_16x16x32_bf16 a[60:63], a[252:255], v[96:99], a[60:63]
 ds_read_b64_tr_b16 a[248:249], v204 offset:32768
 ds_read_b64_tr_b16 a[250:251], v204 offset:36864
 v_mfma_f32_16x16x32_bf16 a[64:67], a[252:255], v[100:103], a[64:67]
 v_exp_f32 v179, v67
 v_mfma_f32_16x16x32_bf16 a[68:71], a[252:255], v[104:107], a[68:71]
 v_exp_f32 v180, v68
 v_mfma_f32_16x16x32_bf16 a[72:75], a[252:255], v[108:111], a[72:75]
 v_cvt_pk_bf16_f32 v119, v182, v183
 v_cvt_pk_bf16_f32 v120, v176, v177
 v_mfma_f32_16x16x32_bf16 a[76:79], a[252:255], v[112:115], a[76:79]
 ds_read_b64_tr_b16 a[252:253], v205 offset:32768
 s_waitcnt lgkmcnt(3)
 v_mfma_f32_16x16x32_bf16 a[80:83], a[240:243], v[96:99], a[80:83]
 ds_read_b64_tr_b16 a[254:255], v205 offset:36864
 v_cvt_pk_bf16_f32 v121, v178, v179
 v_mfma_f32_16x16x32_bf16 a[84:87], a[240:243], v[100:103], a[84:87]
 v_exp_f32 v181, v69
 v_mfma_f32_16x16x32_bf16 a[88:91], a[240:243], v[104:107], a[88:91]
 v_exp_f32 v182, v70
 v_mfma_f32_16x16x32_bf16 a[92:95], a[240:243], v[108:111], a[92:95]
 v_exp_f32 v183, v71
 v_mfma_f32_16x16x32_bf16 a[96:99], a[240:243], v[112:115], a[96:99]
 v_exp_f32 v176, v72
 v_mfma_f32_16x16x32_bf16 a[100:103], a[244:247], v[96:99], a[100:103]
 ds_read_b128 a[240:243], v190 offset:32768
 s_waitcnt vmcnt(6)
 v_mfma_f32_16x16x32_bf16 a[104:107], a[244:247], v[100:103], a[104:107]
 s_add_u32 m0, s44, 0
 s_mov_b32 s46, 229376
 buffer_load_dwordx4 v214, s[28:31], s46 offen offset:0 nt lds
 v_mfma_f32_16x16x32_bf16 a[108:111], a[244:247], v[104:107], a[108:111]
 v_exp_f32 v177, v73
 v_mfma_f32_16x16x32_bf16 a[112:115], a[244:247], v[108:111], a[112:115]
 v_exp_f32 v178, v74
 v_mfma_f32_16x16x32_bf16 a[116:119], a[244:247], v[112:115], a[116:119]
 v_cvt_pk_bf16_f32 v122, v180, v181
 s_waitcnt lgkmcnt(1)
 v_mfma_f32_16x16x32_bf16 a[120:123], a[248:251], v[96:99], a[120:123]
 ds_read_b128 a[244:247], v191 offset:32768
 v_cvt_pk_bf16_f32 v123, v182, v183
 v_mfma_f32_16x16x32_bf16 a[124:127], a[248:251], v[100:103], a[124:127]
 v_exp_f32 v179, v75
 v_mfma_f32_16x16x32_bf16 a[128:131], a[248:251], v[104:107], a[128:131]
 v_exp_f32 v180, v76
 v_mfma_f32_16x16x32_bf16 a[132:135], a[248:251], v[108:111], a[132:135]
 v_exp_f32 v181, v77
 v_mfma_f32_16x16x32_bf16 a[136:139], a[248:251], v[112:115], a[136:139]
 v_exp_f32 v182, v78
 v_mfma_f32_16x16x32_bf16 a[140:143], a[252:255], v[96:99], a[140:143]
 v_cvt_pk_bf16_f32 v124, v176, v177
 ds_read_b128 a[248:251], v192 offset:32768
 v_mfma_f32_16x16x32_bf16 a[144:147], a[252:255], v[100:103], a[144:147]
 v_exp_f32 v183, v79
 v_mfma_f32_16x16x32_bf16 a[148:151], a[252:255], v[104:107], a[148:151]
 s_waitcnt vmcnt(6)
 v_cvt_pk_bf16_f32 v125, v178, v179
 v_mfma_f32_16x16x32_bf16 a[152:155], a[252:255], v[108:111], a[152:155]
 buffer_load_dwordx4 v215, s[28:31], s46 offen offset:1024 nt lds
 v_mfma_f32_16x16x32_bf16 a[156:159], a[252:255], v[112:115], a[156:159]
 ds_read_b128 a[252:255], v193 offset:32768
 s_waitcnt lgkmcnt(2)
 v_mfma_f32_16x16x32_bf16 v[16:19], a[240:243], a[160:163], v[136:139]
 v_exp_f32 v176, v80
 v_mfma_f32_16x16x32_bf16 v[24:27], a[240:243], a[176:179], v[140:143]
 v_exp_f32 v177, v81
 v_mfma_f32_16x16x32_bf16 v[32:35], a[240:243], a[192:195], v[144:147]
 v_exp_f32 v178, v82
 v_mfma_f32_16x16x32_bf16 v[40:43], a[240:243], a[208:211], v[148:151]
 v_cvt_pk_bf16_f32 v126, v180, v181
 v_cvt_pk_bf16_f32 v127, v182, v183
 v_mfma_f32_16x16x32_bf16 v[48:51], a[240:243], a[224:227], v[152:155]
 v_exp_f32 v179, v83
 v_mfma_f32_16x16x32_bf16 v[16:19], a[244:247], a[164:167], v[16:19]
 ds_read_b128 a[240:243], v190 offset:36864
 v_cvt_pk_bf16_f32 v128, v176, v177
 v_mfma_f32_16x16x32_bf16 v[24:27], a[244:247], a[180:183], v[24:27]
 v_exp_f32 v180, v84
 v_mfma_f32_16x16x32_bf16 v[32:35], a[244:247], a[196:199], v[32:35]
 v_cvt_pk_bf16_f32 v129, v178, v179
 s_waitcnt vmcnt(6)
 v_mfma_f32_16x16x32_bf16 v[40:43], a[244:247], a[212:215], v[40:43]
 buffer_load_dwordx4 v216, s[28:31], s46 offen offset:2048 nt lds
 v_mfma_f32_16x16x32_bf16 v[48:51], a[244:247], a[228:231], v[48:51]
 ds_read_b128 a[244:247], v191 offset:36864
 s_waitcnt lgkmcnt(2)
 v_mfma_f32_16x16x32_bf16 v[16:19], a[248:251], a[168:171], v[16:19]
 v_exp_f32 v181, v85
 v_mfma_f32_16x16x32_bf16 v[24:27], a[248:251], a[184:187], v[24:27]
 v_exp_f32 v182, v86
 v_mfma_f32_16x16x32_bf16 v[32:35], a[248:251], a[200:203], v[32:35]
 v_exp_f32 v183, v87
 v_mfma_f32_16x16x32_bf16 v[40:43], a[248:251], a[216:219], v[40:43]
 v_exp_f32 v176, v88
 v_mfma_f32_16x16x32_bf16 v[48:51], a[248:251], a[232:235], v[48:51]
 ds_read_b128 a[248:251], v192 offset:36864
 v_cvt_pk_bf16_f32 v130, v180, v181
 v_mfma_f32_16x16x32_bf16 v[16:19], a[252:255], a[172:175], v[16:19]
 v_exp_f32 v177, v89
 v_mfma_f32_16x16x32_bf16 v[24:27], a[252:255], a[188:191], v[24:27]
 v_cvt_pk_bf16_f32 v131, v182, v183
 v_cvt_pk_bf16_f32 v132, v176, v177
 v_mfma_f32_16x16x32_bf16 v[32:35], a[252:255], a[204:207], v[32:35]
 v_exp_f32 v178, v90
 v_mfma_f32_16x16x32_bf16 v[40:43], a[252:255], a[220:223], v[40:43]
 v_or3_b32 v188, v116, v117, v118
 v_or3_b32 v188, v188, v119, v120
 v_mfma_f32_16x16x32_bf16 v[48:51], a[252:255], a[236:239], v[48:51]
 ds_read_b128 a[252:255], v193 offset:36864
 s_waitcnt lgkmcnt(2)
 v_mfma_f32_16x16x32_bf16 v[20:23], a[240:243], a[160:163], v[136:139]
 v_exp_f32 v179, v91
 v_mfma_f32_16x16x32_bf16 v[28:31], a[240:243], a[176:179], v[140:143]
 v_exp_f32 v180, v92
 v_mfma_f32_16x16x32_bf16 v[36:39], a[240:243], a[192:195], v[144:147]
 s_waitcnt vmcnt(6)
 v_cvt_pk_bf16_f32 v133, v178, v179
 v_mfma_f32_16x16x32_bf16 v[44:47], a[240:243], a[208:211], v[148:151]
 buffer_load_dwordx4 v217, s[28:31], s46 offen offset:3072 nt lds
 v_mfma_f32_16x16x32_bf16 v[52:55], a[240:243], a[224:227], v[152:155]
 v_or3_b32 v188, v188, v121, v122
 s_barrier
 v_mfma_f32_16x16x32_bf16 v[20:23], a[244:247], a[164:167], v[20:23]
 v_exp_f32 v181, v93
 v_mfma_f32_16x16x32_bf16 v[28:31], a[244:247], a[180:183], v[28:31]
 ds_read_b64_tr_b16 a[240:241], v198 offset:16384
 ds_read_b64_tr_b16 a[242:243], v198 offset:20480
 v_mfma_f32_16x16x32_bf16 v[36:39], a[244:247], a[196:199], v[36:39]
 v_exp_f32 v182, v94
 v_mfma_f32_16x16x32_bf16 v[44:47], a[244:247], a[212:215], v[44:47]
 v_exp_f32 v183, v95
 v_mfma_f32_16x16x32_bf16 v[52:55], a[244:247], a[228:231], v[52:55]
 ds_read_b64_tr_b16 a[244:245], v199 offset:16384
 s_waitcnt lgkmcnt(3)
 v_mfma_f32_16x16x32_bf16 v[20:23], a[248:251], a[168:171], v[20:23]
 ds_read_b64_tr_b16 a[246:247], v199 offset:20480
 v_cvt_pk_bf16_f32 v134, v180, v181
 v_mfma_f32_16x16x32_bf16 v[28:31], a[248:251], a[184:187], v[28:31]
 v_cvt_pk_bf16_f32 v135, v182, v183
 v_or3_b32 v188, v188, v123, v124
 v_mfma_f32_16x16x32_bf16 v[36:39], a[248:251], a[200:203], v[36:39]
 v_or3_b32 v188, v188, v125, v126
 v_or3_b32 v188, v188, v127, v128
 v_mfma_f32_16x16x32_bf16 v[44:47], a[248:251], a[216:219], v[44:47]
 s_waitcnt vmcnt(6)
 s_add_u32 m0, s44, 65536
 v_mfma_f32_16x16x32_bf16 v[52:55], a[248:251], a[232:235], v[52:55]
 s_mov_b32 s46, 212992
 ds_read_b64_tr_b16 a[248:249], v200 offset:16384
 v_mfma_f32_16x16x32_bf16 v[20:23], a[252:255], a[172:175], v[20:23]
 buffer_load_dwordx4 v218, s[32:35], s46 offen offset:0 nt lds
 v_mfma_f32_16x16x32_bf16 v[28:31], a[252:255], a[188:191], v[28:31]
 ds_read_b64_tr_b16 a[250:251], v200 offset:20480
 v_or3_b32 v188, v188, v129, v130
 v_mfma_f32_16x16x32_bf16 v[36:39], a[252:255], a[204:207], v[36:39]
 v_or3_b32 v188, v188, v131, v132
 v_or3_b32 v188, v188, v133, v134
 v_mfma_f32_16x16x32_bf16 v[44:47], a[252:255], a[220:223], v[44:47]
 v_bitop3_b32 v188, v188, v135, s45 bitop3:0xa8
 v_cmp_ne_u32 vcc, 0, v188
 v_mfma_f32_16x16x32_bf16 v[52:55], a[252:255], a[236:239], v[52:55]
 s_cbranch_vccnz L_rareb12
L_rareb12_back:
 v_mfma_f32_16x16x32_bf16 v[156:159], v[184:187], v[116:119], v[156:159]
 v_mfma_f32_16x16x32_bf16 v[160:163], v[184:187], v[120:123], v[160:163]
 v_exp_f32 v176, v16
 v_mfma_f32_16x16x32_bf16 v[164:167], v[184:187], v[124:127], v[164:167]
 v_exp_f32 v177, v17
 v_mfma_f32_16x16x32_bf16 v[168:171], v[184:187], v[128:131], v[168:171]
 v_exp_f32 v178, v18
 v_mfma_f32_16x16x32_bf16 v[172:175], v[184:187], v[132:135], v[172:175]
 ds_read_b64_tr_b16 a[252:253], v201 offset:16384
 s_waitcnt lgkmcnt(3)
 v_mfma_f32_16x16x32_bf16 a[0:3], a[240:243], v[116:119], a[0:3]
 ds_read_b64_tr_b16 a[254:255], v201 offset:20480
 s_waitcnt vmcnt(6)
 v_mfma_f32_16x16x32_bf16 a[4:7], a[240:243], v[120:123], a[4:7]
 buffer_load_dwordx4 v219, s[32:35], s46 offen offset:1024 nt lds
 v_mfma_f32_16x16x32_bf16 a[8:11], a[240:243], v[124:127], a[8:11]
 v_exp_f32 v179, v19
 v_mfma_f32_16x16x32_bf16 a[12:15], a[240:243], v[128:131], a[12:15]
 v_exp_f32 v180, v20
 v_mfma_f32_16x16x32_bf16 a[16:19], a[240:243], v[132:135], a[16:19]
 v_exp_f32 v181, v21
 v_mfma_f32_16x16x32_bf16 a[20:23], a[244:247], v[116:119], a[20:23]
 ds_read_b64_tr_b16 a[240:241], v202 offset:16384
 ds_read_b64_tr_b16 a[242:243], v202 offset:20480
 v_mfma_f32_16x16x32_bf16 a[24:27], a[244:247], v[120:123], a[24:27]
 v_exp_f32 v182, v22
 v_mfma_f32_16x16x32_bf16 a[28:31], a[244:247], v[124:127], a[28:31]
 v_cvt_pk_bf16_f32 v96, v176, v177
 v_cvt_pk_bf16_f32 v97, v178, v179
 v_mfma_f32_16x16x32_bf16 a[32:35], a[244:247], v[128:131], a[32:35]
 v_exp_f32 v183, v23
 v_mfma_f32_16x16x32_bf16 a[36:39], a[244:247], v[132:135], a[36:39]
 ds_read_b64_tr_b16 a[244:245], v203 offset:16384
 s_waitcnt lgkmcnt(3)
 v_mfma_f32_16x16x32_bf16 a[40:43], a[248:251], v[116:119], a[40:43]
 ds_read_b64_tr_b16 a[246:247], v203 offset:20480
 v_cvt_pk_bf16_f32 v98, v180, v181
 v_mfma_f32_16x16x32_bf16 a[44:47], a[248:251], v[120:123], a[44:47]
 v_exp_f32 v176, v24
 v_mfma_f32_16x16x32_bf16 a[48:51], a[248:251], v[124:127], a[48:51]
 v_exp_f32 v177, v25
 v_mfma_f32_16x16x32_bf16 a[52:55], a[248:251], v[128:131], a[52:55]
 v_exp_f32 v178, v26
 v_mfma_f32_16x16x32_bf16 a[56:59], a[248:251], v[132:135], a[56:59]
 s_waitcnt vmcnt(6)
 buffer_load_dwordx4 v218, s[32:35], s46 offen offset:2048 nt lds
 v_mfma_f32_16x16x32_bf16 a[60:63], a[252:255], v[116:119], a[60:63]
 ds_read_b64_tr_b16 a[248:249], v204 offset:16384
 ds_read_b64_tr_b16 a[250:251], v204 offset:20480
 v_mfma_f32_16x16x32_bf16 a[64:67], a[252:255], v[120:123], a[64:67]
 v_exp_f32 v179, v27
 v_mfma_f32_16x16x32_bf16 a[68:71], a[252:255], v[124:127], a[68:71]
 v_exp_f32 v180, v28
 v_mfma_f32_16x16x32_bf16 a[72:75], a[252:255], v[128:131], a[72:75]
 v_cvt_pk_bf16_f32 v99, v182, v183
 v_cvt_pk_bf16_f32 v100, v176, v177
 v_mfma_f32_16x16x32_bf16 a[76:79], a[252:255], v[132:135], a[76:79]
 ds_read_b64_tr_b16 a[252:253], v205 offset:16384
 s_waitcnt lgkmcnt(3)
 v_mfma_f32_16x16x32_bf16 a[80:83], a[240:243], v[116:119], a[80:83]
 ds_read_b64_tr_b16 a[254:255], v205 offset:20480
 v_cvt_pk_bf16_f32 v101, v178, v179
 v_mfma_f32_16x16x32_bf16 a[84:87], a[240:243], v[120:123], a[84:87]
 v_exp_f32 v181, v29
 v_mfma_f32_16x16x32_bf16 a[88:91], a[240:243], v[124:127], a[88:91]
 v_exp_f32 v182, v30
 v_mfma_f32_16x16x32_bf16 a[92:95], a[240:243], v[128:131], a[92:95]
 v_exp_f32 v183, v31
 v_mfma_f32_16x16x32_bf16 a[96:99], a[240:243], v[132:135], a[96:99]
 v_exp_f32 v176, v32
 v_mfma_f32_16x16x32_bf16 a[100:103], a[244:247], v[116:119], a[100:103]
 ds_read_b128 a[240:243], v190 offset:49152
 s_waitcnt vmcnt(6)
 v_mfma_f32_16x16x32_bf16 a[104:107], a[244:247], v[120:123], a[104:107]
 buffer_load_dwordx4 v219, s[32:35], s46 offen offset:3072 nt lds
 v_mfma_f32_16x16x32_bf16 a[108:111], a[244:247], v[124:127], a[108:111]
 v_exp_f32 v177, v33
 v_mfma_f32_16x16x32_bf16 a[112:115], a[244:247], v[128:131], a[112:115]
 v_exp_f32 v178, v34
 v_mfma_f32_16x16x32_bf16 a[116:119], a[244:247], v[132:135], a[116:119]
 v_cvt_pk_bf16_f32 v102, v180, v181
 s_waitcnt lgkmcnt(1)
 v_mfma_f32_16x16x32_bf16 a[120:123], a[248:251], v[116:119], a[120:123]
 ds_read_b128 a[244:247], v191 offset:49152
 v_cvt_pk_bf16_f32 v103, v182, v183
 v_mfma_f32_16x16x32_bf16 a[124:127], a[248:251], v[120:123], a[124:127]
 v_exp_f32 v179, v35
 v_mfma_f32_16x16x32_bf16 a[128:131], a[248:251], v[124:127], a[128:131]
 v_exp_f32 v180, v36
 v_mfma_f32_16x16x32_bf16 a[132:135], a[248:251], v[128:131], a[132:135]
 v_exp_f32 v181, v37
 v_mfma_f32_16x16x32_bf16 a[136:139], a[248:251], v[132:135], a[136:139]
 v_exp_f32 v182, v38
 v_mfma_f32_16x16x32_bf16 a[140:143], a[252:255], v[116:119], a[140:143]
 v_cvt_pk_bf16_f32 v104, v176, v177
 ds_read_b128 a[248:251], v192 offset:49152
 v_mfma_f32_16x16x32_bf16 a[144:147], a[252:255], v[120:123], a[144:147]
 v_exp_f32 v183, v39
 v_mfma_f32_16x16x32_bf16 a[148:151], a[252:255], v[124:127], a[148:151]
 s_waitcnt vmcnt(6)
 s_add_u32 m0, s44, 16384
 v_mfma_f32_16x16x32_bf16 a[152:155], a[252:255], v[128:131], a[152:155]
 s_mov_b32 s46, 245760
 v_cvt_pk_bf16_f32 v105, v178, v179
 v_mfma_f32_16x16x32_bf16 a[156:159], a[252:255], v[132:135], a[156:159]
 buffer_load_dwordx4 v214, s[28:31], s46 offen offset:0 nt lds
 s_waitcnt lgkmcnt(1)
 v_mfma_f32_16x16x32_bf16 v[56:59], a[240:243], a[160:163], v[136:139]
 ds_read_b128 a[252:255], v193 offset:49152
 v_cvt_pk_bf16_f32 v106, v180, v181
 v_mfma_f32_16x16x32_bf16 v[64:67], a[240:243], a[176:179], v[140:143]
 v_exp_f32 v176, v40
 v_mfma_f32_16x16x32_bf16 v[72:75], a[240:243], a[192:195], v[144:147]
 v_exp_f32 v177, v41
 v_mfma_f32_16x16x32_bf16 v[80:83], a[240:243], a[208:211], v[148:151]
 v_exp_f32 v178, v42
 v_mfma_f32_16x16x32_bf16 v[88:91], a[240:243], a[224:227], v[152:155]
 v_exp_f32 v179, v43
 v_mfma_f32_16x16x32_bf16 v[56:59], a[244:247], a[164:167], v[56:59]
 ds_read_b128 a[240:243], v190 offset:53248
 v_cvt_pk_bf16_f32 v107, v182, v183
 v_mfma_f32_16x16x32_bf16 v[64:67], a[244:247], a[180:183], v[64:67]
 v_exp_f32 v180, v44
 v_mfma_f32_16x16x32_bf16 v[72:75], a[244:247], a[196:199], v[72:75]
 v_cvt_pk_bf16_f32 v108, v176, v177
 v_cvt_pk_bf16_f32 v109, v178, v179
 v_mfma_f32_16x16x32_bf16 v[80:83], a[244:247], a[212:215], v[80:83]
 v_exp_f32 v181, v45
 v_mfma_f32_16x16x32_bf16 v[88:91], a[244:247], a[228:231], v[88:91]
 ds_read_b128 a[244:247], v191 offset:53248
 s_waitcnt lgkmcnt(2)
 v_mfma_f32_16x16x32_bf16 v[56:59], a[248:251], a[168:171], v[56:59]
 v_exp_f32 v182, v46
 v_mfma_f32_16x16x32_bf16 v[64:67], a[248:251], a[184:187], v[64:67]
 s_waitcnt vmcnt(6)
 buffer_load_dwordx4 v215, s[28:31], s46 offen offset:1024 nt lds
 v_mfma_f32_16x16x32_bf16 v[72:75], a[248:251], a[200:203], v[72:75]
 v_exp_f32 v183, v47
 v_mfma_f32_16x16x32_bf16 v[80:83], a[248:251], a[216:219], v[80:83]
 v_exp_f32 v176, v48
 v_mfma_f32_16x16x32_bf16 v[88:91], a[248:251], a[232:235], v[88:91]
 ds_read_b128 a[248:251], v192 offset:53248
 v_cvt_pk_bf16_f32 v110, v180, v181
 v_mfma_f32_16x16x32_bf16 v[56:59], a[252:255], a[172:175], v[56:59]
 v_exp_f32 v177, v49
 v_mfma_f32_16x16x32_bf16 v[64:67], a[252:255], a[188:191], v[64:67]
 v_cvt_pk_bf16_f32 v111, v182, v183
 v_cvt_pk_bf16_f32 v112, v176, v177
 v_mfma_f32_16x16x32_bf16 v[72:75], a[252:255], a[204:207], v[72:75]
 v_exp_f32 v178, v50
 v_mfma_f32_16x16x32_bf16 v[80:83], a[252:255], a[220:223], v[80:83]
 v_or3_b32 v188, v96, v97, v98
 v_or3_b32 v188, v188, v99, v100
 v_mfma_f32_16x16x32_bf16 v[88:91], a[252:255], a[236:239], v[88:91]
 ds_read_b128 a[252:255], v193 offset:53248
 s_waitcnt lgkmcnt(2)
 v_mfma_f32_16x16x32_bf16 v[60:63], a[240:243], a[160:163], v[136:139]
 v_exp_f32 v179, v51
 v_mfma_f32_16x16x32_bf16 v[68:71], a[240:243], a[176:179], v[140:143]
 v_exp_f32 v180, v52
 v_mfma_f32_16x16x32_bf16 v[76:79], a[240:243], a[192:195], v[144:147]
 s_waitcnt vmcnt(6)
 v_cvt_pk_bf16_f32 v113, v178, v179
 v_mfma_f32_16x16x32_bf16 v[84:87], a[240:243], a[208:211], v[148:151]
 buffer_load_dwordx4 v216, s[28:31], s46 offen offset:2048 nt lds
 v_mfma_f32_16x16x32_bf16 v[92:95], a[240:243], a[224:227], v[152:155]
 v_or3_b32 v188, v188, v101, v102
 s_barrier
 v_mfma_f32_16x16x32_bf16 v[60:63], a[244:247], a[164:167], v[60:63]
 v_exp_f32 v181, v53
 v_mfma_f32_16x16x32_bf16 v[68:71], a[244:247], a[180:183], v[68:71]
 ds_read_b64_tr_b16 a[240:241], v198 offset:49152
 ds_read_b64_tr_b16 a[242:243], v198 offset:53248
 v_mfma_f32_16x16x32_bf16 v[76:79], a[244:247], a[196:199], v[76:79]
 v_exp_f32 v182, v54
 v_mfma_f32_16x16x32_bf16 v[84:87], a[244:247], a[212:215], v[84:87]
 v_exp_f32 v183, v55
 v_mfma_f32_16x16x32_bf16 v[92:95], a[244:247], a[228:231], v[92:95]
 ds_read_b64_tr_b16 a[244:245], v199 offset:49152
 s_waitcnt lgkmcnt(3)
 v_mfma_f32_16x16x32_bf16 v[60:63], a[248:251], a[168:171], v[60:63]
 ds_read_b64_tr_b16 a[246:247], v199 offset:53248
 v_cvt_pk_bf16_f32 v114, v180, v181
 v_mfma_f32_16x16x32_bf16 v[68:71], a[248:251], a[184:187], v[68:71]
 v_cvt_pk_bf16_f32 v115, v182, v183
 v_or3_b32 v188, v188, v103, v104
 v_mfma_f32_16x16x32_bf16 v[76:79], a[248:251], a[200:203], v[76:79]
 v_or3_b32 v188, v188, v105, v106
 v_or3_b32 v188, v188, v107, v108
 v_mfma_f32_16x16x32_bf16 v[84:87], a[248:251], a[216:219], v[84:87]
 s_waitcnt vmcnt(6)
 v_or3_b32 v188, v188, v109, v110
 v_mfma_f32_16x16x32_bf16 v[92:95], a[248:251], a[232:235], v[92:95]
 buffer_load_dwordx4 v217, s[28:31], s46 offen offset:3072 nt lds
 v_mfma_f32_16x16x32_bf16 v[60:63], a[252:255], a[172:175], v[60:63]
 ds_read_b64_tr_b16 a[248:249], v200 offset:49152
 ds_read_b64_tr_b16 a[250:251], v200 offset:53248
 v_mfma_f32_16x16x32_bf16 v[68:71], a[252:255], a[188:191], v[68:71]
 v_or3_b32 v188, v188, v111, v112
 v_or3_b32 v188, v188, v113, v114
 v_mfma_f32_16x16x32_bf16 v[76:79], a[252:255], a[204:207], v[76:79]
 v_bitop3_b32 v188, v188, v115, s45 bitop3:0xa8
 v_cmp_ne_u32 vcc, 0, v188
 v_mfma_f32_16x16x32_bf16 v[84:87], a[252:255], a[220:223], v[84:87]
 v_mfma_f32_16x16x32_bf16 v[92:95], a[252:255], a[236:239], v[92:95]
 s_cbranch_vccnz L_rareb13
L_rareb13_back:
 v_mfma_f32_16x16x32_bf16 v[156:159], v[184:187], v[96:99], v[156:159]
 v_mfma_f32_16x16x32_bf16 v[160:163], v[184:187], v[100:103], v[160:163]
 v_exp_f32 v176, v56
 v_mfma_f32_16x16x32_bf16 v[164:167], v[184:187], v[104:107], v[164:167]
 v_exp_f32 v177, v57
 v_mfma_f32_16x16x32_bf16 v[168:171], v[184:187], v[108:111], v[168:171]
 v_exp_f32 v178, v58
 v_mfma_f32_16x16x32_bf16 v[172:175], v[184:187], v[112:115], v[172:175]
 ds_read_b64_tr_b16 a[252:253], v201 offset:49152
 s_waitcnt lgkmcnt(3)
 v_mfma_f32_16x16x32_bf16 a[0:3], a[240:243], v[96:99], a[0:3]
 ds_read_b64_tr_b16 a[254:255], v201 offset:53248
 s_waitcnt vmcnt(6)
 v_mfma_f32_16x16x32_bf16 a[4:7], a[240:243], v[100:103], a[4:7]
 s_add_u32 m0, s44, 98304
 s_mov_b32 s46, 229376
 v_mfma_f32_16x16x32_bf16 a[8:11], a[240:243], v[104:107], a[8:11]
 buffer_load_dwordx4 v218, s[32:35], s46 offen offset:0 nt lds
 v_mfma_f32_16x16x32_bf16 a[12:15], a[240:243], v[108:111], a[12:15]
 v_exp_f32 v179, v59
 v_mfma_f32_16x16x32_bf16 a[16:19], a[240:243], v[112:115], a[16:19]
 v_exp_f32 v180, v60
 v_mfma_f32_16x16x32_bf16 a[20:23], a[244:247], v[96:99], a[20:23]
 ds_read_b64_tr_b16 a[240:241], v202 offset:49152
 ds_read_b64_tr_b16 a[242:243], v202 offset:53248
 v_mfma_f32_16x16x32_bf16 a[24:27], a[244:247], v[100:103], a[24:27]
 v_exp_f32 v181, v61
 v_mfma_f32_16x16x32_bf16 a[28:31], a[244:247], v[104:107], a[28:31]
 v_exp_f32 v182, v62
 v_mfma_f32_16x16x32_bf16 a[32:35], a[244:247], v[108:111], a[32:35]
 v_cvt_pk_bf16_f32 v116, v176, v177
 v_cvt_pk_bf16_f32 v117, v178, v179
 v_mfma_f32_16x16x32_bf16 a[36:39], a[244:247], v[112:115], a[36:39]
 ds_read_b64_tr_b16 a[244:245], v203 offset:49152
 s_waitcnt lgkmcnt(3)
 v_mfma_f32_16x16x32_bf16 a[40:43], a[248:251], v[96:99], a[40:43]
 ds_read_b64_tr_b16 a[246:247], v203 offset:53248
 v_cvt_pk_bf16_f32 v118, v180, v181
 v_mfma_f32_16x16x32_bf16 a[44:47], a[248:251], v[100:103], a[44:47]
 v_exp_f32 v183, v63
 v_mfma_f32_16x16x32_bf16 a[48:51], a[248:251], v[104:107], a[48:51]
 v_exp_f32 v176, v64
 v_mfma_f32_16x16x32_bf16 a[52:55], a[248:251], v[108:111], a[52:55]
 v_exp_f32 v177, v65
 v_mfma_f32_16x16x32_bf16 a[56:59], a[248:251], v[112:115], a[56:59]
 v_exp_f32 v178, v66
 v_mfma_f32_16x16x32_bf16 a[60:63], a[252:255], v[96:99], a[60:63]
 s_waitcnt vmcnt(6)
 buffer_load_dwordx4 v219, s[32:35], s46 offen offset:1024 nt lds
 v_mfma_f32_16x16x32_bf16 a[64:67], a[252:255], v[100:103], a[64:67]
 ds_read_b64_tr_b16 a[248:249], v204 offset:49152
 ds_read_b64_tr_b16 a[250:251], v204 offset:53248
 v_mfma_f32_16x16x32_bf16 a[68:71], a[252:255], v[104:107], a[68:71]
 v_exp_f32 v179, v67
 v_mfma_f32_16x16x32_bf16 a[72:75], a[252:255], v[108:111], a[72:75]
 v_exp_f32 v180, v68
 v_mfma_f32_16x16x32_bf16 a[76:79], a[252:255], v[112:115], a[76:79]
 v_cvt_pk_bf16_f32 v119, v182, v183
 s_waitcnt lgkmcnt(2)
 v_mfma_f32_16x16x32_bf16 a[80:83], a[240:243], v[96:99], a[80:83]
 ds_read_b64_tr_b16 a[252:253], v205 offset:49152
 ds_read_b64_tr_b16 a[254:255], v205 offset:53248
 v_mfma_f32_16x16x32_bf16 a[84:87], a[240:243], v[100:103], a[84:87]
 v_exp_f32 v181, v69
 v_mfma_f32_16x16x32_bf16 a[88:91], a[240:243], v[104:107], a[88:91]
 v_exp_f32 v182, v70
 v_mfma_f32_16x16x32_bf16 a[92:95], a[240:243], v[108:111], a[92:95]
 v_cvt_pk_bf16_f32 v120, v176, v177
 v_cvt_pk_bf16_f32 v121, v178, v179
 v_mfma_f32_16x16x32_bf16 a[96:99], a[240:243], v[112:115], a[96:99]
 v_exp_f32 v183, v71
 v_mfma_f32_16x16x32_bf16 a[100:103], a[244:247], v[96:99], a[100:103]
 ds_read_b128 a[240:243], v190 offset:0
 s_waitcnt vmcnt(6)
 v_mfma_f32_16x16x32_bf16 a[104:107], a[244:247], v[100:103], a[104:107]
 buffer_load_dwordx4 v218, s[32:35], s46 offen offset:2048 nt lds
 v_mfma_f32_16x16x32_bf16 a[108:111], a[244:247], v[104:107], a[108:111]
 v_exp_f32 v176, v72
 v_mfma_f32_16x16x32_bf16 a[112:115], a[244:247], v[108:111], a[112:115]
 v_exp_f32 v177, v73
 v_mfma_f32_16x16x32_bf16 a[116:119], a[244:247], v[112:115], a[116:119]
 ds_read_b128 a[244:247], v191 offset:0
 s_waitcnt lgkmcnt(2)
 v_mfma_f32_16x16x32_bf16 a[120:123], a[248:251], v[96:99], a[120:123]
 v_exp_f32 v178, v74
 v_mfma_f32_16x16x32_bf16 a[124:127], a[248:251], v[100:103], a[124:127]
 v_cvt_pk_bf16_f32 v122, v180, v181
 v_cvt_pk_bf16_f32 v123, v182, v183
 v_mfma_f32_16x16x32_bf16 a[128:131], a[248:251], v[104:107], a[128:131]
 v_exp_f32 v179, v75
 v_mfma_f32_16x16x32_bf16 a[132:135], a[248:251], v[108:111], a[132:135]
 v_exp_f32 v180, v76
 v_mfma_f32_16x16x32_bf16 a[136:139], a[248:251], v[112:115], a[136:139]
 v_exp_f32 v181, v77
 v_mfma_f32_16x16x32_bf16 a[140:143], a[252:255], v[96:99], a[140:143]
 ds_read_b128 a[248:251], v192 offset:0
 v_cvt_pk_bf16_f32 v124, v176, v177
 v_mfma_f32_16x16x32_bf16 a[144:147], a[252:255], v[100:103], a[144:147]
 v_exp_f32 v182, v78
 v_mfma_f32_16x16x32_bf16 a[148:151], a[252:255], v[104:107], a[148:151]
 v_exp_f32 v183, v79
 v_mfma_f32_16x16x32_bf16 a[152:155], a[252:255], v[108:111], a[152:155]
 v_exp_f32 v176, v80
 v_mfma_f32_16x16x32_bf16 a[156:159], a[252:255], v[112:115], a[156:159]
 v_cvt_pk_bf16_f32 v125, v178, v179
 s_waitcnt vmcnt(6)
 buffer_load_dwordx4 v219, s[32:35], s46 offen offset:3072 nt lds
 s_waitcnt lgkmcnt(1)
 v_mfma_f32_16x16x32_bf16 v[16:19], a[240:243], a[160:163], v[136:139]
 ds_read_b128 a[252:255], v193 offset:0
 v_cvt_pk_bf16_f32 v126, v180, v181
 v_mfma_f32_16x16x32_bf16 v[24:27], a[240:243], a[176:179], v[140:143]
 v_exp_f32 v177, v81
 v_mfma_f32_16x16x32_bf16 v[32:35], a[240:243], a[192:195], v[144:147]
 v_exp_f32 v178, v82
 v_mfma_f32_16x16x32_bf16 v[40:43], a[240:243], a[208:211], v[148:151]
 v_cvt_pk_bf16_f32 v127, v182, v183
 v_cvt_pk_bf16_f32 v128, v176, v177
 v_mfma_f32_16x16x32_bf16 v[48:51], a[240:243], a[224:227], v[152:155]
 v_exp_f32 v179, v83
 v_mfma_f32_16x16x32_bf16 v[16:19], a[244:247], a[164:167], v[16:19]
 ds_read_b128 a[240:243], v190 offset:4096
 v_cvt_pk_bf16_f32 v129, v178, v179
 v_mfma_f32_16x16x32_bf16 v[24:27], a[244:247], a[180:183], v[24:27]
 v_exp_f32 v180, v84
 v_mfma_f32_16x16x32_bf16 v[32:35], a[244:247], a[196:199], v[32:35]
 s_waitcnt vmcnt(6)
 s_add_u32 m0, s44, 81920
 v_mfma_f32_16x16x32_bf16 v[40:43], a[244:247], a[212:215], v[40:43]
 v_exp_f32 v181, v85
 v_mfma_f32_16x16x32_bf16 v[48:51], a[244:247], a[228:231], v[48:51]
 s_mov_b32 s46, 245760
 s_waitcnt lgkmcnt(1)
 v_mfma_f32_16x16x32_bf16 v[16:19], a[248:251], a[168:171], v[16:19]
 buffer_load_dwordx4 v218, s[32:35], s46 offen offset:0 nt lds
 v_mfma_f32_16x16x32_bf16 v[24:27], a[248:251], a[184:187], v[24:27]
 ds_read_b128 a[244:247], v191 offset:4096
 v_cvt_pk_bf16_f32 v130, v180, v181
 v_mfma_f32_16x16x32_bf16 v[32:35], a[248:251], a[200:203], v[32:35]
 v_exp_f32 v182, v86
 v_mfma_f32_16x16x32_bf16 v[40:43], a[248:251], a[216:219], v[40:43]
 v_exp_f32 v183, v87
 v_mfma_f32_16x16x32_bf16 v[48:51], a[248:251], a[232:235], v[48:51]
 v_exp_f32 v176, v88
 v_mfma_f32_16x16x32_bf16 v[16:19], a[252:255], a[172:175], v[16:19]
 ds_read_b128 a[248:251], v192 offset:4096
 v_cvt_pk_bf16_f32 v131, v182, v183
 v_mfma_f32_16x16x32_bf16 v[24:27], a[252:255], a[188:191], v[24:27]
 v_exp_f32 v177, v89
 v_mfma_f32_16x16x32_bf16 v[32:35], a[252:255], a[204:207], v[32:35]
 v_exp_f32 v178, v90
 v_mfma_f32_16x16x32_bf16 v[40:43], a[252:255], a[220:223], v[40:43]
 v_cvt_pk_bf16_f32 v132, v176, v177
 v_or3_b32 v188, v116, v117, v118
 v_mfma_f32_16x16x32_bf16 v[48:51], a[252:255], a[236:239], v[48:51]
 ds_read_b128 a[252:255], v193 offset:4096
 s_waitcnt lgkmcnt(2)
 v_mfma_f32_16x16x32_bf16 v[20:23], a[240:243], a[160:163], v[136:139]
 v_exp_f32 v179, v91
 v_mfma_f32_16x16x32_bf16 v[28:31], a[240:243], a[176:179], v[140:143]
 v_exp_f32 v180, v92
 v_mfma_f32_16x16x32_bf16 v[36:39], a[240:243], a[192:195], v[144:147]
 s_waitcnt vmcnt(6)
 v_cvt_pk_bf16_f32 v133, v178, v179
 v_mfma_f32_16x16x32_bf16 v[44:47], a[240:243], a[208:211], v[148:151]
 buffer_load_dwordx4 v219, s[32:35], s46 offen offset:1024 nt lds
 v_mfma_f32_16x16x32_bf16 v[52:55], a[240:243], a[224:227], v[152:155]
 v_or3_b32 v188, v188, v119, v120
 s_waitcnt vmcnt(6)
 s_barrier
 v_mfma_f32_16x16x32_bf16 v[20:23], a[244:247], a[164:167], v[20:23]
 v_exp_f32 v181, v93
 v_mfma_f32_16x16x32_bf16 v[28:31], a[244:247], a[180:183], v[28:31]
 ds_read_b64_tr_b16 a[240:241], v198 offset:0
 ds_read_b64_tr_b16 a[242:243], v198 offset:4096
 v_mfma_f32_16x16x32_bf16 v[36:39], a[244:247], a[196:199], v[36:39]
 v_exp_f32 v182, v94
 v_mfma_f32_16x16x32_bf16 v[44:47], a[244:247], a[212:215], v[44:47]
 v_exp_f32 v183, v95
 v_mfma_f32_16x16x32_bf16 v[52:55], a[244:247], a[228:231], v[52:55]
 ds_read_b64_tr_b16 a[244:245], v199 offset:0
 s_waitcnt lgkmcnt(3)
 v_mfma_f32_16x16x32_bf16 v[20:23], a[248:251], a[168:171], v[20:23]
 ds_read_b64_tr_b16 a[246:247], v199 offset:4096
 v_cvt_pk_bf16_f32 v134, v180, v181
 v_mfma_f32_16x16x32_bf16 v[28:31], a[248:251], a[184:187], v[28:31]
 v_cvt_pk_bf16_f32 v135, v182, v183
 v_or3_b32 v188, v188, v121, v122
 v_mfma_f32_16x16x32_bf16 v[36:39], a[248:251], a[200:203], v[36:39]
 v_or3_b32 v188, v188, v123, v124
 v_or3_b32 v188, v188, v125, v126
 v_mfma_f32_16x16x32_bf16 v[44:47], a[248:251], a[216:219], v[44:47]
 v_or3_b32 v188, v188, v127, v128
 v_or3_b32 v188, v188, v129, v130
 v_mfma_f32_16x16x32_bf16 v[52:55], a[248:251], a[232:235], v[52:55]
 ds_read_b64_tr_b16 a[248:249], v200 offset:0
 ds_read_b64_tr_b16 a[250:251], v200 offset:4096
 v_mfma_f32_16x16x32_bf16 v[20:23], a[252:255], a[172:175], v[20:23]
 v_or3_b32 v188, v188, v131, v132
 v_mfma_f32_16x16x32_bf16 v[28:31], a[252:255], a[188:191], v[28:31]
 buffer_load_dwordx4 v218, s[32:35], s46 offen offset:2048 nt lds
 v_mfma_f32_16x16x32_bf16 v[36:39], a[252:255], a[204:207], v[36:39]
 v_or3_b32 v188, v188, v133, v134
 v_bitop3_b32 v188, v188, v135, s45 bitop3:0xa8
 v_mfma_f32_16x16x32_bf16 v[44:47], a[252:255], a[220:223], v[44:47]
 v_cmp_ne_u32 vcc, 0, v188
 v_mfma_f32_16x16x32_bf16 v[52:55], a[252:255], a[236:239], v[52:55]
 s_cbranch_vccnz L_rareb14
L_rareb14_back:
 v_mfma_f32_16x16x32_bf16 v[156:159], v[184:187], v[116:119], v[156:159]
 v_mfma_f32_16x16x32_bf16 v[160:163], v[184:187], v[120:123], v[160:163]
 v_exp_f32 v176, v16
 v_mfma_f32_16x16x32_bf16 v[164:167], v[184:187], v[124:127], v[164:167]
 v_exp_f32 v177, v17
 v_mfma_f32_16x16x32_bf16 v[168:171], v[184:187], v[128:131], v[168:171]
 v_exp_f32 v178, v18
 v_mfma_f32_16x16x32_bf16 v[172:175], v[184:187], v[132:135], v[172:175]
 ds_read_b64_tr_b16 a[252:253], v201 offset:0
 s_waitcnt lgkmcnt(3)
 v_mfma_f32_16x16x32_bf16 a[0:3], a[240:243], v[116:119], a[0:3]
 ds_read_b64_tr_b16 a[254:255], v201 offset:4096
 v_cvt_pk_bf16_f32 v96, v176, v177
 v_mfma_f32_16x16x32_bf16 a[4:7], a[240:243], v[120:123], a[4:7]
 v_exp_f32 v179, v19
 v_mfma_f32_16x16x32_bf16 a[8:11], a[240:243], v[124:127], a[8:11]
 v_exp_f32 v180, v20
 v_mfma_f32_16x16x32_bf16 a[12:15], a[240:243], v[128:131], a[12:15]
 s_waitcnt vmcnt(6)
 buffer_load_dwordx4 v219, s[32:35], s46 offen offset:3072 nt lds
 v_mfma_f32_16x16x32_bf16 a[16:19], a[240:243], v[132:135], a[16:19]
 v_exp_f32 v181, v21
 v_mfma_f32_16x16x32_bf16 a[20:23], a[244:247], v[116:119], a[20:23]
 ds_read_b64_tr_b16 a[240:241], v202 offset:0
 ds_read_b64_tr_b16 a[242:243], v202 offset:4096
 v_mfma_f32_16x16x32_bf16 a[24:27], a[244:247], v[120:123], a[24:27]
 v_exp_f32 v182, v22
 v_mfma_f32_16x16x32_bf16 a[28:31], a[244:247], v[124:127], a[28:31]
 v_exp_f32 v183, v23
 v_mfma_f32_16x16x32_bf16 a[32:35], a[244:247], v[128:131], a[32:35]
 v_exp_f32 v176, v24
 v_mfma_f32_16x16x32_bf16 a[36:39], a[244:247], v[132:135], a[36:39]
 v_cvt_pk_bf16_f32 v97, v178, v179
 s_waitcnt lgkmcnt(2)
 v_mfma_f32_16x16x32_bf16 a[40:43], a[248:251], v[116:119], a[40:43]
 ds_read_b64_tr_b16 a[244:245], v203 offset:0
 ds_read_b64_tr_b16 a[246:247], v203 offset:4096
 v_mfma_f32_16x16x32_bf16 a[44:47], a[248:251], v[120:123], a[44:47]
 v_exp_f32 v177, v25
 v_mfma_f32_16x16x32_bf16 a[48:51], a[248:251], v[124:127], a[48:51]
 v_exp_f32 v178, v26
 v_mfma_f32_16x16x32_bf16 a[52:55], a[248:251], v[128:131], a[52:55]
 v_cvt_pk_bf16_f32 v98, v180, v181
 v_cvt_pk_bf16_f32 v99, v182, v183
 v_mfma_f32_16x16x32_bf16 a[56:59], a[248:251], v[132:135], a[56:59]
 v_exp_f32 v179, v27
 v_mfma_f32_16x16x32_bf16 a[60:63], a[252:255], v[116:119], a[60:63]
 ds_read_b64_tr_b16 a[248:249], v204 offset:0
 ds_read_b64_tr_b16 a[250:251], v204 offset:4096
 v_mfma_f32_16x16x32_bf16 a[64:67], a[252:255], v[120:123], a[64:67]
 v_exp_f32 v180, v28
 v_mfma_f32_16x16x32_bf16 a[68:71], a[252:255], v[124:127], a[68:71]
 v_exp_f32 v181, v29
 v_mfma_f32_16x16x32_bf16 a[72:75], a[252:255], v[128:131], a[72:75]
 v_cvt_pk_bf16_f32 v100, v176, v177
 v_cvt_pk_bf16_f32 v101, v178, v179
 v_mfma_f32_16x16x32_bf16 a[76:79], a[252:255], v[132:135], a[76:79]
 ds_read_b64_tr_b16 a[252:253], v205 offset:0
 s_waitcnt lgkmcnt(3)
 v_mfma_f32_16x16x32_bf16 a[80:83], a[240:243], v[116:119], a[80:83]
 ds_read_b64_tr_b16 a[254:255], v205 offset:4096
 v_cvt_pk_bf16_f32 v102, v180, v181
 v_mfma_f32_16x16x32_bf16 a[84:87], a[240:243], v[120:123], a[84:87]
 v_exp_f32 v182, v30
 v_mfma_f32_16x16x32_bf16 a[88:91], a[240:243], v[124:127], a[88:91]
 v_exp_f32 v183, v31
 v_mfma_f32_16x16x32_bf16 a[92:95], a[240:243], v[128:131], a[92:95]
 v_exp_f32 v176, v32
 v_mfma_f32_16x16x32_bf16 a[96:99], a[240:243], v[132:135], a[96:99]
 ds_read_b128 a[240:243], v190 offset:16384
 v_cvt_pk_bf16_f32 v103, v182, v183
 v_mfma_f32_16x16x32_bf16 a[100:103], a[244:247], v[116:119], a[100:103]
 v_exp_f32 v177, v33
 v_mfma_f32_16x16x32_bf16 a[104:107], a[244:247], v[120:123], a[104:107]
 v_cvt_pk_bf16_f32 v104, v176, v177
 v_or3_b32 v188, v96, v97, v98
 v_mfma_f32_16x16x32_bf16 a[108:111], a[244:247], v[124:127], a[108:111]
 v_exp_f32 v178, v34
 v_mfma_f32_16x16x32_bf16 a[112:115], a[244:247], v[128:131], a[112:115]
 v_or3_b32 v188, v188, v99, v100
 v_or3_b32 v188, v188, v101, v102
 v_mfma_f32_16x16x32_bf16 a[116:119], a[244:247], v[132:135], a[116:119]
 ds_read_b128 a[244:247], v191 offset:16384
 s_waitcnt lgkmcnt(2)
 v_mfma_f32_16x16x32_bf16 a[120:123], a[248:251], v[116:119], a[120:123]
 v_exp_f32 v179, v35
 v_mfma_f32_16x16x32_bf16 a[124:127], a[248:251], v[120:123], a[124:127]
 v_exp_f32 v180, v36
 v_mfma_f32_16x16x32_bf16 a[128:131], a[248:251], v[124:127], a[128:131]
 v_cvt_pk_bf16_f32 v105, v178, v179
 v_or3_b32 v188, v188, v103, v104
 v_mfma_f32_16x16x32_bf16 a[132:135], a[248:251], v[128:131], a[132:135]
 v_exp_f32 v181, v37
 v_mfma_f32_16x16x32_bf16 a[136:139], a[248:251], v[132:135], a[136:139]
 v_exp_f32 v182, v38
 v_mfma_f32_16x16x32_bf16 a[140:143], a[252:255], v[116:119], a[140:143]
 ds_read_b128 a[248:251], v192 offset:16384
 v_cvt_pk_bf16_f32 v106, v180, v181
 v_mfma_f32_16x16x32_bf16 a[144:147], a[252:255], v[120:123], a[144:147]
 v_exp_f32 v183, v39
 v_mfma_f32_16x16x32_bf16 a[148:151], a[252:255], v[124:127], a[148:151]
 v_cvt_pk_bf16_f32 v107, v182, v183
 v_or3_b32 v188, v188, v105, v106
 v_mfma_f32_16x16x32_bf16 a[152:155], a[252:255], v[128:131], a[152:155]
 v_exp_f32 v176, v40
 v_mfma_f32_16x16x32_bf16 a[156:159], a[252:255], v[132:135], a[156:159]
 ds_read_b128 a[252:255], v193 offset:16384
 s_waitcnt lgkmcnt(2)
 v_mfma_f32_16x16x32_bf16 v[56:59], a[240:243], a[160:163], v[136:139]
 v_exp_f32 v177, v41
 v_mfma_f32_16x16x32_bf16 v[64:67], a[240:243], a[176:179], v[140:143]
 v_cvt_pk_bf16_f32 v108, v176, v177
 v_or3_b32 v188, v188, v107, v108
 v_mfma_f32_16x16x32_bf16 v[72:75], a[240:243], a[192:195], v[144:147]
 v_exp_f32 v178, v42
 v_mfma_f32_16x16x32_bf16 v[80:83], a[240:243], a[208:211], v[148:151]
 v_exp_f32 v179, v43
 v_mfma_f32_16x16x32_bf16 v[88:91], a[240:243], a[224:227], v[152:155]
 ds_read_b128 a[240:243], v190 offset:20480
 v_cvt_pk_bf16_f32 v109, v178, v179
 v_mfma_f32_16x16x32_bf16 v[56:59], a[244:247], a[164:167], v[56:59]
 v_exp_f32 v180, v44
 v_mfma_f32_16x16x32_bf16 v[64:67], a[244:247], a[180:183], v[64:67]
 v_exp_f32 v181, v45
 v_mfma_f32_16x16x32_bf16 v[72:75], a[244:247], a[196:199], v[72:75]
 v_cvt_pk_bf16_f32 v110, v180, v181
 v_or3_b32 v188, v188, v109, v110
 v_mfma_f32_16x16x32_bf16 v[80:83], a[244:247], a[212:215], v[80:83]
 v_exp_f32 v182, v46
 v_mfma_f32_16x16x32_bf16 v[88:91], a[244:247], a[228:231], v[88:91]
 ds_read_b128 a[244:247], v191 offset:20480
 s_waitcnt lgkmcnt(2)
 v_mfma_f32_16x16x32_bf16 v[56:59], a[248:251], a[168:171], v[56:59]
 v_exp_f32 v183, v47
 v_mfma_f32_16x16x32_bf16 v[64:67], a[248:251], a[184:187], v[64:67]
 v_cvt_pk_bf16_f32 v111, v182, v183
 v_mfma_f32_16x16x32_bf16 v[72:75], a[248:251], a[200:203], v[72:75]
 v_exp_f32 v176, v48
 v_mfma_f32_16x16x32_bf16 v[80:83], a[248:251], a[216:219], v[80:83]
 v_exp_f32 v177, v49
 v_mfma_f32_16x16x32_bf16 v[88:91], a[248:251], a[232:235], v[88:91]
 ds_read_b128 a[248:251], v192 offset:20480
 v_cvt_pk_bf16_f32 v112, v176, v177
 v_mfma_f32_16x16x32_bf16 v[56:59], a[252:255], a[172:175], v[56:59]
 v_or3_b32 v188, v188, v111, v112
 v_mfma_f32_16x16x32_bf16 v[64:67], a[252:255], a[188:191], v[64:67]
 v_exp_f32 v178, v50
 v_mfma_f32_16x16x32_bf16 v[72:75], a[252:255], a[204:207], v[72:75]
 v_exp_f32 v179, v51
 v_mfma_f32_16x16x32_bf16 v[80:83], a[252:255], a[220:223], v[80:83]
 v_cvt_pk_bf16_f32 v113, v178, v179
 v_mfma_f32_16x16x32_bf16 v[88:91], a[252:255], a[236:239], v[88:91]
 ds_read_b128 a[252:255], v193 offset:20480
 s_waitcnt lgkmcnt(2)
 v_mfma_f32_16x16x32_bf16 v[60:63], a[240:243], a[160:163], v[136:139]
 v_exp_f32 v180, v52
 v_mfma_f32_16x16x32_bf16 v[68:71], a[240:243], a[176:179], v[140:143]
 v_exp_f32 v181, v53
 v_mfma_f32_16x16x32_bf16 v[76:79], a[240:243], a[192:195], v[144:147]
 v_cvt_pk_bf16_f32 v114, v180, v181
 v_or3_b32 v188, v188, v113, v114
 v_mfma_f32_16x16x32_bf16 v[84:87], a[240:243], a[208:211], v[148:151]
 v_exp_f32 v182, v54
 v_mfma_f32_16x16x32_bf16 v[92:95], a[240:243], a[224:227], v[152:155]
 s_waitcnt vmcnt(4)
 s_barrier
 v_mfma_f32_16x16x32_bf16 v[60:63], a[244:247], a[164:167], v[60:63]
 ds_read_b64_tr_b16 a[240:241], v198 offset:32768
 ds_read_b64_tr_b16 a[242:243], v198 offset:36864
 v_mfma_f32_16x16x32_bf16 v[68:71], a[244:247], a[180:183], v[68:71]
 v_exp_f32 v183, v55
 v_mfma_f32_16x16x32_bf16 v[76:79], a[244:247], a[196:199], v[76:79]
 v_cvt_pk_bf16_f32 v115, v182, v183
 v_bitop3_b32 v188, v188, v115, s45 bitop3:0xa8
 v_mfma_f32_16x16x32_bf16 v[84:87], a[244:247], a[212:215], v[84:87]
 v_cmp_ne_u32 vcc, 0, v188
 v_mfma_f32_16x16x32_bf16 v[92:95], a[244:247], a[228:231], v[92:95]
 ds_read_b64_tr_b16 a[244:245], v199 offset:32768
 s_waitcnt lgkmcnt(3)
 v_mfma_f32_16x16x32_bf16 v[60:63], a[248:251], a[168:171], v[60:63]
 ds_read_b64_tr_b16 a[246:247], v199 offset:36864
 v_mfma_f32_16x16x32_bf16 v[68:71], a[248:251], a[184:187], v[68:71]
 v_mfma_f32_16x16x32_bf16 v[76:79], a[248:251], a[200:203], v[76:79]
 v_mfma_f32_16x16x32_bf16 v[84:87], a[248:251], a[216:219], v[84:87]
 v_mfma_f32_16x16x32_bf16 v[92:95], a[248:251], a[232:235], v[92:95]
 ds_read_b64_tr_b16 a[248:249], v200 offset:32768
 ds_read_b64_tr_b16 a[250:251], v200 offset:36864
 v_mfma_f32_16x16x32_bf16 v[60:63], a[252:255], a[172:175], v[60:63]
 v_mfma_f32_16x16x32_bf16 v[68:71], a[252:255], a[188:191], v[68:71]
 v_mfma_f32_16x16x32_bf16 v[76:79], a[252:255], a[204:207], v[76:79]
 v_mfma_f32_16x16x32_bf16 v[84:87], a[252:255], a[220:223], v[84:87]
 v_mfma_f32_16x16x32_bf16 v[92:95], a[252:255], a[236:239], v[92:95]
 s_cbranch_vccnz L_rareb15
L_rareb15_back:
 v_mfma_f32_16x16x32_bf16 v[156:159], v[184:187], v[96:99], v[156:159]
 v_mfma_f32_16x16x32_bf16 v[160:163], v[184:187], v[100:103], v[160:163]
 v_exp_f32 v176, v56
 v_mfma_f32_16x16x32_bf16 v[164:167], v[184:187], v[104:107], v[164:167]
 v_exp_f32 v177, v57
 v_mfma_f32_16x16x32_bf16 v[168:171], v[184:187], v[108:111], v[168:171]
 v_exp_f32 v178, v58
 v_mfma_f32_16x16x32_bf16 v[172:175], v[184:187], v[112:115], v[172:175]
 ds_read_b64_tr_b16 a[252:253], v201 offset:32768
 s_waitcnt lgkmcnt(3)
 v_mfma_f32_16x16x32_bf16 a[0:3], a[240:243], v[96:99], a[0:3]
 ds_read_b64_tr_b16 a[254:255], v201 offset:36864
 v_cvt_pk_bf16_f32 v116, v176, v177
 v_mfma_f32_16x16x32_bf16 a[4:7], a[240:243], v[100:103], a[4:7]
 v_exp_f32 v179, v59
 v_mfma_f32_16x16x32_bf16 a[8:11], a[240:243], v[104:107], a[8:11]
 v_exp_f32 v180, v60
 v_mfma_f32_16x16x32_bf16 a[12:15], a[240:243], v[108:111], a[12:15]
 v_exp_f32 v181, v61
 v_mfma_f32_16x16x32_bf16 a[16:19], a[240:243], v[112:115], a[16:19]
 v_exp_f32 v182, v62
 v_mfma_f32_16x16x32_bf16 a[20:23], a[244:247], v[96:99], a[20:23]
 ds_read_b64_tr_b16 a[240:241], v202 offset:32768
 ds_read_b64_tr_b16 a[242:243], v202 offset:36864
 v_mfma_f32_16x16x32_bf16 a[24:27], a[244:247], v[100:103], a[24:27]
 v_exp_f32 v183, v63
 v_mfma_f32_16x16x32_bf16 a[28:31], a[244:247], v[104:107], a[28:31]
 v_cvt_pk_bf16_f32 v117, v178, v179
 v_cvt_pk_bf16_f32 v118, v180, v181
 v_mfma_f32_16x16x32_bf16 a[32:35], a[244:247], v[108:111], a[32:35]
 v_exp_f32 v176, v64
 v_mfma_f32_16x16x32_bf16 a[36:39], a[244:247], v[112:115], a[36:39]
 ds_read_b64_tr_b16 a[244:245], v203 offset:32768
 s_waitcnt lgkmcnt(3)
 v_mfma_f32_16x16x32_bf16 a[40:43], a[248:251], v[96:99], a[40:43]
 ds_read_b64_tr_b16 a[246:247], v203 offset:36864
 v_cvt_pk_bf16_f32 v119, v182, v183
 v_mfma_f32_16x16x32_bf16 a[44:47], a[248:251], v[100:103], a[44:47]
 v_exp_f32 v177, v65
 v_mfma_f32_16x16x32_bf16 a[48:51], a[248:251], v[104:107], a[48:51]
 v_exp_f32 v178, v66
 v_mfma_f32_16x16x32_bf16 a[52:55], a[248:251], v[108:111], a[52:55]
 v_cvt_pk_bf16_f32 v120, v176, v177
 v_or3_b32 v188, v116, v117, v118
 v_mfma_f32_16x16x32_bf16 a[56:59], a[248:251], v[112:115], a[56:59]
 v_exp_f32 v179, v67
 v_mfma_f32_16x16x32_bf16 a[60:63], a[252:255], v[96:99], a[60:63]
 ds_read_b64_tr_b16 a[248:249], v204 offset:32768
 ds_read_b64_tr_b16 a[250:251], v204 offset:36864
 v_mfma_f32_16x16x32_bf16 a[64:67], a[252:255], v[100:103], a[64:67]
 v_exp_f32 v180, v68
 v_mfma_f32_16x16x32_bf16 a[68:71], a[252:255], v[104:107], a[68:71]
 v_exp_f32 v181, v69
 v_mfma_f32_16x16x32_bf16 a[72:75], a[252:255], v[108:111], a[72:75]
 v_cvt_pk_bf16_f32 v121, v178, v179
 v_cvt_pk_bf16_f32 v122, v180, v181
 v_mfma_f32_16x16x32_bf16 a[76:79], a[252:255], v[112:115], a[76:79]
 ds_read_b64_tr_b16 a[252:253], v205 offset:32768
 s_waitcnt lgkmcnt(3)
 v_mfma_f32_16x16x32_bf16 a[80:83], a[240:243], v[96:99], a[80:83]
 ds_read_b64_tr_b16 a[254:255], v205 offset:36864
 v_or3_b32 v188, v188, v119, v120
 v_mfma_f32_16x16x32_bf16 a[84:87], a[240:243], v[100:103], a[84:87]
 v_exp_f32 v182, v70
 v_mfma_f32_16x16x32_bf16 a[88:91], a[240:243], v[104:107], a[88:91]
 v_exp_f32 v183, v71
 v_mfma_f32_16x16x32_bf16 a[92:95], a[240:243], v[108:111], a[92:95]
 v_exp_f32 v176, v72
 v_mfma_f32_16x16x32_bf16 a[96:99], a[240:243], v[112:115], a[96:99]
 v_cvt_pk_bf16_f32 v123, v182, v183
 v_or3_b32 v188, v188, v121, v122
 v_mfma_f32_16x16x32_bf16 a[100:103], a[244:247], v[96:99], a[100:103]
 v_exp_f32 v177, v73
 v_mfma_f32_16x16x32_bf16 a[104:107], a[244:247], v[100:103], a[104:107]
 v_cvt_pk_bf16_f32 v124, v176, v177
 v_or3_b32 v188, v188, v123, v124
 v_mfma_f32_16x16x32_bf16 a[108:111], a[244:247], v[104:107], a[108:111]
 v_exp_f32 v178, v74
 v_mfma_f32_16x16x32_bf16 a[112:115], a[244:247], v[108:111], a[112:115]
 v_exp_f32 v179, v75
 v_mfma_f32_16x16x32_bf16 a[116:119], a[244:247], v[112:115], a[116:119]
 v_cvt_pk_bf16_f32 v125, v178, v179
 s_waitcnt lgkmcnt(0)
 v_mfma_f32_16x16x32_bf16 a[120:123], a[248:251], v[96:99], a[120:123]
 v_exp_f32 v180, v76
 v_mfma_f32_16x16x32_bf16 a[124:127], a[248:251], v[100:103], a[124:127]
 v_exp_f32 v181, v77
 v_mfma_f32_16x16x32_bf16 a[128:131], a[248:251], v[104:107], a[128:131]
 v_cvt_pk_bf16_f32 v126, v180, v181
 v_or3_b32 v188, v188, v125, v126
 v_mfma_f32_16x16x32_bf16 a[132:135], a[248:251], v[108:111], a[132:135]
 v_exp_f32 v182, v78
 v_mfma_f32_16x16x32_bf16 a[136:139], a[248:251], v[112:115], a[136:139]
 v_exp_f32 v183, v79
 v_mfma_f32_16x16x32_bf16 a[140:143], a[252:255], v[96:99], a[140:143]
 v_cvt_pk_bf16_f32 v127, v182, v183
 v_mfma_f32_16x16x32_bf16 a[144:147], a[252:255], v[100:103], a[144:147]
 v_exp_f32 v176, v80
 v_mfma_f32_16x16x32_bf16 a[148:151], a[252:255], v[104:107], a[148:151]
 v_exp_f32 v177, v81
 v_mfma_f32_16x16x32_bf16 a[152:155], a[252:255], v[108:111], a[152:155]
 v_cvt_pk_bf16_f32 v128, v176, v177
 v_or3_b32 v188, v188, v127, v128
 v_mfma_f32_16x16x32_bf16 a[156:159], a[252:255], v[112:115], a[156:159]
 v_add_u32 v4, s44, v189
 v_xor_b32 v7, 0x2000, v4
 v_add_u32 v5, 0x10000, v4
 v_add_u32 v8, 0x10000, v7
 v_add_u32 v6, 0x20000, v4
 v_add_u32 v9, 0x20000, v7
 v_lshlrev_b32 v10, 2, v2
 v_lshl_add_u32 v10, v1, 12, v10
 v_xor_b32 v11, 0x2000, v10
 v_add_u32 v10, 49152, v10
 v_add_u32 v11, 49152, v11
 s_mul_i32 s56, s41, 10
 s_and_b32 s57, s40, 1
 s_mul_i32 s57, s57, 5
 s_add_u32 s56, s56, s57
 s_lshl_b32 s56, s56, 17
 s_lshl_b32 s57, s42, 12
 s_add_u32 s56, s56, s57
 s_and_b32 s57, s40, 2
 s_lshl_b32 s57, s57, 10
 s_add_u32 s56, s56, s57
 v_exp_f32 v178, v82
 v_exp_f32 v179, v83
 v_exp_f32 v180, v84
 v_cvt_pk_bf16_f32 v129, v178, v179
 v_exp_f32 v181, v85
 v_exp_f32 v182, v86
 v_cvt_pk_bf16_f32 v130, v180, v181
 v_or3_b32 v188, v188, v129, v130
 v_exp_f32 v183, v87
 v_exp_f32 v176, v88
 v_cvt_pk_bf16_f32 v131, v182, v183
 v_exp_f32 v177, v89
 v_exp_f32 v178, v90
 v_cvt_pk_bf16_f32 v132, v176, v177
 v_or3_b32 v188, v188, v131, v132
 v_exp_f32 v179, v91
 v_exp_f32 v180, v92
 v_cvt_pk_bf16_f32 v133, v178, v179
 v_exp_f32 v181, v93
 v_exp_f32 v182, v94
 v_cvt_pk_bf16_f32 v134, v180, v181
 v_or3_b32 v188, v188, v133, v134
 v_exp_f32 v183, v95
 s_waitcnt vmcnt(0)
 s_barrier
 ds_read_b64_tr_b16 a[240:241], v202 offset:16384
 ds_read_b64_tr_b16 a[242:243], v202 offset:20480
 v_cvt_pk_bf16_f32 v135, v182, v183
 v_bitop3_b32 v188, v188, v135, s45 bitop3:0xa8
 v_cmp_ne_u32 vcc, 0, v188
 ds_read_b64_tr_b16 a[244:245], v203 offset:16384
 ds_read_b64_tr_b16 a[246:247], v203 offset:20480
 ds_read_b64_tr_b16 a[248:249], v204 offset:16384
 ds_read_b64_tr_b16 a[250:251], v204 offset:20480
 s_cbranch_vccnz L_rareb16
L_rareb16_back:
 v_mfma_f32_16x16x32_bf16 v[156:159], v[184:187], v[116:119], v[156:159]
 v_mfma_f32_16x16x32_bf16 v[160:163], v[184:187], v[120:123], v[160:163]
 ds_write_b32 v10, v136 offset:0
 v_mfma_f32_16x16x32_bf16 v[164:167], v[184:187], v[124:127], v[164:167]
 ds_write_b32 v10, v140 offset:256
 v_mfma_f32_16x16x32_bf16 v[168:171], v[184:187], v[128:131], v[168:171]
 ds_write_b32 v10, v144 offset:512
 v_mfma_f32_16x16x32_bf16 v[172:175], v[184:187], v[132:135], v[172:175]
 ds_read_b64_tr_b16 a[252:253], v205 offset:16384
 ds_write_b32 v10, v148 offset:768
 s_waitcnt lgkmcnt(7)
 v_mfma_f32_16x16x32_bf16 a[80:83], a[240:243], v[116:119], a[80:83]
 ds_read_b64_tr_b16 a[254:255], v205 offset:20480
 ds_write_b32 v10, v152 offset:1024
 v_mfma_f32_16x16x32_bf16 a[84:87], a[240:243], v[120:123], a[84:87]
 v_mfma_f32_16x16x32_bf16 a[88:91], a[240:243], v[124:127], a[88:91]
 ds_write_b32 v10, v156 offset:1280
 v_mfma_f32_16x16x32_bf16 a[92:95], a[240:243], v[128:131], a[92:95]
 ds_write_b32 v10, v160 offset:1536
 v_mfma_f32_16x16x32_bf16 a[96:99], a[240:243], v[132:135], a[96:99]
 ds_read_b64_tr_b16 a[240:241], v198 offset:16384
 ds_read_b64_tr_b16 a[242:243], v198 offset:20480
 ds_write_b32 v10, v164 offset:1792
 v_mfma_f32_16x16x32_bf16 a[100:103], a[244:247], v[116:119], a[100:103]
 ds_write_b32 v10, v168 offset:2048
 v_mfma_f32_16x16x32_bf16 a[104:107], a[244:247], v[120:123], a[104:107]
 ds_write_b32 v10, v172 offset:2304
 v_mfma_f32_16x16x32_bf16 a[108:111], a[244:247], v[124:127], a[108:111]
 v_mfma_f32_16x16x32_bf16 a[112:115], a[244:247], v[128:131], a[112:115]
 s_waitcnt lgkmcnt(0)
 s_barrier
 ds_read_b32 v220, v11 offset:0
 ds_read_b32 v221, v11 offset:256
 ds_read_b32 v222, v11 offset:512
 ds_read_b32 v223, v11 offset:768
 ds_read_b32 v224, v11 offset:1024
 v_mfma_f32_16x16x32_bf16 a[116:119], a[244:247], v[132:135], a[116:119]
 ds_read_b64_tr_b16 a[244:245], v199 offset:16384
 ds_read_b32 v225, v11 offset:1280
 ds_read_b32 v226, v11 offset:1536
 ds_read_b32 v227, v11 offset:1792
 ds_read_b32 v228, v11 offset:2048
 ds_read_b32 v229, v11 offset:2304
 ds_write_b128 v5, a[80:83] offset:49152
 v_mfma_f32_16x16x32_bf16 a[120:123], a[248:251], v[116:119], a[120:123]
 ds_read_b64_tr_b16 a[246:247], v199 offset:20480
 ds_write_b128 v5, a[84:87] offset:50176
 v_mfma_f32_16x16x32_bf16 a[124:127], a[248:251], v[120:123], a[124:127]
 ds_write_b128 v5, a[88:91] offset:51200
 v_mfma_f32_16x16x32_bf16 a[128:131], a[248:251], v[124:127], a[128:131]
 ds_write_b128 v5, a[92:95] offset:52224
 v_mfma_f32_16x16x32_bf16 a[132:135], a[248:251], v[128:131], a[132:135]
 ds_write_b128 v4, a[96:99] offset:0
 v_mfma_f32_16x16x32_bf16 a[136:139], a[248:251], v[132:135], a[136:139]
 ds_read_b64_tr_b16 a[248:249], v200 offset:16384
 ds_read_b64_tr_b16 a[250:251], v200 offset:20480
 s_waitcnt lgkmcnt(8)
 v_min_f32 v139, v136, v220
 v_min_f32 v143, v140, v221
 v_min_f32 v147, v144, v222
 ds_write_b128 v4, a[100:103] offset:1024
 v_mfma_f32_16x16x32_bf16 a[140:143], a[252:255], v[116:119], a[140:143]
 v_min_f32 v151, v148, v223
 v_min_f32 v155, v152, v224
 v_sub_f32 v137, v139, v136
 ds_write_b128 v4, a[104:107] offset:2048
 v_mfma_f32_16x16x32_bf16 a[144:147], a[252:255], v[120:123], a[144:147]
 v_sub_f32 v138, v139, v220
 v_sub_f32 v141, v143, v140
 v_sub_f32 v142, v143, v221
 ds_write_b128 v4, a[108:111] offset:3072
 v_mfma_f32_16x16x32_bf16 a[148:151], a[252:255], v[124:127], a[148:151]
 v_sub_f32 v145, v147, v144
 v_sub_f32 v146, v147, v222
 v_sub_f32 v149, v151, v148
 ds_write_b128 v5, a[112:115] offset:0
 v_mfma_f32_16x16x32_bf16 a[152:155], a[252:255], v[128:131], a[152:155]
 v_sub_f32 v150, v151, v223
 v_sub_f32 v153, v155, v152
 v_sub_f32 v154, v155, v224
 ds_write_b128 v5, a[116:119] offset:1024
 v_mfma_f32_16x16x32_bf16 a[156:159], a[252:255], v[132:135], a[156:159]
 ds_read_b64_tr_b16 a[252:253], v201 offset:16384
 v_exp_f32 v137, v137
 v_exp_f32 v138, v138
 v_exp_f32 v141, v141
 ds_write_b128 v5, a[120:123] offset:2048
 s_waitcnt lgkmcnt(13)
 v_mfma_f32_16x16x32_bf16 a[0:3], a[240:243], v[116:119], a[0:3]
 ds_read_b64_tr_b16 a[254:255], v201 offset:20480
 v_exp_f32 v142, v142
 v_exp_f32 v145, v145
 v_exp_f32 v146, v146
 ds_write_b128 v5, a[124:127] offset:3072
 v_mfma_f32_16x16x32_bf16 a[4:7], a[240:243], v[120:123], a[4:7]
 v_exp_f32 v149, v149
 v_exp_f32 v150, v150
 v_exp_f32 v153, v153
 ds_write_b128 v4, a[128:131] offset:16384
 v_mfma_f32_16x16x32_bf16 a[8:11], a[240:243], v[124:127], a[8:11]
 v_exp_f32 v154, v154
 v_mul_f32 v156, v156, v137
 v_mul_f32 v160, v160, v141
 ds_write_b128 v4, a[132:135] offset:17408
 v_mfma_f32_16x16x32_bf16 a[12:15], a[240:243], v[128:131], a[12:15]
 v_mul_f32 v164, v164, v145
 v_mul_f32 v168, v168, v149
 v_mul_f32 v172, v172, v153
 ds_write_b128 v4, a[136:139] offset:18432
 v_mfma_f32_16x16x32_bf16 a[16:19], a[240:243], v[132:135], a[16:19]
 v_fmac_f32 v156, v225, v138
 v_fmac_f32 v160, v226, v142
 v_fmac_f32 v164, v227, v146
 ds_write_b128 v4, a[140:143] offset:19456
 v_mfma_f32_16x16x32_bf16 a[20:23], a[244:247], v[116:119], a[20:23]
 v_fmac_f32 v168, v228, v150
 v_fmac_f32 v172, v229, v154
 v_rcp_f32 v156, v156
 ds_write_b128 v5, a[144:147] offset:32768
 v_mfma_f32_16x16x32_bf16 a[24:27], a[244:247], v[120:123], a[24:27]
 v_rcp_f32 v160, v160
 v_rcp_f32 v164, v164
 v_rcp_f32 v168, v168
 ds_write_b128 v5, a[148:151] offset:33792
 v_mfma_f32_16x16x32_bf16 a[28:31], a[244:247], v[124:127], a[28:31]
 v_rcp_f32 v172, v172
 v_mul_f32 v137, v137, v156
 v_mul_f32 v138, v138, v156
 ds_write_b128 v5, a[152:155] offset:34816
 v_accvgpr_read_b32 v16, a0
 v_accvgpr_read_b32 v17, a1
 v_accvgpr_read_b32 v18, a2
 v_accvgpr_read_b32 v19, a3
 v_mfma_f32_16x16x32_bf16 a[32:35], a[244:247], v[128:131], a[32:35]
 v_mul_f32 v141, v141, v160
 v_mul_f32 v142, v142, v160
 v_mul_f32 v145, v145, v164
 ds_write_b128 v5, a[156:159] offset:35840
 v_accvgpr_read_b32 v20, a4
 v_accvgpr_read_b32 v21, a5
 v_accvgpr_read_b32 v22, a6
 v_accvgpr_read_b32 v23, a7
 v_mfma_f32_16x16x32_bf16 a[36:39], a[244:247], v[132:135], a[36:39]
 v_mul_f32 v146, v146, v164
 v_mul_f32 v149, v149, v168
 v_mul_f32 v150, v150, v168
 v_accvgpr_read_b32 v24, a8
 v_accvgpr_read_b32 v25, a9
 v_accvgpr_read_b32 v26, a10
 v_accvgpr_read_b32 v27, a11
 s_waitcnt lgkmcnt(9)
 v_mfma_f32_16x16x32_bf16 a[40:43], a[248:251], v[116:119], a[40:43]
 v_mul_f32 v153, v153, v172
 v_mul_f32 v154, v154, v172
 v_accvgpr_read_b32 v28, a12
 v_accvgpr_read_b32 v29, a13
 v_accvgpr_read_b32 v30, a14
 v_accvgpr_read_b32 v31, a15
 v_mfma_f32_16x16x32_bf16 a[44:47], a[248:251], v[120:123], a[44:47]
 v_accvgpr_read_b32 v32, a16
 v_accvgpr_read_b32 v33, a17
 v_accvgpr_read_b32 v34, a18
 v_accvgpr_read_b32 v35, a19
 v_mfma_f32_16x16x32_bf16 a[48:51], a[248:251], v[124:127], a[48:51]
 v_accvgpr_read_b32 v36, a20
 v_accvgpr_read_b32 v37, a21
 v_accvgpr_read_b32 v38, a22
 v_accvgpr_read_b32 v39, a23
 v_mfma_f32_16x16x32_bf16 a[52:55], a[248:251], v[128:131], a[52:55]
 v_accvgpr_read_b32 v40, a24
 v_accvgpr_read_b32 v41, a25
 v_accvgpr_read_b32 v42, a26
 v_accvgpr_read_b32 v43, a27
 v_mfma_f32_16x16x32_bf16 a[56:59], a[248:251], v[132:135], a[56:59]
 v_accvgpr_read_b32 v44, a28
 v_accvgpr_read_b32 v45, a29
 v_accvgpr_read_b32 v46, a30
 v_accvgpr_read_b32 v47, a31
 v_mfma_f32_16x16x32_bf16 a[60:63], a[252:255], v[116:119], a[60:63]
 v_accvgpr_read_b32 v48, a32
 v_accvgpr_read_b32 v49, a33
 v_accvgpr_read_b32 v50, a34
 v_accvgpr_read_b32 v51, a35
 v_mfma_f32_16x16x32_bf16 a[64:67], a[252:255], v[120:123], a[64:67]
 v_accvgpr_read_b32 v52, a36
 v_accvgpr_read_b32 v53, a37
 v_accvgpr_read_b32 v54, a38
 v_accvgpr_read_b32 v55, a39
 v_mfma_f32_16x16x32_bf16 a[68:71], a[252:255], v[124:127], a[68:71]
 v_accvgpr_read_b32 v56, a40
 v_accvgpr_read_b32 v57, a41
 v_accvgpr_read_b32 v58, a42
 v_accvgpr_read_b32 v59, a43
 v_mfma_f32_16x16x32_bf16 a[72:75], a[252:255], v[128:131], a[72:75]
 v_accvgpr_read_b32 v60, a44
 v_accvgpr_read_b32 v61, a45
 v_accvgpr_read_b32 v62, a46
 v_accvgpr_read_b32 v63, a47
 v_mfma_f32_16x16x32_bf16 a[76:79], a[252:255], v[132:135], a[76:79]
 v_accvgpr_read_b32 v64, a48
 v_accvgpr_read_b32 v65, a49
 v_accvgpr_read_b32 v66, a50
 v_accvgpr_read_b32 v67, a51
 v_accvgpr_read_b32 v68, a52
 v_accvgpr_read_b32 v69, a53
 v_accvgpr_read_b32 v70, a54
 v_accvgpr_read_b32 v71, a55
 v_accvgpr_read_b32 v72, a56
 v_accvgpr_read_b32 v73, a57
 v_accvgpr_read_b32 v74, a58
 v_accvgpr_read_b32 v75, a59
 s_waitcnt lgkmcnt(0)
 s_barrier
 ds_read_b128 v[96:99], v8 offset:49152
 ds_read_b128 v[116:119], v7 offset:1024
 ds_read_b128 v[176:179], v8 offset:2048
 ds_read_b128 v[214:217], v7 offset:19456
 ds_read_b128 v[100:103], v8 offset:50176
 ds_read_b128 v[120:123], v7 offset:2048
 ds_read_b128 v[180:183], v8 offset:3072
 ds_read_b128 v[250:253], v8 offset:32768
 ds_read_b128 v[104:107], v8 offset:51200
 ds_read_b128 v[124:127], v7 offset:3072
 ds_read_b128 v[184:187], v7 offset:16384
 ds_read_b128 v[218:221], v8 offset:33792
 v_accvgpr_read_b32 v76, a60
 v_accvgpr_read_b32 v77, a61
 v_accvgpr_read_b32 v78, a62
 v_accvgpr_read_b32 v79, a63
 v_accvgpr_read_b32 v80, a64
 v_accvgpr_read_b32 v81, a65
 v_accvgpr_read_b32 v82, a66
 v_accvgpr_read_b32 v83, a67
 v_accvgpr_read_b32 v84, a68
 v_accvgpr_read_b32 v85, a69
 v_accvgpr_read_b32 v86, a70
 v_accvgpr_read_b32 v87, a71
 v_accvgpr_read_b32 v88, a72
 v_accvgpr_read_b32 v89, a73
 v_accvgpr_read_b32 v90, a74
 v_accvgpr_read_b32 v91, a75
 v_accvgpr_read_b32 v92, a76
 v_accvgpr_read_b32 v93, a77
 v_accvgpr_read_b32 v94, a78
 v_accvgpr_read_b32 v95, a79
 v_pk_mul_f32 v[16:17], v[16:17], v[136:137] op_sel:[0,1] op_sel_hi:[1,1]
 v_pk_mul_f32 v[18:19], v[18:19], v[136:137] op_sel:[0,1] op_sel_hi:[1,1]
 v_pk_mul_f32 v[36:37], v[36:37], v[136:137] op_sel:[0,1] op_sel_hi:[1,1]
 v_pk_mul_f32 v[38:39], v[38:39], v[136:137] op_sel:[0,1] op_sel_hi:[1,1]
 v_pk_mul_f32 v[56:57], v[56:57], v[136:137] op_sel:[0,1] op_sel_hi:[1,1]
 v_pk_mul_f32 v[58:59], v[58:59], v[136:137] op_sel:[0,1] op_sel_hi:[1,1]
 v_pk_mul_f32 v[76:77], v[76:77], v[136:137] op_sel:[0,1] op_sel_hi:[1,1]
 v_pk_mul_f32 v[78:79], v[78:79], v[136:137] op_sel:[0,1] op_sel_hi:[1,1]
 s_waitcnt lgkmcnt(8)
 ds_read_b128 v[108:111], v8 offset:52224
 ds_read_b128 v[128:131], v8 offset:0
 ds_read_b128 v[206:209], v7 offset:17408
 ds_read_b128 v[222:225], v8 offset:34816
 v_pk_fma_f32 v[16:17], v[96:97], v[138:139], v[16:17] op_sel_hi:[1,0,1]
 v_pk_fma_f32 v[18:19], v[98:99], v[138:139], v[18:19] op_sel_hi:[1,0,1]
 v_pk_fma_f32 v[36:37], v[116:117], v[138:139], v[36:37] op_sel_hi:[1,0,1]
 v_pk_fma_f32 v[38:39], v[118:119], v[138:139], v[38:39] op_sel_hi:[1,0,1]
 v_pk_fma_f32 v[56:57], v[176:177], v[138:139], v[56:57] op_sel_hi:[1,0,1]
 v_pk_fma_f32 v[58:59], v[178:179], v[138:139], v[58:59] op_sel_hi:[1,0,1]
 v_pk_fma_f32 v[76:77], v[214:215], v[138:139], v[76:77] op_sel_hi:[1,0,1]
 v_pk_fma_f32 v[78:79], v[216:217], v[138:139], v[78:79] op_sel_hi:[1,0,1]
 v_cvt_pk_bf16_f32 v190, v16, v17
 v_cvt_pk_bf16_f32 v191, v18, v19
 v_cvt_pk_bf16_f32 v192, v36, v37
 v_cvt_pk_bf16_f32 v193, v38, v39
 v_cvt_pk_bf16_f32 v194, v56, v57
 v_cvt_pk_bf16_f32 v195, v58, v59
 v_cvt_pk_bf16_f32 v196, v76, v77
 v_cvt_pk_bf16_f32 v197, v78, v79
 buffer_store_dwordx4 v[190:193], v189, s[36:39], s56 offen offset:0 sc1
 buffer_store_dwordx4 v[194:197], v189, s[36:39], s56 offen offset:1024 sc1
 s_add_u32 s56, s56, 131072
 v_pk_mul_f32 v[20:21], v[20:21], v[140:141] op_sel:[0,1] op_sel_hi:[1,1]
 v_pk_mul_f32 v[22:23], v[22:23], v[140:141] op_sel:[0,1] op_sel_hi:[1,1]
 v_pk_mul_f32 v[40:41], v[40:41], v[140:141] op_sel:[0,1] op_sel_hi:[1,1]
 v_pk_mul_f32 v[42:43], v[42:43], v[140:141] op_sel:[0,1] op_sel_hi:[1,1]
 v_pk_mul_f32 v[60:61], v[60:61], v[140:141] op_sel:[0,1] op_sel_hi:[1,1]
 v_pk_mul_f32 v[62:63], v[62:63], v[140:141] op_sel:[0,1] op_sel_hi:[1,1]
 v_pk_mul_f32 v[80:81], v[80:81], v[140:141] op_sel:[0,1] op_sel_hi:[1,1]
 v_pk_mul_f32 v[82:83], v[82:83], v[140:141] op_sel:[0,1] op_sel_hi:[1,1]
 s_waitcnt lgkmcnt(8)
 ds_read_b128 v[112:115], v7 offset:0
 ds_read_b128 v[132:135], v8 offset:1024
 ds_read_b128 v[210:213], v7 offset:18432
 ds_read_b128 v[226:229], v8 offset:35840
 v_pk_fma_f32 v[20:21], v[100:101], v[142:143], v[20:21] op_sel_hi:[1,0,1]
 v_pk_fma_f32 v[22:23], v[102:103], v[142:143], v[22:23] op_sel_hi:[1,0,1]
 v_pk_fma_f32 v[40:41], v[120:121], v[142:143], v[40:41] op_sel_hi:[1,0,1]
 v_pk_fma_f32 v[42:43], v[122:123], v[142:143], v[42:43] op_sel_hi:[1,0,1]
 v_pk_fma_f32 v[60:61], v[180:181], v[142:143], v[60:61] op_sel_hi:[1,0,1]
 v_pk_fma_f32 v[62:63], v[182:183], v[142:143], v[62:63] op_sel_hi:[1,0,1]
 v_pk_fma_f32 v[80:81], v[250:251], v[142:143], v[80:81] op_sel_hi:[1,0,1]
 v_pk_fma_f32 v[82:83], v[252:253], v[142:143], v[82:83] op_sel_hi:[1,0,1]
 v_cvt_pk_bf16_f32 v198, v20, v21
 v_cvt_pk_bf16_f32 v199, v22, v23
 v_cvt_pk_bf16_f32 v200, v40, v41
 v_cvt_pk_bf16_f32 v201, v42, v43
 v_cvt_pk_bf16_f32 v202, v60, v61
 v_cvt_pk_bf16_f32 v203, v62, v63
 v_cvt_pk_bf16_f32 v204, v80, v81
 v_cvt_pk_bf16_f32 v205, v82, v83
 buffer_store_dwordx4 v[198:201], v189, s[36:39], s56 offen offset:0 sc1
 buffer_store_dwordx4 v[202:205], v189, s[36:39], s56 offen offset:1024 sc1
 s_add_u32 s56, s56, 131072
 v_pk_mul_f32 v[24:25], v[24:25], v[144:145] op_sel:[0,1] op_sel_hi:[1,1]
 v_pk_mul_f32 v[26:27], v[26:27], v[144:145] op_sel:[0,1] op_sel_hi:[1,1]
 v_pk_mul_f32 v[44:45], v[44:45], v[144:145] op_sel:[0,1] op_sel_hi:[1,1]
 v_pk_mul_f32 v[46:47], v[46:47], v[144:145] op_sel:[0,1] op_sel_hi:[1,1]
 v_pk_mul_f32 v[64:65], v[64:65], v[144:145] op_sel:[0,1] op_sel_hi:[1,1]
 v_pk_mul_f32 v[66:67], v[66:67], v[144:145] op_sel:[0,1] op_sel_hi:[1,1]
 v_pk_mul_f32 v[84:85], v[84:85], v[144:145] op_sel:[0,1] op_sel_hi:[1,1]
 v_pk_mul_f32 v[86:87], v[86:87], v[144:145] op_sel:[0,1] op_sel_hi:[1,1]
 s_waitcnt lgkmcnt(8)
 v_pk_fma_f32 v[24:25], v[104:105], v[146:147], v[24:25] op_sel_hi:[1,0,1]
 v_pk_fma_f32 v[26:27], v[106:107], v[146:147], v[26:27] op_sel_hi:[1,0,1]
 v_pk_fma_f32 v[44:45], v[124:125], v[146:147], v[44:45] op_sel_hi:[1,0,1]
 v_pk_fma_f32 v[46:47], v[126:127], v[146:147], v[46:47] op_sel_hi:[1,0,1]
 v_pk_fma_f32 v[64:65], v[184:185], v[146:147], v[64:65] op_sel_hi:[1,0,1]
 v_pk_fma_f32 v[66:67], v[186:187], v[146:147], v[66:67] op_sel_hi:[1,0,1]
 v_pk_fma_f32 v[84:85], v[218:219], v[146:147], v[84:85] op_sel_hi:[1,0,1]
 v_pk_fma_f32 v[86:87], v[220:221], v[146:147], v[86:87] op_sel_hi:[1,0,1]
 v_cvt_pk_bf16_f32 v190, v24, v25
 v_cvt_pk_bf16_f32 v191, v26, v27
 v_cvt_pk_bf16_f32 v192, v44, v45
 v_cvt_pk_bf16_f32 v193, v46, v47
 v_cvt_pk_bf16_f32 v194, v64, v65
 v_cvt_pk_bf16_f32 v195, v66, v67
 v_cvt_pk_bf16_f32 v196, v84, v85
 v_cvt_pk_bf16_f32 v197, v86, v87
 buffer_store_dwordx4 v[190:193], v189, s[36:39], s56 offen offset:0 sc1
 buffer_store_dwordx4 v[194:197], v189, s[36:39], s56 offen offset:1024 sc1
 s_add_u32 s56, s56, 131072
 v_pk_mul_f32 v[28:29], v[28:29], v[148:149] op_sel:[0,1] op_sel_hi:[1,1]
 v_pk_mul_f32 v[30:31], v[30:31], v[148:149] op_sel:[0,1] op_sel_hi:[1,1]
 v_pk_mul_f32 v[48:49], v[48:49], v[148:149] op_sel:[0,1] op_sel_hi:[1,1]
 v_pk_mul_f32 v[50:51], v[50:51], v[148:149] op_sel:[0,1] op_sel_hi:[1,1]
 v_pk_mul_f32 v[68:69], v[68:69], v[148:149] op_sel:[0,1] op_sel_hi:[1,1]
 v_pk_mul_f32 v[70:71], v[70:71], v[148:149] op_sel:[0,1] op_sel_hi:[1,1]
 v_pk_mul_f32 v[88:89], v[88:89], v[148:149] op_sel:[0,1] op_sel_hi:[1,1]
 v_pk_mul_f32 v[90:91], v[90:91], v[148:149] op_sel:[0,1] op_sel_hi:[1,1]
 s_waitcnt lgkmcnt(4)
 v_pk_fma_f32 v[28:29], v[108:109], v[150:151], v[28:29] op_sel_hi:[1,0,1]
 v_pk_fma_f32 v[30:31], v[110:111], v[150:151], v[30:31] op_sel_hi:[1,0,1]
 v_pk_fma_f32 v[48:49], v[128:129], v[150:151], v[48:49] op_sel_hi:[1,0,1]
 v_pk_fma_f32 v[50:51], v[130:131], v[150:151], v[50:51] op_sel_hi:[1,0,1]
 v_pk_fma_f32 v[68:69], v[206:207], v[150:151], v[68:69] op_sel_hi:[1,0,1]
 v_pk_fma_f32 v[70:71], v[208:209], v[150:151], v[70:71] op_sel_hi:[1,0,1]
 v_pk_fma_f32 v[88:89], v[222:223], v[150:151], v[88:89] op_sel_hi:[1,0,1]
 v_pk_fma_f32 v[90:91], v[224:225], v[150:151], v[90:91] op_sel_hi:[1,0,1]
 v_cvt_pk_bf16_f32 v198, v28, v29
 v_cvt_pk_bf16_f32 v199, v30, v31
 v_cvt_pk_bf16_f32 v200, v48, v49
 v_cvt_pk_bf16_f32 v201, v50, v51
 v_cvt_pk_bf16_f32 v202, v68, v69
 v_cvt_pk_bf16_f32 v203, v70, v71
 v_cvt_pk_bf16_f32 v204, v88, v89
 v_cvt_pk_bf16_f32 v205, v90, v91
 buffer_store_dwordx4 v[198:201], v189, s[36:39], s56 offen offset:0 sc1
 buffer_store_dwordx4 v[202:205], v189, s[36:39], s56 offen offset:1024 sc1
 s_add_u32 s56, s56, 131072
 v_pk_mul_f32 v[32:33], v[32:33], v[152:153] op_sel:[0,1] op_sel_hi:[1,1]
 v_pk_mul_f32 v[34:35], v[34:35], v[152:153] op_sel:[0,1] op_sel_hi:[1,1]
 v_pk_mul_f32 v[52:53], v[52:53], v[152:153] op_sel:[0,1] op_sel_hi:[1,1]
 v_pk_mul_f32 v[54:55], v[54:55], v[152:153] op_sel:[0,1] op_sel_hi:[1,1]
 v_pk_mul_f32 v[72:73], v[72:73], v[152:153] op_sel:[0,1] op_sel_hi:[1,1]
 v_pk_mul_f32 v[74:75], v[74:75], v[152:153] op_sel:[0,1] op_sel_hi:[1,1]
 v_pk_mul_f32 v[92:93], v[92:93], v[152:153] op_sel:[0,1] op_sel_hi:[1,1]
 v_pk_mul_f32 v[94:95], v[94:95], v[152:153] op_sel:[0,1] op_sel_hi:[1,1]
 s_waitcnt lgkmcnt(0)
 v_pk_fma_f32 v[32:33], v[112:113], v[154:155], v[32:33] op_sel_hi:[1,0,1]
 v_pk_fma_f32 v[34:35], v[114:115], v[154:155], v[34:35] op_sel_hi:[1,0,1]
 v_pk_fma_f32 v[52:53], v[132:133], v[154:155], v[52:53] op_sel_hi:[1,0,1]
 v_pk_fma_f32 v[54:55], v[134:135], v[154:155], v[54:55] op_sel_hi:[1,0,1]
 v_pk_fma_f32 v[72:73], v[210:211], v[154:155], v[72:73] op_sel_hi:[1,0,1]
 v_pk_fma_f32 v[74:75], v[212:213], v[154:155], v[74:75] op_sel_hi:[1,0,1]
 v_pk_fma_f32 v[92:93], v[226:227], v[154:155], v[92:93] op_sel_hi:[1,0,1]
 v_pk_fma_f32 v[94:95], v[228:229], v[154:155], v[94:95] op_sel_hi:[1,0,1]
 v_cvt_pk_bf16_f32 v190, v32, v33
 v_cvt_pk_bf16_f32 v191, v34, v35
 v_cvt_pk_bf16_f32 v192, v52, v53
 v_cvt_pk_bf16_f32 v193, v54, v55
 v_cvt_pk_bf16_f32 v194, v72, v73
 v_cvt_pk_bf16_f32 v195, v74, v75
 v_cvt_pk_bf16_f32 v196, v92, v93
 v_cvt_pk_bf16_f32 v197, v94, v95
 buffer_store_dwordx4 v[190:193], v189, s[36:39], s56 offen offset:0 sc1
 buffer_store_dwordx4 v[194:197], v189, s[36:39], s56 offen offset:1024 sc1
 s_add_u32 s56, s56, 131072
 v_mov_b32 v14, 0
 s_mov_b32 s49, 0
L_tagwaitb:
 v_cmp_eq_u32 vcc, 0, v232
 s_cbranch_vccz L_tagokb
 global_load_dword v232, v14, s[16:17] sc1
 s_add_u32 s49, s49, 1
 s_cmp_lt_u32 s49, 0x40000
 s_waitcnt vmcnt(0)
 s_cbranch_scc1 L_tagwaitb
L_tagokb:
 s_lshl_b32 s3, s41, 5
 s_add_u32 s3, s3, s42
 s_lshl_b32 s3, s3, 7
 s_add_u32 s58, s3, 16777216
 s_waitcnt vmcnt(0) lgkmcnt(0)
 s_barrier
 s_cmp_lg_u32 s40, 0
 s_cbranch_scc1 L_noflagb
 buffer_store_dword v232, v14, s[36:39], s58 offen sc1
L_noflagb:
 s_branch L_done
L_rarea1:
 s_call_b64 s[50:51], L_fix0
 s_branch L_rarea1_back
L_rarea2:
 s_call_b64 s[50:51], L_fix1
 s_branch L_rarea2_back
L_rarea3:
 s_call_b64 s[50:51], L_fix0
 s_branch L_rarea3_back
L_rarea4:
 s_call_b64 s[50:51], L_fix1
 s_branch L_rarea4_back
L_rarea5:
 s_call_b64 s[50:51], L_fix0
 s_branch L_rarea5_back
L_rarea6:
 s_call_b64 s[50:51], L_fix1
 s_branch L_rarea6_back
L_rarea7:
 s_call_b64 s[50:51], L_fix0
 s_branch L_rarea7_back
L_rarea8:
 s_call_b64 s[50:51], L_fix1
 s_branch L_rarea8_back
L_rarea9:
 s_call_b64 s[50:51], L_fix0
 s_branch L_rarea9_back
L_rarea10:
 s_call_b64 s[50:51], L_fix1
 s_branch L_rarea10_back
L_rarea11:
 s_call_b64 s[50:51], L_fix0
 s_branch L_rarea11_back
L_rarea12:
 s_call_b64 s[50:51], L_fix1
 s_branch L_rarea12_back
L_rarea13:
 s_call_b64 s[50:51], L_fix0
 s_branch L_rarea13_back
L_rarea14:
 s_call_b64 s[50:51], L_fix1
 s_branch L_rarea14_back
L_rarea15:
 s_call_b64 s[50:51], L_fix0
 s_branch L_rarea15_back
L_rarea16:
 s_call_b64 s[50:51], L_fix1
 s_branch L_rarea16_back
L_rareb1:
 s_call_b64 s[50:51], L_fix0
 s_branch L_rareb1_back
L_rareb2:
 s_call_b64 s[50:51], L_fix1
 s_branch L_rareb2_back
L_rareb3:
 s_call_b64 s[50:51], L_fix0
 s_branch L_rareb3_back
L_rareb4:
 s_call_b64 s[50:51], L_fix1
 s_branch L_rareb4_back
L_rareb5:
 s_call_b64 s[50:51], L_fix0
 s_branch L_rareb5_back
L_rareb6:
 s_call_b64 s[50:51], L_fix1
 s_branch L_rareb6_back
L_rareb7:
 s_call_b64 s[50:51], L_fix0
 s_branch L_rareb7_back
L_rareb8:
 s_call_b64 s[50:51], L_fix1
 s_branch L_rareb8_back
L_rareb9:
 s_call_b64 s[50:51], L_fix0
 s_branch L_rareb9_back
L_rareb10:
 s_call_b64 s[50:51], L_fix1
 s_branch L_rareb10_back
L_rareb11:
 s_call_b64 s[50:51], L_fix0
 s_branch L_rareb11_back
L_rareb12:
 s_call_b64 s[50:51], L_fix1
 s_branch L_rareb12_back
L_rareb13:
 s_call_b64 s[50:51], L_fix0
 s_branch L_rareb13_back
L_rareb14:
 s_call_b64 s[50:51], L_fix1
 s_branch L_rareb14_back
L_rareb15:
 s_call_b64 s[50:51], L_fix0
 s_branch L_rareb15_back
L_rareb16:
 s_call_b64 s[50:51], L_fix1
 s_branch L_rareb16_back
L_code_end:
L_fix0:
 s_nop 7
 v_max3_f32 v220, v16, v17, v18
 v_max3_f32 v220, v220, v19, v20
 v_max3_f32 v220, v220, v21, v22
 v_max_f32 v220, v220, v23
 v_max3_f32 v221, v24, v25, v26
 v_max3_f32 v221, v221, v27, v28
 v_max3_f32 v221, v221, v29, v30
 v_max_f32 v221, v221, v31
 v_max3_f32 v222, v32, v33, v34
 v_max3_f32 v222, v222, v35, v36
 v_max3_f32 v222, v222, v37, v38
 v_max_f32 v222, v222, v39
 v_max3_f32 v223, v40, v41, v42
 v_max3_f32 v223, v223, v43, v44
 v_max3_f32 v223, v223, v45, v46
 v_max_f32 v223, v223, v47
 v_max3_f32 v224, v48, v49, v50
 v_max3_f32 v224, v224, v51, v52
 v_max3_f32 v224, v224, v53, v54
 v_max_f32 v224, v224, v55
 v_mov_b32 v225, v220
 v_mov_b32 v226, v221
 v_mov_b32 v227, v222
 v_mov_b32 v228, v223
 v_mov_b32 v229, v224
 s_nop 0
 v_permlane16_swap_b32 v220, v225
 v_permlane16_swap_b32 v221, v226
 v_permlane16_swap_b32 v222, v227
 v_permlane16_swap_b32 v223, v228
 v_permlane16_swap_b32 v224, v229
 v_max_f32 v220, v220, v225
 v_max_f32 v221, v221, v226
 v_max_f32 v222, v222, v227
 v_max_f32 v223, v223, v228
 v_max_f32 v224, v224, v229
 v_mov_b32 v225, v220
 v_mov_b32 v226, v221
 v_mov_b32 v227, v222
 v_mov_b32 v228, v223
 v_mov_b32 v229, v224
 s_nop 0
 v_permlane32_swap_b32 v220, v225
 v_permlane32_swap_b32 v221, v226
 v_permlane32_swap_b32 v222, v227
 v_permlane32_swap_b32 v223, v228
 v_permlane32_swap_b32 v224, v229
 v_max_f32 v220, v220, v225
 v_max_f32 v221, v221, v226
 v_max_f32 v222, v222, v227
 v_max_f32 v223, v223, v228
 v_max_f32 v224, v224, v229
 v_add_f32 v220, 0x41300000, v220
 v_max_f32 v220, 0, v220
 v_add_f32 v221, 0x41300000, v221
 v_max_f32 v221, 0, v221
 v_add_f32 v222, 0x41300000, v222
 v_max_f32 v222, 0, v222
 v_add_f32 v223, 0x41300000, v223
 v_max_f32 v223, 0, v223
 v_add_f32 v224, 0x41300000, v224
 v_max_f32 v224, 0, v224
 v_sub_f32 v16, v16, v220
 v_sub_f32 v17, v17, v220
 v_sub_f32 v18, v18, v220
 v_sub_f32 v19, v19, v220
 v_sub_f32 v20, v20, v220
 v_sub_f32 v21, v21, v220
 v_sub_f32 v22, v22, v220
 v_sub_f32 v23, v23, v220
 v_sub_f32 v136, v136, v220
 v_sub_f32 v137, v137, v220
 v_sub_f32 v138, v138, v220
 v_sub_f32 v139, v139, v220
 v_sub_f32 v56, v56, v220
 v_sub_f32 v57, v57, v220
 v_sub_f32 v58, v58, v220
 v_sub_f32 v59, v59, v220
 v_sub_f32 v60, v60, v220
 v_sub_f32 v61, v61, v220
 v_sub_f32 v62, v62, v220
 v_sub_f32 v63, v63, v220
 v_sub_f32 v24, v24, v221
 v_sub_f32 v25, v25, v221
 v_sub_f32 v26, v26, v221
 v_sub_f32 v27, v27, v221
 v_sub_f32 v28, v28, v221
 v_sub_f32 v29, v29, v221
 v_sub_f32 v30, v30, v221
 v_sub_f32 v31, v31, v221
 v_sub_f32 v140, v140, v221
 v_sub_f32 v141, v141, v221
 v_sub_f32 v142, v142, v221
 v_sub_f32 v143, v143, v221
 v_sub_f32 v64, v64, v221
 v_sub_f32 v65, v65, v221
 v_sub_f32 v66, v66, v221
 v_sub_f32 v67, v67, v221
 v_sub_f32 v68, v68, v221
 v_sub_f32 v69, v69, v221
 v_sub_f32 v70, v70, v221
 v_sub_f32 v71, v71, v221
 v_sub_f32 v32, v32, v222
 v_sub_f32 v33, v33, v222
 v_sub_f32 v34, v34, v222
 v_sub_f32 v35, v35, v222
 v_sub_f32 v36, v36, v222
 v_sub_f32 v37, v37, v222
 v_sub_f32 v38, v38, v222
 v_sub_f32 v39, v39, v222
 v_sub_f32 v144, v144, v222
 v_sub_f32 v145, v145, v222
 v_sub_f32 v146, v146, v222
 v_sub_f32 v147, v147, v222
 v_sub_f32 v72, v72, v222
 v_sub_f32 v73, v73, v222
 v_sub_f32 v74, v74, v222
 v_sub_f32 v75, v75, v222
 v_sub_f32 v76, v76, v222
 v_sub_f32 v77, v77, v222
 v_sub_f32 v78, v78, v222
 v_sub_f32 v79, v79, v222
 v_sub_f32 v40, v40, v223
 v_sub_f32 v41, v41, v223
 v_sub_f32 v42, v42, v223
 v_sub_f32 v43, v43, v223
 v_sub_f32 v44, v44, v223
 v_sub_f32 v45, v45, v223
 v_sub_f32 v46, v46, v223
 v_sub_f32 v47, v47, v223
 v_sub_f32 v148, v148, v223
 v_sub_f32 v149, v149, v223
 v_sub_f32 v150, v150, v223
 v_sub_f32 v151, v151, v223
 v_sub_f32 v80, v80, v223
 v_sub_f32 v81, v81, v223
 v_sub_f32 v82, v82, v223
 v_sub_f32 v83, v83, v223
 v_sub_f32 v84, v84, v223
 v_sub_f32 v85, v85, v223
 v_sub_f32 v86, v86, v223
 v_sub_f32 v87, v87, v223
 v_sub_f32 v48, v48, v224
 v_sub_f32 v49, v49, v224
 v_sub_f32 v50, v50, v224
 v_sub_f32 v51, v51, v224
 v_sub_f32 v52, v52, v224
 v_sub_f32 v53, v53, v224
 v_sub_f32 v54, v54, v224
 v_sub_f32 v55, v55, v224
 v_sub_f32 v152, v152, v224
 v_sub_f32 v153, v153, v224
 v_sub_f32 v154, v154, v224
 v_sub_f32 v155, v155, v224
 v_sub_f32 v88, v88, v224
 v_sub_f32 v89, v89, v224
 v_sub_f32 v90, v90, v224
 v_sub_f32 v91, v91, v224
 v_sub_f32 v92, v92, v224
 v_sub_f32 v93, v93, v224
 v_sub_f32 v94, v94, v224
 v_sub_f32 v95, v95, v224
 v_exp_f32 v176, v16
 v_exp_f32 v177, v17
 v_exp_f32 v178, v18
 v_cvt_pk_bf16_f32 v96, v176, v177
 v_exp_f32 v179, v19
 v_exp_f32 v180, v20
 v_cvt_pk_bf16_f32 v97, v178, v179
 v_exp_f32 v181, v21
 v_exp_f32 v182, v22
 v_cvt_pk_bf16_f32 v98, v180, v181
 v_exp_f32 v183, v23
 v_exp_f32 v176, v24
 v_cvt_pk_bf16_f32 v99, v182, v183
 v_exp_f32 v177, v25
 v_exp_f32 v178, v26
 v_cvt_pk_bf16_f32 v100, v176, v177
 v_exp_f32 v179, v27
 v_exp_f32 v180, v28
 v_cvt_pk_bf16_f32 v101, v178, v179
 v_exp_f32 v181, v29
 v_exp_f32 v182, v30
 v_cvt_pk_bf16_f32 v102, v180, v181
 v_exp_f32 v183, v31
 v_exp_f32 v176, v32
 v_cvt_pk_bf16_f32 v103, v182, v183
 v_exp_f32 v177, v33
 v_exp_f32 v178, v34
 v_cvt_pk_bf16_f32 v104, v176, v177
 v_exp_f32 v179, v35
 v_exp_f32 v180, v36
 v_cvt_pk_bf16_f32 v105, v178, v179
 v_exp_f32 v181, v37
 v_exp_f32 v182, v38
 v_cvt_pk_bf16_f32 v106, v180, v181
 v_exp_f32 v183, v39
 v_exp_f32 v176, v40
 v_cvt_pk_bf16_f32 v107, v182, v183
 v_exp_f32 v177, v41
 v_exp_f32 v178, v42
 v_cvt_pk_bf16_f32 v108, v176, v177
 v_exp_f32 v179, v43
 v_exp_f32 v180, v44
 v_cvt_pk_bf16_f32 v109, v178, v179
 v_exp_f32 v181, v45
 v_exp_f32 v182, v46
 v_cvt_pk_bf16_f32 v110, v180, v181
 v_exp_f32 v183, v47
 v_exp_f32 v176, v48
 v_cvt_pk_bf16_f32 v111, v182, v183
 v_exp_f32 v177, v49
 v_exp_f32 v178, v50
 v_cvt_pk_bf16_f32 v112, v176, v177
 v_exp_f32 v179, v51
 v_exp_f32 v180, v52
 v_cvt_pk_bf16_f32 v113, v178, v179
 v_exp_f32 v181, v53
 v_exp_f32 v182, v54
 v_cvt_pk_bf16_f32 v114, v180, v181
 v_exp_f32 v183, v55
 s_nop 0
 v_cvt_pk_bf16_f32 v115, v182, v183
 v_exp_f32 v220, -v220
 v_exp_f32 v221, -v221
 v_exp_f32 v222, -v222
 v_exp_f32 v223, -v223
 v_exp_f32 v224, -v224
 s_nop 0
 v_mul_f32 v156, v156, v220
 v_mul_f32 v160, v160, v221
 v_mul_f32 v164, v164, v222
 v_mul_f32 v168, v168, v223
 v_mul_f32 v172, v172, v224
 v_accvgpr_read_b32 v12, a0
 v_accvgpr_read_b32 v13, a1
 v_accvgpr_read_b32 v14, a2
 v_accvgpr_read_b32 v15, a3
 v_mul_f32 v12, v220, v12
 v_mul_f32 v13, v220, v13
 v_mul_f32 v14, v220, v14
 v_mul_f32 v15, v220, v15
 v_accvgpr_write_b32 a0, v12
 v_accvgpr_write_b32 a1, v13
 v_accvgpr_write_b32 a2, v14
 v_accvgpr_write_b32 a3, v15
 v_accvgpr_read_b32 v12, a4
 v_accvgpr_read_b32 v13, a5
 v_accvgpr_read_b32 v14, a6
 v_accvgpr_read_b32 v15, a7
 v_mul_f32 v12, v221, v12
 v_mul_f32 v13, v221, v13
 v_mul_f32 v14, v221, v14
 v_mul_f32 v15, v221, v15
 v_accvgpr_write_b32 a4, v12
 v_accvgpr_write_b32 a5, v13
 v_accvgpr_write_b32 a6, v14
 v_accvgpr_write_b32 a7, v15
 v_accvgpr_read_b32 v12, a8
 v_accvgpr_read_b32 v13, a9
 v_accvgpr_read_b32 v14, a10
 v_accvgpr_read_b32 v15, a11
 v_mul_f32 v12, v222, v12
 v_mul_f32 v13, v222, v13
 v_mul_f32 v14, v222, v14
 v_mul_f32 v15, v222, v15
 v_accvgpr_write_b32 a8, v12
 v_accvgpr_write_b32 a9, v13
 v_accvgpr_write_b32 a10, v14
 v_accvgpr_write_b32 a11, v15
 v_accvgpr_read_b32 v12, a12
 v_accvgpr_read_b32 v13, a13
 v_accvgpr_read_b32 v14, a14
 v_accvgpr_read_b32 v15, a15
 v_mul_f32 v12, v223, v12
 v_mul_f32 v13, v223, v13
 v_mul_f32 v14, v223, v14
 v_mul_f32 v15, v223, v15
 v_accvgpr_write_b32 a12, v12
 v_accvgpr_write_b32 a13, v13
 v_accvgpr_write_b32 a14, v14
 v_accvgpr_write_b32 a15, v15
 v_accvgpr_read_b32 v12, a16
 v_accvgpr_read_b32 v13, a17
 v_accvgpr_read_b32 v14, a18
 v_accvgpr_read_b32 v15, a19
 v_mul_f32 v12, v224, v12
 v_mul_f32 v13, v224, v13
 v_mul_f32 v14, v224, v14
 v_mul_f32 v15, v224, v15
 v_accvgpr_write_b32 a16, v12
 v_accvgpr_write_b32 a17, v13
 v_accvgpr_write_b32 a18, v14
 v_accvgpr_write_b32 a19, v15
 v_accvgpr_read_b32 v12, a20
 v_accvgpr_read_b32 v13, a21
 v_accvgpr_read_b32 v14, a22
 v_accvgpr_read_b32 v15, a23
 v_mul_f32 v12, v220, v12
 v_mul_f32 v13, v220, v13
 v_mul_f32 v14, v220, v14
 v_mul_f32 v15, v220, v15
 v_accvgpr_write_b32 a20, v12
 v_accvgpr_write_b32 a21, v13
 v_accvgpr_write_b32 a22, v14
 v_accvgpr_write_b32 a23, v15
 v_accvgpr_read_b32 v12, a24
 v_accvgpr_read_b32 v13, a25
 v_accvgpr_read_b32 v14, a26
 v_accvgpr_read_b32 v15, a27
 v_mul_f32 v12, v221, v12
 v_mul_f32 v13, v221, v13
 v_mul_f32 v14, v221, v14
 v_mul_f32 v15, v221, v15
 v_accvgpr_write_b32 a24, v12
 v_accvgpr_write_b32 a25, v13
 v_accvgpr_write_b32 a26, v14
 v_accvgpr_write_b32 a27, v15
 v_accvgpr_read_b32 v12, a28
 v_accvgpr_read_b32 v13, a29
 v_accvgpr_read_b32 v14, a30
 v_accvgpr_read_b32 v15, a31
 v_mul_f32 v12, v222, v12
 v_mul_f32 v13, v222, v13
 v_mul_f32 v14, v222, v14
 v_mul_f32 v15, v222, v15
 v_accvgpr_write_b32 a28, v12
 v_accvgpr_write_b32 a29, v13
 v_accvgpr_write_b32 a30, v14
 v_accvgpr_write_b32 a31, v15
 v_accvgpr_read_b32 v12, a32
 v_accvgpr_read_b32 v13, a33
 v_accvgpr_read_b32 v14, a34
 v_accvgpr_read_b32 v15, a35
 v_mul_f32 v12, v223, v12
 v_mul_f32 v13, v223, v13
 v_mul_f32 v14, v223, v14
 v_mul_f32 v15, v223, v15
 v_accvgpr_write_b32 a32, v12
 v_accvgpr_write_b32 a33, v13
 v_accvgpr_write_b32 a34, v14
 v_accvgpr_write_b32 a35, v15
 v_accvgpr_read_b32 v12, a36
 v_accvgpr_read_b32 v13, a37
 v_accvgpr_read_b32 v14, a38
 v_accvgpr_read_b32 v15, a39
 v_mul_f32 v12, v224, v12
 v_mul_f32 v13, v224, v13
 v_mul_f32 v14, v224, v14
 v_mul_f32 v15, v224, v15
 v_accvgpr_write_b32 a36, v12
 v_accvgpr_write_b32 a37, v13
 v_accvgpr_write_b32 a38, v14
 v_accvgpr_write_b32 a39, v15
 v_accvgpr_read_b32 v12, a40
 v_accvgpr_read_b32 v13, a41
 v_accvgpr_read_b32 v14, a42
 v_accvgpr_read_b32 v15, a43
 v_mul_f32 v12, v220, v12
 v_mul_f32 v13, v220, v13
 v_mul_f32 v14, v220, v14
 v_mul_f32 v15, v220, v15
 v_accvgpr_write_b32 a40, v12
 v_accvgpr_write_b32 a41, v13
 v_accvgpr_write_b32 a42, v14
 v_accvgpr_write_b32 a43, v15
 v_accvgpr_read_b32 v12, a44
 v_accvgpr_read_b32 v13, a45
 v_accvgpr_read_b32 v14, a46
 v_accvgpr_read_b32 v15, a47
 v_mul_f32 v12, v221, v12
 v_mul_f32 v13, v221, v13
 v_mul_f32 v14, v221, v14
 v_mul_f32 v15, v221, v15
 v_accvgpr_write_b32 a44, v12
 v_accvgpr_write_b32 a45, v13
 v_accvgpr_write_b32 a46, v14
 v_accvgpr_write_b32 a47, v15
 v_accvgpr_read_b32 v12, a48
 v_accvgpr_read_b32 v13, a49
 v_accvgpr_read_b32 v14, a50
 v_accvgpr_read_b32 v15, a51
 v_mul_f32 v12, v222, v12
 v_mul_f32 v13, v222, v13
 v_mul_f32 v14, v222, v14
 v_mul_f32 v15, v222, v15
 v_accvgpr_write_b32 a48, v12
 v_accvgpr_write_b32 a49, v13
 v_accvgpr_write_b32 a50, v14
 v_accvgpr_write_b32 a51, v15
 v_accvgpr_read_b32 v12, a52
 v_accvgpr_read_b32 v13, a53
 v_accvgpr_read_b32 v14, a54
 v_accvgpr_read_b32 v15, a55
 v_mul_f32 v12, v223, v12
 v_mul_f32 v13, v223, v13
 v_mul_f32 v14, v223, v14
 v_mul_f32 v15, v223, v15
 v_accvgpr_write_b32 a52, v12
 v_accvgpr_write_b32 a53, v13
 v_accvgpr_write_b32 a54, v14
 v_accvgpr_write_b32 a55, v15
 v_accvgpr_read_b32 v12, a56
 v_accvgpr_read_b32 v13, a57
 v_accvgpr_read_b32 v14, a58
 v_accvgpr_read_b32 v15, a59
 v_mul_f32 v12, v224, v12
 v_mul_f32 v13, v224, v13
 v_mul_f32 v14, v224, v14
 v_mul_f32 v15, v224, v15
 v_accvgpr_write_b32 a56, v12
 v_accvgpr_write_b32 a57, v13
 v_accvgpr_write_b32 a58, v14
 v_accvgpr_write_b32 a59, v15
 v_accvgpr_read_b32 v12, a60
 v_accvgpr_read_b32 v13, a61
 v_accvgpr_read_b32 v14, a62
 v_accvgpr_read_b32 v15, a63
 v_mul_f32 v12, v220, v12
 v_mul_f32 v13, v220, v13
 v_mul_f32 v14, v220, v14
 v_mul_f32 v15, v220, v15
 v_accvgpr_write_b32 a60, v12
 v_accvgpr_write_b32 a61, v13
 v_accvgpr_write_b32 a62, v14
 v_accvgpr_write_b32 a63, v15
 v_accvgpr_read_b32 v12, a64
 v_accvgpr_read_b32 v13, a65
 v_accvgpr_read_b32 v14, a66
 v_accvgpr_read_b32 v15, a67
 v_mul_f32 v12, v221, v12
 v_mul_f32 v13, v221, v13
 v_mul_f32 v14, v221, v14
 v_mul_f32 v15, v221, v15
 v_accvgpr_write_b32 a64, v12
 v_accvgpr_write_b32 a65, v13
 v_accvgpr_write_b32 a66, v14
 v_accvgpr_write_b32 a67, v15
 v_accvgpr_read_b32 v12, a68
 v_accvgpr_read_b32 v13, a69
 v_accvgpr_read_b32 v14, a70
 v_accvgpr_read_b32 v15, a71
 v_mul_f32 v12, v222, v12
 v_mul_f32 v13, v222, v13
 v_mul_f32 v14, v222, v14
 v_mul_f32 v15, v222, v15
 v_accvgpr_write_b32 a68, v12
 v_accvgpr_write_b32 a69, v13
 v_accvgpr_write_b32 a70, v14
 v_accvgpr_write_b32 a71, v15
 v_accvgpr_read_b32 v12, a72
 v_accvgpr_read_b32 v13, a73
 v_accvgpr_read_b32 v14, a74
 v_accvgpr_read_b32 v15, a75
 v_mul_f32 v12, v223, v12
 v_mul_f32 v13, v223, v13
 v_mul_f32 v14, v223, v14
 v_mul_f32 v15, v223, v15
 v_accvgpr_write_b32 a72, v12
 v_accvgpr_write_b32 a73, v13
 v_accvgpr_write_b32 a74, v14
 v_accvgpr_write_b32 a75, v15
 v_accvgpr_read_b32 v12, a76
 v_accvgpr_read_b32 v13, a77
 v_accvgpr_read_b32 v14, a78
 v_accvgpr_read_b32 v15, a79
 v_mul_f32 v12, v224, v12
 v_mul_f32 v13, v224, v13
 v_mul_f32 v14, v224, v14
 v_mul_f32 v15, v224, v15
 v_accvgpr_write_b32 a76, v12
 v_accvgpr_write_b32 a77, v13
 v_accvgpr_write_b32 a78, v14
 v_accvgpr_write_b32 a79, v15
 v_accvgpr_read_b32 v12, a80
 v_accvgpr_read_b32 v13, a81
 v_accvgpr_read_b32 v14, a82
 v_accvgpr_read_b32 v15, a83
 v_mul_f32 v12, v220, v12
 v_mul_f32 v13, v220, v13
 v_mul_f32 v14, v220, v14
 v_mul_f32 v15, v220, v15
 v_accvgpr_write_b32 a80, v12
 v_accvgpr_write_b32 a81, v13
 v_accvgpr_write_b32 a82, v14
 v_accvgpr_write_b32 a83, v15
 v_accvgpr_read_b32 v12, a84
 v_accvgpr_read_b32 v13, a85
 v_accvgpr_read_b32 v14, a86
 v_accvgpr_read_b32 v15, a87
 v_mul_f32 v12, v221, v12
 v_mul_f32 v13, v221, v13
 v_mul_f32 v14, v221, v14
 v_mul_f32 v15, v221, v15
 v_accvgpr_write_b32 a84, v12
 v_accvgpr_write_b32 a85, v13
 v_accvgpr_write_b32 a86, v14
 v_accvgpr_write_b32 a87, v15
 v_accvgpr_read_b32 v12, a88
 v_accvgpr_read_b32 v13, a89
 v_accvgpr_read_b32 v14, a90
 v_accvgpr_read_b32 v15, a91
 v_mul_f32 v12, v222, v12
 v_mul_f32 v13, v222, v13
 v_mul_f32 v14, v222, v14
 v_mul_f32 v15, v222, v15
 v_accvgpr_write_b32 a88, v12
 v_accvgpr_write_b32 a89, v13
 v_accvgpr_write_b32 a90, v14
 v_accvgpr_write_b32 a91, v15
 v_accvgpr_read_b32 v12, a92
 v_accvgpr_read_b32 v13, a93
 v_accvgpr_read_b32 v14, a94
 v_accvgpr_read_b32 v15, a95
 v_mul_f32 v12, v223, v12
 v_mul_f32 v13, v223, v13
 v_mul_f32 v14, v223, v14
 v_mul_f32 v15, v223, v15
 v_accvgpr_write_b32 a92, v12
 v_accvgpr_write_b32 a93, v13
 v_accvgpr_write_b32 a94, v14
 v_accvgpr_write_b32 a95, v15
 v_accvgpr_read_b32 v12, a96
 v_accvgpr_read_b32 v13, a97
 v_accvgpr_read_b32 v14, a98
 v_accvgpr_read_b32 v15, a99
 v_mul_f32 v12, v224, v12
 v_mul_f32 v13, v224, v13
 v_mul_f32 v14, v224, v14
 v_mul_f32 v15, v224, v15
 v_accvgpr_write_b32 a96, v12
 v_accvgpr_write_b32 a97, v13
 v_accvgpr_write_b32 a98, v14
 v_accvgpr_write_b32 a99, v15
 v_accvgpr_read_b32 v12, a100
 v_accvgpr_read_b32 v13, a101
 v_accvgpr_read_b32 v14, a102
 v_accvgpr_read_b32 v15, a103
 v_mul_f32 v12, v220, v12
 v_mul_f32 v13, v220, v13
 v_mul_f32 v14, v220, v14
 v_mul_f32 v15, v220, v15
 v_accvgpr_write_b32 a100, v12
 v_accvgpr_write_b32 a101, v13
 v_accvgpr_write_b32 a102, v14
 v_accvgpr_write_b32 a103, v15
 v_accvgpr_read_b32 v12, a104
 v_accvgpr_read_b32 v13, a105
 v_accvgpr_read_b32 v14, a106
 v_accvgpr_read_b32 v15, a107
 v_mul_f32 v12, v221, v12
 v_mul_f32 v13, v221, v13
 v_mul_f32 v14, v221, v14
 v_mul_f32 v15, v221, v15
 v_accvgpr_write_b32 a104, v12
 v_accvgpr_write_b32 a105, v13
 v_accvgpr_write_b32 a106, v14
 v_accvgpr_write_b32 a107, v15
 v_accvgpr_read_b32 v12, a108
 v_accvgpr_read_b32 v13, a109
 v_accvgpr_read_b32 v14, a110
 v_accvgpr_read_b32 v15, a111
 v_mul_f32 v12, v222, v12
 v_mul_f32 v13, v222, v13
 v_mul_f32 v14, v222, v14
 v_mul_f32 v15, v222, v15
 v_accvgpr_write_b32 a108, v12
 v_accvgpr_write_b32 a109, v13
 v_accvgpr_write_b32 a110, v14
 v_accvgpr_write_b32 a111, v15
 v_accvgpr_read_b32 v12, a112
 v_accvgpr_read_b32 v13, a113
 v_accvgpr_read_b32 v14, a114
 v_accvgpr_read_b32 v15, a115
 v_mul_f32 v12, v223, v12
 v_mul_f32 v13, v223, v13
 v_mul_f32 v14, v223, v14
 v_mul_f32 v15, v223, v15
 v_accvgpr_write_b32 a112, v12
 v_accvgpr_write_b32 a113, v13
 v_accvgpr_write_b32 a114, v14
 v_accvgpr_write_b32 a115, v15
 v_accvgpr_read_b32 v12, a116
 v_accvgpr_read_b32 v13, a117
 v_accvgpr_read_b32 v14, a118
 v_accvgpr_read_b32 v15, a119
 v_mul_f32 v12, v224, v12
 v_mul_f32 v13, v224, v13
 v_mul_f32 v14, v224, v14
 v_mul_f32 v15, v224, v15
 v_accvgpr_write_b32 a116, v12
 v_accvgpr_write_b32 a117, v13
 v_accvgpr_write_b32 a118, v14
 v_accvgpr_write_b32 a119, v15
 v_accvgpr_read_b32 v12, a120
 v_accvgpr_read_b32 v13, a121
 v_accvgpr_read_b32 v14, a122
 v_accvgpr_read_b32 v15, a123
 v_mul_f32 v12, v220, v12
 v_mul_f32 v13, v220, v13
 v_mul_f32 v14, v220, v14
 v_mul_f32 v15, v220, v15
 v_accvgpr_write_b32 a120, v12
 v_accvgpr_write_b32 a121, v13
 v_accvgpr_write_b32 a122, v14
 v_accvgpr_write_b32 a123, v15
 v_accvgpr_read_b32 v12, a124
 v_accvgpr_read_b32 v13, a125
 v_accvgpr_read_b32 v14, a126
 v_accvgpr_read_b32 v15, a127
 v_mul_f32 v12, v221, v12
 v_mul_f32 v13, v221, v13
 v_mul_f32 v14, v221, v14
 v_mul_f32 v15, v221, v15
 v_accvgpr_write_b32 a124, v12
 v_accvgpr_write_b32 a125, v13
 v_accvgpr_write_b32 a126, v14
 v_accvgpr_write_b32 a127, v15
 v_accvgpr_read_b32 v12, a128
 v_accvgpr_read_b32 v13, a129
 v_accvgpr_read_b32 v14, a130
 v_accvgpr_read_b32 v15, a131
 v_mul_f32 v12, v222, v12
 v_mul_f32 v13, v222, v13
 v_mul_f32 v14, v222, v14
 v_mul_f32 v15, v222, v15
 v_accvgpr_write_b32 a128, v12
 v_accvgpr_write_b32 a129, v13
 v_accvgpr_write_b32 a130, v14
 v_accvgpr_write_b32 a131, v15
 v_accvgpr_read_b32 v12, a132
 v_accvgpr_read_b32 v13, a133
 v_accvgpr_read_b32 v14, a134
 v_accvgpr_read_b32 v15, a135
 v_mul_f32 v12, v223, v12
 v_mul_f32 v13, v223, v13
 v_mul_f32 v14, v223, v14
 v_mul_f32 v15, v223, v15
 v_accvgpr_write_b32 a132, v12
 v_accvgpr_write_b32 a133, v13
 v_accvgpr_write_b32 a134, v14
 v_accvgpr_write_b32 a135, v15
 v_accvgpr_read_b32 v12, a136
 v_accvgpr_read_b32 v13, a137
 v_accvgpr_read_b32 v14, a138
 v_accvgpr_read_b32 v15, a139
 v_mul_f32 v12, v224, v12
 v_mul_f32 v13, v224, v13
 v_mul_f32 v14, v224, v14
 v_mul_f32 v15, v224, v15
 v_accvgpr_write_b32 a136, v12
 v_accvgpr_write_b32 a137, v13
 v_accvgpr_write_b32 a138, v14
 v_accvgpr_write_b32 a139, v15
 v_accvgpr_read_b32 v12, a140
 v_accvgpr_read_b32 v13, a141
 v_accvgpr_read_b32 v14, a142
 v_accvgpr_read_b32 v15, a143
 v_mul_f32 v12, v220, v12
 v_mul_f32 v13, v220, v13
 v_mul_f32 v14, v220, v14
 v_mul_f32 v15, v220, v15
 v_accvgpr_write_b32 a140, v12
 v_accvgpr_write_b32 a141, v13
 v_accvgpr_write_b32 a142, v14
 v_accvgpr_write_b32 a143, v15
 v_accvgpr_read_b32 v12, a144
 v_accvgpr_read_b32 v13, a145
 v_accvgpr_read_b32 v14, a146
 v_accvgpr_read_b32 v15, a147
 v_mul_f32 v12, v221, v12
 v_mul_f32 v13, v221, v13
 v_mul_f32 v14, v221, v14
 v_mul_f32 v15, v221, v15
 v_accvgpr_write_b32 a144, v12
 v_accvgpr_write_b32 a145, v13
 v_accvgpr_write_b32 a146, v14
 v_accvgpr_write_b32 a147, v15
 v_accvgpr_read_b32 v12, a148
 v_accvgpr_read_b32 v13, a149
 v_accvgpr_read_b32 v14, a150
 v_accvgpr_read_b32 v15, a151
 v_mul_f32 v12, v222, v12
 v_mul_f32 v13, v222, v13
 v_mul_f32 v14, v222, v14
 v_mul_f32 v15, v222, v15
 v_accvgpr_write_b32 a148, v12
 v_accvgpr_write_b32 a149, v13
 v_accvgpr_write_b32 a150, v14
 v_accvgpr_write_b32 a151, v15
 v_accvgpr_read_b32 v12, a152
 v_accvgpr_read_b32 v13, a153
 v_accvgpr_read_b32 v14, a154
 v_accvgpr_read_b32 v15, a155
 v_mul_f32 v12, v223, v12
 v_mul_f32 v13, v223, v13
 v_mul_f32 v14, v223, v14
 v_mul_f32 v15, v223, v15
 v_accvgpr_write_b32 a152, v12
 v_accvgpr_write_b32 a153, v13
 v_accvgpr_write_b32 a154, v14
 v_accvgpr_write_b32 a155, v15
 v_accvgpr_read_b32 v12, a156
 v_accvgpr_read_b32 v13, a157
 v_accvgpr_read_b32 v14, a158
 v_accvgpr_read_b32 v15, a159
 v_mul_f32 v12, v224, v12
 v_mul_f32 v13, v224, v13
 v_mul_f32 v14, v224, v14
 v_mul_f32 v15, v224, v15
 v_accvgpr_write_b32 a156, v12
 v_accvgpr_write_b32 a157, v13
 v_accvgpr_write_b32 a158, v14
 v_accvgpr_write_b32 a159, v15
 s_nop 1
 s_setpc_b64 s[50:51]
L_fix1:
 s_nop 7
 v_max3_f32 v220, v56, v57, v58
 v_max3_f32 v220, v220, v59, v60
 v_max3_f32 v220, v220, v61, v62
 v_max_f32 v220, v220, v63
 v_max3_f32 v221, v64, v65, v66
 v_max3_f32 v221, v221, v67, v68
 v_max3_f32 v221, v221, v69, v70
 v_max_f32 v221, v221, v71
 v_max3_f32 v222, v72, v73, v74
 v_max3_f32 v222, v222, v75, v76
 v_max3_f32 v222, v222, v77, v78
 v_max_f32 v222, v222, v79
 v_max3_f32 v223, v80, v81, v82
 v_max3_f32 v223, v223, v83, v84
 v_max3_f32 v223, v223, v85, v86
 v_max_f32 v223, v223, v87
 v_max3_f32 v224, v88, v89, v90
 v_max3_f32 v224, v224, v91, v92
 v_max3_f32 v224, v224, v93, v94
 v_max_f32 v224, v224, v95
 v_mov_b32 v225, v220
 v_mov_b32 v226, v221
 v_mov_b32 v227, v222
 v_mov_b32 v228, v223
 v_mov_b32 v229, v224
 s_nop 0
 v_permlane16_swap_b32 v220, v225
 v_permlane16_swap_b32 v221, v226
 v_permlane16_swap_b32 v222, v227
 v_permlane16_swap_b32 v223, v228
 v_permlane16_swap_b32 v224, v229
 v_max_f32 v220, v220, v225
 v_max_f32 v221, v221, v226
 v_max_f32 v222, v222, v227
 v_max_f32 v223, v223, v228
 v_max_f32 v224, v224, v229
 v_mov_b32 v225, v220
 v_mov_b32 v226, v221
 v_mov_b32 v227, v222
 v_mov_b32 v228, v223
 v_mov_b32 v229, v224
 s_nop 0
 v_permlane32_swap_b32 v220, v225
 v_permlane32_swap_b32 v221, v226
 v_permlane32_swap_b32 v222, v227
 v_permlane32_swap_b32 v223, v228
 v_permlane32_swap_b32 v224, v229
 v_max_f32 v220, v220, v225
 v_max_f32 v221, v221, v226
 v_max_f32 v222, v222, v227
 v_max_f32 v223, v223, v228
 v_max_f32 v224, v224, v229
 v_add_f32 v220, 0x41300000, v220
 v_max_f32 v220, 0, v220
 v_add_f32 v221, 0x41300000, v221
 v_max_f32 v221, 0, v221
 v_add_f32 v222, 0x41300000, v222
 v_max_f32 v222, 0, v222
 v_add_f32 v223, 0x41300000, v223
 v_max_f32 v223, 0, v223
 v_add_f32 v224, 0x41300000, v224
 v_max_f32 v224, 0, v224
 v_sub_f32 v56, v56, v220
 v_sub_f32 v57, v57, v220
 v_sub_f32 v58, v58, v220
 v_sub_f32 v59, v59, v220
 v_sub_f32 v60, v60, v220
 v_sub_f32 v61, v61, v220
 v_sub_f32 v62, v62, v220
 v_sub_f32 v63, v63, v220
 v_sub_f32 v136, v136, v220
 v_sub_f32 v137, v137, v220
 v_sub_f32 v138, v138, v220
 v_sub_f32 v139, v139, v220
 v_sub_f32 v16, v16, v220
 v_sub_f32 v17, v17, v220
 v_sub_f32 v18, v18, v220
 v_sub_f32 v19, v19, v220
 v_sub_f32 v20, v20, v220
 v_sub_f32 v21, v21, v220
 v_sub_f32 v22, v22, v220
 v_sub_f32 v23, v23, v220
 v_sub_f32 v64, v64, v221
 v_sub_f32 v65, v65, v221
 v_sub_f32 v66, v66, v221
 v_sub_f32 v67, v67, v221
 v_sub_f32 v68, v68, v221
 v_sub_f32 v69, v69, v221
 v_sub_f32 v70, v70, v221
 v_sub_f32 v71, v71, v221
 v_sub_f32 v140, v140, v221
 v_sub_f32 v141, v141, v221
 v_sub_f32 v142, v142, v221
 v_sub_f32 v143, v143, v221
 v_sub_f32 v24, v24, v221
 v_sub_f32 v25, v25, v221
 v_sub_f32 v26, v26, v221
 v_sub_f32 v27, v27, v221
 v_sub_f32 v28, v28, v221
 v_sub_f32 v29, v29, v221
 v_sub_f32 v30, v30, v221
 v_sub_f32 v31, v31, v221
 v_sub_f32 v72, v72, v222
 v_sub_f32 v73, v73, v222
 v_sub_f32 v74, v74, v222
 v_sub_f32 v75, v75, v222
 v_sub_f32 v76, v76, v222
 v_sub_f32 v77, v77, v222
 v_sub_f32 v78, v78, v222
 v_sub_f32 v79, v79, v222
 v_sub_f32 v144, v144, v222
 v_sub_f32 v145, v145, v222
 v_sub_f32 v146, v146, v222
 v_sub_f32 v147, v147, v222
 v_sub_f32 v32, v32, v222
 v_sub_f32 v33, v33, v222
 v_sub_f32 v34, v34, v222
 v_sub_f32 v35, v35, v222
 v_sub_f32 v36, v36, v222
 v_sub_f32 v37, v37, v222
 v_sub_f32 v38, v38, v222
 v_sub_f32 v39, v39, v222
 v_sub_f32 v80, v80, v223
 v_sub_f32 v81, v81, v223
 v_sub_f32 v82, v82, v223
 v_sub_f32 v83, v83, v223
 v_sub_f32 v84, v84, v223
 v_sub_f32 v85, v85, v223
 v_sub_f32 v86, v86, v223
 v_sub_f32 v87, v87, v223
 v_sub_f32 v148, v148, v223
 v_sub_f32 v149, v149, v223
 v_sub_f32 v150, v150, v223
 v_sub_f32 v151, v151, v223
 v_sub_f32 v40, v40, v223
 v_sub_f32 v41, v41, v223
 v_sub_f32 v42, v42, v223
 v_sub_f32 v43, v43, v223
 v_sub_f32 v44, v44, v223
 v_sub_f32 v45, v45, v223
 v_sub_f32 v46, v46, v223
 v_sub_f32 v47, v47, v223
 v_sub_f32 v88, v88, v224
 v_sub_f32 v89, v89, v224
 v_sub_f32 v90, v90, v224
 v_sub_f32 v91, v91, v224
 v_sub_f32 v92, v92, v224
 v_sub_f32 v93, v93, v224
 v_sub_f32 v94, v94, v224
 v_sub_f32 v95, v95, v224
 v_sub_f32 v152, v152, v224
 v_sub_f32 v153, v153, v224
 v_sub_f32 v154, v154, v224
 v_sub_f32 v155, v155, v224
 v_sub_f32 v48, v48, v224
 v_sub_f32 v49, v49, v224
 v_sub_f32 v50, v50, v224
 v_sub_f32 v51, v51, v224
 v_sub_f32 v52, v52, v224
 v_sub_f32 v53, v53, v224
 v_sub_f32 v54, v54, v224
 v_sub_f32 v55, v55, v224
 v_exp_f32 v176, v56
 v_exp_f32 v177, v57
 v_exp_f32 v178, v58
 v_cvt_pk_bf16_f32 v116, v176, v177
 v_exp_f32 v179, v59
 v_exp_f32 v180, v60
 v_cvt_pk_bf16_f32 v117, v178, v179
 v_exp_f32 v181, v61
 v_exp_f32 v182, v62
 v_cvt_pk_bf16_f32 v118, v180, v181
 v_exp_f32 v183, v63
 v_exp_f32 v176, v64
 v_cvt_pk_bf16_f32 v119, v182, v183
 v_exp_f32 v177, v65
 v_exp_f32 v178, v66
 v_cvt_pk_bf16_f32 v120, v176, v177
 v_exp_f32 v179, v67
 v_exp_f32 v180, v68
 v_cvt_pk_bf16_f32 v121, v178, v179
 v_exp_f32 v181, v69
 v_exp_f32 v182, v70
 v_cvt_pk_bf16_f32 v122, v180, v181
 v_exp_f32 v183, v71
 v_exp_f32 v176, v72
 v_cvt_pk_bf16_f32 v123, v182, v183
 v_exp_f32 v177, v73
 v_exp_f32 v178, v74
 v_cvt_pk_bf16_f32 v124, v176, v177
 v_exp_f32 v179, v75
 v_exp_f32 v180, v76
 v_cvt_pk_bf16_f32 v125, v178, v179
 v_exp_f32 v181, v77
 v_exp_f32 v182, v78
 v_cvt_pk_bf16_f32 v126, v180, v181
 v_exp_f32 v183, v79
 v_exp_f32 v176, v80
 v_cvt_pk_bf16_f32 v127, v182, v183
 v_exp_f32 v177, v81
 v_exp_f32 v178, v82
 v_cvt_pk_bf16_f32 v128, v176, v177
 v_exp_f32 v179, v83
 v_exp_f32 v180, v84
 v_cvt_pk_bf16_f32 v129, v178, v179
 v_exp_f32 v181, v85
 v_exp_f32 v182, v86
 v_cvt_pk_bf16_f32 v130, v180, v181
 v_exp_f32 v183, v87
 v_exp_f32 v176, v88
 v_cvt_pk_bf16_f32 v131, v182, v183
 v_exp_f32 v177, v89
 v_exp_f32 v178, v90
 v_cvt_pk_bf16_f32 v132, v176, v177
 v_exp_f32 v179, v91
 v_exp_f32 v180, v92
 v_cvt_pk_bf16_f32 v133, v178, v179
 v_exp_f32 v181, v93
 v_exp_f32 v182, v94
 v_cvt_pk_bf16_f32 v134, v180, v181
 v_exp_f32 v183, v95
 s_nop 0
 v_cvt_pk_bf16_f32 v135, v182, v183
 v_exp_f32 v220, -v220
 v_exp_f32 v221, -v221
 v_exp_f32 v222, -v222
 v_exp_f32 v223, -v223
 v_exp_f32 v224, -v224
 s_nop 0
 v_mul_f32 v156, v156, v220
 v_mul_f32 v160, v160, v221
 v_mul_f32 v164, v164, v222
 v_mul_f32 v168, v168, v223
 v_mul_f32 v172, v172, v224
 v_accvgpr_read_b32 v12, a0
 v_accvgpr_read_b32 v13, a1
 v_accvgpr_read_b32 v14, a2
 v_accvgpr_read_b32 v15, a3
 v_mul_f32 v12, v220, v12
 v_mul_f32 v13, v220, v13
 v_mul_f32 v14, v220, v14
 v_mul_f32 v15, v220, v15
 v_accvgpr_write_b32 a0, v12
 v_accvgpr_write_b32 a1, v13
 v_accvgpr_write_b32 a2, v14
 v_accvgpr_write_b32 a3, v15
 v_accvgpr_read_b32 v12, a4
 v_accvgpr_read_b32 v13, a5
 v_accvgpr_read_b32 v14, a6
 v_accvgpr_read_b32 v15, a7
 v_mul_f32 v12, v221, v12
 v_mul_f32 v13, v221, v13
 v_mul_f32 v14, v221, v14
 v_mul_f32 v15, v221, v15
 v_accvgpr_write_b32 a4, v12
 v_accvgpr_write_b32 a5, v13
 v_accvgpr_write_b32 a6, v14
 v_accvgpr_write_b32 a7, v15
 v_accvgpr_read_b32 v12, a8
 v_accvgpr_read_b32 v13, a9
 v_accvgpr_read_b32 v14, a10
 v_accvgpr_read_b32 v15, a11
 v_mul_f32 v12, v222, v12
 v_mul_f32 v13, v222, v13
 v_mul_f32 v14, v222, v14
 v_mul_f32 v15, v222, v15
 v_accvgpr_write_b32 a8, v12
 v_accvgpr_write_b32 a9, v13
 v_accvgpr_write_b32 a10, v14
 v_accvgpr_write_b32 a11, v15
 v_accvgpr_read_b32 v12, a12
 v_accvgpr_read_b32 v13, a13
 v_accvgpr_read_b32 v14, a14
 v_accvgpr_read_b32 v15, a15
 v_mul_f32 v12, v223, v12
 v_mul_f32 v13, v223, v13
 v_mul_f32 v14, v223, v14
 v_mul_f32 v15, v223, v15
 v_accvgpr_write_b32 a12, v12
 v_accvgpr_write_b32 a13, v13
 v_accvgpr_write_b32 a14, v14
 v_accvgpr_write_b32 a15, v15
 v_accvgpr_read_b32 v12, a16
 v_accvgpr_read_b32 v13, a17
 v_accvgpr_read_b32 v14, a18
 v_accvgpr_read_b32 v15, a19
 v_mul_f32 v12, v224, v12
 v_mul_f32 v13, v224, v13
 v_mul_f32 v14, v224, v14
 v_mul_f32 v15, v224, v15
 v_accvgpr_write_b32 a16, v12
 v_accvgpr_write_b32 a17, v13
 v_accvgpr_write_b32 a18, v14
 v_accvgpr_write_b32 a19, v15
 v_accvgpr_read_b32 v12, a20
 v_accvgpr_read_b32 v13, a21
 v_accvgpr_read_b32 v14, a22
 v_accvgpr_read_b32 v15, a23
 v_mul_f32 v12, v220, v12
 v_mul_f32 v13, v220, v13
 v_mul_f32 v14, v220, v14
 v_mul_f32 v15, v220, v15
 v_accvgpr_write_b32 a20, v12
 v_accvgpr_write_b32 a21, v13
 v_accvgpr_write_b32 a22, v14
 v_accvgpr_write_b32 a23, v15
 v_accvgpr_read_b32 v12, a24
 v_accvgpr_read_b32 v13, a25
 v_accvgpr_read_b32 v14, a26
 v_accvgpr_read_b32 v15, a27
 v_mul_f32 v12, v221, v12
 v_mul_f32 v13, v221, v13
 v_mul_f32 v14, v221, v14
 v_mul_f32 v15, v221, v15
 v_accvgpr_write_b32 a24, v12
 v_accvgpr_write_b32 a25, v13
 v_accvgpr_write_b32 a26, v14
 v_accvgpr_write_b32 a27, v15
 v_accvgpr_read_b32 v12, a28
 v_accvgpr_read_b32 v13, a29
 v_accvgpr_read_b32 v14, a30
 v_accvgpr_read_b32 v15, a31
 v_mul_f32 v12, v222, v12
 v_mul_f32 v13, v222, v13
 v_mul_f32 v14, v222, v14
 v_mul_f32 v15, v222, v15
 v_accvgpr_write_b32 a28, v12
 v_accvgpr_write_b32 a29, v13
 v_accvgpr_write_b32 a30, v14
 v_accvgpr_write_b32 a31, v15
 v_accvgpr_read_b32 v12, a32
 v_accvgpr_read_b32 v13, a33
 v_accvgpr_read_b32 v14, a34
 v_accvgpr_read_b32 v15, a35
 v_mul_f32 v12, v223, v12
 v_mul_f32 v13, v223, v13
 v_mul_f32 v14, v223, v14
 v_mul_f32 v15, v223, v15
 v_accvgpr_write_b32 a32, v12
 v_accvgpr_write_b32 a33, v13
 v_accvgpr_write_b32 a34, v14
 v_accvgpr_write_b32 a35, v15
 v_accvgpr_read_b32 v12, a36
 v_accvgpr_read_b32 v13, a37
 v_accvgpr_read_b32 v14, a38
 v_accvgpr_read_b32 v15, a39
 v_mul_f32 v12, v224, v12
 v_mul_f32 v13, v224, v13
 v_mul_f32 v14, v224, v14
 v_mul_f32 v15, v224, v15
 v_accvgpr_write_b32 a36, v12
 v_accvgpr_write_b32 a37, v13
 v_accvgpr_write_b32 a38, v14
 v_accvgpr_write_b32 a39, v15
 v_accvgpr_read_b32 v12, a40
 v_accvgpr_read_b32 v13, a41
 v_accvgpr_read_b32 v14, a42
 v_accvgpr_read_b32 v15, a43
 v_mul_f32 v12, v220, v12
 v_mul_f32 v13, v220, v13
 v_mul_f32 v14, v220, v14
 v_mul_f32 v15, v220, v15
 v_accvgpr_write_b32 a40, v12
 v_accvgpr_write_b32 a41, v13
 v_accvgpr_write_b32 a42, v14
 v_accvgpr_write_b32 a43, v15
 v_accvgpr_read_b32 v12, a44
 v_accvgpr_read_b32 v13, a45
 v_accvgpr_read_b32 v14, a46
 v_accvgpr_read_b32 v15, a47
 v_mul_f32 v12, v221, v12
 v_mul_f32 v13, v221, v13
 v_mul_f32 v14, v221, v14
 v_mul_f32 v15, v221, v15
 v_accvgpr_write_b32 a44, v12
 v_accvgpr_write_b32 a45, v13
 v_accvgpr_write_b32 a46, v14
 v_accvgpr_write_b32 a47, v15
 v_accvgpr_read_b32 v12, a48
 v_accvgpr_read_b32 v13, a49
 v_accvgpr_read_b32 v14, a50
 v_accvgpr_read_b32 v15, a51
 v_mul_f32 v12, v222, v12
 v_mul_f32 v13, v222, v13
 v_mul_f32 v14, v222, v14
 v_mul_f32 v15, v222, v15
 v_accvgpr_write_b32 a48, v12
 v_accvgpr_write_b32 a49, v13
 v_accvgpr_write_b32 a50, v14
 v_accvgpr_write_b32 a51, v15
 v_accvgpr_read_b32 v12, a52
 v_accvgpr_read_b32 v13, a53
 v_accvgpr_read_b32 v14, a54
 v_accvgpr_read_b32 v15, a55
 v_mul_f32 v12, v223, v12
 v_mul_f32 v13, v223, v13
 v_mul_f32 v14, v223, v14
 v_mul_f32 v15, v223, v15
 v_accvgpr_write_b32 a52, v12
 v_accvgpr_write_b32 a53, v13
 v_accvgpr_write_b32 a54, v14
 v_accvgpr_write_b32 a55, v15
 v_accvgpr_read_b32 v12, a56
 v_accvgpr_read_b32 v13, a57
 v_accvgpr_read_b32 v14, a58
 v_accvgpr_read_b32 v15, a59
 v_mul_f32 v12, v224, v12
 v_mul_f32 v13, v224, v13
 v_mul_f32 v14, v224, v14
 v_mul_f32 v15, v224, v15
 v_accvgpr_write_b32 a56, v12
 v_accvgpr_write_b32 a57, v13
 v_accvgpr_write_b32 a58, v14
 v_accvgpr_write_b32 a59, v15
 v_accvgpr_read_b32 v12, a60
 v_accvgpr_read_b32 v13, a61
 v_accvgpr_read_b32 v14, a62
 v_accvgpr_read_b32 v15, a63
 v_mul_f32 v12, v220, v12
 v_mul_f32 v13, v220, v13
 v_mul_f32 v14, v220, v14
 v_mul_f32 v15, v220, v15
 v_accvgpr_write_b32 a60, v12
 v_accvgpr_write_b32 a61, v13
 v_accvgpr_write_b32 a62, v14
 v_accvgpr_write_b32 a63, v15
 v_accvgpr_read_b32 v12, a64
 v_accvgpr_read_b32 v13, a65
 v_accvgpr_read_b32 v14, a66
 v_accvgpr_read_b32 v15, a67
 v_mul_f32 v12, v221, v12
 v_mul_f32 v13, v221, v13
 v_mul_f32 v14, v221, v14
 v_mul_f32 v15, v221, v15
 v_accvgpr_write_b32 a64, v12
 v_accvgpr_write_b32 a65, v13
 v_accvgpr_write_b32 a66, v14
 v_accvgpr_write_b32 a67, v15
 v_accvgpr_read_b32 v12, a68
 v_accvgpr_read_b32 v13, a69
 v_accvgpr_read_b32 v14, a70
 v_accvgpr_read_b32 v15, a71
 v_mul_f32 v12, v222, v12
 v_mul_f32 v13, v222, v13
 v_mul_f32 v14, v222, v14
 v_mul_f32 v15, v222, v15
 v_accvgpr_write_b32 a68, v12
 v_accvgpr_write_b32 a69, v13
 v_accvgpr_write_b32 a70, v14
 v_accvgpr_write_b32 a71, v15
 v_accvgpr_read_b32 v12, a72
 v_accvgpr_read_b32 v13, a73
 v_accvgpr_read_b32 v14, a74
 v_accvgpr_read_b32 v15, a75
 v_mul_f32 v12, v223, v12
 v_mul_f32 v13, v223, v13
 v_mul_f32 v14, v223, v14
 v_mul_f32 v15, v223, v15
 v_accvgpr_write_b32 a72, v12
 v_accvgpr_write_b32 a73, v13
 v_accvgpr_write_b32 a74, v14
 v_accvgpr_write_b32 a75, v15
 v_accvgpr_read_b32 v12, a76
 v_accvgpr_read_b32 v13, a77
 v_accvgpr_read_b32 v14, a78
 v_accvgpr_read_b32 v15, a79
 v_mul_f32 v12, v224, v12
 v_mul_f32 v13, v224, v13
 v_mul_f32 v14, v224, v14
 v_mul_f32 v15, v224, v15
 v_accvgpr_write_b32 a76, v12
 v_accvgpr_write_b32 a77, v13
 v_accvgpr_write_b32 a78, v14
 v_accvgpr_write_b32 a79, v15
 v_accvgpr_read_b32 v12, a80
 v_accvgpr_read_b32 v13, a81
 v_accvgpr_read_b32 v14, a82
 v_accvgpr_read_b32 v15, a83
 v_mul_f32 v12, v220, v12
 v_mul_f32 v13, v220, v13
 v_mul_f32 v14, v220, v14
 v_mul_f32 v15, v220, v15
 v_accvgpr_write_b32 a80, v12
 v_accvgpr_write_b32 a81, v13
 v_accvgpr_write_b32 a82, v14
 v_accvgpr_write_b32 a83, v15
 v_accvgpr_read_b32 v12, a84
 v_accvgpr_read_b32 v13, a85
 v_accvgpr_read_b32 v14, a86
 v_accvgpr_read_b32 v15, a87
 v_mul_f32 v12, v221, v12
 v_mul_f32 v13, v221, v13
 v_mul_f32 v14, v221, v14
 v_mul_f32 v15, v221, v15
 v_accvgpr_write_b32 a84, v12
 v_accvgpr_write_b32 a85, v13
 v_accvgpr_write_b32 a86, v14
 v_accvgpr_write_b32 a87, v15
 v_accvgpr_read_b32 v12, a88
 v_accvgpr_read_b32 v13, a89
 v_accvgpr_read_b32 v14, a90
 v_accvgpr_read_b32 v15, a91
 v_mul_f32 v12, v222, v12
 v_mul_f32 v13, v222, v13
 v_mul_f32 v14, v222, v14
 v_mul_f32 v15, v222, v15
 v_accvgpr_write_b32 a88, v12
 v_accvgpr_write_b32 a89, v13
 v_accvgpr_write_b32 a90, v14
 v_accvgpr_write_b32 a91, v15
 v_accvgpr_read_b32 v12, a92
 v_accvgpr_read_b32 v13, a93
 v_accvgpr_read_b32 v14, a94
 v_accvgpr_read_b32 v15, a95
 v_mul_f32 v12, v223, v12
 v_mul_f32 v13, v223, v13
 v_mul_f32 v14, v223, v14
 v_mul_f32 v15, v223, v15
 v_accvgpr_write_b32 a92, v12
 v_accvgpr_write_b32 a93, v13
 v_accvgpr_write_b32 a94, v14
 v_accvgpr_write_b32 a95, v15
 v_accvgpr_read_b32 v12, a96
 v_accvgpr_read_b32 v13, a97
 v_accvgpr_read_b32 v14, a98
 v_accvgpr_read_b32 v15, a99
 v_mul_f32 v12, v224, v12
 v_mul_f32 v13, v224, v13
 v_mul_f32 v14, v224, v14
 v_mul_f32 v15, v224, v15
 v_accvgpr_write_b32 a96, v12
 v_accvgpr_write_b32 a97, v13
 v_accvgpr_write_b32 a98, v14
 v_accvgpr_write_b32 a99, v15
 v_accvgpr_read_b32 v12, a100
 v_accvgpr_read_b32 v13, a101
 v_accvgpr_read_b32 v14, a102
 v_accvgpr_read_b32 v15, a103
 v_mul_f32 v12, v220, v12
 v_mul_f32 v13, v220, v13
 v_mul_f32 v14, v220, v14
 v_mul_f32 v15, v220, v15
 v_accvgpr_write_b32 a100, v12
 v_accvgpr_write_b32 a101, v13
 v_accvgpr_write_b32 a102, v14
 v_accvgpr_write_b32 a103, v15
 v_accvgpr_read_b32 v12, a104
 v_accvgpr_read_b32 v13, a105
 v_accvgpr_read_b32 v14, a106
 v_accvgpr_read_b32 v15, a107
 v_mul_f32 v12, v221, v12
 v_mul_f32 v13, v221, v13
 v_mul_f32 v14, v221, v14
 v_mul_f32 v15, v221, v15
 v_accvgpr_write_b32 a104, v12
 v_accvgpr_write_b32 a105, v13
 v_accvgpr_write_b32 a106, v14
 v_accvgpr_write_b32 a107, v15
 v_accvgpr_read_b32 v12, a108
 v_accvgpr_read_b32 v13, a109
 v_accvgpr_read_b32 v14, a110
 v_accvgpr_read_b32 v15, a111
 v_mul_f32 v12, v222, v12
 v_mul_f32 v13, v222, v13
 v_mul_f32 v14, v222, v14
 v_mul_f32 v15, v222, v15
 v_accvgpr_write_b32 a108, v12
 v_accvgpr_write_b32 a109, v13
 v_accvgpr_write_b32 a110, v14
 v_accvgpr_write_b32 a111, v15
 v_accvgpr_read_b32 v12, a112
 v_accvgpr_read_b32 v13, a113
 v_accvgpr_read_b32 v14, a114
 v_accvgpr_read_b32 v15, a115
 v_mul_f32 v12, v223, v12
 v_mul_f32 v13, v223, v13
 v_mul_f32 v14, v223, v14
 v_mul_f32 v15, v223, v15
 v_accvgpr_write_b32 a112, v12
 v_accvgpr_write_b32 a113, v13
 v_accvgpr_write_b32 a114, v14
 v_accvgpr_write_b32 a115, v15
 v_accvgpr_read_b32 v12, a116
 v_accvgpr_read_b32 v13, a117
 v_accvgpr_read_b32 v14, a118
 v_accvgpr_read_b32 v15, a119
 v_mul_f32 v12, v224, v12
 v_mul_f32 v13, v224, v13
 v_mul_f32 v14, v224, v14
 v_mul_f32 v15, v224, v15
 v_accvgpr_write_b32 a116, v12
 v_accvgpr_write_b32 a117, v13
 v_accvgpr_write_b32 a118, v14
 v_accvgpr_write_b32 a119, v15
 v_accvgpr_read_b32 v12, a120
 v_accvgpr_read_b32 v13, a121
 v_accvgpr_read_b32 v14, a122
 v_accvgpr_read_b32 v15, a123
 v_mul_f32 v12, v220, v12
 v_mul_f32 v13, v220, v13
 v_mul_f32 v14, v220, v14
 v_mul_f32 v15, v220, v15
 v_accvgpr_write_b32 a120, v12
 v_accvgpr_write_b32 a121, v13
 v_accvgpr_write_b32 a122, v14
 v_accvgpr_write_b32 a123, v15
 v_accvgpr_read_b32 v12, a124
 v_accvgpr_read_b32 v13, a125
 v_accvgpr_read_b32 v14, a126
 v_accvgpr_read_b32 v15, a127
 v_mul_f32 v12, v221, v12
 v_mul_f32 v13, v221, v13
 v_mul_f32 v14, v221, v14
 v_mul_f32 v15, v221, v15
 v_accvgpr_write_b32 a124, v12
 v_accvgpr_write_b32 a125, v13
 v_accvgpr_write_b32 a126, v14
 v_accvgpr_write_b32 a127, v15
 v_accvgpr_read_b32 v12, a128
 v_accvgpr_read_b32 v13, a129
 v_accvgpr_read_b32 v14, a130
 v_accvgpr_read_b32 v15, a131
 v_mul_f32 v12, v222, v12
 v_mul_f32 v13, v222, v13
 v_mul_f32 v14, v222, v14
 v_mul_f32 v15, v222, v15
 v_accvgpr_write_b32 a128, v12
 v_accvgpr_write_b32 a129, v13
 v_accvgpr_write_b32 a130, v14
 v_accvgpr_write_b32 a131, v15
 v_accvgpr_read_b32 v12, a132
 v_accvgpr_read_b32 v13, a133
 v_accvgpr_read_b32 v14, a134
 v_accvgpr_read_b32 v15, a135
 v_mul_f32 v12, v223, v12
 v_mul_f32 v13, v223, v13
 v_mul_f32 v14, v223, v14
 v_mul_f32 v15, v223, v15
 v_accvgpr_write_b32 a132, v12
 v_accvgpr_write_b32 a133, v13
 v_accvgpr_write_b32 a134, v14
 v_accvgpr_write_b32 a135, v15
 v_accvgpr_read_b32 v12, a136
 v_accvgpr_read_b32 v13, a137
 v_accvgpr_read_b32 v14, a138
 v_accvgpr_read_b32 v15, a139
 v_mul_f32 v12, v224, v12
 v_mul_f32 v13, v224, v13
 v_mul_f32 v14, v224, v14
 v_mul_f32 v15, v224, v15
 v_accvgpr_write_b32 a136, v12
 v_accvgpr_write_b32 a137, v13
 v_accvgpr_write_b32 a138, v14
 v_accvgpr_write_b32 a139, v15
 v_accvgpr_read_b32 v12, a140
 v_accvgpr_read_b32 v13, a141
 v_accvgpr_read_b32 v14, a142
 v_accvgpr_read_b32 v15, a143
 v_mul_f32 v12, v220, v12
 v_mul_f32 v13, v220, v13
 v_mul_f32 v14, v220, v14
 v_mul_f32 v15, v220, v15
 v_accvgpr_write_b32 a140, v12
 v_accvgpr_write_b32 a141, v13
 v_accvgpr_write_b32 a142, v14
 v_accvgpr_write_b32 a143, v15
 v_accvgpr_read_b32 v12, a144
 v_accvgpr_read_b32 v13, a145
 v_accvgpr_read_b32 v14, a146
 v_accvgpr_read_b32 v15, a147
 v_mul_f32 v12, v221, v12
 v_mul_f32 v13, v221, v13
 v_mul_f32 v14, v221, v14
 v_mul_f32 v15, v221, v15
 v_accvgpr_write_b32 a144, v12
 v_accvgpr_write_b32 a145, v13
 v_accvgpr_write_b32 a146, v14
 v_accvgpr_write_b32 a147, v15
 v_accvgpr_read_b32 v12, a148
 v_accvgpr_read_b32 v13, a149
 v_accvgpr_read_b32 v14, a150
 v_accvgpr_read_b32 v15, a151
 v_mul_f32 v12, v222, v12
 v_mul_f32 v13, v222, v13
 v_mul_f32 v14, v222, v14
 v_mul_f32 v15, v222, v15
 v_accvgpr_write_b32 a148, v12
 v_accvgpr_write_b32 a149, v13
 v_accvgpr_write_b32 a150, v14
 v_accvgpr_write_b32 a151, v15
 v_accvgpr_read_b32 v12, a152
 v_accvgpr_read_b32 v13, a153
 v_accvgpr_read_b32 v14, a154
 v_accvgpr_read_b32 v15, a155
 v_mul_f32 v12, v223, v12
 v_mul_f32 v13, v223, v13
 v_mul_f32 v14, v223, v14
 v_mul_f32 v15, v223, v15
 v_accvgpr_write_b32 a152, v12
 v_accvgpr_write_b32 a153, v13
 v_accvgpr_write_b32 a154, v14
 v_accvgpr_write_b32 a155, v15
 v_accvgpr_read_b32 v12, a156
 v_accvgpr_read_b32 v13, a157
 v_accvgpr_read_b32 v14, a158
 v_accvgpr_read_b32 v15, a159
 v_mul_f32 v12, v224, v12
 v_mul_f32 v13, v224, v13
 v_mul_f32 v14, v224, v14
 v_mul_f32 v15, v224, v15
 v_accvgpr_write_b32 a156, v12
 v_accvgpr_write_b32 a157, v13
 v_accvgpr_write_b32 a158, v14
 v_accvgpr_write_b32 a159, v15
 s_nop 1
 s_setpc_b64 s[50:51]
.section .rodata,"a"
.p2align 6
.amdhsa_kernel standalone__gqa_block_cached__near_ridge_kernel
  .amdhsa_next_free_vgpr 512
  .amdhsa_next_free_sgpr 102
  .amdhsa_accum_offset 256
  .amdhsa_group_segment_fixed_size 0
  .amdhsa_kernarg_size 64
  .amdhsa_user_sgpr_count 2
  .amdhsa_user_sgpr_kernarg_segment_ptr 1
  .amdhsa_system_sgpr_workgroup_id_x 1
  .amdhsa_float_denorm_mode_32 3
.end_amdhsa_kernel
```
